```python
import torch

def _softmax(x, axis=-1):
    return torch.softmax(x, dim=axis)
def _gelu(x):
    return torch.nn.functional.gelu(x, approximate="tanh")
def _silu(x):
    return torch.nn.functional.silu(x)
def _sigmoid(x):
    return torch.sigmoid(x)
def _layernorm(x, axis=-1, eps=1e-5):
    m = x.mean(dim=axis, keepdim=True)
    v = x.var(dim=axis, keepdim=True, unbiased=False)
    return (x - m) / torch.sqrt(v + eps)
def _scatter_add(tgt, idx, src, axis=0):
    return tgt.clone().index_add_(axis, idx, src)
def _segment_sum(src, seg, n):
    out = torch.zeros((n,) + src.shape[1:], dtype=src.dtype)
    return out.index_add_(0, seg, src)
def _pad(x, pw):
    flat = tuple(v for pair in reversed(pw) for v in pair)
    return torch.nn.functional.pad(x, flat)

kernel_name = 'sequential_preLN__compressed_kv_cla__geglu_ffn__prompt'

def setup_inputs():

    _w = (lambda a: (lambda t: t.to(torch.bfloat16) if t.is_floating_point() else t)(torch.as_tensor(a)))
    def _A_setup():
        B, H, Sq, Sk, D, M = 1, 16, 2048, 2048, 256, 448
        Dc = 4 * D
        return {
            "x": _w((lambda *s: torch.randn(*s, dtype=torch.bfloat16) * 0.05)(B, Sq, M)),
            "c_kv": _w((lambda *s: torch.randn(*s, dtype=torch.bfloat16) * 0.4)(B, Sk, Dc)),
            "w_q": _w((lambda *s: torch.randn(*s, dtype=torch.bfloat16) * 3.2)(M, H, D) * (M ** -0.5)),
            "w_uk": _w((lambda *s: torch.randn(*s, dtype=torch.bfloat16) * 3.2)(Dc, H, D) * (Dc ** -0.5)),
            "w_uv": _w((lambda *s: torch.randn(*s, dtype=torch.bfloat16) * 0.4)(Dc, H, D) * (Dc ** -0.5)),
            "w_o": _w((lambda *s: torch.randn(*s, dtype=torch.bfloat16) * 0.4)(H, D, M) * ((H * D) ** -0.5)),
        }
    _A_in = _A_setup()

    def _B_setup():
        B, S, D, F = 1, 2048, 448, 1792
        return {
            "x": _w((lambda *s: torch.randn(*s, dtype=torch.bfloat16) * 0.05)(B, S, D)),
            "w_gate": _w((lambda *s: torch.randn(*s, dtype=torch.bfloat16) * 0.05)(D, F)),
            "w_up": _w((lambda *s: torch.randn(*s, dtype=torch.bfloat16) * 0.05)(D, F)),
            "w_down": _w((lambda *s: torch.randn(*s, dtype=torch.bfloat16) * 0.05)(F, D)),
        }
    _B_in = _B_setup()

    return {
        "A_x": _A_in["x"],
        "A_c_kv": _A_in["c_kv"],
        "A_w_q": _A_in["w_q"],
        "A_w_uk": _A_in["w_uk"],
        "A_w_uv": _A_in["w_uv"],
        "A_w_o": _A_in["w_o"],
        "B_x": _B_in["x"],
        "B_w_gate": _B_in["w_gate"],
        "B_w_up": _B_in["w_up"],
        "B_w_down": _B_in["w_down"],
    }

def reference(A_x, A_c_kv, A_w_q, A_w_uk, A_w_uv, A_w_o, B_x, B_w_gate, B_w_up, B_w_down):
    def _A_ref(x, c_kv, w_q, w_uk, w_uv, w_o):
        B, Sq, M = x.shape[0], x.shape[1], x.shape[2]
        Sk = c_kv.shape[1]
        H, D = w_q.shape[1], w_q.shape[2]
        q = torch.einsum("bqm,mhd->bhqd", x, w_q)
        k = torch.einsum("bkc,chd->bhkd", c_kv, w_uk)
        v = torch.einsum("bkc,chd->bhkd", c_kv, w_uv)
        scores = torch.einsum("bhqd,bhkd->bhqk", q, k) * (D ** -0.5)
        off = Sk - Sq
        qi = torch.arange(Sq)[:, None]
        kj = torch.arange(Sk)[None, :]
        cmask = kj <= (qi + off)
        scores = torch.where(cmask[None, None], scores, -1e9)
        p = _softmax(scores, axis=-1)
        ctx = torch.einsum("bhqk,bhkd->bhqd", p, v)
        return torch.einsum("bhqd,hdm->bqm", ctx, w_o)

    def _B_ref(x, w_gate, w_up, w_down):
        return (_gelu(x @ w_gate) * (x @ w_up)) @ w_down

    x = A_x
    h = x + _A_ref(_layernorm(x, axis=-1), A_c_kv, A_w_q, A_w_uk, A_w_uv, A_w_o)
    h2 = h + _B_ref(_layernorm(h, axis=-1), B_w_gate, B_w_up, B_w_down)
    return h2
```

```asm
; @launch grid=(256,1,1) block=(256,1,1) lds=163840
.amdgcn_target "amdgcn-amd-amdhsa--gfx950"
.text
.globl sequential_preLN__compressed_kv_cla__geglu_ffn__prompt_kernel
.p2align 8
.type sequential_preLN__compressed_kv_cla__geglu_ffn__prompt_kernel,@function
sequential_preLN__compressed_kv_cla__geglu_ffn__prompt_kernel:
  s_cmp_ge_u32 s2, 256
  s_cbranch_scc1 mega_end
  s_load_dwordx4 s[36:39], s[0:1], 0
  s_load_dwordx4 s[40:43], s[0:1], 16
  s_load_dwordx2 s[44:45], s[0:1], 32
  s_load_dwordx2 s[46:47], s[0:1], 96
  s_load_dwordx2 s[70:71], s[0:1], 88
  v_lshrrev_b32 v23, 6, v0
  v_and_b32 v0, 63, v0
  v_readfirstlane_b32 s28, v23
  s_nop 2
  s_getpc_b64 s[52:53]
mega_pc0:
  s_lshr_b32 s67, s2, 3
  s_lshl_b32 s67, s67, 2
  s_add_u32 s67, s67, s28
  s_lshl_b32 s67, s67, 3
  v_and_b32 v46, 7, v0
  v_add_u32 v46, s67, v46
  v_lshlrev_b32 v46, 7, v46
  s_mov_b32 s68, mega_end-mega_pc0-4
  v_min_u32 v46, s68, v46
  global_load_dword a249, v46, s[52:53]
  s_and_b32 s60, s2, 7
  s_lshr_b32 s61, s2, 3
  s_and_b32 s62, s61, 7
  s_lshr_b32 s63, s61, 3
  s_lshr_b32 s31, s63, 1
  s_and_b32 s63, s63, 1
  s_lshl_b32 s64, s60, 1
  s_add_u32 s63, s64, s63
  s_lshr_b32 s65, s61, 4
  s_add_u32 s65, s64, s65
  s_and_b32 s66, s61, 15
  s_mov_b32 s97, s66
  s_sub_u32 s67, 15, s66
  s_sub_u32 s68, s66, 8
  s_cmp_lt_u32 s66, 8
  s_cselect_b32 s66, s67, s68
  s_lshl_b32 s67, s31, 3
  s_add_u32 s67, s67, s62
  s_lshl_b32 s67, s67, 2
  s_lshl_b32 s68, s63, 7
  s_add_u32 s96, s67, s68
  s_lshr_b32 s29, s28, 1
  s_and_b32 s30, s28, 1
  s_waitcnt lgkmcnt(0)
  s_mov_b32 s98, s46
  s_mov_b32 s99, s47
  s_add_u32 s16, s46, 121634816
  s_addc_u32 s17, s47, 0
  s_mov_b32 s18, 1835008
  s_mov_b32 s19, 0x00020000
  s_mov_b32 s4, s38
  s_mov_b32 s5, s39
  s_mov_b32 s6, 4194304
  s_mov_b32 s7, 0x00020000
  s_lshl_b32 s67, s65, 9
  s_add_u32 s12, s40, s67
  s_addc_u32 s13, s41, 0
  s_sub_u32 s14, 3670016, s67
  s_mov_b32 s15, 0x00020000
  s_cmp_eq_u32 s31, 0
  s_cselect_b32 s68, s42, s44
  s_cselect_b32 s69, s43, s45
  s_lshl_b32 s67, s63, 9
  s_add_u32 s8, s68, s67
  s_addc_u32 s9, s69, 0
  s_sub_u32 s10, 8388608, s67
  s_mov_b32 s11, 0x00020000
  s_lshl_b32 s67, s31, 24
  s_lshl_b32 s68, s63, 20
  s_add_u32 s67, s67, s68
  s_add_u32 s20, s46, s67
  s_addc_u32 s21, s47, 0
  s_mov_b32 s22, 0x100000
  s_mov_b32 s23, 0x00020000
  s_lshl_b32 s67, s65, 20
  s_add_u32 s67, s67, 33554432
  s_add_u32 s24, s46, s67
  s_addc_u32 s25, s47, 0
  s_mov_b32 s26, 0x100000
  s_mov_b32 s27, 0x00020000
  s_mov_b32 s40, s36
  s_mov_b32 s41, s37
  s_mov_b32 s42, 1835008
  s_mov_b32 s43, 0x00020000
  s_mov_b32 s36, s70
  s_mov_b32 s37, s71
  s_mov_b32 s38, 256
  s_mov_b32 s39, 0x00020000
  s_lshl_b32 s67, s2, 3
  s_lshl_b32 s68, s28, 1
  s_add_u32 s67, s67, s68
  v_and_b32 v25, 1, v0
  v_add_u32 v25, s67, v25
  v_lshrrev_b32 v26, 1, v0
  s_movk_i32 s68, 896
  v_mul_lo_u32 v27, v25, s68
  v_lshl_add_u32 v27, v26, 4, v27
  v_add_u32 v28, 512, v27
  v_mov_b32 v29, 0x7f000000
  v_cmp_gt_u32 vcc, 24, v26
  s_nop 1
  v_cndmask_b32 v28, v29, v28, vcc
  buffer_load_dwordx4 v[32:35], v27, s[40:43], 0 offen
  buffer_load_dwordx4 v[36:39], v28, s[40:43], 0 offen
  v_lshrrev_b32 v27, 4, v25
  s_movk_i32 s68, 14336
  v_mul_lo_u32 v27, v27, s68
  v_and_b32 v28, 15, v25
  v_lshl_add_u32 v27, v28, 4, v27
  v_lshrrev_b32 v28, 2, v26
  v_lshl_add_u32 v27, v28, 10, v27
  v_and_b32 v28, 3, v26
  v_lshl_add_u32 v44, v28, 8, v27
  v_add_u32 v45, 0x2000, v44
  v_cndmask_b32 v45, v29, v45, vcc
  s_mov_b32 s70, s2
  s_lshl_b32 s71, s66, 4
  s_lshr_b32 s67, s2, 3
  s_and_b32 s67, s67, 3
  s_sub_u32 s61, 6, s67
  v_and_b32 v23, 15, v0
  v_lshrrev_b32 v24, 4, v0
  v_lshlrev_b32 v1, 4, v0
  s_lshl_b32 s67, s62, 8
  s_lshl_b32 s68, s28, 6
  s_add_u32 s67, s67, s68
  v_lshrrev_b32 v27, 3, v0
  v_add_u32 v27, s67, v27
  v_lshlrev_b32 v27, 11, v27
  v_and_b32 v28, 7, v0
  v_xor_b32 v29, v28, v24
  v_lshl_add_u32 v13, v29, 4, v27
  v_add_u32 v29, 4, v24
  v_xor_b32 v29, v28, v29
  v_lshl_add_u32 v14, v29, 4, v27
  v_add_u32 v14, 15360, v14
  v_xor_b32 v29, v28, v24
  v_lshl_add_u32 v15, v29, 4, v27
  v_add_u32 v15, 30720, v15
  v_add_u32 v29, 4, v24
  v_xor_b32 v29, v28, v29
  v_lshl_add_u32 v16, v29, 4, v27
  v_add_u32 v16, 46080, v16
  v_lshrrev_b32 v27, 5, v0
  v_and_b32 v28, 31, v0
  s_lshl_b32 s67, s28, 3
  s_and_b32 s68, s28, 1
  s_lshl_b32 s68, s68, 2
  v_add_u32 v29, 0, v27
  v_and_b32 v30, 3, v29
  v_or_b32 v30, s68, v30
  v_lshlrev_b32 v30, 1, v30
  v_xor_b32 v30, v28, v30
  v_add_u32 v29, s67, v29
  v_lshlrev_b32 v29, 13, v29
  v_lshl_add_u32 v17, v30, 4, v29
  v_add_u32 v29, 2, v27
  v_and_b32 v30, 3, v29
  v_or_b32 v30, s68, v30
  v_lshlrev_b32 v30, 1, v30
  v_xor_b32 v30, v28, v30
  v_add_u32 v29, s67, v29
  v_lshlrev_b32 v29, 13, v29
  v_lshl_add_u32 v18, v30, 4, v29
  v_subrev_u32 v18, 1024, v18
  v_add_u32 v29, 4, v27
  v_and_b32 v30, 3, v29
  v_or_b32 v30, s68, v30
  v_lshlrev_b32 v30, 1, v30
  v_xor_b32 v30, v28, v30
  v_add_u32 v29, s67, v29
  v_lshlrev_b32 v29, 13, v29
  v_lshl_add_u32 v19, v30, 4, v29
  v_subrev_u32 v19, 2048, v19
  v_add_u32 v29, 6, v27
  v_and_b32 v30, 3, v29
  v_or_b32 v30, s68, v30
  v_lshlrev_b32 v30, 1, v30
  v_xor_b32 v30, v28, v30
  v_add_u32 v29, s67, v29
  v_lshlrev_b32 v29, 13, v29
  v_lshl_add_u32 v20, v30, 4, v29
  v_subrev_u32 v20, 3072, v20
  s_lshl_b32 s48, s28, 12
  s_add_u32 s48, s48, 98304
  s_lshl_b32 s49, s28, 13
  s_mov_b32 s35, 0
  s_mov_b32 s56, 0
  s_add_u32 s33, s49, 0
  s_add_u32 m0, s33, 0
  s_nop 0
  buffer_load_dwordx4 v13, s[4:7], s56 offen offset:0 lds
  buffer_load_dwordx4 v14, s[4:7], s56 offen offset:1024 lds
  buffer_load_dwordx4 v15, s[4:7], s56 offen offset:2048 lds
  buffer_load_dwordx4 v16, s[4:7], s56 offen offset:3072 lds
  s_mov_b32 s57, 65536
  s_add_u32 s33, s49, 0
  s_add_u32 m0, s33, 4096
  s_nop 0
  buffer_load_dwordx4 v13, s[4:7], s57 offen offset:0 lds
  buffer_load_dwordx4 v14, s[4:7], s57 offen offset:1024 lds
  buffer_load_dwordx4 v15, s[4:7], s57 offen offset:2048 lds
  buffer_load_dwordx4 v16, s[4:7], s57 offen offset:3072 lds
  s_add_u32 m0, s48, 0
  s_nop 0
  buffer_load_dwordx4 v17, s[8:11], s35 offen offset:0 lds
  buffer_load_dwordx4 v18, s[8:11], s35 offen offset:1024 lds
  buffer_load_dwordx4 v19, s[8:11], s35 offen offset:2048 lds
  buffer_load_dwordx4 v20, s[8:11], s35 offen offset:3072 lds
  s_add_u32 s35, s35, 0x40000
  s_add_u32 m0, s48, 16384
  s_nop 0
  buffer_load_dwordx4 v17, s[8:11], s35 offen offset:0 lds
  buffer_load_dwordx4 v18, s[8:11], s35 offen offset:1024 lds
  buffer_load_dwordx4 v19, s[8:11], s35 offen offset:2048 lds
  buffer_load_dwordx4 v20, s[8:11], s35 offen offset:3072 lds
  s_add_u32 s35, s35, 0x40000
  s_mov_b32 s56, 128
  s_add_u32 s33, s49, 32768
  s_add_u32 m0, s33, 0
  s_nop 0
  buffer_load_dwordx4 v13, s[4:7], s56 offen offset:0 lds
  buffer_load_dwordx4 v14, s[4:7], s56 offen offset:1024 lds
  buffer_load_dwordx4 v15, s[4:7], s56 offen offset:2048 lds
  buffer_load_dwordx4 v16, s[4:7], s56 offen offset:3072 lds
  s_mov_b32 s57, 65664
  s_add_u32 s33, s49, 32768
  s_add_u32 m0, s33, 4096
  s_nop 0
  buffer_load_dwordx4 v13, s[4:7], s57 offen offset:0 lds
  buffer_load_dwordx4 v14, s[4:7], s57 offen offset:1024 lds
  buffer_load_dwordx4 v15, s[4:7], s57 offen offset:2048 lds
  buffer_load_dwordx4 v16, s[4:7], s57 offen offset:3072 lds
  s_add_u32 m0, s48, 32768
  s_nop 0
  buffer_load_dwordx4 v17, s[8:11], s35 offen offset:0 lds
  buffer_load_dwordx4 v18, s[8:11], s35 offen offset:1024 lds
  buffer_load_dwordx4 v19, s[8:11], s35 offen offset:2048 lds
  buffer_load_dwordx4 v20, s[8:11], s35 offen offset:3072 lds
  s_add_u32 s35, s35, 0x40000
  s_mov_b32 s56, 256
  s_add_u32 s33, s49, 65536
  s_add_u32 m0, s33, 0
  s_nop 0
  buffer_load_dwordx4 v13, s[4:7], s56 offen offset:0 lds
  buffer_load_dwordx4 v14, s[4:7], s56 offen offset:1024 lds
  buffer_load_dwordx4 v15, s[4:7], s56 offen offset:2048 lds
  buffer_load_dwordx4 v16, s[4:7], s56 offen offset:3072 lds
  s_lshl_b32 s67, s2, 2
  s_add_u32 s67, s67, s28
  s_load_dwordx2 s[52:53], s[0:1], 40
  s_load_dwordx2 s[54:55], s[0:1], 72
  s_waitcnt lgkmcnt(0)
  s_mov_b32 s24, s52
  s_mov_b32 s25, s53
  s_mov_b32 s26, 3670016
  s_mov_b32 s27, 0x00020000
  s_mul_i32 s68, s67, 28
  v_min_u32 v46, 27, v0
  v_add_u32 v46, s68, v46
  v_lshlrev_b32 v46, 7, v46
  buffer_load_dword a253, v46, s[24:27], 0 offen
  s_mov_b32 s24, s54
  s_mov_b32 s25, s55
  s_mov_b32 s26, 1605632
  s_mov_b32 s27, 0x00020000
  s_mul_i32 s68, s67, 13
  v_min_u32 v46, 12, v0
  v_add_u32 v46, s68, v46
  v_lshlrev_b32 v46, 7, v46
  buffer_load_dword a253, v46, s[24:27], 0 offen
  s_load_dwordx4 s[52:55], s[0:1], 56
  s_waitcnt lgkmcnt(0)
  s_mov_b32 s24, s52
  s_mov_b32 s25, s53
  s_mov_b32 s26, 1605632
  s_mov_b32 s27, 0x00020000
  s_mul_i32 s68, s67, 13
  v_min_u32 v46, 12, v0
  v_add_u32 v46, s68, v46
  v_lshlrev_b32 v46, 7, v46
  buffer_load_dword a253, v46, s[24:27], 0 offen
  s_mov_b32 s24, s54
  s_mov_b32 s25, s55
  s_mov_b32 s26, 1605632
  s_mov_b32 s27, 0x00020000
  s_mul_i32 s68, s67, 13
  v_min_u32 v46, 12, v0
  v_add_u32 v46, s68, v46
  v_lshlrev_b32 v46, 7, v46
  buffer_load_dword a253, v46, s[24:27], 0 offen
  s_mov_b32 s32, 0
  s_add_u32 s33, s49, 65536
  s_mov_b32 s34, 256
  s_mov_b32 s56, 256
  s_mov_b32 s57, 65792
  s_lshl_b32 s67, s29, 14
  v_lshrrev_b32 v27, 1, v23
  v_add_u32 v28, 0, v24
  v_xor_b32 v28, v28, v27
  v_lshlrev_b32 v28, 4, v28
  v_lshl_add_u32 v28, v23, 7, v28
  v_add_u32 v2, s67, v28
  v_add_u32 v28, 4, v24
  v_xor_b32 v28, v28, v27
  v_lshlrev_b32 v28, 4, v28
  v_lshl_add_u32 v28, v23, 7, v28
  v_add_u32 v3, s67, v28
  v_lshrrev_b32 v27, 2, v23
  v_lshl_add_u32 v28, v24, 3, v27
  v_lshlrev_b32 v28, 9, v28
  v_and_b32 v29, 3, v23
  v_lshl_add_u32 v28, v29, 3, v28
  s_lshl_b32 s67, s30, 8
  s_add_u32 s67, s67, 98304
  v_add_u32 v28, s67, v28
  v_and_b32 v29, 1, v24
  v_lshl_or_b32 v29, v29, 2, v27
  v_lshlrev_b32 v29, 5, v29
  v_xor_b32 v30, 0, v29
  v_add_u32 v5, v28, v30
  v_xor_b32 v30, 32, v29
  v_add_u32 v6, v28, v30
  v_xor_b32 v30, 64, v29
  v_add_u32 v7, v28, v30
  v_xor_b32 v30, 96, v29
  v_add_u32 v8, v28, v30
  v_xor_b32 v30, 128, v29
  v_add_u32 v9, v28, v30
  v_xor_b32 v30, 160, v29
  v_add_u32 v10, v28, v30
  v_xor_b32 v30, 192, v29
  v_add_u32 v11, v28, v30
  v_xor_b32 v30, 224, v29
  v_add_u32 v12, v28, v30
  s_lshl_b32 s67, s62, 17
  s_lshl_b32 s68, s29, 16
  s_add_u32 s67, s67, s68
  s_lshl_b32 s68, s30, 13
  s_add_u32 s67, s67, s68
  v_add_u32 v21, s67, v1
  v_add_u32 v22, 0x1000, v21
  s_mov_b32 s52, 0
  s_mov_b32 s53, 16384
  s_mov_b32 s54, 32768
  s_mov_b32 s55, 49152
  s_lshl_b32 s67, s66, 3
  s_lshl_b32 s68, s28, 1
  s_add_u32 s67, s67, s68
  s_mul_i32 s67, s67, 14336
  v_add_u32 v30, s67, v1
  v_add_u32 v31, 14336, v30
  s_lshl_b32 s58, s28, 12
  s_mov_b32 s69, 0x7f000000
  s_mul_i32 s67, s66, 28
  s_mul_i32 s68, s28, 7
  s_add_u32 s67, s67, s68
  v_bfe_u32 v27, v0, 2, 3
  v_add_u32 v27, s67, v27
  v_lshlrev_b32 v27, 13, v27
  v_and_b32 v26, 3, v0
  v_lshl_add_u32 v28, v26, 7, v27
  s_waitcnt vmcnt(36)
  s_mov_b32 s67, 0x3f803f80
  v_mov_b32 v40, 0
  v_mov_b32 v41, 0
  v_dot2c_f32_bf16 v40, s67, v32
  v_dot2c_f32_bf16 v41, v32, v32
  v_dot2c_f32_bf16 v40, s67, v33
  v_dot2c_f32_bf16 v41, v33, v33
  v_dot2c_f32_bf16 v40, s67, v34
  v_dot2c_f32_bf16 v41, v34, v34
  v_dot2c_f32_bf16 v40, s67, v35
  v_dot2c_f32_bf16 v41, v35, v35
  v_dot2c_f32_bf16 v40, s67, v36
  v_dot2c_f32_bf16 v41, v36, v36
  v_dot2c_f32_bf16 v40, s67, v37
  v_dot2c_f32_bf16 v41, v37, v37
  v_dot2c_f32_bf16 v40, s67, v38
  v_dot2c_f32_bf16 v41, v38, v38
  v_dot2c_f32_bf16 v40, s67, v39
  v_dot2c_f32_bf16 v41, v39, v39
  s_nop 2
  s_nop 1
  v_add_f32_dpp v40, v40, v40 row_ror:2 row_mask:0xf bank_mask:0xf
  s_nop 1
  v_add_f32_dpp v40, v40, v40 row_ror:4 row_mask:0xf bank_mask:0xf
  s_nop 1
  v_add_f32_dpp v40, v40, v40 row_ror:8 row_mask:0xf bank_mask:0xf
  v_mov_b32 v42, v40
  s_nop 1
  v_permlane16_swap_b32 v40, v42
  s_nop 1
  v_add_f32 v40, v40, v42
  v_mov_b32 v42, v40
  s_nop 1
  v_permlane32_swap_b32 v40, v42
  s_nop 1
  v_add_f32 v40, v40, v42
  s_nop 1
  v_add_f32_dpp v41, v41, v41 row_ror:2 row_mask:0xf bank_mask:0xf
  s_nop 1
  v_add_f32_dpp v41, v41, v41 row_ror:4 row_mask:0xf bank_mask:0xf
  s_nop 1
  v_add_f32_dpp v41, v41, v41 row_ror:8 row_mask:0xf bank_mask:0xf
  v_mov_b32 v42, v41
  s_nop 1
  v_permlane16_swap_b32 v41, v42
  s_nop 1
  v_add_f32 v41, v41, v42
  v_mov_b32 v42, v41
  s_nop 1
  v_permlane32_swap_b32 v41, v42
  s_nop 1
  v_add_f32 v41, v41, v42
  s_mov_b32 s67, 0x3b124925
  s_mov_b32 s68, 0x3727c5ac
  v_mul_f32 v40, s67, v40
  v_mul_f32 v41, s67, v41
  v_fma_f32 v41, -v40, v40, v41
  v_max_f32 v41, 0, v41
  v_add_f32 v41, s68, v41
  v_rsq_f32 v41, v41
  s_mov_b32 s67, 0x3db8aa3b
  v_mul_f32 v41, s67, v41
  v_mul_f32 v40, v40, v41
  s_mov_b32 s67, 0xffff0000
  v_lshlrev_b32 v42, 16, v32
  v_and_b32 v43, s67, v32
  v_fma_f32 v42, v42, v41, -v40
  v_fma_f32 v43, v43, v41, -v40
  v_cvt_pk_bf16_f32 v32, v42, v43
  v_lshlrev_b32 v42, 16, v33
  v_and_b32 v43, s67, v33
  v_fma_f32 v42, v42, v41, -v40
  v_fma_f32 v43, v43, v41, -v40
  v_cvt_pk_bf16_f32 v33, v42, v43
  v_lshlrev_b32 v42, 16, v34
  v_and_b32 v43, s67, v34
  v_fma_f32 v42, v42, v41, -v40
  v_fma_f32 v43, v43, v41, -v40
  v_cvt_pk_bf16_f32 v34, v42, v43
  v_lshlrev_b32 v42, 16, v35
  v_and_b32 v43, s67, v35
  v_fma_f32 v42, v42, v41, -v40
  v_fma_f32 v43, v43, v41, -v40
  v_cvt_pk_bf16_f32 v35, v42, v43
  v_lshlrev_b32 v42, 16, v36
  v_and_b32 v43, s67, v36
  v_fma_f32 v42, v42, v41, -v40
  v_fma_f32 v43, v43, v41, -v40
  v_cvt_pk_bf16_f32 v36, v42, v43
  v_lshlrev_b32 v42, 16, v37
  v_and_b32 v43, s67, v37
  v_fma_f32 v42, v42, v41, -v40
  v_fma_f32 v43, v43, v41, -v40
  v_cvt_pk_bf16_f32 v37, v42, v43
  v_lshlrev_b32 v42, 16, v38
  v_and_b32 v43, s67, v38
  v_fma_f32 v42, v42, v41, -v40
  v_fma_f32 v43, v43, v41, -v40
  v_cvt_pk_bf16_f32 v38, v42, v43
  v_lshlrev_b32 v42, 16, v39
  v_and_b32 v43, s67, v39
  v_fma_f32 v42, v42, v41, -v40
  v_fma_f32 v43, v43, v41, -v40
  v_cvt_pk_bf16_f32 v39, v42, v43
  buffer_store_dwordx4 v[32:35], v44, s[16:19], 0 offen sc1
  buffer_store_dwordx4 v[36:39], v45, s[16:19], 0 offen sc1
  s_add_u32 s40, s46, 101711872
  s_addc_u32 s41, s47, 0
  s_mov_b32 s42, 16384
  s_mov_b32 s43, 0x00020000
  s_lshl_b32 s67, s2, 6
  s_lshl_b32 s68, s28, 4
  s_add_u32 s67, s67, s68
  v_and_b32 v42, 3, v0
  v_lshl_add_u32 v42, v42, 2, s67
  v_mov_b32 v43, 0
  buffer_store_dword v43, v42, s[40:43], 0 offen sc1
  s_waitcnt vmcnt(23)
  s_barrier
  s_cmp_eq_u32 s31, 0
  s_cbranch_scc0 k1_V
k1_K:
  v_add_u32 v4, s32, v2
  ds_read_b128 a[32:35], v4 offset:0
  ds_read_b128 a[36:39], v4 offset:2048
  ds_read_b128 a[40:43], v4 offset:4096
  ds_read_b128 a[44:47], v4 offset:6144
  ds_read_b128 a[48:51], v4 offset:8192
  ds_read_b128 a[52:55], v4 offset:10240
  ds_read_b128 a[56:59], v4 offset:12288
  ds_read_b128 a[60:63], v4 offset:14336
  ds_read_b64_tr_b16 a[96:97], v5 offset:0
  ds_read_b64_tr_b16 a[98:99], v5 offset:2048
  ds_read_b64_tr_b16 a[100:101], v6 offset:0
  ds_read_b64_tr_b16 a[102:103], v6 offset:2048
  s_mov_b32 s51, s69
  v_add_u32 v4, s32, v3
  s_waitcnt lgkmcnt(2)
  v_mfma_f32_16x16x32_bf16 v[32:35], a[96:99], a[32:35], 0
  ds_read_b64_tr_b16 a[104:105], v7 offset:0
  v_mfma_f32_16x16x32_bf16 v[36:39], a[96:99], a[36:39], 0
  ds_read_b64_tr_b16 a[106:107], v7 offset:2048
  v_mfma_f32_16x16x32_bf16 v[40:43], a[96:99], a[40:43], 0
  ds_read_b128 a[64:67], v4 offset:0
  v_mfma_f32_16x16x32_bf16 v[44:47], a[96:99], a[44:47], 0
  ds_read_b128 a[68:71], v4 offset:2048
  v_mfma_f32_16x16x32_bf16 v[48:51], a[96:99], a[48:51], 0
  v_mfma_f32_16x16x32_bf16 v[52:55], a[96:99], a[52:55], 0
  v_mfma_f32_16x16x32_bf16 v[56:59], a[96:99], a[56:59], 0
  v_mfma_f32_16x16x32_bf16 v[60:63], a[96:99], a[60:63], 0
  s_waitcnt lgkmcnt(4)
  v_mfma_f32_16x16x32_bf16 v[160:163], a[100:103], a[32:35], 0
  ds_read_b64_tr_b16 a[108:109], v8 offset:0
  v_mfma_f32_16x16x32_bf16 v[164:167], a[100:103], a[36:39], 0
  ds_read_b64_tr_b16 a[110:111], v8 offset:2048
  v_mfma_f32_16x16x32_bf16 v[168:171], a[100:103], a[40:43], 0
  ds_read_b128 a[72:75], v4 offset:4096
  v_mfma_f32_16x16x32_bf16 v[172:175], a[100:103], a[44:47], 0
  ds_read_b128 a[76:79], v4 offset:6144
  v_mfma_f32_16x16x32_bf16 v[176:179], a[100:103], a[48:51], 0
  v_mfma_f32_16x16x32_bf16 v[180:183], a[100:103], a[52:55], 0
  v_mfma_f32_16x16x32_bf16 v[184:187], a[100:103], a[56:59], 0
  v_mfma_f32_16x16x32_bf16 v[188:191], a[100:103], a[60:63], 0
  s_waitcnt lgkmcnt(6)
  v_mfma_f32_16x16x32_bf16 v[64:67], a[104:107], a[32:35], 0
  ds_read_b64_tr_b16 a[96:97], v9 offset:0
  v_mfma_f32_16x16x32_bf16 v[68:71], a[104:107], a[36:39], 0
  ds_read_b64_tr_b16 a[98:99], v9 offset:2048
  v_mfma_f32_16x16x32_bf16 v[72:75], a[104:107], a[40:43], 0
  ds_read_b128 a[80:83], v4 offset:8192
  v_mfma_f32_16x16x32_bf16 v[76:79], a[104:107], a[44:47], 0
  ds_read_b128 a[84:87], v4 offset:10240
  v_mfma_f32_16x16x32_bf16 v[80:83], a[104:107], a[48:51], 0
  v_mfma_f32_16x16x32_bf16 v[84:87], a[104:107], a[52:55], 0
  v_mfma_f32_16x16x32_bf16 v[88:91], a[104:107], a[56:59], 0
  v_mfma_f32_16x16x32_bf16 v[92:95], a[104:107], a[60:63], 0
  s_waitcnt lgkmcnt(6)
  v_mfma_f32_16x16x32_bf16 v[192:195], a[108:111], a[32:35], 0
  ds_read_b64_tr_b16 a[100:101], v10 offset:0
  v_mfma_f32_16x16x32_bf16 v[196:199], a[108:111], a[36:39], 0
  ds_read_b64_tr_b16 a[102:103], v10 offset:2048
  v_mfma_f32_16x16x32_bf16 v[200:203], a[108:111], a[40:43], 0
  ds_read_b128 a[88:91], v4 offset:12288
  v_mfma_f32_16x16x32_bf16 v[204:207], a[108:111], a[44:47], 0
  ds_read_b128 a[92:95], v4 offset:14336
  v_mfma_f32_16x16x32_bf16 v[208:211], a[108:111], a[48:51], 0
  v_mfma_f32_16x16x32_bf16 v[212:215], a[108:111], a[52:55], 0
  v_mfma_f32_16x16x32_bf16 v[216:219], a[108:111], a[56:59], 0
  s_add_u32 m0, s48, 49152
  v_mfma_f32_16x16x32_bf16 v[220:223], a[108:111], a[60:63], 0
  s_waitcnt lgkmcnt(6)
  v_mfma_f32_16x16x32_bf16 v[96:99], a[96:99], a[32:35], 0
  ds_read_b64_tr_b16 a[104:105], v11 offset:0
  v_mfma_f32_16x16x32_bf16 v[100:103], a[96:99], a[36:39], 0
  ds_read_b64_tr_b16 a[106:107], v11 offset:2048
  v_mfma_f32_16x16x32_bf16 v[104:107], a[96:99], a[40:43], 0
  buffer_load_dwordx4 v17, s[8:11], s35 offen offset:0 lds
  v_mfma_f32_16x16x32_bf16 v[108:111], a[96:99], a[44:47], 0
  v_mfma_f32_16x16x32_bf16 v[112:115], a[96:99], a[48:51], 0
  v_mfma_f32_16x16x32_bf16 v[116:119], a[96:99], a[52:55], 0
  buffer_load_dwordx4 v18, s[8:11], s35 offen offset:1024 lds
  v_mfma_f32_16x16x32_bf16 v[120:123], a[96:99], a[56:59], 0
  v_mfma_f32_16x16x32_bf16 v[124:127], a[96:99], a[60:63], 0
  s_waitcnt lgkmcnt(4)
  v_mfma_f32_16x16x32_bf16 v[224:227], a[100:103], a[32:35], 0
  ds_read_b64_tr_b16 a[108:109], v12 offset:0
  buffer_load_dwordx4 v19, s[8:11], s35 offen offset:2048 lds
  v_mfma_f32_16x16x32_bf16 v[228:231], a[100:103], a[36:39], 0
  ds_read_b64_tr_b16 a[110:111], v12 offset:2048
  v_mfma_f32_16x16x32_bf16 v[232:235], a[100:103], a[40:43], 0
  v_mfma_f32_16x16x32_bf16 v[236:239], a[100:103], a[44:47], 0
  buffer_load_dwordx4 v20, s[8:11], s35 offen offset:3072 lds
  v_mfma_f32_16x16x32_bf16 v[240:243], a[100:103], a[48:51], 0
  v_mfma_f32_16x16x32_bf16 v[244:247], a[100:103], a[52:55], 0
  s_add_u32 s35, s35, 0x40000
  v_mfma_f32_16x16x32_bf16 v[248:251], a[100:103], a[56:59], 0
  s_add_u32 m0, s33, 4096
  v_mfma_f32_16x16x32_bf16 v[252:255], a[100:103], a[60:63], 0
  s_waitcnt lgkmcnt(2)
  v_mfma_f32_16x16x32_bf16 v[128:131], a[104:107], a[32:35], 0
  ds_read_b64_tr_b16 a[96:97], v5 offset:16384
  v_mfma_f32_16x16x32_bf16 v[132:135], a[104:107], a[36:39], 0
  ds_read_b64_tr_b16 a[98:99], v5 offset:18432
  buffer_load_dwordx4 v13, s[4:7], s57 offen offset:0 lds
  v_mfma_f32_16x16x32_bf16 v[136:139], a[104:107], a[40:43], 0
  v_mfma_f32_16x16x32_bf16 v[140:143], a[104:107], a[44:47], 0
  v_mfma_f32_16x16x32_bf16 v[144:147], a[104:107], a[48:51], 0
  buffer_load_dwordx4 v14, s[4:7], s57 offen offset:1024 lds
  v_mfma_f32_16x16x32_bf16 v[148:151], a[104:107], a[52:55], 0
  v_mfma_f32_16x16x32_bf16 v[152:155], a[104:107], a[56:59], 0
  v_mfma_f32_16x16x32_bf16 v[156:159], a[104:107], a[60:63], 0
  buffer_load_dwordx4 v15, s[4:7], s57 offen offset:2048 lds
  s_waitcnt lgkmcnt(2)
  v_mfma_f32_16x16x32_bf16 a[0:3], a[108:111], a[32:35], 0
  ds_read_b64_tr_b16 a[100:101], v6 offset:16384
  v_mfma_f32_16x16x32_bf16 a[4:7], a[108:111], a[36:39], 0
  ds_read_b64_tr_b16 a[102:103], v6 offset:18432
  v_mfma_f32_16x16x32_bf16 a[8:11], a[108:111], a[40:43], 0
  buffer_load_dwordx4 v16, s[4:7], s57 offen offset:3072 lds
  v_mfma_f32_16x16x32_bf16 a[12:15], a[108:111], a[44:47], 0
  v_mfma_f32_16x16x32_bf16 a[16:19], a[108:111], a[48:51], 0
  v_mfma_f32_16x16x32_bf16 a[20:23], a[108:111], a[52:55], 0
  v_mfma_f32_16x16x32_bf16 a[24:27], a[108:111], a[56:59], 0
  buffer_load_dword a254, v28, s[12:15], s51 offen
  v_mfma_f32_16x16x32_bf16 a[28:31], a[108:111], a[60:63], 0
  s_waitcnt vmcnt(20)
  s_barrier
  s_add_u32 s33, s32, s49
  s_add_u32 s32, s32, 0x8000
  s_cmp_eq_u32 s32, 0x18000
  s_cselect_b32 s32, 0, s32
  s_add_u32 s34, s34, 128
  s_mov_b32 s56, s34
  s_add_u32 s57, s34, 0x10000
  v_add_u32 v4, s32, v2
  s_waitcnt lgkmcnt(2)
  v_mfma_f32_16x16x32_bf16 v[32:35], a[96:99], a[64:67], v[32:35]
  ds_read_b64_tr_b16 a[104:105], v7 offset:16384
  v_mfma_f32_16x16x32_bf16 v[36:39], a[96:99], a[68:71], v[36:39]
  ds_read_b64_tr_b16 a[106:107], v7 offset:18432
  v_mfma_f32_16x16x32_bf16 v[40:43], a[96:99], a[72:75], v[40:43]
  ds_read_b128 a[32:35], v4 offset:0
  v_mfma_f32_16x16x32_bf16 v[44:47], a[96:99], a[76:79], v[44:47]
  ds_read_b128 a[36:39], v4 offset:2048
  v_mfma_f32_16x16x32_bf16 v[48:51], a[96:99], a[80:83], v[48:51]
  v_mfma_f32_16x16x32_bf16 v[52:55], a[96:99], a[84:87], v[52:55]
  v_mfma_f32_16x16x32_bf16 v[56:59], a[96:99], a[88:91], v[56:59]
  v_mfma_f32_16x16x32_bf16 v[60:63], a[96:99], a[92:95], v[60:63]
  s_waitcnt lgkmcnt(4)
  v_mfma_f32_16x16x32_bf16 v[160:163], a[100:103], a[64:67], v[160:163]
  ds_read_b64_tr_b16 a[108:109], v8 offset:16384
  v_mfma_f32_16x16x32_bf16 v[164:167], a[100:103], a[68:71], v[164:167]
  ds_read_b64_tr_b16 a[110:111], v8 offset:18432
  v_mfma_f32_16x16x32_bf16 v[168:171], a[100:103], a[72:75], v[168:171]
  ds_read_b128 a[40:43], v4 offset:4096
  v_mfma_f32_16x16x32_bf16 v[172:175], a[100:103], a[76:79], v[172:175]
  ds_read_b128 a[44:47], v4 offset:6144
  v_mfma_f32_16x16x32_bf16 v[176:179], a[100:103], a[80:83], v[176:179]
  v_mfma_f32_16x16x32_bf16 v[180:183], a[100:103], a[84:87], v[180:183]
  v_mfma_f32_16x16x32_bf16 v[184:187], a[100:103], a[88:91], v[184:187]
  v_mfma_f32_16x16x32_bf16 v[188:191], a[100:103], a[92:95], v[188:191]
  s_waitcnt lgkmcnt(6)
  v_mfma_f32_16x16x32_bf16 v[64:67], a[104:107], a[64:67], v[64:67]
  ds_read_b64_tr_b16 a[96:97], v9 offset:16384
  v_mfma_f32_16x16x32_bf16 v[68:71], a[104:107], a[68:71], v[68:71]
  ds_read_b64_tr_b16 a[98:99], v9 offset:18432
  v_mfma_f32_16x16x32_bf16 v[72:75], a[104:107], a[72:75], v[72:75]
  ds_read_b128 a[48:51], v4 offset:8192
  v_mfma_f32_16x16x32_bf16 v[76:79], a[104:107], a[76:79], v[76:79]
  ds_read_b128 a[52:55], v4 offset:10240
  v_mfma_f32_16x16x32_bf16 v[80:83], a[104:107], a[80:83], v[80:83]
  v_mfma_f32_16x16x32_bf16 v[84:87], a[104:107], a[84:87], v[84:87]
  v_mfma_f32_16x16x32_bf16 v[88:91], a[104:107], a[88:91], v[88:91]
  v_mfma_f32_16x16x32_bf16 v[92:95], a[104:107], a[92:95], v[92:95]
  s_waitcnt lgkmcnt(6)
  v_mfma_f32_16x16x32_bf16 v[192:195], a[108:111], a[64:67], v[192:195]
  ds_read_b64_tr_b16 a[100:101], v10 offset:16384
  v_mfma_f32_16x16x32_bf16 v[196:199], a[108:111], a[68:71], v[196:199]
  ds_read_b64_tr_b16 a[102:103], v10 offset:18432
  v_mfma_f32_16x16x32_bf16 v[200:203], a[108:111], a[72:75], v[200:203]
  ds_read_b128 a[56:59], v4 offset:12288
  v_mfma_f32_16x16x32_bf16 v[204:207], a[108:111], a[76:79], v[204:207]
  ds_read_b128 a[60:63], v4 offset:14336
  v_mfma_f32_16x16x32_bf16 v[208:211], a[108:111], a[80:83], v[208:211]
  v_mfma_f32_16x16x32_bf16 v[212:215], a[108:111], a[84:87], v[212:215]
  v_mfma_f32_16x16x32_bf16 v[216:219], a[108:111], a[88:91], v[216:219]
  s_add_u32 m0, s48, 0
  v_mfma_f32_16x16x32_bf16 v[220:223], a[108:111], a[92:95], v[220:223]
  s_waitcnt lgkmcnt(6)
  v_mfma_f32_16x16x32_bf16 v[96:99], a[96:99], a[64:67], v[96:99]
  ds_read_b64_tr_b16 a[104:105], v11 offset:16384
  v_mfma_f32_16x16x32_bf16 v[100:103], a[96:99], a[68:71], v[100:103]
  ds_read_b64_tr_b16 a[106:107], v11 offset:18432
  v_mfma_f32_16x16x32_bf16 v[104:107], a[96:99], a[72:75], v[104:107]
  buffer_load_dwordx4 v17, s[8:11], s35 offen offset:0 lds
  v_mfma_f32_16x16x32_bf16 v[108:111], a[96:99], a[76:79], v[108:111]
  v_mfma_f32_16x16x32_bf16 v[112:115], a[96:99], a[80:83], v[112:115]
  v_mfma_f32_16x16x32_bf16 v[116:119], a[96:99], a[84:87], v[116:119]
  buffer_load_dwordx4 v18, s[8:11], s35 offen offset:1024 lds
  v_mfma_f32_16x16x32_bf16 v[120:123], a[96:99], a[88:91], v[120:123]
  v_mfma_f32_16x16x32_bf16 v[124:127], a[96:99], a[92:95], v[124:127]
  s_waitcnt lgkmcnt(4)
  v_mfma_f32_16x16x32_bf16 v[224:227], a[100:103], a[64:67], v[224:227]
  ds_read_b64_tr_b16 a[108:109], v12 offset:16384
  buffer_load_dwordx4 v19, s[8:11], s35 offen offset:2048 lds
  v_mfma_f32_16x16x32_bf16 v[228:231], a[100:103], a[68:71], v[228:231]
  ds_read_b64_tr_b16 a[110:111], v12 offset:18432
  v_mfma_f32_16x16x32_bf16 v[232:235], a[100:103], a[72:75], v[232:235]
  v_mfma_f32_16x16x32_bf16 v[236:239], a[100:103], a[76:79], v[236:239]
  buffer_load_dwordx4 v20, s[8:11], s35 offen offset:3072 lds
  v_mfma_f32_16x16x32_bf16 v[240:243], a[100:103], a[80:83], v[240:243]
  v_mfma_f32_16x16x32_bf16 v[244:247], a[100:103], a[84:87], v[244:247]
  s_add_u32 s35, s35, 0x40000
  v_mfma_f32_16x16x32_bf16 v[248:251], a[100:103], a[88:91], v[248:251]
  s_add_u32 m0, s33, 0
  v_mfma_f32_16x16x32_bf16 v[252:255], a[100:103], a[92:95], v[252:255]
  s_waitcnt lgkmcnt(2)
  v_mfma_f32_16x16x32_bf16 v[128:131], a[104:107], a[64:67], v[128:131]
  ds_read_b64_tr_b16 a[96:97], v5 offset:32768
  v_mfma_f32_16x16x32_bf16 v[132:135], a[104:107], a[68:71], v[132:135]
  ds_read_b64_tr_b16 a[98:99], v5 offset:34816
  buffer_load_dwordx4 v13, s[4:7], s56 offen offset:0 lds
  v_mfma_f32_16x16x32_bf16 v[136:139], a[104:107], a[72:75], v[136:139]
  v_mfma_f32_16x16x32_bf16 v[140:143], a[104:107], a[76:79], v[140:143]
  v_mfma_f32_16x16x32_bf16 v[144:147], a[104:107], a[80:83], v[144:147]
  buffer_load_dwordx4 v14, s[4:7], s56 offen offset:1024 lds
  v_mfma_f32_16x16x32_bf16 v[148:151], a[104:107], a[84:87], v[148:151]
  v_mfma_f32_16x16x32_bf16 v[152:155], a[104:107], a[88:91], v[152:155]
  v_mfma_f32_16x16x32_bf16 v[156:159], a[104:107], a[92:95], v[156:159]
  buffer_load_dwordx4 v15, s[4:7], s56 offen offset:2048 lds
  s_waitcnt lgkmcnt(2)
  v_mfma_f32_16x16x32_bf16 a[0:3], a[108:111], a[64:67], a[0:3]
  ds_read_b64_tr_b16 a[100:101], v6 offset:32768
  v_mfma_f32_16x16x32_bf16 a[4:7], a[108:111], a[68:71], a[4:7]
  ds_read_b64_tr_b16 a[102:103], v6 offset:34816
  v_mfma_f32_16x16x32_bf16 a[8:11], a[108:111], a[72:75], a[8:11]
  buffer_load_dwordx4 v16, s[4:7], s56 offen offset:3072 lds
  v_mfma_f32_16x16x32_bf16 a[12:15], a[108:111], a[76:79], a[12:15]
  v_mfma_f32_16x16x32_bf16 a[16:19], a[108:111], a[80:83], a[16:19]
  v_mfma_f32_16x16x32_bf16 a[20:23], a[108:111], a[84:87], a[20:23]
  v_mfma_f32_16x16x32_bf16 a[24:27], a[108:111], a[88:91], a[24:27]
  v_mfma_f32_16x16x32_bf16 a[28:31], a[108:111], a[92:95], a[28:31]
  s_waitcnt vmcnt(13)
  s_barrier
  v_add_u32 v4, s32, v3
  s_waitcnt lgkmcnt(2)
  v_mfma_f32_16x16x32_bf16 v[32:35], a[96:99], a[32:35], v[32:35]
  ds_read_b64_tr_b16 a[104:105], v7 offset:32768
  v_mfma_f32_16x16x32_bf16 v[36:39], a[96:99], a[36:39], v[36:39]
  ds_read_b64_tr_b16 a[106:107], v7 offset:34816
  v_mfma_f32_16x16x32_bf16 v[40:43], a[96:99], a[40:43], v[40:43]
  ds_read_b128 a[64:67], v4 offset:0
  v_mfma_f32_16x16x32_bf16 v[44:47], a[96:99], a[44:47], v[44:47]
  ds_read_b128 a[68:71], v4 offset:2048
  v_mfma_f32_16x16x32_bf16 v[48:51], a[96:99], a[48:51], v[48:51]
  v_mfma_f32_16x16x32_bf16 v[52:55], a[96:99], a[52:55], v[52:55]
  v_mfma_f32_16x16x32_bf16 v[56:59], a[96:99], a[56:59], v[56:59]
  v_mfma_f32_16x16x32_bf16 v[60:63], a[96:99], a[60:63], v[60:63]
  s_waitcnt lgkmcnt(4)
  v_mfma_f32_16x16x32_bf16 v[160:163], a[100:103], a[32:35], v[160:163]
  ds_read_b64_tr_b16 a[108:109], v8 offset:32768
  v_mfma_f32_16x16x32_bf16 v[164:167], a[100:103], a[36:39], v[164:167]
  ds_read_b64_tr_b16 a[110:111], v8 offset:34816
  v_mfma_f32_16x16x32_bf16 v[168:171], a[100:103], a[40:43], v[168:171]
  ds_read_b128 a[72:75], v4 offset:4096
  v_mfma_f32_16x16x32_bf16 v[172:175], a[100:103], a[44:47], v[172:175]
  ds_read_b128 a[76:79], v4 offset:6144
  v_mfma_f32_16x16x32_bf16 v[176:179], a[100:103], a[48:51], v[176:179]
  v_mfma_f32_16x16x32_bf16 v[180:183], a[100:103], a[52:55], v[180:183]
  v_mfma_f32_16x16x32_bf16 v[184:187], a[100:103], a[56:59], v[184:187]
  v_mfma_f32_16x16x32_bf16 v[188:191], a[100:103], a[60:63], v[188:191]
  s_waitcnt lgkmcnt(6)
  v_mfma_f32_16x16x32_bf16 v[64:67], a[104:107], a[32:35], v[64:67]
  ds_read_b64_tr_b16 a[96:97], v9 offset:32768
  v_mfma_f32_16x16x32_bf16 v[68:71], a[104:107], a[36:39], v[68:71]
  ds_read_b64_tr_b16 a[98:99], v9 offset:34816
  v_mfma_f32_16x16x32_bf16 v[72:75], a[104:107], a[40:43], v[72:75]
  ds_read_b128 a[80:83], v4 offset:8192
  v_mfma_f32_16x16x32_bf16 v[76:79], a[104:107], a[44:47], v[76:79]
  ds_read_b128 a[84:87], v4 offset:10240
  v_mfma_f32_16x16x32_bf16 v[80:83], a[104:107], a[48:51], v[80:83]
  v_mfma_f32_16x16x32_bf16 v[84:87], a[104:107], a[52:55], v[84:87]
  v_mfma_f32_16x16x32_bf16 v[88:91], a[104:107], a[56:59], v[88:91]
  v_mfma_f32_16x16x32_bf16 v[92:95], a[104:107], a[60:63], v[92:95]
  s_waitcnt lgkmcnt(6)
  v_mfma_f32_16x16x32_bf16 v[192:195], a[108:111], a[32:35], v[192:195]
  ds_read_b64_tr_b16 a[100:101], v10 offset:32768
  v_mfma_f32_16x16x32_bf16 v[196:199], a[108:111], a[36:39], v[196:199]
  ds_read_b64_tr_b16 a[102:103], v10 offset:34816
  v_mfma_f32_16x16x32_bf16 v[200:203], a[108:111], a[40:43], v[200:203]
  ds_read_b128 a[88:91], v4 offset:12288
  v_mfma_f32_16x16x32_bf16 v[204:207], a[108:111], a[44:47], v[204:207]
  ds_read_b128 a[92:95], v4 offset:14336
  v_mfma_f32_16x16x32_bf16 v[208:211], a[108:111], a[48:51], v[208:211]
  v_mfma_f32_16x16x32_bf16 v[212:215], a[108:111], a[52:55], v[212:215]
  v_mfma_f32_16x16x32_bf16 v[216:219], a[108:111], a[56:59], v[216:219]
  s_add_u32 m0, s48, 16384
  v_mfma_f32_16x16x32_bf16 v[220:223], a[108:111], a[60:63], v[220:223]
  s_waitcnt lgkmcnt(6)
  v_mfma_f32_16x16x32_bf16 v[96:99], a[96:99], a[32:35], v[96:99]
  ds_read_b64_tr_b16 a[104:105], v11 offset:32768
  v_mfma_f32_16x16x32_bf16 v[100:103], a[96:99], a[36:39], v[100:103]
  ds_read_b64_tr_b16 a[106:107], v11 offset:34816
  v_mfma_f32_16x16x32_bf16 v[104:107], a[96:99], a[40:43], v[104:107]
  buffer_load_dwordx4 v17, s[8:11], s35 offen offset:0 lds
  v_mfma_f32_16x16x32_bf16 v[108:111], a[96:99], a[44:47], v[108:111]
  v_mfma_f32_16x16x32_bf16 v[112:115], a[96:99], a[48:51], v[112:115]
  v_mfma_f32_16x16x32_bf16 v[116:119], a[96:99], a[52:55], v[116:119]
  buffer_load_dwordx4 v18, s[8:11], s35 offen offset:1024 lds
  v_mfma_f32_16x16x32_bf16 v[120:123], a[96:99], a[56:59], v[120:123]
  v_mfma_f32_16x16x32_bf16 v[124:127], a[96:99], a[60:63], v[124:127]
  s_waitcnt lgkmcnt(4)
  v_mfma_f32_16x16x32_bf16 v[224:227], a[100:103], a[32:35], v[224:227]
  ds_read_b64_tr_b16 a[108:109], v12 offset:32768
  buffer_load_dwordx4 v19, s[8:11], s35 offen offset:2048 lds
  v_mfma_f32_16x16x32_bf16 v[228:231], a[100:103], a[36:39], v[228:231]
  ds_read_b64_tr_b16 a[110:111], v12 offset:34816
  v_mfma_f32_16x16x32_bf16 v[232:235], a[100:103], a[40:43], v[232:235]
  v_mfma_f32_16x16x32_bf16 v[236:239], a[100:103], a[44:47], v[236:239]
  buffer_load_dwordx4 v20, s[8:11], s35 offen offset:3072 lds
  v_mfma_f32_16x16x32_bf16 v[240:243], a[100:103], a[48:51], v[240:243]
  v_mfma_f32_16x16x32_bf16 v[244:247], a[100:103], a[52:55], v[244:247]
  s_add_u32 s35, s35, 0x40000
  v_mfma_f32_16x16x32_bf16 v[248:251], a[100:103], a[56:59], v[248:251]
  s_add_u32 m0, s33, 4096
  v_mfma_f32_16x16x32_bf16 v[252:255], a[100:103], a[60:63], v[252:255]
  s_waitcnt lgkmcnt(2)
  v_mfma_f32_16x16x32_bf16 v[128:131], a[104:107], a[32:35], v[128:131]
  ds_read_b64_tr_b16 a[96:97], v5 offset:49152
  v_mfma_f32_16x16x32_bf16 v[132:135], a[104:107], a[36:39], v[132:135]
  ds_read_b64_tr_b16 a[98:99], v5 offset:51200
  buffer_load_dwordx4 v13, s[4:7], s57 offen offset:0 lds
  v_mfma_f32_16x16x32_bf16 v[136:139], a[104:107], a[40:43], v[136:139]
  v_mfma_f32_16x16x32_bf16 v[140:143], a[104:107], a[44:47], v[140:143]
  v_mfma_f32_16x16x32_bf16 v[144:147], a[104:107], a[48:51], v[144:147]
  buffer_load_dwordx4 v14, s[4:7], s57 offen offset:1024 lds
  v_mfma_f32_16x16x32_bf16 v[148:151], a[104:107], a[52:55], v[148:151]
  v_mfma_f32_16x16x32_bf16 v[152:155], a[104:107], a[56:59], v[152:155]
  v_mfma_f32_16x16x32_bf16 v[156:159], a[104:107], a[60:63], v[156:159]
  buffer_load_dwordx4 v15, s[4:7], s57 offen offset:2048 lds
  s_waitcnt lgkmcnt(2)
  v_mfma_f32_16x16x32_bf16 a[0:3], a[108:111], a[32:35], a[0:3]
  ds_read_b64_tr_b16 a[100:101], v6 offset:49152
  v_mfma_f32_16x16x32_bf16 a[4:7], a[108:111], a[36:39], a[4:7]
  ds_read_b64_tr_b16 a[102:103], v6 offset:51200
  v_mfma_f32_16x16x32_bf16 a[8:11], a[108:111], a[40:43], a[8:11]
  buffer_load_dwordx4 v16, s[4:7], s57 offen offset:3072 lds
  v_mfma_f32_16x16x32_bf16 a[12:15], a[108:111], a[44:47], a[12:15]
  v_mfma_f32_16x16x32_bf16 a[16:19], a[108:111], a[48:51], a[16:19]
  v_mfma_f32_16x16x32_bf16 a[20:23], a[108:111], a[52:55], a[20:23]
  v_mfma_f32_16x16x32_bf16 a[24:27], a[108:111], a[56:59], a[24:27]
  v_mfma_f32_16x16x32_bf16 a[28:31], a[108:111], a[60:63], a[28:31]
  s_waitcnt vmcnt(12)
  s_barrier
  s_add_u32 s33, s32, s49
  s_add_u32 s32, s32, 0x8000
  s_cmp_eq_u32 s32, 0x18000
  s_cselect_b32 s32, 0, s32
  s_add_u32 s34, s34, 128
  s_mov_b32 s56, s34
  s_add_u32 s57, s34, 0x10000
  v_add_u32 v4, s32, v2
  s_waitcnt lgkmcnt(2)
  v_mfma_f32_16x16x32_bf16 v[32:35], a[96:99], a[64:67], v[32:35]
  ds_read_b64_tr_b16 a[104:105], v7 offset:49152
  v_mfma_f32_16x16x32_bf16 v[36:39], a[96:99], a[68:71], v[36:39]
  ds_read_b64_tr_b16 a[106:107], v7 offset:51200
  v_mfma_f32_16x16x32_bf16 v[40:43], a[96:99], a[72:75], v[40:43]
  ds_read_b128 a[32:35], v4 offset:0
  v_mfma_f32_16x16x32_bf16 v[44:47], a[96:99], a[76:79], v[44:47]
  ds_read_b128 a[36:39], v4 offset:2048
  v_mfma_f32_16x16x32_bf16 v[48:51], a[96:99], a[80:83], v[48:51]
  v_mfma_f32_16x16x32_bf16 v[52:55], a[96:99], a[84:87], v[52:55]
  v_mfma_f32_16x16x32_bf16 v[56:59], a[96:99], a[88:91], v[56:59]
  v_mfma_f32_16x16x32_bf16 v[60:63], a[96:99], a[92:95], v[60:63]
  s_waitcnt lgkmcnt(4)
  v_mfma_f32_16x16x32_bf16 v[160:163], a[100:103], a[64:67], v[160:163]
  ds_read_b64_tr_b16 a[108:109], v8 offset:49152
  v_mfma_f32_16x16x32_bf16 v[164:167], a[100:103], a[68:71], v[164:167]
  ds_read_b64_tr_b16 a[110:111], v8 offset:51200
  v_mfma_f32_16x16x32_bf16 v[168:171], a[100:103], a[72:75], v[168:171]
  ds_read_b128 a[40:43], v4 offset:4096
  v_mfma_f32_16x16x32_bf16 v[172:175], a[100:103], a[76:79], v[172:175]
  ds_read_b128 a[44:47], v4 offset:6144
  v_mfma_f32_16x16x32_bf16 v[176:179], a[100:103], a[80:83], v[176:179]
  v_mfma_f32_16x16x32_bf16 v[180:183], a[100:103], a[84:87], v[180:183]
  v_mfma_f32_16x16x32_bf16 v[184:187], a[100:103], a[88:91], v[184:187]
  v_mfma_f32_16x16x32_bf16 v[188:191], a[100:103], a[92:95], v[188:191]
  s_waitcnt lgkmcnt(6)
  v_mfma_f32_16x16x32_bf16 v[64:67], a[104:107], a[64:67], v[64:67]
  ds_read_b64_tr_b16 a[96:97], v9 offset:49152
  v_mfma_f32_16x16x32_bf16 v[68:71], a[104:107], a[68:71], v[68:71]
  ds_read_b64_tr_b16 a[98:99], v9 offset:51200
  v_mfma_f32_16x16x32_bf16 v[72:75], a[104:107], a[72:75], v[72:75]
  ds_read_b128 a[48:51], v4 offset:8192
  v_mfma_f32_16x16x32_bf16 v[76:79], a[104:107], a[76:79], v[76:79]
  ds_read_b128 a[52:55], v4 offset:10240
  v_mfma_f32_16x16x32_bf16 v[80:83], a[104:107], a[80:83], v[80:83]
  v_mfma_f32_16x16x32_bf16 v[84:87], a[104:107], a[84:87], v[84:87]
  v_mfma_f32_16x16x32_bf16 v[88:91], a[104:107], a[88:91], v[88:91]
  v_mfma_f32_16x16x32_bf16 v[92:95], a[104:107], a[92:95], v[92:95]
  s_waitcnt lgkmcnt(6)
  v_mfma_f32_16x16x32_bf16 v[192:195], a[108:111], a[64:67], v[192:195]
  ds_read_b64_tr_b16 a[100:101], v10 offset:49152
  v_mfma_f32_16x16x32_bf16 v[196:199], a[108:111], a[68:71], v[196:199]
  ds_read_b64_tr_b16 a[102:103], v10 offset:51200
  v_mfma_f32_16x16x32_bf16 v[200:203], a[108:111], a[72:75], v[200:203]
  ds_read_b128 a[56:59], v4 offset:12288
  v_mfma_f32_16x16x32_bf16 v[204:207], a[108:111], a[76:79], v[204:207]
  ds_read_b128 a[60:63], v4 offset:14336
  v_mfma_f32_16x16x32_bf16 v[208:211], a[108:111], a[80:83], v[208:211]
  v_mfma_f32_16x16x32_bf16 v[212:215], a[108:111], a[84:87], v[212:215]
  v_mfma_f32_16x16x32_bf16 v[216:219], a[108:111], a[88:91], v[216:219]
  s_add_u32 m0, s48, 32768
  v_mfma_f32_16x16x32_bf16 v[220:223], a[108:111], a[92:95], v[220:223]
  s_waitcnt lgkmcnt(6)
  v_mfma_f32_16x16x32_bf16 v[96:99], a[96:99], a[64:67], v[96:99]
  ds_read_b64_tr_b16 a[104:105], v11 offset:49152
  v_mfma_f32_16x16x32_bf16 v[100:103], a[96:99], a[68:71], v[100:103]
  ds_read_b64_tr_b16 a[106:107], v11 offset:51200
  v_mfma_f32_16x16x32_bf16 v[104:107], a[96:99], a[72:75], v[104:107]
  buffer_load_dwordx4 v17, s[8:11], s35 offen offset:0 lds
  v_mfma_f32_16x16x32_bf16 v[108:111], a[96:99], a[76:79], v[108:111]
  v_mfma_f32_16x16x32_bf16 v[112:115], a[96:99], a[80:83], v[112:115]
  v_mfma_f32_16x16x32_bf16 v[116:119], a[96:99], a[84:87], v[116:119]
  buffer_load_dwordx4 v18, s[8:11], s35 offen offset:1024 lds
  v_mfma_f32_16x16x32_bf16 v[120:123], a[96:99], a[88:91], v[120:123]
  v_mfma_f32_16x16x32_bf16 v[124:127], a[96:99], a[92:95], v[124:127]
  s_waitcnt lgkmcnt(4)
  v_mfma_f32_16x16x32_bf16 v[224:227], a[100:103], a[64:67], v[224:227]
  ds_read_b64_tr_b16 a[108:109], v12 offset:49152
  buffer_load_dwordx4 v19, s[8:11], s35 offen offset:2048 lds
  v_mfma_f32_16x16x32_bf16 v[228:231], a[100:103], a[68:71], v[228:231]
  ds_read_b64_tr_b16 a[110:111], v12 offset:51200
  v_mfma_f32_16x16x32_bf16 v[232:235], a[100:103], a[72:75], v[232:235]
  v_mfma_f32_16x16x32_bf16 v[236:239], a[100:103], a[76:79], v[236:239]
  buffer_load_dwordx4 v20, s[8:11], s35 offen offset:3072 lds
  v_mfma_f32_16x16x32_bf16 v[240:243], a[100:103], a[80:83], v[240:243]
  v_mfma_f32_16x16x32_bf16 v[244:247], a[100:103], a[84:87], v[244:247]
  s_add_u32 s35, s35, 0x40000
  v_mfma_f32_16x16x32_bf16 v[248:251], a[100:103], a[88:91], v[248:251]
  s_add_u32 m0, s33, 0
  v_mfma_f32_16x16x32_bf16 v[252:255], a[100:103], a[92:95], v[252:255]
  s_waitcnt lgkmcnt(2)
  v_mfma_f32_16x16x32_bf16 v[128:131], a[104:107], a[64:67], v[128:131]
  ds_read_b64_tr_b16 a[96:97], v5 offset:0
  v_mfma_f32_16x16x32_bf16 v[132:135], a[104:107], a[68:71], v[132:135]
  ds_read_b64_tr_b16 a[98:99], v5 offset:2048
  buffer_load_dwordx4 v13, s[4:7], s56 offen offset:0 lds
  v_mfma_f32_16x16x32_bf16 v[136:139], a[104:107], a[72:75], v[136:139]
  v_mfma_f32_16x16x32_bf16 v[140:143], a[104:107], a[76:79], v[140:143]
  v_mfma_f32_16x16x32_bf16 v[144:147], a[104:107], a[80:83], v[144:147]
  buffer_load_dwordx4 v14, s[4:7], s56 offen offset:1024 lds
  v_mfma_f32_16x16x32_bf16 v[148:151], a[104:107], a[84:87], v[148:151]
  v_mfma_f32_16x16x32_bf16 v[152:155], a[104:107], a[88:91], v[152:155]
  v_mfma_f32_16x16x32_bf16 v[156:159], a[104:107], a[92:95], v[156:159]
  buffer_load_dwordx4 v15, s[4:7], s56 offen offset:2048 lds
  s_waitcnt lgkmcnt(2)
  v_mfma_f32_16x16x32_bf16 a[0:3], a[108:111], a[64:67], a[0:3]
  ds_read_b64_tr_b16 a[100:101], v6 offset:0
  v_mfma_f32_16x16x32_bf16 a[4:7], a[108:111], a[68:71], a[4:7]
  ds_read_b64_tr_b16 a[102:103], v6 offset:2048
  v_mfma_f32_16x16x32_bf16 a[8:11], a[108:111], a[72:75], a[8:11]
  buffer_load_dwordx4 v16, s[4:7], s56 offen offset:3072 lds
  v_mfma_f32_16x16x32_bf16 a[12:15], a[108:111], a[76:79], a[12:15]
  v_mfma_f32_16x16x32_bf16 a[16:19], a[108:111], a[80:83], a[16:19]
  v_mfma_f32_16x16x32_bf16 a[20:23], a[108:111], a[84:87], a[20:23]
  v_mfma_f32_16x16x32_bf16 a[24:27], a[108:111], a[88:91], a[24:27]
  v_mfma_f32_16x16x32_bf16 a[28:31], a[108:111], a[92:95], a[28:31]
  s_waitcnt vmcnt(12)
  s_barrier
  s_mov_b32 s50, 6
  v_mbcnt_lo_u32_b32 v23, -1, 0
  v_mbcnt_hi_u32_b32 v23, -1, v23
  v_and_b32 v23, 15, v23
  v_lshlrev_b32 v23, 4, v23
k1_K_loop:
  s_cmp_eq_u32 s50, 2
  s_cselect_b32 s51, 0, s69
  s_cmp_eq_u32 s50, s61
  s_cbranch_scc0 k1_K_nosig
  s_cmp_eq_u32 s28, 0
  s_cbranch_scc0 k1_K_nosig
  s_mov_b64 exec, 1
  v_mov_b32 v24, 1
  v_mov_b32 v25, s70
  buffer_store_byte v24, v25, s[36:39], 0 offen sc1
  s_mov_b64 exec, -1
k1_K_nosig:
  s_cmp_eq_u32 s50, 1
  s_cbranch_scc0 k1_K_nofl
  buffer_load_dwordx4 v[24:27], v23, s[36:39], 0 offen sc1
k1_K_nofl:
  v_add_u32 v4, s32, v3
  s_waitcnt lgkmcnt(2)
  v_mfma_f32_16x16x32_bf16 v[32:35], a[96:99], a[32:35], v[32:35]
  ds_read_b64_tr_b16 a[104:105], v7 offset:0
  v_mfma_f32_16x16x32_bf16 v[36:39], a[96:99], a[36:39], v[36:39]
  ds_read_b64_tr_b16 a[106:107], v7 offset:2048
  v_mfma_f32_16x16x32_bf16 v[40:43], a[96:99], a[40:43], v[40:43]
  ds_read_b128 a[64:67], v4 offset:0
  v_mfma_f32_16x16x32_bf16 v[44:47], a[96:99], a[44:47], v[44:47]
  ds_read_b128 a[68:71], v4 offset:2048
  v_mfma_f32_16x16x32_bf16 v[48:51], a[96:99], a[48:51], v[48:51]
  v_mfma_f32_16x16x32_bf16 v[52:55], a[96:99], a[52:55], v[52:55]
  v_mfma_f32_16x16x32_bf16 v[56:59], a[96:99], a[56:59], v[56:59]
  v_mfma_f32_16x16x32_bf16 v[60:63], a[96:99], a[60:63], v[60:63]
  s_waitcnt lgkmcnt(4)
  v_mfma_f32_16x16x32_bf16 v[160:163], a[100:103], a[32:35], v[160:163]
  ds_read_b64_tr_b16 a[108:109], v8 offset:0
  v_mfma_f32_16x16x32_bf16 v[164:167], a[100:103], a[36:39], v[164:167]
  ds_read_b64_tr_b16 a[110:111], v8 offset:2048
  v_mfma_f32_16x16x32_bf16 v[168:171], a[100:103], a[40:43], v[168:171]
  ds_read_b128 a[72:75], v4 offset:4096
  v_mfma_f32_16x16x32_bf16 v[172:175], a[100:103], a[44:47], v[172:175]
  ds_read_b128 a[76:79], v4 offset:6144
  v_mfma_f32_16x16x32_bf16 v[176:179], a[100:103], a[48:51], v[176:179]
  v_mfma_f32_16x16x32_bf16 v[180:183], a[100:103], a[52:55], v[180:183]
  v_mfma_f32_16x16x32_bf16 v[184:187], a[100:103], a[56:59], v[184:187]
  v_mfma_f32_16x16x32_bf16 v[188:191], a[100:103], a[60:63], v[188:191]
  s_waitcnt lgkmcnt(6)
  v_mfma_f32_16x16x32_bf16 v[64:67], a[104:107], a[32:35], v[64:67]
  ds_read_b64_tr_b16 a[96:97], v9 offset:0
  v_mfma_f32_16x16x32_bf16 v[68:71], a[104:107], a[36:39], v[68:71]
  ds_read_b64_tr_b16 a[98:99], v9 offset:2048
  v_mfma_f32_16x16x32_bf16 v[72:75], a[104:107], a[40:43], v[72:75]
  ds_read_b128 a[80:83], v4 offset:8192
  v_mfma_f32_16x16x32_bf16 v[76:79], a[104:107], a[44:47], v[76:79]
  ds_read_b128 a[84:87], v4 offset:10240
  v_mfma_f32_16x16x32_bf16 v[80:83], a[104:107], a[48:51], v[80:83]
  v_mfma_f32_16x16x32_bf16 v[84:87], a[104:107], a[52:55], v[84:87]
  v_mfma_f32_16x16x32_bf16 v[88:91], a[104:107], a[56:59], v[88:91]
  v_mfma_f32_16x16x32_bf16 v[92:95], a[104:107], a[60:63], v[92:95]
  s_waitcnt lgkmcnt(6)
  v_mfma_f32_16x16x32_bf16 v[192:195], a[108:111], a[32:35], v[192:195]
  ds_read_b64_tr_b16 a[100:101], v10 offset:0
  v_mfma_f32_16x16x32_bf16 v[196:199], a[108:111], a[36:39], v[196:199]
  ds_read_b64_tr_b16 a[102:103], v10 offset:2048
  v_mfma_f32_16x16x32_bf16 v[200:203], a[108:111], a[40:43], v[200:203]
  ds_read_b128 a[88:91], v4 offset:12288
  v_mfma_f32_16x16x32_bf16 v[204:207], a[108:111], a[44:47], v[204:207]
  ds_read_b128 a[92:95], v4 offset:14336
  v_mfma_f32_16x16x32_bf16 v[208:211], a[108:111], a[48:51], v[208:211]
  v_mfma_f32_16x16x32_bf16 v[212:215], a[108:111], a[52:55], v[212:215]
  v_mfma_f32_16x16x32_bf16 v[216:219], a[108:111], a[56:59], v[216:219]
  s_add_u32 m0, s48, 49152
  v_mfma_f32_16x16x32_bf16 v[220:223], a[108:111], a[60:63], v[220:223]
  s_waitcnt lgkmcnt(6)
  v_mfma_f32_16x16x32_bf16 v[96:99], a[96:99], a[32:35], v[96:99]
  ds_read_b64_tr_b16 a[104:105], v11 offset:0
  v_mfma_f32_16x16x32_bf16 v[100:103], a[96:99], a[36:39], v[100:103]
  ds_read_b64_tr_b16 a[106:107], v11 offset:2048
  v_mfma_f32_16x16x32_bf16 v[104:107], a[96:99], a[40:43], v[104:107]
  buffer_load_dwordx4 v17, s[8:11], s35 offen offset:0 lds
  v_mfma_f32_16x16x32_bf16 v[108:111], a[96:99], a[44:47], v[108:111]
  v_mfma_f32_16x16x32_bf16 v[112:115], a[96:99], a[48:51], v[112:115]
  v_mfma_f32_16x16x32_bf16 v[116:119], a[96:99], a[52:55], v[116:119]
  buffer_load_dwordx4 v18, s[8:11], s35 offen offset:1024 lds
  v_mfma_f32_16x16x32_bf16 v[120:123], a[96:99], a[56:59], v[120:123]
  v_mfma_f32_16x16x32_bf16 v[124:127], a[96:99], a[60:63], v[124:127]
  s_waitcnt lgkmcnt(4)
  v_mfma_f32_16x16x32_bf16 v[224:227], a[100:103], a[32:35], v[224:227]
  ds_read_b64_tr_b16 a[108:109], v12 offset:0
  buffer_load_dwordx4 v19, s[8:11], s35 offen offset:2048 lds
  v_mfma_f32_16x16x32_bf16 v[228:231], a[100:103], a[36:39], v[228:231]
  ds_read_b64_tr_b16 a[110:111], v12 offset:2048
  v_mfma_f32_16x16x32_bf16 v[232:235], a[100:103], a[40:43], v[232:235]
  v_mfma_f32_16x16x32_bf16 v[236:239], a[100:103], a[44:47], v[236:239]
  buffer_load_dwordx4 v20, s[8:11], s35 offen offset:3072 lds
  v_mfma_f32_16x16x32_bf16 v[240:243], a[100:103], a[48:51], v[240:243]
  v_mfma_f32_16x16x32_bf16 v[244:247], a[100:103], a[52:55], v[244:247]
  s_add_u32 s35, s35, 0x40000
  v_mfma_f32_16x16x32_bf16 v[248:251], a[100:103], a[56:59], v[248:251]
  s_add_u32 m0, s33, 4096
  v_mfma_f32_16x16x32_bf16 v[252:255], a[100:103], a[60:63], v[252:255]
  s_waitcnt lgkmcnt(2)
  v_mfma_f32_16x16x32_bf16 v[128:131], a[104:107], a[32:35], v[128:131]
  ds_read_b64_tr_b16 a[96:97], v5 offset:16384
  v_mfma_f32_16x16x32_bf16 v[132:135], a[104:107], a[36:39], v[132:135]
  ds_read_b64_tr_b16 a[98:99], v5 offset:18432
  buffer_load_dwordx4 v13, s[4:7], s57 offen offset:0 lds
  v_mfma_f32_16x16x32_bf16 v[136:139], a[104:107], a[40:43], v[136:139]
  v_mfma_f32_16x16x32_bf16 v[140:143], a[104:107], a[44:47], v[140:143]
  v_mfma_f32_16x16x32_bf16 v[144:147], a[104:107], a[48:51], v[144:147]
  buffer_load_dwordx4 v14, s[4:7], s57 offen offset:1024 lds
  v_mfma_f32_16x16x32_bf16 v[148:151], a[104:107], a[52:55], v[148:151]
  v_mfma_f32_16x16x32_bf16 v[152:155], a[104:107], a[56:59], v[152:155]
  v_mfma_f32_16x16x32_bf16 v[156:159], a[104:107], a[60:63], v[156:159]
  buffer_load_dwordx4 v15, s[4:7], s57 offen offset:2048 lds
  s_waitcnt lgkmcnt(2)
  v_mfma_f32_16x16x32_bf16 a[0:3], a[108:111], a[32:35], a[0:3]
  ds_read_b64_tr_b16 a[100:101], v6 offset:16384
  v_mfma_f32_16x16x32_bf16 a[4:7], a[108:111], a[36:39], a[4:7]
  ds_read_b64_tr_b16 a[102:103], v6 offset:18432
  v_mfma_f32_16x16x32_bf16 a[8:11], a[108:111], a[40:43], a[8:11]
  buffer_load_dwordx4 v16, s[4:7], s57 offen offset:3072 lds
  v_mfma_f32_16x16x32_bf16 a[12:15], a[108:111], a[44:47], a[12:15]
  v_mfma_f32_16x16x32_bf16 a[16:19], a[108:111], a[48:51], a[16:19]
  v_mfma_f32_16x16x32_bf16 a[20:23], a[108:111], a[52:55], a[20:23]
  v_mfma_f32_16x16x32_bf16 a[24:27], a[108:111], a[56:59], a[24:27]
  buffer_load_dword a254, v28, s[12:15], s51 offen
  v_mfma_f32_16x16x32_bf16 a[28:31], a[108:111], a[60:63], a[28:31]
  s_waitcnt vmcnt(13)
  s_barrier
  s_add_u32 s33, s32, s49
  s_add_u32 s32, s32, 0x8000
  s_cmp_eq_u32 s32, 0x18000
  s_cselect_b32 s32, 0, s32
  s_add_u32 s34, s34, 128
  s_mov_b32 s56, s34
  s_add_u32 s57, s34, 0x10000
  v_add_u32 v4, s32, v2
  s_waitcnt lgkmcnt(2)
  v_mfma_f32_16x16x32_bf16 v[32:35], a[96:99], a[64:67], v[32:35]
  ds_read_b64_tr_b16 a[104:105], v7 offset:16384
  v_mfma_f32_16x16x32_bf16 v[36:39], a[96:99], a[68:71], v[36:39]
  ds_read_b64_tr_b16 a[106:107], v7 offset:18432
  v_mfma_f32_16x16x32_bf16 v[40:43], a[96:99], a[72:75], v[40:43]
  ds_read_b128 a[32:35], v4 offset:0
  v_mfma_f32_16x16x32_bf16 v[44:47], a[96:99], a[76:79], v[44:47]
  ds_read_b128 a[36:39], v4 offset:2048
  v_mfma_f32_16x16x32_bf16 v[48:51], a[96:99], a[80:83], v[48:51]
  v_mfma_f32_16x16x32_bf16 v[52:55], a[96:99], a[84:87], v[52:55]
  v_mfma_f32_16x16x32_bf16 v[56:59], a[96:99], a[88:91], v[56:59]
  v_mfma_f32_16x16x32_bf16 v[60:63], a[96:99], a[92:95], v[60:63]
  s_waitcnt lgkmcnt(4)
  v_mfma_f32_16x16x32_bf16 v[160:163], a[100:103], a[64:67], v[160:163]
  ds_read_b64_tr_b16 a[108:109], v8 offset:16384
  v_mfma_f32_16x16x32_bf16 v[164:167], a[100:103], a[68:71], v[164:167]
  ds_read_b64_tr_b16 a[110:111], v8 offset:18432
  v_mfma_f32_16x16x32_bf16 v[168:171], a[100:103], a[72:75], v[168:171]
  ds_read_b128 a[40:43], v4 offset:4096
  v_mfma_f32_16x16x32_bf16 v[172:175], a[100:103], a[76:79], v[172:175]
  ds_read_b128 a[44:47], v4 offset:6144
  v_mfma_f32_16x16x32_bf16 v[176:179], a[100:103], a[80:83], v[176:179]
  v_mfma_f32_16x16x32_bf16 v[180:183], a[100:103], a[84:87], v[180:183]
  v_mfma_f32_16x16x32_bf16 v[184:187], a[100:103], a[88:91], v[184:187]
  v_mfma_f32_16x16x32_bf16 v[188:191], a[100:103], a[92:95], v[188:191]
  s_waitcnt lgkmcnt(6)
  v_mfma_f32_16x16x32_bf16 v[64:67], a[104:107], a[64:67], v[64:67]
  ds_read_b64_tr_b16 a[96:97], v9 offset:16384
  v_mfma_f32_16x16x32_bf16 v[68:71], a[104:107], a[68:71], v[68:71]
  ds_read_b64_tr_b16 a[98:99], v9 offset:18432
  v_mfma_f32_16x16x32_bf16 v[72:75], a[104:107], a[72:75], v[72:75]
  ds_read_b128 a[48:51], v4 offset:8192
  v_mfma_f32_16x16x32_bf16 v[76:79], a[104:107], a[76:79], v[76:79]
  ds_read_b128 a[52:55], v4 offset:10240
  v_mfma_f32_16x16x32_bf16 v[80:83], a[104:107], a[80:83], v[80:83]
  v_mfma_f32_16x16x32_bf16 v[84:87], a[104:107], a[84:87], v[84:87]
  v_mfma_f32_16x16x32_bf16 v[88:91], a[104:107], a[88:91], v[88:91]
  v_mfma_f32_16x16x32_bf16 v[92:95], a[104:107], a[92:95], v[92:95]
  s_waitcnt lgkmcnt(6)
  v_mfma_f32_16x16x32_bf16 v[192:195], a[108:111], a[64:67], v[192:195]
  ds_read_b64_tr_b16 a[100:101], v10 offset:16384
  v_mfma_f32_16x16x32_bf16 v[196:199], a[108:111], a[68:71], v[196:199]
  ds_read_b64_tr_b16 a[102:103], v10 offset:18432
  v_mfma_f32_16x16x32_bf16 v[200:203], a[108:111], a[72:75], v[200:203]
  ds_read_b128 a[56:59], v4 offset:12288
  v_mfma_f32_16x16x32_bf16 v[204:207], a[108:111], a[76:79], v[204:207]
  ds_read_b128 a[60:63], v4 offset:14336
  v_mfma_f32_16x16x32_bf16 v[208:211], a[108:111], a[80:83], v[208:211]
  v_mfma_f32_16x16x32_bf16 v[212:215], a[108:111], a[84:87], v[212:215]
  v_mfma_f32_16x16x32_bf16 v[216:219], a[108:111], a[88:91], v[216:219]
  s_add_u32 m0, s48, 0
  v_mfma_f32_16x16x32_bf16 v[220:223], a[108:111], a[92:95], v[220:223]
  s_waitcnt lgkmcnt(6)
  v_mfma_f32_16x16x32_bf16 v[96:99], a[96:99], a[64:67], v[96:99]
  ds_read_b64_tr_b16 a[104:105], v11 offset:16384
  v_mfma_f32_16x16x32_bf16 v[100:103], a[96:99], a[68:71], v[100:103]
  ds_read_b64_tr_b16 a[106:107], v11 offset:18432
  v_mfma_f32_16x16x32_bf16 v[104:107], a[96:99], a[72:75], v[104:107]
  buffer_load_dwordx4 v17, s[8:11], s35 offen offset:0 lds
  v_mfma_f32_16x16x32_bf16 v[108:111], a[96:99], a[76:79], v[108:111]
  v_mfma_f32_16x16x32_bf16 v[112:115], a[96:99], a[80:83], v[112:115]
  v_mfma_f32_16x16x32_bf16 v[116:119], a[96:99], a[84:87], v[116:119]
  buffer_load_dwordx4 v18, s[8:11], s35 offen offset:1024 lds
  v_mfma_f32_16x16x32_bf16 v[120:123], a[96:99], a[88:91], v[120:123]
  v_mfma_f32_16x16x32_bf16 v[124:127], a[96:99], a[92:95], v[124:127]
  s_waitcnt lgkmcnt(4)
  v_mfma_f32_16x16x32_bf16 v[224:227], a[100:103], a[64:67], v[224:227]
  ds_read_b64_tr_b16 a[108:109], v12 offset:16384
  buffer_load_dwordx4 v19, s[8:11], s35 offen offset:2048 lds
  v_mfma_f32_16x16x32_bf16 v[228:231], a[100:103], a[68:71], v[228:231]
  ds_read_b64_tr_b16 a[110:111], v12 offset:18432
  v_mfma_f32_16x16x32_bf16 v[232:235], a[100:103], a[72:75], v[232:235]
  v_mfma_f32_16x16x32_bf16 v[236:239], a[100:103], a[76:79], v[236:239]
  buffer_load_dwordx4 v20, s[8:11], s35 offen offset:3072 lds
  v_mfma_f32_16x16x32_bf16 v[240:243], a[100:103], a[80:83], v[240:243]
  v_mfma_f32_16x16x32_bf16 v[244:247], a[100:103], a[84:87], v[244:247]
  s_add_u32 s35, s35, 0x40000
  v_mfma_f32_16x16x32_bf16 v[248:251], a[100:103], a[88:91], v[248:251]
  s_add_u32 m0, s33, 0
  v_mfma_f32_16x16x32_bf16 v[252:255], a[100:103], a[92:95], v[252:255]
  s_waitcnt lgkmcnt(2)
  v_mfma_f32_16x16x32_bf16 v[128:131], a[104:107], a[64:67], v[128:131]
  ds_read_b64_tr_b16 a[96:97], v5 offset:32768
  v_mfma_f32_16x16x32_bf16 v[132:135], a[104:107], a[68:71], v[132:135]
  ds_read_b64_tr_b16 a[98:99], v5 offset:34816
  buffer_load_dwordx4 v13, s[4:7], s56 offen offset:0 lds
  v_mfma_f32_16x16x32_bf16 v[136:139], a[104:107], a[72:75], v[136:139]
  v_mfma_f32_16x16x32_bf16 v[140:143], a[104:107], a[76:79], v[140:143]
  v_mfma_f32_16x16x32_bf16 v[144:147], a[104:107], a[80:83], v[144:147]
  buffer_load_dwordx4 v14, s[4:7], s56 offen offset:1024 lds
  v_mfma_f32_16x16x32_bf16 v[148:151], a[104:107], a[84:87], v[148:151]
  v_mfma_f32_16x16x32_bf16 v[152:155], a[104:107], a[88:91], v[152:155]
  v_mfma_f32_16x16x32_bf16 v[156:159], a[104:107], a[92:95], v[156:159]
  buffer_load_dwordx4 v15, s[4:7], s56 offen offset:2048 lds
  s_waitcnt lgkmcnt(2)
  v_mfma_f32_16x16x32_bf16 a[0:3], a[108:111], a[64:67], a[0:3]
  ds_read_b64_tr_b16 a[100:101], v6 offset:32768
  v_mfma_f32_16x16x32_bf16 a[4:7], a[108:111], a[68:71], a[4:7]
  ds_read_b64_tr_b16 a[102:103], v6 offset:34816
  v_mfma_f32_16x16x32_bf16 a[8:11], a[108:111], a[72:75], a[8:11]
  buffer_load_dwordx4 v16, s[4:7], s56 offen offset:3072 lds
  v_mfma_f32_16x16x32_bf16 a[12:15], a[108:111], a[76:79], a[12:15]
  v_mfma_f32_16x16x32_bf16 a[16:19], a[108:111], a[80:83], a[16:19]
  v_mfma_f32_16x16x32_bf16 a[20:23], a[108:111], a[84:87], a[20:23]
  v_mfma_f32_16x16x32_bf16 a[24:27], a[108:111], a[88:91], a[24:27]
  v_mfma_f32_16x16x32_bf16 a[28:31], a[108:111], a[92:95], a[28:31]
  s_waitcnt vmcnt(13)
  s_barrier
  v_add_u32 v4, s32, v3
  s_waitcnt lgkmcnt(2)
  v_mfma_f32_16x16x32_bf16 v[32:35], a[96:99], a[32:35], v[32:35]
  ds_read_b64_tr_b16 a[104:105], v7 offset:32768
  v_mfma_f32_16x16x32_bf16 v[36:39], a[96:99], a[36:39], v[36:39]
  ds_read_b64_tr_b16 a[106:107], v7 offset:34816
  v_mfma_f32_16x16x32_bf16 v[40:43], a[96:99], a[40:43], v[40:43]
  ds_read_b128 a[64:67], v4 offset:0
  v_mfma_f32_16x16x32_bf16 v[44:47], a[96:99], a[44:47], v[44:47]
  ds_read_b128 a[68:71], v4 offset:2048
  v_mfma_f32_16x16x32_bf16 v[48:51], a[96:99], a[48:51], v[48:51]
  v_mfma_f32_16x16x32_bf16 v[52:55], a[96:99], a[52:55], v[52:55]
  v_mfma_f32_16x16x32_bf16 v[56:59], a[96:99], a[56:59], v[56:59]
  v_mfma_f32_16x16x32_bf16 v[60:63], a[96:99], a[60:63], v[60:63]
  s_waitcnt lgkmcnt(4)
  v_mfma_f32_16x16x32_bf16 v[160:163], a[100:103], a[32:35], v[160:163]
  ds_read_b64_tr_b16 a[108:109], v8 offset:32768
  v_mfma_f32_16x16x32_bf16 v[164:167], a[100:103], a[36:39], v[164:167]
  ds_read_b64_tr_b16 a[110:111], v8 offset:34816
  v_mfma_f32_16x16x32_bf16 v[168:171], a[100:103], a[40:43], v[168:171]
  ds_read_b128 a[72:75], v4 offset:4096
  v_mfma_f32_16x16x32_bf16 v[172:175], a[100:103], a[44:47], v[172:175]
  ds_read_b128 a[76:79], v4 offset:6144
  v_mfma_f32_16x16x32_bf16 v[176:179], a[100:103], a[48:51], v[176:179]
  v_mfma_f32_16x16x32_bf16 v[180:183], a[100:103], a[52:55], v[180:183]
  v_mfma_f32_16x16x32_bf16 v[184:187], a[100:103], a[56:59], v[184:187]
  v_mfma_f32_16x16x32_bf16 v[188:191], a[100:103], a[60:63], v[188:191]
  s_waitcnt lgkmcnt(6)
  v_mfma_f32_16x16x32_bf16 v[64:67], a[104:107], a[32:35], v[64:67]
  ds_read_b64_tr_b16 a[96:97], v9 offset:32768
  v_mfma_f32_16x16x32_bf16 v[68:71], a[104:107], a[36:39], v[68:71]
  ds_read_b64_tr_b16 a[98:99], v9 offset:34816
  v_mfma_f32_16x16x32_bf16 v[72:75], a[104:107], a[40:43], v[72:75]
  ds_read_b128 a[80:83], v4 offset:8192
  v_mfma_f32_16x16x32_bf16 v[76:79], a[104:107], a[44:47], v[76:79]
  ds_read_b128 a[84:87], v4 offset:10240
  v_mfma_f32_16x16x32_bf16 v[80:83], a[104:107], a[48:51], v[80:83]
  v_mfma_f32_16x16x32_bf16 v[84:87], a[104:107], a[52:55], v[84:87]
  v_mfma_f32_16x16x32_bf16 v[88:91], a[104:107], a[56:59], v[88:91]
  v_mfma_f32_16x16x32_bf16 v[92:95], a[104:107], a[60:63], v[92:95]
  s_waitcnt lgkmcnt(6)
  v_mfma_f32_16x16x32_bf16 v[192:195], a[108:111], a[32:35], v[192:195]
  ds_read_b64_tr_b16 a[100:101], v10 offset:32768
  v_mfma_f32_16x16x32_bf16 v[196:199], a[108:111], a[36:39], v[196:199]
  ds_read_b64_tr_b16 a[102:103], v10 offset:34816
  v_mfma_f32_16x16x32_bf16 v[200:203], a[108:111], a[40:43], v[200:203]
  ds_read_b128 a[88:91], v4 offset:12288
  v_mfma_f32_16x16x32_bf16 v[204:207], a[108:111], a[44:47], v[204:207]
  ds_read_b128 a[92:95], v4 offset:14336
  v_mfma_f32_16x16x32_bf16 v[208:211], a[108:111], a[48:51], v[208:211]
  v_mfma_f32_16x16x32_bf16 v[212:215], a[108:111], a[52:55], v[212:215]
  v_mfma_f32_16x16x32_bf16 v[216:219], a[108:111], a[56:59], v[216:219]
  s_add_u32 m0, s48, 16384
  v_mfma_f32_16x16x32_bf16 v[220:223], a[108:111], a[60:63], v[220:223]
  s_waitcnt lgkmcnt(6)
  v_mfma_f32_16x16x32_bf16 v[96:99], a[96:99], a[32:35], v[96:99]
  ds_read_b64_tr_b16 a[104:105], v11 offset:32768
  v_mfma_f32_16x16x32_bf16 v[100:103], a[96:99], a[36:39], v[100:103]
  ds_read_b64_tr_b16 a[106:107], v11 offset:34816
  v_mfma_f32_16x16x32_bf16 v[104:107], a[96:99], a[40:43], v[104:107]
  buffer_load_dwordx4 v17, s[8:11], s35 offen offset:0 lds
  v_mfma_f32_16x16x32_bf16 v[108:111], a[96:99], a[44:47], v[108:111]
  v_mfma_f32_16x16x32_bf16 v[112:115], a[96:99], a[48:51], v[112:115]
  v_mfma_f32_16x16x32_bf16 v[116:119], a[96:99], a[52:55], v[116:119]
  buffer_load_dwordx4 v18, s[8:11], s35 offen offset:1024 lds
  v_mfma_f32_16x16x32_bf16 v[120:123], a[96:99], a[56:59], v[120:123]
  v_mfma_f32_16x16x32_bf16 v[124:127], a[96:99], a[60:63], v[124:127]
  s_waitcnt lgkmcnt(4)
  v_mfma_f32_16x16x32_bf16 v[224:227], a[100:103], a[32:35], v[224:227]
  ds_read_b64_tr_b16 a[108:109], v12 offset:32768
  buffer_load_dwordx4 v19, s[8:11], s35 offen offset:2048 lds
  v_mfma_f32_16x16x32_bf16 v[228:231], a[100:103], a[36:39], v[228:231]
  ds_read_b64_tr_b16 a[110:111], v12 offset:34816
  v_mfma_f32_16x16x32_bf16 v[232:235], a[100:103], a[40:43], v[232:235]
  v_mfma_f32_16x16x32_bf16 v[236:239], a[100:103], a[44:47], v[236:239]
  buffer_load_dwordx4 v20, s[8:11], s35 offen offset:3072 lds
  v_mfma_f32_16x16x32_bf16 v[240:243], a[100:103], a[48:51], v[240:243]
  v_mfma_f32_16x16x32_bf16 v[244:247], a[100:103], a[52:55], v[244:247]
  s_add_u32 s35, s35, 0x40000
  v_mfma_f32_16x16x32_bf16 v[248:251], a[100:103], a[56:59], v[248:251]
  s_add_u32 m0, s33, 4096
  v_mfma_f32_16x16x32_bf16 v[252:255], a[100:103], a[60:63], v[252:255]
  s_waitcnt lgkmcnt(2)
  v_mfma_f32_16x16x32_bf16 v[128:131], a[104:107], a[32:35], v[128:131]
  ds_read_b64_tr_b16 a[96:97], v5 offset:49152
  v_mfma_f32_16x16x32_bf16 v[132:135], a[104:107], a[36:39], v[132:135]
  ds_read_b64_tr_b16 a[98:99], v5 offset:51200
  buffer_load_dwordx4 v13, s[4:7], s57 offen offset:0 lds
  v_mfma_f32_16x16x32_bf16 v[136:139], a[104:107], a[40:43], v[136:139]
  v_mfma_f32_16x16x32_bf16 v[140:143], a[104:107], a[44:47], v[140:143]
  v_mfma_f32_16x16x32_bf16 v[144:147], a[104:107], a[48:51], v[144:147]
  buffer_load_dwordx4 v14, s[4:7], s57 offen offset:1024 lds
  v_mfma_f32_16x16x32_bf16 v[148:151], a[104:107], a[52:55], v[148:151]
  v_mfma_f32_16x16x32_bf16 v[152:155], a[104:107], a[56:59], v[152:155]
  v_mfma_f32_16x16x32_bf16 v[156:159], a[104:107], a[60:63], v[156:159]
  buffer_load_dwordx4 v15, s[4:7], s57 offen offset:2048 lds
  s_waitcnt lgkmcnt(2)
  v_mfma_f32_16x16x32_bf16 a[0:3], a[108:111], a[32:35], a[0:3]
  ds_read_b64_tr_b16 a[100:101], v6 offset:49152
  v_mfma_f32_16x16x32_bf16 a[4:7], a[108:111], a[36:39], a[4:7]
  ds_read_b64_tr_b16 a[102:103], v6 offset:51200
  v_mfma_f32_16x16x32_bf16 a[8:11], a[108:111], a[40:43], a[8:11]
  buffer_load_dwordx4 v16, s[4:7], s57 offen offset:3072 lds
  v_mfma_f32_16x16x32_bf16 a[12:15], a[108:111], a[44:47], a[12:15]
  v_mfma_f32_16x16x32_bf16 a[16:19], a[108:111], a[48:51], a[16:19]
  v_mfma_f32_16x16x32_bf16 a[20:23], a[108:111], a[52:55], a[20:23]
  v_mfma_f32_16x16x32_bf16 a[24:27], a[108:111], a[56:59], a[24:27]
  v_mfma_f32_16x16x32_bf16 a[28:31], a[108:111], a[60:63], a[28:31]
  s_waitcnt vmcnt(12)
  s_barrier
  s_add_u32 s33, s32, s49
  s_add_u32 s32, s32, 0x8000
  s_cmp_eq_u32 s32, 0x18000
  s_cselect_b32 s32, 0, s32
  s_add_u32 s34, s34, 128
  s_mov_b32 s56, s34
  s_add_u32 s57, s34, 0x10000
  v_add_u32 v4, s32, v2
  s_waitcnt lgkmcnt(2)
  v_mfma_f32_16x16x32_bf16 v[32:35], a[96:99], a[64:67], v[32:35]
  ds_read_b64_tr_b16 a[104:105], v7 offset:49152
  v_mfma_f32_16x16x32_bf16 v[36:39], a[96:99], a[68:71], v[36:39]
  ds_read_b64_tr_b16 a[106:107], v7 offset:51200
  v_mfma_f32_16x16x32_bf16 v[40:43], a[96:99], a[72:75], v[40:43]
  ds_read_b128 a[32:35], v4 offset:0
  v_mfma_f32_16x16x32_bf16 v[44:47], a[96:99], a[76:79], v[44:47]
  ds_read_b128 a[36:39], v4 offset:2048
  v_mfma_f32_16x16x32_bf16 v[48:51], a[96:99], a[80:83], v[48:51]
  v_mfma_f32_16x16x32_bf16 v[52:55], a[96:99], a[84:87], v[52:55]
  v_mfma_f32_16x16x32_bf16 v[56:59], a[96:99], a[88:91], v[56:59]
  v_mfma_f32_16x16x32_bf16 v[60:63], a[96:99], a[92:95], v[60:63]
  s_waitcnt lgkmcnt(4)
  v_mfma_f32_16x16x32_bf16 v[160:163], a[100:103], a[64:67], v[160:163]
  ds_read_b64_tr_b16 a[108:109], v8 offset:49152
  v_mfma_f32_16x16x32_bf16 v[164:167], a[100:103], a[68:71], v[164:167]
  ds_read_b64_tr_b16 a[110:111], v8 offset:51200
  v_mfma_f32_16x16x32_bf16 v[168:171], a[100:103], a[72:75], v[168:171]
  ds_read_b128 a[40:43], v4 offset:4096
  v_mfma_f32_16x16x32_bf16 v[172:175], a[100:103], a[76:79], v[172:175]
  ds_read_b128 a[44:47], v4 offset:6144
  v_mfma_f32_16x16x32_bf16 v[176:179], a[100:103], a[80:83], v[176:179]
  v_mfma_f32_16x16x32_bf16 v[180:183], a[100:103], a[84:87], v[180:183]
  v_mfma_f32_16x16x32_bf16 v[184:187], a[100:103], a[88:91], v[184:187]
  v_mfma_f32_16x16x32_bf16 v[188:191], a[100:103], a[92:95], v[188:191]
  s_waitcnt lgkmcnt(6)
  v_mfma_f32_16x16x32_bf16 v[64:67], a[104:107], a[64:67], v[64:67]
  ds_read_b64_tr_b16 a[96:97], v9 offset:49152
  v_mfma_f32_16x16x32_bf16 v[68:71], a[104:107], a[68:71], v[68:71]
  ds_read_b64_tr_b16 a[98:99], v9 offset:51200
  v_mfma_f32_16x16x32_bf16 v[72:75], a[104:107], a[72:75], v[72:75]
  ds_read_b128 a[48:51], v4 offset:8192
  v_mfma_f32_16x16x32_bf16 v[76:79], a[104:107], a[76:79], v[76:79]
  ds_read_b128 a[52:55], v4 offset:10240
  v_mfma_f32_16x16x32_bf16 v[80:83], a[104:107], a[80:83], v[80:83]
  v_mfma_f32_16x16x32_bf16 v[84:87], a[104:107], a[84:87], v[84:87]
  v_mfma_f32_16x16x32_bf16 v[88:91], a[104:107], a[88:91], v[88:91]
  v_mfma_f32_16x16x32_bf16 v[92:95], a[104:107], a[92:95], v[92:95]
  s_waitcnt lgkmcnt(6)
  v_mfma_f32_16x16x32_bf16 v[192:195], a[108:111], a[64:67], v[192:195]
  ds_read_b64_tr_b16 a[100:101], v10 offset:49152
  v_mfma_f32_16x16x32_bf16 v[196:199], a[108:111], a[68:71], v[196:199]
  ds_read_b64_tr_b16 a[102:103], v10 offset:51200
  v_mfma_f32_16x16x32_bf16 v[200:203], a[108:111], a[72:75], v[200:203]
  ds_read_b128 a[56:59], v4 offset:12288
  v_mfma_f32_16x16x32_bf16 v[204:207], a[108:111], a[76:79], v[204:207]
  ds_read_b128 a[60:63], v4 offset:14336
  v_mfma_f32_16x16x32_bf16 v[208:211], a[108:111], a[80:83], v[208:211]
  v_mfma_f32_16x16x32_bf16 v[212:215], a[108:111], a[84:87], v[212:215]
  v_mfma_f32_16x16x32_bf16 v[216:219], a[108:111], a[88:91], v[216:219]
  s_add_u32 m0, s48, 32768
  v_mfma_f32_16x16x32_bf16 v[220:223], a[108:111], a[92:95], v[220:223]
  s_waitcnt lgkmcnt(6)
  v_mfma_f32_16x16x32_bf16 v[96:99], a[96:99], a[64:67], v[96:99]
  ds_read_b64_tr_b16 a[104:105], v11 offset:49152
  v_mfma_f32_16x16x32_bf16 v[100:103], a[96:99], a[68:71], v[100:103]
  ds_read_b64_tr_b16 a[106:107], v11 offset:51200
  v_mfma_f32_16x16x32_bf16 v[104:107], a[96:99], a[72:75], v[104:107]
  buffer_load_dwordx4 v17, s[8:11], s35 offen offset:0 lds
  v_mfma_f32_16x16x32_bf16 v[108:111], a[96:99], a[76:79], v[108:111]
  v_mfma_f32_16x16x32_bf16 v[112:115], a[96:99], a[80:83], v[112:115]
  v_mfma_f32_16x16x32_bf16 v[116:119], a[96:99], a[84:87], v[116:119]
  buffer_load_dwordx4 v18, s[8:11], s35 offen offset:1024 lds
  v_mfma_f32_16x16x32_bf16 v[120:123], a[96:99], a[88:91], v[120:123]
  v_mfma_f32_16x16x32_bf16 v[124:127], a[96:99], a[92:95], v[124:127]
  s_waitcnt lgkmcnt(4)
  v_mfma_f32_16x16x32_bf16 v[224:227], a[100:103], a[64:67], v[224:227]
  ds_read_b64_tr_b16 a[108:109], v12 offset:49152
  buffer_load_dwordx4 v19, s[8:11], s35 offen offset:2048 lds
  v_mfma_f32_16x16x32_bf16 v[228:231], a[100:103], a[68:71], v[228:231]
  ds_read_b64_tr_b16 a[110:111], v12 offset:51200
  v_mfma_f32_16x16x32_bf16 v[232:235], a[100:103], a[72:75], v[232:235]
  v_mfma_f32_16x16x32_bf16 v[236:239], a[100:103], a[76:79], v[236:239]
  buffer_load_dwordx4 v20, s[8:11], s35 offen offset:3072 lds
  v_mfma_f32_16x16x32_bf16 v[240:243], a[100:103], a[80:83], v[240:243]
  v_mfma_f32_16x16x32_bf16 v[244:247], a[100:103], a[84:87], v[244:247]
  s_add_u32 s35, s35, 0x40000
  v_mfma_f32_16x16x32_bf16 v[248:251], a[100:103], a[88:91], v[248:251]
  s_add_u32 m0, s33, 0
  v_mfma_f32_16x16x32_bf16 v[252:255], a[100:103], a[92:95], v[252:255]
  s_waitcnt lgkmcnt(2)
  v_mfma_f32_16x16x32_bf16 v[128:131], a[104:107], a[64:67], v[128:131]
  ds_read_b64_tr_b16 a[96:97], v5 offset:0
  v_mfma_f32_16x16x32_bf16 v[132:135], a[104:107], a[68:71], v[132:135]
  ds_read_b64_tr_b16 a[98:99], v5 offset:2048
  buffer_load_dwordx4 v13, s[4:7], s56 offen offset:0 lds
  v_mfma_f32_16x16x32_bf16 v[136:139], a[104:107], a[72:75], v[136:139]
  v_mfma_f32_16x16x32_bf16 v[140:143], a[104:107], a[76:79], v[140:143]
  v_mfma_f32_16x16x32_bf16 v[144:147], a[104:107], a[80:83], v[144:147]
  buffer_load_dwordx4 v14, s[4:7], s56 offen offset:1024 lds
  v_mfma_f32_16x16x32_bf16 v[148:151], a[104:107], a[84:87], v[148:151]
  v_mfma_f32_16x16x32_bf16 v[152:155], a[104:107], a[88:91], v[152:155]
  v_mfma_f32_16x16x32_bf16 v[156:159], a[104:107], a[92:95], v[156:159]
  buffer_load_dwordx4 v15, s[4:7], s56 offen offset:2048 lds
  s_waitcnt lgkmcnt(2)
  v_mfma_f32_16x16x32_bf16 a[0:3], a[108:111], a[64:67], a[0:3]
  ds_read_b64_tr_b16 a[100:101], v6 offset:0
  v_mfma_f32_16x16x32_bf16 a[4:7], a[108:111], a[68:71], a[4:7]
  ds_read_b64_tr_b16 a[102:103], v6 offset:2048
  v_mfma_f32_16x16x32_bf16 a[8:11], a[108:111], a[72:75], a[8:11]
  buffer_load_dwordx4 v16, s[4:7], s56 offen offset:3072 lds
  v_mfma_f32_16x16x32_bf16 a[12:15], a[108:111], a[76:79], a[12:15]
  v_mfma_f32_16x16x32_bf16 a[16:19], a[108:111], a[80:83], a[16:19]
  v_mfma_f32_16x16x32_bf16 a[20:23], a[108:111], a[84:87], a[20:23]
  v_mfma_f32_16x16x32_bf16 a[24:27], a[108:111], a[88:91], a[24:27]
  v_mfma_f32_16x16x32_bf16 a[28:31], a[108:111], a[92:95], a[28:31]
  s_waitcnt vmcnt(12)
  s_barrier
  s_sub_u32 s50, s50, 1
  s_cmp_lg_u32 s50, 0
  s_cbranch_scc1 k1_K_loop
  s_mov_b32 s68, 0
k1_K_poll:
  v_and_b32 v24, v24, v25
  v_and_b32 v26, v26, v27
  v_and_b32 v24, v24, v26
  v_cmp_ne_u32 vcc, 0x01010101, v24
  s_add_u32 s68, s68, 1
  s_cbranch_vccz k1_K_ok
  s_cmp_lt_u32 s68, 0x40000
  s_cbranch_scc0 k1_K_ok
  s_sleep 4
  buffer_load_dwordx4 v[24:27], v23, s[36:39], 0 offen sc1
  s_waitcnt vmcnt(0)
  s_branch k1_K_poll
k1_K_ok:
  v_add_u32 v4, s32, v3
  s_waitcnt lgkmcnt(2)
  v_mfma_f32_16x16x32_bf16 v[32:35], a[96:99], a[32:35], v[32:35]
  ds_read_b64_tr_b16 a[104:105], v7 offset:0
  v_mfma_f32_16x16x32_bf16 v[36:39], a[96:99], a[36:39], v[36:39]
  ds_read_b64_tr_b16 a[106:107], v7 offset:2048
  v_mfma_f32_16x16x32_bf16 v[40:43], a[96:99], a[40:43], v[40:43]
  ds_read_b128 a[64:67], v4 offset:0
  v_mfma_f32_16x16x32_bf16 v[44:47], a[96:99], a[44:47], v[44:47]
  ds_read_b128 a[68:71], v4 offset:2048
  s_add_u32 m0, s48, 49152
  v_mfma_f32_16x16x32_bf16 v[48:51], a[96:99], a[48:51], v[48:51]
  buffer_load_dwordx4 v17, s[8:11], s35 offen offset:0 lds
  v_mfma_f32_16x16x32_bf16 v[52:55], a[96:99], a[52:55], v[52:55]
  buffer_load_dwordx4 v18, s[8:11], s35 offen offset:1024 lds
  v_mfma_f32_16x16x32_bf16 v[56:59], a[96:99], a[56:59], v[56:59]
  buffer_load_dwordx4 v19, s[8:11], s35 offen offset:2048 lds
  v_mfma_f32_16x16x32_bf16 v[60:63], a[96:99], a[60:63], v[60:63]
  buffer_load_dwordx4 v20, s[8:11], s35 offen offset:3072 lds
  s_waitcnt lgkmcnt(4)
  v_mfma_f32_16x16x32_bf16 v[160:163], a[100:103], a[32:35], v[160:163]
  ds_read_b64_tr_b16 a[108:109], v8 offset:0
  s_mov_b32 s59, 0
  v_mfma_f32_16x16x32_bf16 v[164:167], a[100:103], a[36:39], v[164:167]
  ds_read_b64_tr_b16 a[110:111], v8 offset:2048
  buffer_load_dwordx4 a[112:115], v30, s[16:19], s59 offen offset:0 sc1
  v_mfma_f32_16x16x32_bf16 v[168:171], a[100:103], a[40:43], v[168:171]
  ds_read_b128 a[72:75], v4 offset:4096
  s_mov_b32 s59, 0
  v_mfma_f32_16x16x32_bf16 v[172:175], a[100:103], a[44:47], v[172:175]
  ds_read_b128 a[76:79], v4 offset:6144
  buffer_load_dwordx4 a[168:171], v31, s[16:19], s59 offen offset:0 sc1
  v_mfma_f32_16x16x32_bf16 v[176:179], a[100:103], a[48:51], v[176:179]
  s_mov_b32 s59, 0
  v_mfma_f32_16x16x32_bf16 v[180:183], a[100:103], a[52:55], v[180:183]
  buffer_load_dwordx4 a[116:119], v30, s[16:19], s59 offen offset:1024 sc1
  v_mfma_f32_16x16x32_bf16 v[184:187], a[100:103], a[56:59], v[184:187]
  s_mov_b32 s59, 0
  v_mfma_f32_16x16x32_bf16 v[188:191], a[100:103], a[60:63], v[188:191]
  buffer_load_dwordx4 a[172:175], v31, s[16:19], s59 offen offset:1024 sc1
  s_waitcnt lgkmcnt(6)
  v_mfma_f32_16x16x32_bf16 v[64:67], a[104:107], a[32:35], v[64:67]
  ds_read_b64_tr_b16 a[96:97], v9 offset:0
  s_mov_b32 s59, 0
  v_mfma_f32_16x16x32_bf16 v[68:71], a[104:107], a[36:39], v[68:71]
  ds_read_b64_tr_b16 a[98:99], v9 offset:2048
  buffer_load_dwordx4 a[120:123], v30, s[16:19], s59 offen offset:2048 sc1
  v_mfma_f32_16x16x32_bf16 v[72:75], a[104:107], a[40:43], v[72:75]
  ds_read_b128 a[80:83], v4 offset:8192
  s_mov_b32 s59, 0
  v_mfma_f32_16x16x32_bf16 v[76:79], a[104:107], a[44:47], v[76:79]
  ds_read_b128 a[84:87], v4 offset:10240
  buffer_load_dwordx4 a[176:179], v31, s[16:19], s59 offen offset:2048 sc1
  v_mfma_f32_16x16x32_bf16 v[80:83], a[104:107], a[48:51], v[80:83]
  v_mfma_f32_16x16x32_bf16 v[84:87], a[104:107], a[52:55], v[84:87]
  v_mfma_f32_16x16x32_bf16 v[88:91], a[104:107], a[56:59], v[88:91]
  v_mfma_f32_16x16x32_bf16 v[92:95], a[104:107], a[60:63], v[92:95]
  s_waitcnt lgkmcnt(6)
  v_mfma_f32_16x16x32_bf16 v[192:195], a[108:111], a[32:35], v[192:195]
  ds_read_b64_tr_b16 a[100:101], v10 offset:0
  v_mfma_f32_16x16x32_bf16 v[196:199], a[108:111], a[36:39], v[196:199]
  ds_read_b64_tr_b16 a[102:103], v10 offset:2048
  v_mfma_f32_16x16x32_bf16 v[200:203], a[108:111], a[40:43], v[200:203]
  ds_read_b128 a[88:91], v4 offset:12288
  v_mfma_f32_16x16x32_bf16 v[204:207], a[108:111], a[44:47], v[204:207]
  ds_read_b128 a[92:95], v4 offset:14336
  v_mfma_f32_16x16x32_bf16 v[208:211], a[108:111], a[48:51], v[208:211]
  v_mfma_f32_16x16x32_bf16 v[212:215], a[108:111], a[52:55], v[212:215]
  v_mfma_f32_16x16x32_bf16 v[216:219], a[108:111], a[56:59], v[216:219]
  v_mfma_f32_16x16x32_bf16 v[220:223], a[108:111], a[60:63], v[220:223]
  s_waitcnt lgkmcnt(6)
  v_mfma_f32_16x16x32_bf16 v[96:99], a[96:99], a[32:35], v[96:99]
  ds_read_b64_tr_b16 a[104:105], v11 offset:0
  v_mfma_f32_16x16x32_bf16 v[100:103], a[96:99], a[36:39], v[100:103]
  ds_read_b64_tr_b16 a[106:107], v11 offset:2048
  v_mfma_f32_16x16x32_bf16 v[104:107], a[96:99], a[40:43], v[104:107]
  v_mfma_f32_16x16x32_bf16 v[108:111], a[96:99], a[44:47], v[108:111]
  v_mfma_f32_16x16x32_bf16 v[112:115], a[96:99], a[48:51], v[112:115]
  v_mfma_f32_16x16x32_bf16 v[116:119], a[96:99], a[52:55], v[116:119]
  v_mfma_f32_16x16x32_bf16 v[120:123], a[96:99], a[56:59], v[120:123]
  v_mfma_f32_16x16x32_bf16 v[124:127], a[96:99], a[60:63], v[124:127]
  s_waitcnt lgkmcnt(4)
  v_mfma_f32_16x16x32_bf16 v[224:227], a[100:103], a[32:35], v[224:227]
  ds_read_b64_tr_b16 a[108:109], v12 offset:0
  v_mfma_f32_16x16x32_bf16 v[228:231], a[100:103], a[36:39], v[228:231]
  ds_read_b64_tr_b16 a[110:111], v12 offset:2048
  v_mfma_f32_16x16x32_bf16 v[232:235], a[100:103], a[40:43], v[232:235]
  v_mfma_f32_16x16x32_bf16 v[236:239], a[100:103], a[44:47], v[236:239]
  v_mfma_f32_16x16x32_bf16 v[240:243], a[100:103], a[48:51], v[240:243]
  v_mfma_f32_16x16x32_bf16 v[244:247], a[100:103], a[52:55], v[244:247]
  v_mfma_f32_16x16x32_bf16 v[248:251], a[100:103], a[56:59], v[248:251]
  v_mfma_f32_16x16x32_bf16 v[252:255], a[100:103], a[60:63], v[252:255]
  s_waitcnt lgkmcnt(2)
  v_mfma_f32_16x16x32_bf16 v[128:131], a[104:107], a[32:35], v[128:131]
  ds_read_b64_tr_b16 a[96:97], v5 offset:16384
  v_mfma_f32_16x16x32_bf16 v[132:135], a[104:107], a[36:39], v[132:135]
  ds_read_b64_tr_b16 a[98:99], v5 offset:18432
  v_mfma_f32_16x16x32_bf16 v[136:139], a[104:107], a[40:43], v[136:139]
  v_mfma_f32_16x16x32_bf16 v[140:143], a[104:107], a[44:47], v[140:143]
  v_mfma_f32_16x16x32_bf16 v[144:147], a[104:107], a[48:51], v[144:147]
  v_mfma_f32_16x16x32_bf16 v[148:151], a[104:107], a[52:55], v[148:151]
  v_mfma_f32_16x16x32_bf16 v[152:155], a[104:107], a[56:59], v[152:155]
  v_mfma_f32_16x16x32_bf16 v[156:159], a[104:107], a[60:63], v[156:159]
  s_waitcnt lgkmcnt(2)
  v_mfma_f32_16x16x32_bf16 a[0:3], a[108:111], a[32:35], a[0:3]
  ds_read_b64_tr_b16 a[100:101], v6 offset:16384
  v_mfma_f32_16x16x32_bf16 a[4:7], a[108:111], a[36:39], a[4:7]
  ds_read_b64_tr_b16 a[102:103], v6 offset:18432
  v_mfma_f32_16x16x32_bf16 a[8:11], a[108:111], a[40:43], a[8:11]
  v_mfma_f32_16x16x32_bf16 a[12:15], a[108:111], a[44:47], a[12:15]
  v_mfma_f32_16x16x32_bf16 a[16:19], a[108:111], a[48:51], a[16:19]
  v_mfma_f32_16x16x32_bf16 a[20:23], a[108:111], a[52:55], a[20:23]
  v_mfma_f32_16x16x32_bf16 a[24:27], a[108:111], a[56:59], a[24:27]
  v_mfma_f32_16x16x32_bf16 a[28:31], a[108:111], a[60:63], a[28:31]
  s_waitcnt vmcnt(10)
  s_barrier
  s_add_u32 s33, s32, s49
  s_add_u32 s32, s32, 0x8000
  s_cmp_eq_u32 s32, 0x18000
  s_cselect_b32 s32, 0, s32
  s_add_u32 s34, s34, 128
  s_mov_b32 s56, s34
  s_add_u32 s57, s34, 0x10000
  v_add_u32 v4, s32, v2
  s_waitcnt lgkmcnt(2)
  v_mfma_f32_16x16x32_bf16 v[32:35], a[96:99], a[64:67], v[32:35]
  ds_read_b64_tr_b16 a[104:105], v7 offset:16384
  v_mfma_f32_16x16x32_bf16 v[36:39], a[96:99], a[68:71], v[36:39]
  ds_read_b64_tr_b16 a[106:107], v7 offset:18432
  v_mfma_f32_16x16x32_bf16 v[40:43], a[96:99], a[72:75], v[40:43]
  ds_read_b128 a[32:35], v4 offset:0
  v_mfma_f32_16x16x32_bf16 v[44:47], a[96:99], a[76:79], v[44:47]
  ds_read_b128 a[36:39], v4 offset:2048
  s_add_u32 m0, s58, 32768
  v_mfma_f32_16x16x32_bf16 v[48:51], a[96:99], a[80:83], v[48:51]
  s_mov_b32 s59, 0
  v_mfma_f32_16x16x32_bf16 v[52:55], a[96:99], a[84:87], v[52:55]
  buffer_load_dwordx4 v17, s[12:15], s59 offen offset:0 lds
  v_mfma_f32_16x16x32_bf16 v[56:59], a[96:99], a[88:91], v[56:59]
  buffer_load_dwordx4 v18, s[12:15], s59 offen offset:1024 lds
  v_mfma_f32_16x16x32_bf16 v[60:63], a[96:99], a[92:95], v[60:63]
  buffer_load_dwordx4 v19, s[12:15], s59 offen offset:2048 lds
  s_waitcnt lgkmcnt(4)
  v_mfma_f32_16x16x32_bf16 v[160:163], a[100:103], a[64:67], v[160:163]
  ds_read_b64_tr_b16 a[108:109], v8 offset:16384
  buffer_load_dwordx4 v20, s[12:15], s59 offen offset:3072 lds
  v_mfma_f32_16x16x32_bf16 v[164:167], a[100:103], a[68:71], v[164:167]
  ds_read_b64_tr_b16 a[110:111], v8 offset:18432
  s_add_u32 m0, s58, 49152
  v_mfma_f32_16x16x32_bf16 v[168:171], a[100:103], a[72:75], v[168:171]
  ds_read_b128 a[40:43], v4 offset:4096
  s_mov_b32 s59, 262144
  v_mfma_f32_16x16x32_bf16 v[172:175], a[100:103], a[76:79], v[172:175]
  ds_read_b128 a[44:47], v4 offset:6144
  buffer_load_dwordx4 v17, s[12:15], s59 offen offset:0 lds
  v_mfma_f32_16x16x32_bf16 v[176:179], a[100:103], a[80:83], v[176:179]
  buffer_load_dwordx4 v18, s[12:15], s59 offen offset:1024 lds
  v_mfma_f32_16x16x32_bf16 v[180:183], a[100:103], a[84:87], v[180:183]
  buffer_load_dwordx4 v19, s[12:15], s59 offen offset:2048 lds
  v_mfma_f32_16x16x32_bf16 v[184:187], a[100:103], a[88:91], v[184:187]
  buffer_load_dwordx4 v20, s[12:15], s59 offen offset:3072 lds
  v_mfma_f32_16x16x32_bf16 v[188:191], a[100:103], a[92:95], v[188:191]
  s_mov_b32 s59, 0
  s_waitcnt lgkmcnt(6)
  v_mfma_f32_16x16x32_bf16 v[64:67], a[104:107], a[64:67], v[64:67]
  ds_read_b64_tr_b16 a[96:97], v9 offset:16384
  buffer_load_dwordx4 a[124:127], v30, s[16:19], s59 offen offset:3072 sc1
  v_mfma_f32_16x16x32_bf16 v[68:71], a[104:107], a[68:71], v[68:71]
  ds_read_b64_tr_b16 a[98:99], v9 offset:18432
  s_mov_b32 s59, 0
  v_mfma_f32_16x16x32_bf16 v[72:75], a[104:107], a[72:75], v[72:75]
  ds_read_b128 a[48:51], v4 offset:8192
  buffer_load_dwordx4 a[180:183], v31, s[16:19], s59 offen offset:3072 sc1
  v_mfma_f32_16x16x32_bf16 v[76:79], a[104:107], a[76:79], v[76:79]
  ds_read_b128 a[52:55], v4 offset:10240
  s_add_u32 m0, s58, 65536
  v_mfma_f32_16x16x32_bf16 v[80:83], a[104:107], a[80:83], v[80:83]
  s_mov_b32 s59, 524288
  v_mfma_f32_16x16x32_bf16 v[84:87], a[104:107], a[84:87], v[84:87]
  buffer_load_dwordx4 v17, s[12:15], s59 offen offset:0 lds
  v_mfma_f32_16x16x32_bf16 v[88:91], a[104:107], a[88:91], v[88:91]
  buffer_load_dwordx4 v18, s[12:15], s59 offen offset:1024 lds
  v_mfma_f32_16x16x32_bf16 v[92:95], a[104:107], a[92:95], v[92:95]
  buffer_load_dwordx4 v19, s[12:15], s59 offen offset:2048 lds
  s_waitcnt lgkmcnt(6)
  v_mfma_f32_16x16x32_bf16 v[192:195], a[108:111], a[64:67], v[192:195]
  ds_read_b64_tr_b16 a[100:101], v10 offset:16384
  buffer_load_dwordx4 v20, s[12:15], s59 offen offset:3072 lds
  v_mfma_f32_16x16x32_bf16 v[196:199], a[108:111], a[68:71], v[196:199]
  ds_read_b64_tr_b16 a[102:103], v10 offset:18432
  v_mfma_f32_16x16x32_bf16 v[200:203], a[108:111], a[72:75], v[200:203]
  ds_read_b128 a[56:59], v4 offset:12288
  v_mfma_f32_16x16x32_bf16 v[204:207], a[108:111], a[76:79], v[204:207]
  ds_read_b128 a[60:63], v4 offset:14336
  v_mfma_f32_16x16x32_bf16 v[208:211], a[108:111], a[80:83], v[208:211]
  v_mfma_f32_16x16x32_bf16 v[212:215], a[108:111], a[84:87], v[212:215]
  v_mfma_f32_16x16x32_bf16 v[216:219], a[108:111], a[88:91], v[216:219]
  v_mfma_f32_16x16x32_bf16 v[220:223], a[108:111], a[92:95], v[220:223]
  s_waitcnt lgkmcnt(6)
  v_mfma_f32_16x16x32_bf16 v[96:99], a[96:99], a[64:67], v[96:99]
  ds_read_b64_tr_b16 a[104:105], v11 offset:16384
  v_mfma_f32_16x16x32_bf16 v[100:103], a[96:99], a[68:71], v[100:103]
  ds_read_b64_tr_b16 a[106:107], v11 offset:18432
  v_mfma_f32_16x16x32_bf16 v[104:107], a[96:99], a[72:75], v[104:107]
  v_mfma_f32_16x16x32_bf16 v[108:111], a[96:99], a[76:79], v[108:111]
  v_mfma_f32_16x16x32_bf16 v[112:115], a[96:99], a[80:83], v[112:115]
  v_mfma_f32_16x16x32_bf16 v[116:119], a[96:99], a[84:87], v[116:119]
  v_mfma_f32_16x16x32_bf16 v[120:123], a[96:99], a[88:91], v[120:123]
  v_mfma_f32_16x16x32_bf16 v[124:127], a[96:99], a[92:95], v[124:127]
  s_waitcnt lgkmcnt(4)
  v_mfma_f32_16x16x32_bf16 v[224:227], a[100:103], a[64:67], v[224:227]
  ds_read_b64_tr_b16 a[108:109], v12 offset:16384
  v_mfma_f32_16x16x32_bf16 v[228:231], a[100:103], a[68:71], v[228:231]
  ds_read_b64_tr_b16 a[110:111], v12 offset:18432
  v_mfma_f32_16x16x32_bf16 v[232:235], a[100:103], a[72:75], v[232:235]
  v_mfma_f32_16x16x32_bf16 v[236:239], a[100:103], a[76:79], v[236:239]
  v_mfma_f32_16x16x32_bf16 v[240:243], a[100:103], a[80:83], v[240:243]
  v_mfma_f32_16x16x32_bf16 v[244:247], a[100:103], a[84:87], v[244:247]
  v_mfma_f32_16x16x32_bf16 v[248:251], a[100:103], a[88:91], v[248:251]
  v_mfma_f32_16x16x32_bf16 v[252:255], a[100:103], a[92:95], v[252:255]
  s_waitcnt lgkmcnt(2)
  v_mfma_f32_16x16x32_bf16 v[128:131], a[104:107], a[64:67], v[128:131]
  ds_read_b64_tr_b16 a[96:97], v5 offset:32768
  v_mfma_f32_16x16x32_bf16 v[132:135], a[104:107], a[68:71], v[132:135]
  ds_read_b64_tr_b16 a[98:99], v5 offset:34816
  v_mfma_f32_16x16x32_bf16 v[136:139], a[104:107], a[72:75], v[136:139]
  v_mfma_f32_16x16x32_bf16 v[140:143], a[104:107], a[76:79], v[140:143]
  v_mfma_f32_16x16x32_bf16 v[144:147], a[104:107], a[80:83], v[144:147]
  v_mfma_f32_16x16x32_bf16 v[148:151], a[104:107], a[84:87], v[148:151]
  v_mfma_f32_16x16x32_bf16 v[152:155], a[104:107], a[88:91], v[152:155]
  v_mfma_f32_16x16x32_bf16 v[156:159], a[104:107], a[92:95], v[156:159]
  s_waitcnt lgkmcnt(2)
  v_mfma_f32_16x16x32_bf16 a[0:3], a[108:111], a[64:67], a[0:3]
  ds_read_b64_tr_b16 a[100:101], v6 offset:32768
  v_mfma_f32_16x16x32_bf16 a[4:7], a[108:111], a[68:71], a[4:7]
  ds_read_b64_tr_b16 a[102:103], v6 offset:34816
  v_mfma_f32_16x16x32_bf16 a[8:11], a[108:111], a[72:75], a[8:11]
  v_mfma_f32_16x16x32_bf16 a[12:15], a[108:111], a[76:79], a[12:15]
  v_mfma_f32_16x16x32_bf16 a[16:19], a[108:111], a[80:83], a[16:19]
  v_mfma_f32_16x16x32_bf16 a[20:23], a[108:111], a[84:87], a[20:23]
  v_mfma_f32_16x16x32_bf16 a[24:27], a[108:111], a[88:91], a[24:27]
  v_mfma_f32_16x16x32_bf16 a[28:31], a[108:111], a[92:95], a[28:31]
  s_waitcnt vmcnt(20)
  s_barrier
  v_add_u32 v4, s32, v3
  s_waitcnt lgkmcnt(2)
  v_mfma_f32_16x16x32_bf16 v[32:35], a[96:99], a[32:35], v[32:35]
  ds_read_b64_tr_b16 a[104:105], v7 offset:32768
  v_mfma_f32_16x16x32_bf16 v[36:39], a[96:99], a[36:39], v[36:39]
  ds_read_b64_tr_b16 a[106:107], v7 offset:34816
  v_mfma_f32_16x16x32_bf16 v[40:43], a[96:99], a[40:43], v[40:43]
  ds_read_b128 a[64:67], v4 offset:0
  v_mfma_f32_16x16x32_bf16 v[44:47], a[96:99], a[44:47], v[44:47]
  ds_read_b128 a[68:71], v4 offset:2048
  s_add_u32 m0, s58, 81920
  v_mfma_f32_16x16x32_bf16 v[48:51], a[96:99], a[48:51], v[48:51]
  s_mov_b32 s59, 786432
  v_mfma_f32_16x16x32_bf16 v[52:55], a[96:99], a[52:55], v[52:55]
  buffer_load_dwordx4 v17, s[12:15], s59 offen offset:0 lds
  v_mfma_f32_16x16x32_bf16 v[56:59], a[96:99], a[56:59], v[56:59]
  buffer_load_dwordx4 v18, s[12:15], s59 offen offset:1024 lds
  v_mfma_f32_16x16x32_bf16 v[60:63], a[96:99], a[60:63], v[60:63]
  buffer_load_dwordx4 v19, s[12:15], s59 offen offset:2048 lds
  s_waitcnt lgkmcnt(4)
  v_mfma_f32_16x16x32_bf16 v[160:163], a[100:103], a[32:35], v[160:163]
  ds_read_b64_tr_b16 a[108:109], v8 offset:32768
  buffer_load_dwordx4 v20, s[12:15], s59 offen offset:3072 lds
  v_mfma_f32_16x16x32_bf16 v[164:167], a[100:103], a[36:39], v[164:167]
  ds_read_b64_tr_b16 a[110:111], v8 offset:34816
  s_mov_b32 s59, 4096
  v_mfma_f32_16x16x32_bf16 v[168:171], a[100:103], a[40:43], v[168:171]
  ds_read_b128 a[72:75], v4 offset:4096
  buffer_load_dwordx4 a[128:131], v30, s[16:19], s59 offen offset:0 sc1
  v_mfma_f32_16x16x32_bf16 v[172:175], a[100:103], a[44:47], v[172:175]
  ds_read_b128 a[76:79], v4 offset:6144
  s_mov_b32 s59, 4096
  v_mfma_f32_16x16x32_bf16 v[176:179], a[100:103], a[48:51], v[176:179]
  buffer_load_dwordx4 a[184:187], v31, s[16:19], s59 offen offset:0 sc1
  v_mfma_f32_16x16x32_bf16 v[180:183], a[100:103], a[52:55], v[180:183]
  s_mov_b32 s59, 4096
  v_mfma_f32_16x16x32_bf16 v[184:187], a[100:103], a[56:59], v[184:187]
  buffer_load_dwordx4 a[132:135], v30, s[16:19], s59 offen offset:1024 sc1
  v_mfma_f32_16x16x32_bf16 v[188:191], a[100:103], a[60:63], v[188:191]
  s_add_u32 m0, s58, 98304
  s_waitcnt lgkmcnt(6)
  v_mfma_f32_16x16x32_bf16 v[64:67], a[104:107], a[32:35], v[64:67]
  ds_read_b64_tr_b16 a[96:97], v9 offset:32768
  s_mov_b32 s59, 1048576
  v_mfma_f32_16x16x32_bf16 v[68:71], a[104:107], a[36:39], v[68:71]
  ds_read_b64_tr_b16 a[98:99], v9 offset:34816
  buffer_load_dwordx4 v17, s[12:15], s59 offen offset:0 lds
  v_mfma_f32_16x16x32_bf16 v[72:75], a[104:107], a[40:43], v[72:75]
  ds_read_b128 a[80:83], v4 offset:8192
  buffer_load_dwordx4 v18, s[12:15], s59 offen offset:1024 lds
  v_mfma_f32_16x16x32_bf16 v[76:79], a[104:107], a[44:47], v[76:79]
  ds_read_b128 a[84:87], v4 offset:10240
  buffer_load_dwordx4 v19, s[12:15], s59 offen offset:2048 lds
  v_mfma_f32_16x16x32_bf16 v[80:83], a[104:107], a[48:51], v[80:83]
  buffer_load_dwordx4 v20, s[12:15], s59 offen offset:3072 lds
  v_mfma_f32_16x16x32_bf16 v[84:87], a[104:107], a[52:55], v[84:87]
  s_add_u32 m0, s58, 114688
  v_mfma_f32_16x16x32_bf16 v[88:91], a[104:107], a[56:59], v[88:91]
  s_mov_b32 s59, 1310720
  v_mfma_f32_16x16x32_bf16 v[92:95], a[104:107], a[60:63], v[92:95]
  buffer_load_dwordx4 v17, s[12:15], s59 offen offset:0 lds
  s_waitcnt lgkmcnt(6)
  v_mfma_f32_16x16x32_bf16 v[192:195], a[108:111], a[32:35], v[192:195]
  ds_read_b64_tr_b16 a[100:101], v10 offset:32768
  buffer_load_dwordx4 v18, s[12:15], s59 offen offset:1024 lds
  v_mfma_f32_16x16x32_bf16 v[196:199], a[108:111], a[36:39], v[196:199]
  ds_read_b64_tr_b16 a[102:103], v10 offset:34816
  buffer_load_dwordx4 v19, s[12:15], s59 offen offset:2048 lds
  v_mfma_f32_16x16x32_bf16 v[200:203], a[108:111], a[40:43], v[200:203]
  ds_read_b128 a[88:91], v4 offset:12288
  buffer_load_dwordx4 v20, s[12:15], s59 offen offset:3072 lds
  v_mfma_f32_16x16x32_bf16 v[204:207], a[108:111], a[44:47], v[204:207]
  ds_read_b128 a[92:95], v4 offset:14336
  v_mfma_f32_16x16x32_bf16 v[208:211], a[108:111], a[48:51], v[208:211]
  v_mfma_f32_16x16x32_bf16 v[212:215], a[108:111], a[52:55], v[212:215]
  v_mfma_f32_16x16x32_bf16 v[216:219], a[108:111], a[56:59], v[216:219]
  v_mfma_f32_16x16x32_bf16 v[220:223], a[108:111], a[60:63], v[220:223]
  s_waitcnt lgkmcnt(6)
  v_mfma_f32_16x16x32_bf16 v[96:99], a[96:99], a[32:35], v[96:99]
  ds_read_b64_tr_b16 a[104:105], v11 offset:32768
  v_mfma_f32_16x16x32_bf16 v[100:103], a[96:99], a[36:39], v[100:103]
  ds_read_b64_tr_b16 a[106:107], v11 offset:34816
  v_mfma_f32_16x16x32_bf16 v[104:107], a[96:99], a[40:43], v[104:107]
  v_mfma_f32_16x16x32_bf16 v[108:111], a[96:99], a[44:47], v[108:111]
  v_mfma_f32_16x16x32_bf16 v[112:115], a[96:99], a[48:51], v[112:115]
  v_mfma_f32_16x16x32_bf16 v[116:119], a[96:99], a[52:55], v[116:119]
  v_mfma_f32_16x16x32_bf16 v[120:123], a[96:99], a[56:59], v[120:123]
  v_mfma_f32_16x16x32_bf16 v[124:127], a[96:99], a[60:63], v[124:127]
  s_waitcnt lgkmcnt(4)
  v_mfma_f32_16x16x32_bf16 v[224:227], a[100:103], a[32:35], v[224:227]
  ds_read_b64_tr_b16 a[108:109], v12 offset:32768
  v_mfma_f32_16x16x32_bf16 v[228:231], a[100:103], a[36:39], v[228:231]
  ds_read_b64_tr_b16 a[110:111], v12 offset:34816
  v_mfma_f32_16x16x32_bf16 v[232:235], a[100:103], a[40:43], v[232:235]
  v_mfma_f32_16x16x32_bf16 v[236:239], a[100:103], a[44:47], v[236:239]
  v_mfma_f32_16x16x32_bf16 v[240:243], a[100:103], a[48:51], v[240:243]
  v_mfma_f32_16x16x32_bf16 v[244:247], a[100:103], a[52:55], v[244:247]
  v_mfma_f32_16x16x32_bf16 v[248:251], a[100:103], a[56:59], v[248:251]
  v_mfma_f32_16x16x32_bf16 v[252:255], a[100:103], a[60:63], v[252:255]
  s_waitcnt lgkmcnt(2)
  v_mfma_f32_16x16x32_bf16 v[128:131], a[104:107], a[32:35], v[128:131]
  ds_read_b64_tr_b16 a[96:97], v5 offset:49152
  v_mfma_f32_16x16x32_bf16 v[132:135], a[104:107], a[36:39], v[132:135]
  ds_read_b64_tr_b16 a[98:99], v5 offset:51200
  v_mfma_f32_16x16x32_bf16 v[136:139], a[104:107], a[40:43], v[136:139]
  v_mfma_f32_16x16x32_bf16 v[140:143], a[104:107], a[44:47], v[140:143]
  v_mfma_f32_16x16x32_bf16 v[144:147], a[104:107], a[48:51], v[144:147]
  v_mfma_f32_16x16x32_bf16 v[148:151], a[104:107], a[52:55], v[148:151]
  v_mfma_f32_16x16x32_bf16 v[152:155], a[104:107], a[56:59], v[152:155]
  v_mfma_f32_16x16x32_bf16 v[156:159], a[104:107], a[60:63], v[156:159]
  s_waitcnt lgkmcnt(2)
  v_mfma_f32_16x16x32_bf16 a[0:3], a[108:111], a[32:35], a[0:3]
  ds_read_b64_tr_b16 a[100:101], v6 offset:49152
  v_mfma_f32_16x16x32_bf16 a[4:7], a[108:111], a[36:39], a[4:7]
  ds_read_b64_tr_b16 a[102:103], v6 offset:51200
  v_mfma_f32_16x16x32_bf16 a[8:11], a[108:111], a[40:43], a[8:11]
  v_mfma_f32_16x16x32_bf16 a[12:15], a[108:111], a[44:47], a[12:15]
  v_mfma_f32_16x16x32_bf16 a[16:19], a[108:111], a[48:51], a[16:19]
  v_mfma_f32_16x16x32_bf16 a[20:23], a[108:111], a[52:55], a[20:23]
  v_mfma_f32_16x16x32_bf16 a[24:27], a[108:111], a[56:59], a[24:27]
  v_mfma_f32_16x16x32_bf16 a[28:31], a[108:111], a[60:63], a[28:31]
  s_waitcnt vmcnt(29)
  s_barrier
  s_add_u32 s33, s32, s49
  s_add_u32 s32, s32, 0x8000
  s_cmp_eq_u32 s32, 0x18000
  s_cselect_b32 s32, 0, s32
  s_add_u32 s34, s34, 128
  s_mov_b32 s56, s34
  s_add_u32 s57, s34, 0x10000
  s_waitcnt lgkmcnt(2)
  v_mfma_f32_16x16x32_bf16 v[32:35], a[96:99], a[64:67], v[32:35]
  ds_read_b64_tr_b16 a[104:105], v7 offset:49152
  v_mfma_f32_16x16x32_bf16 v[36:39], a[96:99], a[68:71], v[36:39]
  ds_read_b64_tr_b16 a[106:107], v7 offset:51200
  v_mfma_f32_16x16x32_bf16 v[40:43], a[96:99], a[72:75], v[40:43]
  v_mfma_f32_16x16x32_bf16 v[44:47], a[96:99], a[76:79], v[44:47]
  s_add_u32 m0, s58, 131072
  v_mfma_f32_16x16x32_bf16 v[48:51], a[96:99], a[80:83], v[48:51]
  s_mov_b32 s59, 1572864
  v_mfma_f32_16x16x32_bf16 v[52:55], a[96:99], a[84:87], v[52:55]
  buffer_load_dwordx4 v17, s[12:15], s59 offen offset:0 lds
  v_mfma_f32_16x16x32_bf16 v[56:59], a[96:99], a[88:91], v[56:59]
  buffer_load_dwordx4 v18, s[12:15], s59 offen offset:1024 lds
  v_mfma_f32_16x16x32_bf16 v[60:63], a[96:99], a[92:95], v[60:63]
  buffer_load_dwordx4 v19, s[12:15], s59 offen offset:2048 lds
  s_waitcnt lgkmcnt(2)
  v_mfma_f32_16x16x32_bf16 v[160:163], a[100:103], a[64:67], v[160:163]
  ds_read_b64_tr_b16 a[108:109], v8 offset:49152
  buffer_load_dwordx4 v20, s[12:15], s59 offen offset:3072 lds
  v_mfma_f32_16x16x32_bf16 v[164:167], a[100:103], a[68:71], v[164:167]
  ds_read_b64_tr_b16 a[110:111], v8 offset:51200
  s_mov_b32 s59, 4096
  v_mfma_f32_16x16x32_bf16 v[168:171], a[100:103], a[72:75], v[168:171]
  buffer_load_dwordx4 a[188:191], v31, s[16:19], s59 offen offset:1024 sc1
  v_mfma_f32_16x16x32_bf16 v[172:175], a[100:103], a[76:79], v[172:175]
  s_mov_b32 s59, 4096
  v_mfma_f32_16x16x32_bf16 v[176:179], a[100:103], a[80:83], v[176:179]
  buffer_load_dwordx4 a[136:139], v30, s[16:19], s59 offen offset:2048 sc1
  v_mfma_f32_16x16x32_bf16 v[180:183], a[100:103], a[84:87], v[180:183]
  s_mov_b32 s59, 4096
  v_mfma_f32_16x16x32_bf16 v[184:187], a[100:103], a[88:91], v[184:187]
  buffer_load_dwordx4 a[192:195], v31, s[16:19], s59 offen offset:2048 sc1
  v_mfma_f32_16x16x32_bf16 v[188:191], a[100:103], a[92:95], v[188:191]
  s_add_u32 m0, s58, 0
  s_waitcnt lgkmcnt(2)
  v_mfma_f32_16x16x32_bf16 v[64:67], a[104:107], a[64:67], v[64:67]
  ds_read_b64_tr_b16 a[96:97], v9 offset:49152
  s_mov_b32 s59, 2097152
  v_mfma_f32_16x16x32_bf16 v[68:71], a[104:107], a[68:71], v[68:71]
  ds_read_b64_tr_b16 a[98:99], v9 offset:51200
  buffer_load_dwordx4 v17, s[12:15], s59 offen offset:0 lds
  v_mfma_f32_16x16x32_bf16 v[72:75], a[104:107], a[72:75], v[72:75]
  buffer_load_dwordx4 v18, s[12:15], s59 offen offset:1024 lds
  v_mfma_f32_16x16x32_bf16 v[76:79], a[104:107], a[76:79], v[76:79]
  buffer_load_dwordx4 v19, s[12:15], s59 offen offset:2048 lds
  v_mfma_f32_16x16x32_bf16 v[80:83], a[104:107], a[80:83], v[80:83]
  buffer_load_dwordx4 v20, s[12:15], s59 offen offset:3072 lds
  v_mfma_f32_16x16x32_bf16 v[84:87], a[104:107], a[84:87], v[84:87]
  v_mfma_f32_16x16x32_bf16 v[88:91], a[104:107], a[88:91], v[88:91]
  v_mfma_f32_16x16x32_bf16 v[92:95], a[104:107], a[92:95], v[92:95]
  s_waitcnt lgkmcnt(2)
  v_mfma_f32_16x16x32_bf16 v[192:195], a[108:111], a[64:67], v[192:195]
  ds_read_b64_tr_b16 a[100:101], v10 offset:49152
  v_mfma_f32_16x16x32_bf16 v[196:199], a[108:111], a[68:71], v[196:199]
  ds_read_b64_tr_b16 a[102:103], v10 offset:51200
  v_mfma_f32_16x16x32_bf16 v[200:203], a[108:111], a[72:75], v[200:203]
  v_mfma_f32_16x16x32_bf16 v[204:207], a[108:111], a[76:79], v[204:207]
  v_mfma_f32_16x16x32_bf16 v[208:211], a[108:111], a[80:83], v[208:211]
  v_mfma_f32_16x16x32_bf16 v[212:215], a[108:111], a[84:87], v[212:215]
  v_mfma_f32_16x16x32_bf16 v[216:219], a[108:111], a[88:91], v[216:219]
  v_mfma_f32_16x16x32_bf16 v[220:223], a[108:111], a[92:95], v[220:223]
  s_waitcnt lgkmcnt(2)
  v_mfma_f32_16x16x32_bf16 v[96:99], a[96:99], a[64:67], v[96:99]
  ds_read_b64_tr_b16 a[104:105], v11 offset:49152
  v_mfma_f32_16x16x32_bf16 v[100:103], a[96:99], a[68:71], v[100:103]
  ds_read_b64_tr_b16 a[106:107], v11 offset:51200
  v_mfma_f32_16x16x32_bf16 v[104:107], a[96:99], a[72:75], v[104:107]
  v_mfma_f32_16x16x32_bf16 v[108:111], a[96:99], a[76:79], v[108:111]
  v_mfma_f32_16x16x32_bf16 v[112:115], a[96:99], a[80:83], v[112:115]
  v_mfma_f32_16x16x32_bf16 v[116:119], a[96:99], a[84:87], v[116:119]
  v_mfma_f32_16x16x32_bf16 v[120:123], a[96:99], a[88:91], v[120:123]
  v_mfma_f32_16x16x32_bf16 v[124:127], a[96:99], a[92:95], v[124:127]
  s_waitcnt lgkmcnt(2)
  v_mfma_f32_16x16x32_bf16 v[224:227], a[100:103], a[64:67], v[224:227]
  ds_read_b64_tr_b16 a[108:109], v12 offset:49152
  v_mfma_f32_16x16x32_bf16 v[228:231], a[100:103], a[68:71], v[228:231]
  ds_read_b64_tr_b16 a[110:111], v12 offset:51200
  v_mfma_f32_16x16x32_bf16 v[232:235], a[100:103], a[72:75], v[232:235]
  v_mfma_f32_16x16x32_bf16 v[236:239], a[100:103], a[76:79], v[236:239]
  v_mfma_f32_16x16x32_bf16 v[240:243], a[100:103], a[80:83], v[240:243]
  v_mfma_f32_16x16x32_bf16 v[244:247], a[100:103], a[84:87], v[244:247]
  v_mfma_f32_16x16x32_bf16 v[248:251], a[100:103], a[88:91], v[248:251]
  v_mfma_f32_16x16x32_bf16 v[252:255], a[100:103], a[92:95], v[252:255]
  s_waitcnt lgkmcnt(2)
  v_mfma_f32_16x16x32_bf16 v[128:131], a[104:107], a[64:67], v[128:131]
  v_mfma_f32_16x16x32_bf16 v[132:135], a[104:107], a[68:71], v[132:135]
  v_mfma_f32_16x16x32_bf16 v[136:139], a[104:107], a[72:75], v[136:139]
  v_mfma_f32_16x16x32_bf16 v[140:143], a[104:107], a[76:79], v[140:143]
  v_mfma_f32_16x16x32_bf16 v[144:147], a[104:107], a[80:83], v[144:147]
  v_mfma_f32_16x16x32_bf16 v[148:151], a[104:107], a[84:87], v[148:151]
  v_mfma_f32_16x16x32_bf16 v[152:155], a[104:107], a[88:91], v[152:155]
  v_mfma_f32_16x16x32_bf16 v[156:159], a[104:107], a[92:95], v[156:159]
  s_waitcnt lgkmcnt(0)
  v_mfma_f32_16x16x32_bf16 a[0:3], a[108:111], a[64:67], a[0:3]
  v_mfma_f32_16x16x32_bf16 a[4:7], a[108:111], a[68:71], a[4:7]
  v_mfma_f32_16x16x32_bf16 a[8:11], a[108:111], a[72:75], a[8:11]
  v_mfma_f32_16x16x32_bf16 a[12:15], a[108:111], a[76:79], a[12:15]
  v_mfma_f32_16x16x32_bf16 a[16:19], a[108:111], a[80:83], a[16:19]
  v_mfma_f32_16x16x32_bf16 a[20:23], a[108:111], a[84:87], a[20:23]
  v_mfma_f32_16x16x32_bf16 a[24:27], a[108:111], a[88:91], a[24:27]
  v_mfma_f32_16x16x32_bf16 a[28:31], a[108:111], a[92:95], a[28:31]
  s_waitcnt vmcnt(26)
  s_barrier
  s_add_u32 m0, s58, 16384
  s_mov_b32 s59, 2359296
  buffer_load_dwordx4 v17, s[12:15], s59 offen offset:0 lds
  buffer_load_dwordx4 v18, s[12:15], s59 offen offset:1024 lds
  buffer_load_dwordx4 v19, s[12:15], s59 offen offset:2048 lds
  buffer_load_dwordx4 v20, s[12:15], s59 offen offset:3072 lds
  s_add_u32 m0, s58, 147456
  s_mov_b32 s59, 1835008
  buffer_load_dwordx4 v17, s[12:15], s59 offen offset:0 lds
  buffer_load_dwordx4 v18, s[12:15], s59 offen offset:1024 lds
  buffer_load_dwordx4 v19, s[12:15], s59 offen offset:2048 lds
  buffer_load_dwordx4 v20, s[12:15], s59 offen offset:3072 lds
  s_nop 3
  v_cvt_pk_bf16_f32 v32, v32, v33
  v_cvt_pk_bf16_f32 v33, v34, v35
  v_cvt_pk_bf16_f32 v34, v160, v161
  v_cvt_pk_bf16_f32 v35, v162, v163
  s_mov_b32 s59, 4096
  buffer_load_dwordx4 a[140:143], v30, s[16:19], s59 offen offset:3072 sc1
  v_cvt_pk_bf16_f32 v36, v36, v37
  v_cvt_pk_bf16_f32 v37, v38, v39
  v_cvt_pk_bf16_f32 v38, v164, v165
  v_cvt_pk_bf16_f32 v39, v166, v167
  v_cvt_pk_bf16_f32 v40, v40, v41
  v_cvt_pk_bf16_f32 v41, v42, v43
  v_cvt_pk_bf16_f32 v42, v168, v169
  v_cvt_pk_bf16_f32 v43, v170, v171
  s_mov_b32 s59, 4096
  buffer_load_dwordx4 a[196:199], v31, s[16:19], s59 offen offset:3072 sc1
  v_cvt_pk_bf16_f32 v44, v44, v45
  v_cvt_pk_bf16_f32 v45, v46, v47
  v_cvt_pk_bf16_f32 v46, v172, v173
  v_cvt_pk_bf16_f32 v47, v174, v175
  v_cvt_pk_bf16_f32 v48, v48, v49
  v_cvt_pk_bf16_f32 v49, v50, v51
  v_cvt_pk_bf16_f32 v50, v176, v177
  v_cvt_pk_bf16_f32 v51, v178, v179
  s_mov_b32 s59, 8192
  buffer_load_dwordx4 a[144:147], v30, s[16:19], s59 offen offset:0 sc1
  v_cvt_pk_bf16_f32 v52, v52, v53
  v_cvt_pk_bf16_f32 v53, v54, v55
  v_cvt_pk_bf16_f32 v54, v180, v181
  v_cvt_pk_bf16_f32 v55, v182, v183
  v_cvt_pk_bf16_f32 v56, v56, v57
  v_cvt_pk_bf16_f32 v57, v58, v59
  v_cvt_pk_bf16_f32 v58, v184, v185
  v_cvt_pk_bf16_f32 v59, v186, v187
  s_mov_b32 s59, 8192
  buffer_load_dwordx4 a[200:203], v31, s[16:19], s59 offen offset:0 sc1
  v_cvt_pk_bf16_f32 v60, v60, v61
  v_cvt_pk_bf16_f32 v61, v62, v63
  v_cvt_pk_bf16_f32 v62, v188, v189
  v_cvt_pk_bf16_f32 v63, v190, v191
  v_cvt_pk_bf16_f32 v64, v64, v65
  v_cvt_pk_bf16_f32 v65, v66, v67
  v_cvt_pk_bf16_f32 v66, v192, v193
  v_cvt_pk_bf16_f32 v67, v194, v195
  s_mov_b32 s59, 8192
  buffer_load_dwordx4 a[148:151], v30, s[16:19], s59 offen offset:1024 sc1
  v_cvt_pk_bf16_f32 v68, v68, v69
  v_cvt_pk_bf16_f32 v69, v70, v71
  v_cvt_pk_bf16_f32 v70, v196, v197
  v_cvt_pk_bf16_f32 v71, v198, v199
  v_cvt_pk_bf16_f32 v72, v72, v73
  v_cvt_pk_bf16_f32 v73, v74, v75
  v_cvt_pk_bf16_f32 v74, v200, v201
  v_cvt_pk_bf16_f32 v75, v202, v203
  s_mov_b32 s59, 8192
  buffer_load_dwordx4 a[204:207], v31, s[16:19], s59 offen offset:1024 sc1
  v_cvt_pk_bf16_f32 v76, v76, v77
  v_cvt_pk_bf16_f32 v77, v78, v79
  v_cvt_pk_bf16_f32 v78, v204, v205
  v_cvt_pk_bf16_f32 v79, v206, v207
  v_cvt_pk_bf16_f32 v80, v80, v81
  v_cvt_pk_bf16_f32 v81, v82, v83
  v_cvt_pk_bf16_f32 v82, v208, v209
  v_cvt_pk_bf16_f32 v83, v210, v211
  s_mov_b32 s59, 8192
  buffer_load_dwordx4 a[152:155], v30, s[16:19], s59 offen offset:2048 sc1
  v_cvt_pk_bf16_f32 v84, v84, v85
  v_cvt_pk_bf16_f32 v85, v86, v87
  v_cvt_pk_bf16_f32 v86, v212, v213
  v_cvt_pk_bf16_f32 v87, v214, v215
  v_cvt_pk_bf16_f32 v88, v88, v89
  v_cvt_pk_bf16_f32 v89, v90, v91
  v_cvt_pk_bf16_f32 v90, v216, v217
  v_cvt_pk_bf16_f32 v91, v218, v219
  s_mov_b32 s59, 8192
  buffer_load_dwordx4 a[208:211], v31, s[16:19], s59 offen offset:2048 sc1
  v_cvt_pk_bf16_f32 v92, v92, v93
  v_cvt_pk_bf16_f32 v93, v94, v95
  v_cvt_pk_bf16_f32 v94, v220, v221
  v_cvt_pk_bf16_f32 v95, v222, v223
  v_cvt_pk_bf16_f32 v96, v96, v97
  v_cvt_pk_bf16_f32 v97, v98, v99
  v_cvt_pk_bf16_f32 v98, v224, v225
  v_cvt_pk_bf16_f32 v99, v226, v227
  s_mov_b32 s59, 8192
  buffer_load_dwordx4 a[156:159], v30, s[16:19], s59 offen offset:3072 sc1
  v_cvt_pk_bf16_f32 v100, v100, v101
  v_cvt_pk_bf16_f32 v101, v102, v103
  v_cvt_pk_bf16_f32 v102, v228, v229
  v_cvt_pk_bf16_f32 v103, v230, v231
  v_cvt_pk_bf16_f32 v104, v104, v105
  v_cvt_pk_bf16_f32 v105, v106, v107
  v_cvt_pk_bf16_f32 v106, v232, v233
  v_cvt_pk_bf16_f32 v107, v234, v235
  s_mov_b32 s59, 8192
  buffer_load_dwordx4 a[212:215], v31, s[16:19], s59 offen offset:3072 sc1
  v_cvt_pk_bf16_f32 v108, v108, v109
  v_cvt_pk_bf16_f32 v109, v110, v111
  v_cvt_pk_bf16_f32 v110, v236, v237
  v_cvt_pk_bf16_f32 v111, v238, v239
  v_cvt_pk_bf16_f32 v112, v112, v113
  v_cvt_pk_bf16_f32 v113, v114, v115
  v_cvt_pk_bf16_f32 v114, v240, v241
  v_cvt_pk_bf16_f32 v115, v242, v243
  s_mov_b32 s59, 12288
  buffer_load_dwordx4 a[160:163], v30, s[16:19], s59 offen offset:0 sc1
  v_cvt_pk_bf16_f32 v116, v116, v117
  v_cvt_pk_bf16_f32 v117, v118, v119
  v_cvt_pk_bf16_f32 v118, v244, v245
  v_cvt_pk_bf16_f32 v119, v246, v247
  v_cvt_pk_bf16_f32 v120, v120, v121
  v_cvt_pk_bf16_f32 v121, v122, v123
  v_cvt_pk_bf16_f32 v122, v248, v249
  v_cvt_pk_bf16_f32 v123, v250, v251
  s_mov_b32 s59, 12288
  buffer_load_dwordx4 a[216:219], v31, s[16:19], s59 offen offset:0 sc1
  v_cvt_pk_bf16_f32 v124, v124, v125
  v_cvt_pk_bf16_f32 v125, v126, v127
  v_cvt_pk_bf16_f32 v126, v252, v253
  v_cvt_pk_bf16_f32 v127, v254, v255
  v_accvgpr_read_b32 v24, a0
  v_accvgpr_read_b32 v25, a1
  v_accvgpr_read_b32 v26, a2
  v_accvgpr_read_b32 v27, a3
  v_cvt_pk_bf16_f32 v128, v128, v129
  v_cvt_pk_bf16_f32 v129, v130, v131
  v_cvt_pk_bf16_f32 v130, v24, v25
  v_cvt_pk_bf16_f32 v131, v26, v27
  s_mov_b32 s59, 12288
  buffer_load_dwordx4 a[164:167], v30, s[16:19], s59 offen offset:1024 sc1
  v_accvgpr_read_b32 v24, a4
  v_accvgpr_read_b32 v25, a5
  v_accvgpr_read_b32 v26, a6
  v_accvgpr_read_b32 v27, a7
  v_cvt_pk_bf16_f32 v132, v132, v133
  v_cvt_pk_bf16_f32 v133, v134, v135
  v_cvt_pk_bf16_f32 v134, v24, v25
  v_cvt_pk_bf16_f32 v135, v26, v27
  v_accvgpr_read_b32 v24, a8
  v_accvgpr_read_b32 v25, a9
  v_accvgpr_read_b32 v26, a10
  v_accvgpr_read_b32 v27, a11
  v_cvt_pk_bf16_f32 v136, v136, v137
  v_cvt_pk_bf16_f32 v137, v138, v139
  v_cvt_pk_bf16_f32 v138, v24, v25
  v_cvt_pk_bf16_f32 v139, v26, v27
  s_mov_b32 s59, 12288
  buffer_load_dwordx4 a[220:223], v31, s[16:19], s59 offen offset:1024 sc1
  v_accvgpr_read_b32 v24, a12
  v_accvgpr_read_b32 v25, a13
  v_accvgpr_read_b32 v26, a14
  v_accvgpr_read_b32 v27, a15
  v_cvt_pk_bf16_f32 v140, v140, v141
  v_cvt_pk_bf16_f32 v141, v142, v143
  v_cvt_pk_bf16_f32 v142, v24, v25
  v_cvt_pk_bf16_f32 v143, v26, v27
  v_accvgpr_read_b32 v24, a16
  v_accvgpr_read_b32 v25, a17
  v_accvgpr_read_b32 v26, a18
  v_accvgpr_read_b32 v27, a19
  v_cvt_pk_bf16_f32 v144, v144, v145
  v_cvt_pk_bf16_f32 v145, v146, v147
  v_cvt_pk_bf16_f32 v146, v24, v25
  v_cvt_pk_bf16_f32 v147, v26, v27
  v_accvgpr_read_b32 v24, a20
  v_accvgpr_read_b32 v25, a21
  v_accvgpr_read_b32 v26, a22
  v_accvgpr_read_b32 v27, a23
  v_cvt_pk_bf16_f32 v148, v148, v149
  v_cvt_pk_bf16_f32 v149, v150, v151
  v_cvt_pk_bf16_f32 v150, v24, v25
  v_cvt_pk_bf16_f32 v151, v26, v27
  v_accvgpr_read_b32 v24, a24
  v_accvgpr_read_b32 v25, a25
  v_accvgpr_read_b32 v26, a26
  v_accvgpr_read_b32 v27, a27
  v_cvt_pk_bf16_f32 v152, v152, v153
  v_cvt_pk_bf16_f32 v153, v154, v155
  v_cvt_pk_bf16_f32 v154, v24, v25
  v_cvt_pk_bf16_f32 v155, v26, v27
  v_accvgpr_read_b32 v24, a28
  v_accvgpr_read_b32 v25, a29
  v_accvgpr_read_b32 v26, a30
  v_accvgpr_read_b32 v27, a31
  v_cvt_pk_bf16_f32 v156, v156, v157
  v_cvt_pk_bf16_f32 v157, v158, v159
  v_cvt_pk_bf16_f32 v158, v24, v25
  v_cvt_pk_bf16_f32 v159, v26, v27
  s_lshl_b32 s67, s30, 8
  s_add_u32 s67, s67, 98304
  v_subrev_u32 v5, s67, v5
  v_subrev_u32 v6, s67, v6
  v_subrev_u32 v7, s67, v7
  v_subrev_u32 v8, s67, v8
  v_subrev_u32 v9, s67, v9
  v_subrev_u32 v10, s67, v10
  v_subrev_u32 v11, s67, v11
  v_subrev_u32 v12, s67, v12
  s_waitcnt vmcnt(29)
  s_barrier
  ds_read_b64_tr_b16 a[32:33], v5 offset:32768
  ds_read_b64_tr_b16 a[34:35], v5 offset:34816
  ds_read_b64_tr_b16 a[36:37], v6 offset:32768
  ds_read_b64_tr_b16 a[38:39], v6 offset:34816
  ds_read_b64_tr_b16 a[40:41], v7 offset:32768
  ds_read_b64_tr_b16 a[42:43], v7 offset:34816
  ds_read_b64_tr_b16 a[44:45], v8 offset:32768
  ds_read_b64_tr_b16 a[46:47], v8 offset:34816
  ds_read_b64_tr_b16 a[48:49], v9 offset:32768
  ds_read_b64_tr_b16 a[50:51], v9 offset:34816
  ds_read_b64_tr_b16 a[52:53], v10 offset:32768
  ds_read_b64_tr_b16 a[54:55], v10 offset:34816
  s_waitcnt lgkmcnt(10)
  v_mfma_f32_16x16x32_bf16 v[160:163], a[32:35], a[112:115], 0
  ds_read_b64_tr_b16 a[56:57], v11 offset:32768
  v_mfma_f32_16x16x32_bf16 v[164:167], a[32:35], a[168:171], 0
  ds_read_b64_tr_b16 a[58:59], v11 offset:34816
  s_waitcnt lgkmcnt(10)
  v_mfma_f32_16x16x32_bf16 v[168:171], a[36:39], a[112:115], 0
  ds_read_b64_tr_b16 a[60:61], v12 offset:32768
  v_mfma_f32_16x16x32_bf16 v[172:175], a[36:39], a[168:171], 0
  ds_read_b64_tr_b16 a[62:63], v12 offset:34816
  buffer_store_dwordx4 v[32:35], v21, s[20:23], s52 offen offset:0 sc1
  s_waitcnt lgkmcnt(10)
  v_mfma_f32_16x16x32_bf16 v[176:179], a[40:43], a[112:115], 0
  ds_read_b64_tr_b16 a[32:33], v5 offset:33024
  v_mfma_f32_16x16x32_bf16 v[180:183], a[40:43], a[168:171], 0
  ds_read_b64_tr_b16 a[34:35], v5 offset:35072
  s_waitcnt lgkmcnt(10)
  v_mfma_f32_16x16x32_bf16 v[184:187], a[44:47], a[112:115], 0
  ds_read_b64_tr_b16 a[36:37], v6 offset:33024
  v_mfma_f32_16x16x32_bf16 v[188:191], a[44:47], a[168:171], 0
  ds_read_b64_tr_b16 a[38:39], v6 offset:35072
  s_waitcnt lgkmcnt(10)
  v_mfma_f32_16x16x32_bf16 v[192:195], a[48:51], a[112:115], 0
  ds_read_b64_tr_b16 a[40:41], v7 offset:33024
  v_mfma_f32_16x16x32_bf16 v[196:199], a[48:51], a[168:171], 0
  ds_read_b64_tr_b16 a[42:43], v7 offset:35072
  s_waitcnt lgkmcnt(10)
  v_mfma_f32_16x16x32_bf16 v[200:203], a[52:55], a[112:115], 0
  ds_read_b64_tr_b16 a[44:45], v8 offset:33024
  v_mfma_f32_16x16x32_bf16 v[204:207], a[52:55], a[168:171], 0
  ds_read_b64_tr_b16 a[46:47], v8 offset:35072
  buffer_store_dwordx4 v[36:39], v21, s[20:23], s52 offen offset:1024 sc1
  s_waitcnt lgkmcnt(10)
  v_mfma_f32_16x16x32_bf16 v[208:211], a[56:59], a[112:115], 0
  ds_read_b64_tr_b16 a[48:49], v9 offset:33024
  v_mfma_f32_16x16x32_bf16 v[212:215], a[56:59], a[168:171], 0
  ds_read_b64_tr_b16 a[50:51], v9 offset:35072
  s_waitcnt lgkmcnt(10)
  v_mfma_f32_16x16x32_bf16 v[216:219], a[60:63], a[112:115], 0
  ds_read_b64_tr_b16 a[52:53], v10 offset:33024
  v_mfma_f32_16x16x32_bf16 v[220:223], a[60:63], a[168:171], 0
  ds_read_b64_tr_b16 a[54:55], v10 offset:35072
  s_waitcnt lgkmcnt(10)
  v_mfma_f32_16x16x32_bf16 v[224:227], a[32:35], a[112:115], 0
  ds_read_b64_tr_b16 a[56:57], v11 offset:33024
  v_mfma_f32_16x16x32_bf16 v[228:231], a[32:35], a[168:171], 0
  ds_read_b64_tr_b16 a[58:59], v11 offset:35072
  s_waitcnt lgkmcnt(10)
  v_mfma_f32_16x16x32_bf16 v[232:235], a[36:39], a[112:115], 0
  ds_read_b64_tr_b16 a[60:61], v12 offset:33024
  v_mfma_f32_16x16x32_bf16 v[236:239], a[36:39], a[168:171], 0
  ds_read_b64_tr_b16 a[62:63], v12 offset:35072
  buffer_store_dwordx4 v[40:43], v21, s[20:23], s53 offen offset:0 sc1
  s_waitcnt lgkmcnt(10)
  v_mfma_f32_16x16x32_bf16 v[240:243], a[40:43], a[112:115], 0
  ds_read_b64_tr_b16 a[32:33], v5 offset:49152
  v_mfma_f32_16x16x32_bf16 v[244:247], a[40:43], a[168:171], 0
  ds_read_b64_tr_b16 a[34:35], v5 offset:51200
  s_waitcnt lgkmcnt(10)
  v_mfma_f32_16x16x32_bf16 v[248:251], a[44:47], a[112:115], 0
  ds_read_b64_tr_b16 a[36:37], v6 offset:49152
  v_mfma_f32_16x16x32_bf16 v[252:255], a[44:47], a[168:171], 0
  ds_read_b64_tr_b16 a[38:39], v6 offset:51200
  s_waitcnt lgkmcnt(10)
  v_mfma_f32_16x16x32_bf16 a[0:3], a[48:51], a[112:115], 0
  ds_read_b64_tr_b16 a[40:41], v7 offset:49152
  v_mfma_f32_16x16x32_bf16 a[4:7], a[48:51], a[168:171], 0
  ds_read_b64_tr_b16 a[42:43], v7 offset:51200
  s_waitcnt lgkmcnt(10)
  v_mfma_f32_16x16x32_bf16 a[8:11], a[52:55], a[112:115], 0
  ds_read_b64_tr_b16 a[44:45], v8 offset:49152
  v_mfma_f32_16x16x32_bf16 a[12:15], a[52:55], a[168:171], 0
  ds_read_b64_tr_b16 a[46:47], v8 offset:51200
  buffer_store_dwordx4 v[44:47], v21, s[20:23], s53 offen offset:1024 sc1
  s_waitcnt lgkmcnt(10)
  v_mfma_f32_16x16x32_bf16 a[16:19], a[56:59], a[112:115], 0
  ds_read_b64_tr_b16 a[48:49], v9 offset:49152
  v_mfma_f32_16x16x32_bf16 a[20:23], a[56:59], a[168:171], 0
  ds_read_b64_tr_b16 a[50:51], v9 offset:51200
  s_waitcnt lgkmcnt(10)
  v_mfma_f32_16x16x32_bf16 a[24:27], a[60:63], a[112:115], 0
  ds_read_b64_tr_b16 a[52:53], v10 offset:49152
  v_mfma_f32_16x16x32_bf16 a[28:31], a[60:63], a[168:171], 0
  ds_read_b64_tr_b16 a[54:55], v10 offset:51200
  s_waitcnt lgkmcnt(10)
  v_mfma_f32_16x16x32_bf16 v[160:163], a[32:35], a[116:119], v[160:163]
  ds_read_b64_tr_b16 a[56:57], v11 offset:49152
  v_mfma_f32_16x16x32_bf16 v[164:167], a[32:35], a[172:175], v[164:167]
  ds_read_b64_tr_b16 a[58:59], v11 offset:51200
  s_waitcnt lgkmcnt(10)
  v_mfma_f32_16x16x32_bf16 v[168:171], a[36:39], a[116:119], v[168:171]
  ds_read_b64_tr_b16 a[60:61], v12 offset:49152
  v_mfma_f32_16x16x32_bf16 v[172:175], a[36:39], a[172:175], v[172:175]
  ds_read_b64_tr_b16 a[62:63], v12 offset:51200
  buffer_store_dwordx4 v[48:51], v21, s[20:23], s54 offen offset:0 sc1
  s_waitcnt lgkmcnt(10)
  v_mfma_f32_16x16x32_bf16 v[176:179], a[40:43], a[116:119], v[176:179]
  ds_read_b64_tr_b16 a[32:33], v5 offset:49408
  v_mfma_f32_16x16x32_bf16 v[180:183], a[40:43], a[172:175], v[180:183]
  ds_read_b64_tr_b16 a[34:35], v5 offset:51456
  s_waitcnt lgkmcnt(10)
  v_mfma_f32_16x16x32_bf16 v[184:187], a[44:47], a[116:119], v[184:187]
  ds_read_b64_tr_b16 a[36:37], v6 offset:49408
  v_mfma_f32_16x16x32_bf16 v[188:191], a[44:47], a[172:175], v[188:191]
  ds_read_b64_tr_b16 a[38:39], v6 offset:51456
  s_waitcnt lgkmcnt(10)
  v_mfma_f32_16x16x32_bf16 v[192:195], a[48:51], a[116:119], v[192:195]
  ds_read_b64_tr_b16 a[40:41], v7 offset:49408
  v_mfma_f32_16x16x32_bf16 v[196:199], a[48:51], a[172:175], v[196:199]
  ds_read_b64_tr_b16 a[42:43], v7 offset:51456
  s_waitcnt lgkmcnt(10)
  v_mfma_f32_16x16x32_bf16 v[200:203], a[52:55], a[116:119], v[200:203]
  ds_read_b64_tr_b16 a[44:45], v8 offset:49408
  v_mfma_f32_16x16x32_bf16 v[204:207], a[52:55], a[172:175], v[204:207]
  ds_read_b64_tr_b16 a[46:47], v8 offset:51456
  buffer_store_dwordx4 v[52:55], v21, s[20:23], s54 offen offset:1024 sc1
  s_waitcnt lgkmcnt(10)
  v_mfma_f32_16x16x32_bf16 v[208:211], a[56:59], a[116:119], v[208:211]
  ds_read_b64_tr_b16 a[48:49], v9 offset:49408
  v_mfma_f32_16x16x32_bf16 v[212:215], a[56:59], a[172:175], v[212:215]
  ds_read_b64_tr_b16 a[50:51], v9 offset:51456
  s_waitcnt lgkmcnt(10)
  v_mfma_f32_16x16x32_bf16 v[216:219], a[60:63], a[116:119], v[216:219]
  ds_read_b64_tr_b16 a[52:53], v10 offset:49408
  v_mfma_f32_16x16x32_bf16 v[220:223], a[60:63], a[172:175], v[220:223]
  ds_read_b64_tr_b16 a[54:55], v10 offset:51456
  s_waitcnt lgkmcnt(10)
  v_mfma_f32_16x16x32_bf16 v[224:227], a[32:35], a[116:119], v[224:227]
  ds_read_b64_tr_b16 a[56:57], v11 offset:49408
  v_mfma_f32_16x16x32_bf16 v[228:231], a[32:35], a[172:175], v[228:231]
  ds_read_b64_tr_b16 a[58:59], v11 offset:51456
  s_waitcnt lgkmcnt(10)
  v_mfma_f32_16x16x32_bf16 v[232:235], a[36:39], a[116:119], v[232:235]
  ds_read_b64_tr_b16 a[60:61], v12 offset:49408
  v_mfma_f32_16x16x32_bf16 v[236:239], a[36:39], a[172:175], v[236:239]
  ds_read_b64_tr_b16 a[62:63], v12 offset:51456
  buffer_store_dwordx4 v[56:59], v21, s[20:23], s55 offen offset:0 sc1
  s_waitcnt lgkmcnt(10)
  v_mfma_f32_16x16x32_bf16 v[240:243], a[40:43], a[116:119], v[240:243]
  v_add_u32 v5, 0x10000, v5
  ds_read_b64_tr_b16 a[32:33], v5 offset:0
  v_mfma_f32_16x16x32_bf16 v[244:247], a[40:43], a[172:175], v[244:247]
  ds_read_b64_tr_b16 a[34:35], v5 offset:2048
  s_waitcnt lgkmcnt(10)
  v_mfma_f32_16x16x32_bf16 v[248:251], a[44:47], a[116:119], v[248:251]
  v_add_u32 v6, 0x10000, v6
  ds_read_b64_tr_b16 a[36:37], v6 offset:0
  v_mfma_f32_16x16x32_bf16 v[252:255], a[44:47], a[172:175], v[252:255]
  ds_read_b64_tr_b16 a[38:39], v6 offset:2048
  s_waitcnt lgkmcnt(10)
  v_mfma_f32_16x16x32_bf16 a[0:3], a[48:51], a[116:119], a[0:3]
  v_add_u32 v7, 0x10000, v7
  ds_read_b64_tr_b16 a[40:41], v7 offset:0
  v_mfma_f32_16x16x32_bf16 a[4:7], a[48:51], a[172:175], a[4:7]
  ds_read_b64_tr_b16 a[42:43], v7 offset:2048
  s_waitcnt lgkmcnt(10)
  v_mfma_f32_16x16x32_bf16 a[8:11], a[52:55], a[116:119], a[8:11]
  v_add_u32 v8, 0x10000, v8
  ds_read_b64_tr_b16 a[44:45], v8 offset:0
  v_mfma_f32_16x16x32_bf16 a[12:15], a[52:55], a[172:175], a[12:15]
  ds_read_b64_tr_b16 a[46:47], v8 offset:2048
  buffer_store_dwordx4 v[60:63], v21, s[20:23], s55 offen offset:1024 sc1
  s_waitcnt lgkmcnt(10)
  v_mfma_f32_16x16x32_bf16 a[16:19], a[56:59], a[116:119], a[16:19]
  v_add_u32 v9, 0x10000, v9
  ds_read_b64_tr_b16 a[48:49], v9 offset:0
  v_mfma_f32_16x16x32_bf16 a[20:23], a[56:59], a[172:175], a[20:23]
  ds_read_b64_tr_b16 a[50:51], v9 offset:2048
  s_waitcnt lgkmcnt(10)
  v_mfma_f32_16x16x32_bf16 a[24:27], a[60:63], a[116:119], a[24:27]
  v_add_u32 v10, 0x10000, v10
  ds_read_b64_tr_b16 a[52:53], v10 offset:0
  v_mfma_f32_16x16x32_bf16 a[28:31], a[60:63], a[172:175], a[28:31]
  ds_read_b64_tr_b16 a[54:55], v10 offset:2048
  v_add_u32 v11, 0x10000, v11
  v_add_u32 v12, 0x10000, v12
  s_waitcnt lgkmcnt(10)
  v_mfma_f32_16x16x32_bf16 v[160:163], a[32:35], a[120:123], v[160:163]
  ds_read_b64_tr_b16 a[56:57], v11 offset:0
  v_mfma_f32_16x16x32_bf16 v[164:167], a[32:35], a[176:179], v[164:167]
  ds_read_b64_tr_b16 a[58:59], v11 offset:2048
  s_waitcnt lgkmcnt(10)
  v_mfma_f32_16x16x32_bf16 v[168:171], a[36:39], a[120:123], v[168:171]
  ds_read_b64_tr_b16 a[60:61], v12 offset:0
  v_mfma_f32_16x16x32_bf16 v[172:175], a[36:39], a[176:179], v[172:175]
  ds_read_b64_tr_b16 a[62:63], v12 offset:2048
  buffer_store_dwordx4 v[64:67], v21, s[20:23], s52 offen offset:2048 sc1
  s_waitcnt lgkmcnt(10)
  v_mfma_f32_16x16x32_bf16 v[176:179], a[40:43], a[120:123], v[176:179]
  ds_read_b64_tr_b16 a[32:33], v5 offset:256
  v_mfma_f32_16x16x32_bf16 v[180:183], a[40:43], a[176:179], v[180:183]
  ds_read_b64_tr_b16 a[34:35], v5 offset:2304
  s_waitcnt lgkmcnt(10)
  v_mfma_f32_16x16x32_bf16 v[184:187], a[44:47], a[120:123], v[184:187]
  ds_read_b64_tr_b16 a[36:37], v6 offset:256
  v_mfma_f32_16x16x32_bf16 v[188:191], a[44:47], a[176:179], v[188:191]
  ds_read_b64_tr_b16 a[38:39], v6 offset:2304
  s_waitcnt lgkmcnt(10)
  v_mfma_f32_16x16x32_bf16 v[192:195], a[48:51], a[120:123], v[192:195]
  ds_read_b64_tr_b16 a[40:41], v7 offset:256
  v_mfma_f32_16x16x32_bf16 v[196:199], a[48:51], a[176:179], v[196:199]
  ds_read_b64_tr_b16 a[42:43], v7 offset:2304
  s_waitcnt lgkmcnt(10)
  v_mfma_f32_16x16x32_bf16 v[200:203], a[52:55], a[120:123], v[200:203]
  ds_read_b64_tr_b16 a[44:45], v8 offset:256
  v_mfma_f32_16x16x32_bf16 v[204:207], a[52:55], a[176:179], v[204:207]
  ds_read_b64_tr_b16 a[46:47], v8 offset:2304
  buffer_store_dwordx4 v[68:71], v21, s[20:23], s52 offen offset:3072 sc1
  s_waitcnt lgkmcnt(10)
  v_mfma_f32_16x16x32_bf16 v[208:211], a[56:59], a[120:123], v[208:211]
  ds_read_b64_tr_b16 a[48:49], v9 offset:256
  v_mfma_f32_16x16x32_bf16 v[212:215], a[56:59], a[176:179], v[212:215]
  ds_read_b64_tr_b16 a[50:51], v9 offset:2304
  s_waitcnt lgkmcnt(10)
  v_mfma_f32_16x16x32_bf16 v[216:219], a[60:63], a[120:123], v[216:219]
  ds_read_b64_tr_b16 a[52:53], v10 offset:256
  v_mfma_f32_16x16x32_bf16 v[220:223], a[60:63], a[176:179], v[220:223]
  ds_read_b64_tr_b16 a[54:55], v10 offset:2304
  s_waitcnt lgkmcnt(10)
  v_mfma_f32_16x16x32_bf16 v[224:227], a[32:35], a[120:123], v[224:227]
  ds_read_b64_tr_b16 a[56:57], v11 offset:256
  v_mfma_f32_16x16x32_bf16 v[228:231], a[32:35], a[176:179], v[228:231]
  ds_read_b64_tr_b16 a[58:59], v11 offset:2304
  s_waitcnt lgkmcnt(10)
  v_mfma_f32_16x16x32_bf16 v[232:235], a[36:39], a[120:123], v[232:235]
  ds_read_b64_tr_b16 a[60:61], v12 offset:256
  v_mfma_f32_16x16x32_bf16 v[236:239], a[36:39], a[176:179], v[236:239]
  ds_read_b64_tr_b16 a[62:63], v12 offset:2304
  buffer_store_dwordx4 v[72:75], v21, s[20:23], s53 offen offset:2048 sc1
  s_waitcnt lgkmcnt(10)
  v_mfma_f32_16x16x32_bf16 v[240:243], a[40:43], a[120:123], v[240:243]
  ds_read_b64_tr_b16 a[32:33], v5 offset:16384
  v_mfma_f32_16x16x32_bf16 v[244:247], a[40:43], a[176:179], v[244:247]
  ds_read_b64_tr_b16 a[34:35], v5 offset:18432
  s_waitcnt lgkmcnt(10)
  v_mfma_f32_16x16x32_bf16 v[248:251], a[44:47], a[120:123], v[248:251]
  ds_read_b64_tr_b16 a[36:37], v6 offset:16384
  v_mfma_f32_16x16x32_bf16 v[252:255], a[44:47], a[176:179], v[252:255]
  ds_read_b64_tr_b16 a[38:39], v6 offset:18432
  s_waitcnt lgkmcnt(10)
  v_mfma_f32_16x16x32_bf16 a[0:3], a[48:51], a[120:123], a[0:3]
  ds_read_b64_tr_b16 a[40:41], v7 offset:16384
  v_mfma_f32_16x16x32_bf16 a[4:7], a[48:51], a[176:179], a[4:7]
  ds_read_b64_tr_b16 a[42:43], v7 offset:18432
  s_waitcnt lgkmcnt(10)
  v_mfma_f32_16x16x32_bf16 a[8:11], a[52:55], a[120:123], a[8:11]
  ds_read_b64_tr_b16 a[44:45], v8 offset:16384
  v_mfma_f32_16x16x32_bf16 a[12:15], a[52:55], a[176:179], a[12:15]
  ds_read_b64_tr_b16 a[46:47], v8 offset:18432
  buffer_store_dwordx4 v[76:79], v21, s[20:23], s53 offen offset:3072 sc1
  s_waitcnt lgkmcnt(10)
  v_mfma_f32_16x16x32_bf16 a[16:19], a[56:59], a[120:123], a[16:19]
  ds_read_b64_tr_b16 a[48:49], v9 offset:16384
  v_mfma_f32_16x16x32_bf16 a[20:23], a[56:59], a[176:179], a[20:23]
  ds_read_b64_tr_b16 a[50:51], v9 offset:18432
  s_waitcnt lgkmcnt(10)
  v_mfma_f32_16x16x32_bf16 a[24:27], a[60:63], a[120:123], a[24:27]
  ds_read_b64_tr_b16 a[52:53], v10 offset:16384
  v_mfma_f32_16x16x32_bf16 a[28:31], a[60:63], a[176:179], a[28:31]
  ds_read_b64_tr_b16 a[54:55], v10 offset:18432
  s_waitcnt lgkmcnt(10)
  v_mfma_f32_16x16x32_bf16 v[160:163], a[32:35], a[124:127], v[160:163]
  ds_read_b64_tr_b16 a[56:57], v11 offset:16384
  v_mfma_f32_16x16x32_bf16 v[164:167], a[32:35], a[180:183], v[164:167]
  ds_read_b64_tr_b16 a[58:59], v11 offset:18432
  s_waitcnt lgkmcnt(10)
  v_mfma_f32_16x16x32_bf16 v[168:171], a[36:39], a[124:127], v[168:171]
  ds_read_b64_tr_b16 a[60:61], v12 offset:16384
  v_mfma_f32_16x16x32_bf16 v[172:175], a[36:39], a[180:183], v[172:175]
  ds_read_b64_tr_b16 a[62:63], v12 offset:18432
  buffer_store_dwordx4 v[80:83], v21, s[20:23], s54 offen offset:2048 sc1
  s_waitcnt lgkmcnt(10)
  v_mfma_f32_16x16x32_bf16 v[176:179], a[40:43], a[124:127], v[176:179]
  ds_read_b64_tr_b16 a[32:33], v5 offset:16640
  v_mfma_f32_16x16x32_bf16 v[180:183], a[40:43], a[180:183], v[180:183]
  ds_read_b64_tr_b16 a[34:35], v5 offset:18688
  s_waitcnt lgkmcnt(10)
  v_mfma_f32_16x16x32_bf16 v[184:187], a[44:47], a[124:127], v[184:187]
  ds_read_b64_tr_b16 a[36:37], v6 offset:16640
  v_mfma_f32_16x16x32_bf16 v[188:191], a[44:47], a[180:183], v[188:191]
  ds_read_b64_tr_b16 a[38:39], v6 offset:18688
  s_waitcnt lgkmcnt(10)
  v_mfma_f32_16x16x32_bf16 v[192:195], a[48:51], a[124:127], v[192:195]
  ds_read_b64_tr_b16 a[40:41], v7 offset:16640
  v_mfma_f32_16x16x32_bf16 v[196:199], a[48:51], a[180:183], v[196:199]
  ds_read_b64_tr_b16 a[42:43], v7 offset:18688
  s_waitcnt lgkmcnt(10)
  v_mfma_f32_16x16x32_bf16 v[200:203], a[52:55], a[124:127], v[200:203]
  ds_read_b64_tr_b16 a[44:45], v8 offset:16640
  v_mfma_f32_16x16x32_bf16 v[204:207], a[52:55], a[180:183], v[204:207]
  ds_read_b64_tr_b16 a[46:47], v8 offset:18688
  buffer_store_dwordx4 v[84:87], v21, s[20:23], s54 offen offset:3072 sc1
  s_waitcnt lgkmcnt(10)
  v_mfma_f32_16x16x32_bf16 v[208:211], a[56:59], a[124:127], v[208:211]
  ds_read_b64_tr_b16 a[48:49], v9 offset:16640
  v_mfma_f32_16x16x32_bf16 v[212:215], a[56:59], a[180:183], v[212:215]
  ds_read_b64_tr_b16 a[50:51], v9 offset:18688
  s_waitcnt lgkmcnt(10)
  v_mfma_f32_16x16x32_bf16 v[216:219], a[60:63], a[124:127], v[216:219]
  ds_read_b64_tr_b16 a[52:53], v10 offset:16640
  v_mfma_f32_16x16x32_bf16 v[220:223], a[60:63], a[180:183], v[220:223]
  ds_read_b64_tr_b16 a[54:55], v10 offset:18688
  s_waitcnt lgkmcnt(10)
  v_mfma_f32_16x16x32_bf16 v[224:227], a[32:35], a[124:127], v[224:227]
  ds_read_b64_tr_b16 a[56:57], v11 offset:16640
  v_mfma_f32_16x16x32_bf16 v[228:231], a[32:35], a[180:183], v[228:231]
  ds_read_b64_tr_b16 a[58:59], v11 offset:18688
  s_waitcnt lgkmcnt(10)
  v_mfma_f32_16x16x32_bf16 v[232:235], a[36:39], a[124:127], v[232:235]
  ds_read_b64_tr_b16 a[60:61], v12 offset:16640
  v_mfma_f32_16x16x32_bf16 v[236:239], a[36:39], a[180:183], v[236:239]
  ds_read_b64_tr_b16 a[62:63], v12 offset:18688
  buffer_store_dwordx4 v[88:91], v21, s[20:23], s55 offen offset:2048 sc1
  s_waitcnt lgkmcnt(10)
  v_mfma_f32_16x16x32_bf16 v[240:243], a[40:43], a[124:127], v[240:243]
  ds_read_b64_tr_b16 a[32:33], v5 offset:32768
  v_mfma_f32_16x16x32_bf16 v[244:247], a[40:43], a[180:183], v[244:247]
  ds_read_b64_tr_b16 a[34:35], v5 offset:34816
  s_waitcnt lgkmcnt(10)
  v_mfma_f32_16x16x32_bf16 v[248:251], a[44:47], a[124:127], v[248:251]
  ds_read_b64_tr_b16 a[36:37], v6 offset:32768
  v_mfma_f32_16x16x32_bf16 v[252:255], a[44:47], a[180:183], v[252:255]
  ds_read_b64_tr_b16 a[38:39], v6 offset:34816
  s_waitcnt lgkmcnt(10)
  v_mfma_f32_16x16x32_bf16 a[0:3], a[48:51], a[124:127], a[0:3]
  ds_read_b64_tr_b16 a[40:41], v7 offset:32768
  v_mfma_f32_16x16x32_bf16 a[4:7], a[48:51], a[180:183], a[4:7]
  ds_read_b64_tr_b16 a[42:43], v7 offset:34816
  s_waitcnt lgkmcnt(10)
  v_mfma_f32_16x16x32_bf16 a[8:11], a[52:55], a[124:127], a[8:11]
  ds_read_b64_tr_b16 a[44:45], v8 offset:32768
  v_mfma_f32_16x16x32_bf16 a[12:15], a[52:55], a[180:183], a[12:15]
  ds_read_b64_tr_b16 a[46:47], v8 offset:34816
  buffer_store_dwordx4 v[92:95], v21, s[20:23], s55 offen offset:3072 sc1
  s_waitcnt lgkmcnt(10)
  v_mfma_f32_16x16x32_bf16 a[16:19], a[56:59], a[124:127], a[16:19]
  ds_read_b64_tr_b16 a[48:49], v9 offset:32768
  v_mfma_f32_16x16x32_bf16 a[20:23], a[56:59], a[180:183], a[20:23]
  ds_read_b64_tr_b16 a[50:51], v9 offset:34816
  s_waitcnt lgkmcnt(10)
  v_mfma_f32_16x16x32_bf16 a[24:27], a[60:63], a[124:127], a[24:27]
  ds_read_b64_tr_b16 a[52:53], v10 offset:32768
  v_mfma_f32_16x16x32_bf16 a[28:31], a[60:63], a[180:183], a[28:31]
  ds_read_b64_tr_b16 a[54:55], v10 offset:34816
  s_waitcnt vmcnt(30)
  s_barrier
  s_waitcnt lgkmcnt(10)
  v_mfma_f32_16x16x32_bf16 v[160:163], a[32:35], a[128:131], v[160:163]
  ds_read_b64_tr_b16 a[56:57], v11 offset:32768
  v_mfma_f32_16x16x32_bf16 v[164:167], a[32:35], a[184:187], v[164:167]
  ds_read_b64_tr_b16 a[58:59], v11 offset:34816
  s_add_u32 m0, s58, 32768
  s_waitcnt lgkmcnt(10)
  v_mfma_f32_16x16x32_bf16 v[168:171], a[36:39], a[128:131], v[168:171]
  ds_read_b64_tr_b16 a[60:61], v12 offset:32768
  s_mov_b32 s59, 2621440
  v_mfma_f32_16x16x32_bf16 v[172:175], a[36:39], a[184:187], v[172:175]
  ds_read_b64_tr_b16 a[62:63], v12 offset:34816
  buffer_load_dwordx4 v17, s[12:15], s59 offen offset:0 lds
  s_waitcnt lgkmcnt(10)
  v_mfma_f32_16x16x32_bf16 v[176:179], a[40:43], a[128:131], v[176:179]
  ds_read_b64_tr_b16 a[32:33], v5 offset:33024
  buffer_load_dwordx4 v18, s[12:15], s59 offen offset:1024 lds
  v_mfma_f32_16x16x32_bf16 v[180:183], a[40:43], a[184:187], v[180:183]
  ds_read_b64_tr_b16 a[34:35], v5 offset:35072
  buffer_load_dwordx4 v19, s[12:15], s59 offen offset:2048 lds
  s_waitcnt lgkmcnt(10)
  v_mfma_f32_16x16x32_bf16 v[184:187], a[44:47], a[128:131], v[184:187]
  ds_read_b64_tr_b16 a[36:37], v6 offset:33024
  buffer_load_dwordx4 v20, s[12:15], s59 offen offset:3072 lds
  v_mfma_f32_16x16x32_bf16 v[188:191], a[44:47], a[184:187], v[188:191]
  ds_read_b64_tr_b16 a[38:39], v6 offset:35072
  s_add_u32 m0, s58, 49152
  s_waitcnt lgkmcnt(10)
  v_mfma_f32_16x16x32_bf16 v[192:195], a[48:51], a[128:131], v[192:195]
  ds_read_b64_tr_b16 a[40:41], v7 offset:33024
  s_mov_b32 s59, 2883584
  v_mfma_f32_16x16x32_bf16 v[196:199], a[48:51], a[184:187], v[196:199]
  ds_read_b64_tr_b16 a[42:43], v7 offset:35072
  buffer_load_dwordx4 v17, s[12:15], s59 offen offset:0 lds
  s_waitcnt lgkmcnt(10)
  v_mfma_f32_16x16x32_bf16 v[200:203], a[52:55], a[128:131], v[200:203]
  ds_read_b64_tr_b16 a[44:45], v8 offset:33024
  buffer_load_dwordx4 v18, s[12:15], s59 offen offset:1024 lds
  v_mfma_f32_16x16x32_bf16 v[204:207], a[52:55], a[184:187], v[204:207]
  ds_read_b64_tr_b16 a[46:47], v8 offset:35072
  buffer_load_dwordx4 v19, s[12:15], s59 offen offset:2048 lds
  s_waitcnt lgkmcnt(10)
  v_mfma_f32_16x16x32_bf16 v[208:211], a[56:59], a[128:131], v[208:211]
  ds_read_b64_tr_b16 a[48:49], v9 offset:33024
  buffer_load_dwordx4 v20, s[12:15], s59 offen offset:3072 lds
  v_mfma_f32_16x16x32_bf16 v[212:215], a[56:59], a[184:187], v[212:215]
  ds_read_b64_tr_b16 a[50:51], v9 offset:35072
  s_add_u32 m0, s58, 65536
  s_waitcnt lgkmcnt(10)
  v_mfma_f32_16x16x32_bf16 v[216:219], a[60:63], a[128:131], v[216:219]
  ds_read_b64_tr_b16 a[52:53], v10 offset:33024
  s_mov_b32 s59, 3145728
  v_mfma_f32_16x16x32_bf16 v[220:223], a[60:63], a[184:187], v[220:223]
  ds_read_b64_tr_b16 a[54:55], v10 offset:35072
  buffer_load_dwordx4 v17, s[12:15], s59 offen offset:0 lds
  s_waitcnt lgkmcnt(10)
  v_mfma_f32_16x16x32_bf16 v[224:227], a[32:35], a[128:131], v[224:227]
  ds_read_b64_tr_b16 a[56:57], v11 offset:33024
  buffer_load_dwordx4 v18, s[12:15], s59 offen offset:1024 lds
  v_mfma_f32_16x16x32_bf16 v[228:231], a[32:35], a[184:187], v[228:231]
  ds_read_b64_tr_b16 a[58:59], v11 offset:35072
  buffer_load_dwordx4 v19, s[12:15], s59 offen offset:2048 lds
  s_waitcnt lgkmcnt(10)
  v_mfma_f32_16x16x32_bf16 v[232:235], a[36:39], a[128:131], v[232:235]
  ds_read_b64_tr_b16 a[60:61], v12 offset:33024
  buffer_load_dwordx4 v20, s[12:15], s59 offen offset:3072 lds
  v_mfma_f32_16x16x32_bf16 v[236:239], a[36:39], a[184:187], v[236:239]
  ds_read_b64_tr_b16 a[62:63], v12 offset:35072
  s_add_u32 m0, s58, 81920
  s_waitcnt lgkmcnt(10)
  v_mfma_f32_16x16x32_bf16 v[240:243], a[40:43], a[128:131], v[240:243]
  ds_read_b64_tr_b16 a[32:33], v5 offset:49152
  s_mov_b32 s59, 3407872
  v_mfma_f32_16x16x32_bf16 v[244:247], a[40:43], a[184:187], v[244:247]
  ds_read_b64_tr_b16 a[34:35], v5 offset:51200
  buffer_load_dwordx4 v17, s[12:15], s59 offen offset:0 lds
  s_waitcnt lgkmcnt(10)
  v_mfma_f32_16x16x32_bf16 v[248:251], a[44:47], a[128:131], v[248:251]
  ds_read_b64_tr_b16 a[36:37], v6 offset:49152
  buffer_load_dwordx4 v18, s[12:15], s59 offen offset:1024 lds
  v_mfma_f32_16x16x32_bf16 v[252:255], a[44:47], a[184:187], v[252:255]
  ds_read_b64_tr_b16 a[38:39], v6 offset:51200
  buffer_load_dwordx4 v19, s[12:15], s59 offen offset:2048 lds
  s_waitcnt lgkmcnt(10)
  v_mfma_f32_16x16x32_bf16 a[0:3], a[48:51], a[128:131], a[0:3]
  ds_read_b64_tr_b16 a[40:41], v7 offset:49152
  buffer_load_dwordx4 v20, s[12:15], s59 offen offset:3072 lds
  v_mfma_f32_16x16x32_bf16 a[4:7], a[48:51], a[184:187], a[4:7]
  ds_read_b64_tr_b16 a[42:43], v7 offset:51200
  s_waitcnt lgkmcnt(10)
  v_mfma_f32_16x16x32_bf16 a[8:11], a[52:55], a[128:131], a[8:11]
  ds_read_b64_tr_b16 a[44:45], v8 offset:49152
  v_mfma_f32_16x16x32_bf16 a[12:15], a[52:55], a[184:187], a[12:15]
  ds_read_b64_tr_b16 a[46:47], v8 offset:51200
  s_waitcnt lgkmcnt(10)
  v_mfma_f32_16x16x32_bf16 a[16:19], a[56:59], a[128:131], a[16:19]
  ds_read_b64_tr_b16 a[48:49], v9 offset:49152
  v_mfma_f32_16x16x32_bf16 a[20:23], a[56:59], a[184:187], a[20:23]
  ds_read_b64_tr_b16 a[50:51], v9 offset:51200
  s_waitcnt lgkmcnt(10)
  v_mfma_f32_16x16x32_bf16 a[24:27], a[60:63], a[128:131], a[24:27]
  ds_read_b64_tr_b16 a[52:53], v10 offset:49152
  v_mfma_f32_16x16x32_bf16 a[28:31], a[60:63], a[184:187], a[28:31]
  ds_read_b64_tr_b16 a[54:55], v10 offset:51200
  s_waitcnt lgkmcnt(10)
  v_mfma_f32_16x16x32_bf16 v[160:163], a[32:35], a[132:135], v[160:163]
  ds_read_b64_tr_b16 a[56:57], v11 offset:49152
  v_mfma_f32_16x16x32_bf16 v[164:167], a[32:35], a[188:191], v[164:167]
  ds_read_b64_tr_b16 a[58:59], v11 offset:51200
  s_waitcnt lgkmcnt(10)
  v_mfma_f32_16x16x32_bf16 v[168:171], a[36:39], a[132:135], v[168:171]
  ds_read_b64_tr_b16 a[60:61], v12 offset:49152
  v_mfma_f32_16x16x32_bf16 v[172:175], a[36:39], a[188:191], v[172:175]
  ds_read_b64_tr_b16 a[62:63], v12 offset:51200
  buffer_store_dwordx4 v[96:99], v22, s[20:23], s52 offen offset:0 sc1
  s_waitcnt lgkmcnt(10)
  v_mfma_f32_16x16x32_bf16 v[176:179], a[40:43], a[132:135], v[176:179]
  ds_read_b64_tr_b16 a[32:33], v5 offset:49408
  v_mfma_f32_16x16x32_bf16 v[180:183], a[40:43], a[188:191], v[180:183]
  ds_read_b64_tr_b16 a[34:35], v5 offset:51456
  s_waitcnt lgkmcnt(10)
  v_mfma_f32_16x16x32_bf16 v[184:187], a[44:47], a[132:135], v[184:187]
  ds_read_b64_tr_b16 a[36:37], v6 offset:49408
  v_mfma_f32_16x16x32_bf16 v[188:191], a[44:47], a[188:191], v[188:191]
  ds_read_b64_tr_b16 a[38:39], v6 offset:51456
  s_waitcnt lgkmcnt(10)
  v_mfma_f32_16x16x32_bf16 v[192:195], a[48:51], a[132:135], v[192:195]
  ds_read_b64_tr_b16 a[40:41], v7 offset:49408
  v_mfma_f32_16x16x32_bf16 v[196:199], a[48:51], a[188:191], v[196:199]
  ds_read_b64_tr_b16 a[42:43], v7 offset:51456
  s_waitcnt lgkmcnt(10)
  v_mfma_f32_16x16x32_bf16 v[200:203], a[52:55], a[132:135], v[200:203]
  ds_read_b64_tr_b16 a[44:45], v8 offset:49408
  v_mfma_f32_16x16x32_bf16 v[204:207], a[52:55], a[188:191], v[204:207]
  ds_read_b64_tr_b16 a[46:47], v8 offset:51456
  buffer_store_dwordx4 v[100:103], v22, s[20:23], s52 offen offset:1024 sc1
  s_waitcnt lgkmcnt(10)
  v_mfma_f32_16x16x32_bf16 v[208:211], a[56:59], a[132:135], v[208:211]
  ds_read_b64_tr_b16 a[48:49], v9 offset:49408
  v_mfma_f32_16x16x32_bf16 v[212:215], a[56:59], a[188:191], v[212:215]
  ds_read_b64_tr_b16 a[50:51], v9 offset:51456
  s_waitcnt lgkmcnt(10)
  v_mfma_f32_16x16x32_bf16 v[216:219], a[60:63], a[132:135], v[216:219]
  ds_read_b64_tr_b16 a[52:53], v10 offset:49408
  v_mfma_f32_16x16x32_bf16 v[220:223], a[60:63], a[188:191], v[220:223]
  ds_read_b64_tr_b16 a[54:55], v10 offset:51456
  s_waitcnt lgkmcnt(10)
  v_mfma_f32_16x16x32_bf16 v[224:227], a[32:35], a[132:135], v[224:227]
  ds_read_b64_tr_b16 a[56:57], v11 offset:49408
  v_mfma_f32_16x16x32_bf16 v[228:231], a[32:35], a[188:191], v[228:231]
  ds_read_b64_tr_b16 a[58:59], v11 offset:51456
  s_waitcnt lgkmcnt(10)
  v_mfma_f32_16x16x32_bf16 v[232:235], a[36:39], a[132:135], v[232:235]
  ds_read_b64_tr_b16 a[60:61], v12 offset:49408
  v_mfma_f32_16x16x32_bf16 v[236:239], a[36:39], a[188:191], v[236:239]
  ds_read_b64_tr_b16 a[62:63], v12 offset:51456
  buffer_store_dwordx4 v[104:107], v22, s[20:23], s53 offen offset:0 sc1
  s_waitcnt lgkmcnt(10)
  v_mfma_f32_16x16x32_bf16 v[240:243], a[40:43], a[132:135], v[240:243]
  v_add_u32 v5, 0x10000, v5
  ds_read_b64_tr_b16 a[32:33], v5 offset:0
  v_mfma_f32_16x16x32_bf16 v[244:247], a[40:43], a[188:191], v[244:247]
  ds_read_b64_tr_b16 a[34:35], v5 offset:2048
  s_waitcnt lgkmcnt(10)
  v_mfma_f32_16x16x32_bf16 v[248:251], a[44:47], a[132:135], v[248:251]
  v_add_u32 v6, 0x10000, v6
  ds_read_b64_tr_b16 a[36:37], v6 offset:0
  v_mfma_f32_16x16x32_bf16 v[252:255], a[44:47], a[188:191], v[252:255]
  ds_read_b64_tr_b16 a[38:39], v6 offset:2048
  s_waitcnt lgkmcnt(10)
  v_mfma_f32_16x16x32_bf16 a[0:3], a[48:51], a[132:135], a[0:3]
  v_add_u32 v7, 0x10000, v7
  ds_read_b64_tr_b16 a[40:41], v7 offset:0
  v_mfma_f32_16x16x32_bf16 a[4:7], a[48:51], a[188:191], a[4:7]
  ds_read_b64_tr_b16 a[42:43], v7 offset:2048
  s_waitcnt lgkmcnt(10)
  v_mfma_f32_16x16x32_bf16 a[8:11], a[52:55], a[132:135], a[8:11]
  v_add_u32 v8, 0x10000, v8
  ds_read_b64_tr_b16 a[44:45], v8 offset:0
  v_mfma_f32_16x16x32_bf16 a[12:15], a[52:55], a[188:191], a[12:15]
  ds_read_b64_tr_b16 a[46:47], v8 offset:2048
  buffer_store_dwordx4 v[108:111], v22, s[20:23], s53 offen offset:1024 sc1
  s_waitcnt lgkmcnt(10)
  v_mfma_f32_16x16x32_bf16 a[16:19], a[56:59], a[132:135], a[16:19]
  v_add_u32 v9, 0x10000, v9
  ds_read_b64_tr_b16 a[48:49], v9 offset:0
  v_mfma_f32_16x16x32_bf16 a[20:23], a[56:59], a[188:191], a[20:23]
  ds_read_b64_tr_b16 a[50:51], v9 offset:2048
  s_waitcnt lgkmcnt(10)
  v_mfma_f32_16x16x32_bf16 a[24:27], a[60:63], a[132:135], a[24:27]
  v_add_u32 v10, 0x10000, v10
  ds_read_b64_tr_b16 a[52:53], v10 offset:0
  v_mfma_f32_16x16x32_bf16 a[28:31], a[60:63], a[188:191], a[28:31]
  ds_read_b64_tr_b16 a[54:55], v10 offset:2048
  v_add_u32 v11, 0x10000, v11
  v_add_u32 v12, 0x10000, v12
  s_waitcnt lgkmcnt(10)
  v_mfma_f32_16x16x32_bf16 v[160:163], a[32:35], a[136:139], v[160:163]
  ds_read_b64_tr_b16 a[56:57], v11 offset:0
  v_mfma_f32_16x16x32_bf16 v[164:167], a[32:35], a[192:195], v[164:167]
  ds_read_b64_tr_b16 a[58:59], v11 offset:2048
  s_waitcnt lgkmcnt(10)
  v_mfma_f32_16x16x32_bf16 v[168:171], a[36:39], a[136:139], v[168:171]
  ds_read_b64_tr_b16 a[60:61], v12 offset:0
  v_mfma_f32_16x16x32_bf16 v[172:175], a[36:39], a[192:195], v[172:175]
  ds_read_b64_tr_b16 a[62:63], v12 offset:2048
  buffer_store_dwordx4 v[112:115], v22, s[20:23], s54 offen offset:0 sc1
  s_waitcnt lgkmcnt(10)
  v_mfma_f32_16x16x32_bf16 v[176:179], a[40:43], a[136:139], v[176:179]
  ds_read_b64_tr_b16 a[32:33], v5 offset:256
  v_mfma_f32_16x16x32_bf16 v[180:183], a[40:43], a[192:195], v[180:183]
  ds_read_b64_tr_b16 a[34:35], v5 offset:2304
  s_waitcnt lgkmcnt(10)
  v_mfma_f32_16x16x32_bf16 v[184:187], a[44:47], a[136:139], v[184:187]
  ds_read_b64_tr_b16 a[36:37], v6 offset:256
  v_mfma_f32_16x16x32_bf16 v[188:191], a[44:47], a[192:195], v[188:191]
  ds_read_b64_tr_b16 a[38:39], v6 offset:2304
  s_waitcnt lgkmcnt(10)
  v_mfma_f32_16x16x32_bf16 v[192:195], a[48:51], a[136:139], v[192:195]
  ds_read_b64_tr_b16 a[40:41], v7 offset:256
  v_mfma_f32_16x16x32_bf16 v[196:199], a[48:51], a[192:195], v[196:199]
  ds_read_b64_tr_b16 a[42:43], v7 offset:2304
  s_waitcnt lgkmcnt(10)
  v_mfma_f32_16x16x32_bf16 v[200:203], a[52:55], a[136:139], v[200:203]
  ds_read_b64_tr_b16 a[44:45], v8 offset:256
  v_mfma_f32_16x16x32_bf16 v[204:207], a[52:55], a[192:195], v[204:207]
  ds_read_b64_tr_b16 a[46:47], v8 offset:2304
  buffer_store_dwordx4 v[116:119], v22, s[20:23], s54 offen offset:1024 sc1
  s_waitcnt lgkmcnt(10)
  v_mfma_f32_16x16x32_bf16 v[208:211], a[56:59], a[136:139], v[208:211]
  ds_read_b64_tr_b16 a[48:49], v9 offset:256
  v_mfma_f32_16x16x32_bf16 v[212:215], a[56:59], a[192:195], v[212:215]
  ds_read_b64_tr_b16 a[50:51], v9 offset:2304
  s_waitcnt lgkmcnt(10)
  v_mfma_f32_16x16x32_bf16 v[216:219], a[60:63], a[136:139], v[216:219]
  ds_read_b64_tr_b16 a[52:53], v10 offset:256
  v_mfma_f32_16x16x32_bf16 v[220:223], a[60:63], a[192:195], v[220:223]
  ds_read_b64_tr_b16 a[54:55], v10 offset:2304
  s_waitcnt lgkmcnt(10)
  v_mfma_f32_16x16x32_bf16 v[224:227], a[32:35], a[136:139], v[224:227]
  ds_read_b64_tr_b16 a[56:57], v11 offset:256
  v_mfma_f32_16x16x32_bf16 v[228:231], a[32:35], a[192:195], v[228:231]
  ds_read_b64_tr_b16 a[58:59], v11 offset:2304
  s_waitcnt lgkmcnt(10)
  v_mfma_f32_16x16x32_bf16 v[232:235], a[36:39], a[136:139], v[232:235]
  ds_read_b64_tr_b16 a[60:61], v12 offset:256
  v_mfma_f32_16x16x32_bf16 v[236:239], a[36:39], a[192:195], v[236:239]
  ds_read_b64_tr_b16 a[62:63], v12 offset:2304
  buffer_store_dwordx4 v[120:123], v22, s[20:23], s55 offen offset:0 sc1
  s_waitcnt lgkmcnt(10)
  v_mfma_f32_16x16x32_bf16 v[240:243], a[40:43], a[136:139], v[240:243]
  ds_read_b64_tr_b16 a[32:33], v5 offset:16384
  v_mfma_f32_16x16x32_bf16 v[244:247], a[40:43], a[192:195], v[244:247]
  ds_read_b64_tr_b16 a[34:35], v5 offset:18432
  s_waitcnt lgkmcnt(10)
  v_mfma_f32_16x16x32_bf16 v[248:251], a[44:47], a[136:139], v[248:251]
  ds_read_b64_tr_b16 a[36:37], v6 offset:16384
  v_mfma_f32_16x16x32_bf16 v[252:255], a[44:47], a[192:195], v[252:255]
  ds_read_b64_tr_b16 a[38:39], v6 offset:18432
  s_waitcnt lgkmcnt(10)
  v_mfma_f32_16x16x32_bf16 a[0:3], a[48:51], a[136:139], a[0:3]
  ds_read_b64_tr_b16 a[40:41], v7 offset:16384
  v_mfma_f32_16x16x32_bf16 a[4:7], a[48:51], a[192:195], a[4:7]
  ds_read_b64_tr_b16 a[42:43], v7 offset:18432
  s_waitcnt lgkmcnt(10)
  v_mfma_f32_16x16x32_bf16 a[8:11], a[52:55], a[136:139], a[8:11]
  ds_read_b64_tr_b16 a[44:45], v8 offset:16384
  v_mfma_f32_16x16x32_bf16 a[12:15], a[52:55], a[192:195], a[12:15]
  ds_read_b64_tr_b16 a[46:47], v8 offset:18432
  buffer_store_dwordx4 v[124:127], v22, s[20:23], s55 offen offset:1024 sc1
  s_waitcnt lgkmcnt(10)
  v_mfma_f32_16x16x32_bf16 a[16:19], a[56:59], a[136:139], a[16:19]
  ds_read_b64_tr_b16 a[48:49], v9 offset:16384
  v_mfma_f32_16x16x32_bf16 a[20:23], a[56:59], a[192:195], a[20:23]
  ds_read_b64_tr_b16 a[50:51], v9 offset:18432
  s_waitcnt lgkmcnt(10)
  v_mfma_f32_16x16x32_bf16 a[24:27], a[60:63], a[136:139], a[24:27]
  ds_read_b64_tr_b16 a[52:53], v10 offset:16384
  v_mfma_f32_16x16x32_bf16 a[28:31], a[60:63], a[192:195], a[28:31]
  ds_read_b64_tr_b16 a[54:55], v10 offset:18432
  s_waitcnt vmcnt(52)
  s_waitcnt lgkmcnt(10)
  v_mfma_f32_16x16x32_bf16 v[160:163], a[32:35], a[140:143], v[160:163]
  ds_read_b64_tr_b16 a[56:57], v11 offset:16384
  v_mfma_f32_16x16x32_bf16 v[164:167], a[32:35], a[196:199], v[164:167]
  ds_read_b64_tr_b16 a[58:59], v11 offset:18432
  s_waitcnt lgkmcnt(10)
  v_mfma_f32_16x16x32_bf16 v[168:171], a[36:39], a[140:143], v[168:171]
  ds_read_b64_tr_b16 a[60:61], v12 offset:16384
  v_mfma_f32_16x16x32_bf16 v[172:175], a[36:39], a[196:199], v[172:175]
  ds_read_b64_tr_b16 a[62:63], v12 offset:18432
  buffer_store_dwordx4 v[128:131], v22, s[20:23], s52 offen offset:2048 sc1
  s_waitcnt lgkmcnt(10)
  v_mfma_f32_16x16x32_bf16 v[176:179], a[40:43], a[140:143], v[176:179]
  ds_read_b64_tr_b16 a[32:33], v5 offset:16640
  v_mfma_f32_16x16x32_bf16 v[180:183], a[40:43], a[196:199], v[180:183]
  ds_read_b64_tr_b16 a[34:35], v5 offset:18688
  s_waitcnt lgkmcnt(10)
  v_mfma_f32_16x16x32_bf16 v[184:187], a[44:47], a[140:143], v[184:187]
  ds_read_b64_tr_b16 a[36:37], v6 offset:16640
  v_mfma_f32_16x16x32_bf16 v[188:191], a[44:47], a[196:199], v[188:191]
  ds_read_b64_tr_b16 a[38:39], v6 offset:18688
  s_waitcnt lgkmcnt(10)
  v_mfma_f32_16x16x32_bf16 v[192:195], a[48:51], a[140:143], v[192:195]
  ds_read_b64_tr_b16 a[40:41], v7 offset:16640
  v_mfma_f32_16x16x32_bf16 v[196:199], a[48:51], a[196:199], v[196:199]
  ds_read_b64_tr_b16 a[42:43], v7 offset:18688
  s_waitcnt lgkmcnt(10)
  v_mfma_f32_16x16x32_bf16 v[200:203], a[52:55], a[140:143], v[200:203]
  ds_read_b64_tr_b16 a[44:45], v8 offset:16640
  v_mfma_f32_16x16x32_bf16 v[204:207], a[52:55], a[196:199], v[204:207]
  ds_read_b64_tr_b16 a[46:47], v8 offset:18688
  buffer_store_dwordx4 v[132:135], v22, s[20:23], s52 offen offset:3072 sc1
  s_waitcnt lgkmcnt(10)
  v_mfma_f32_16x16x32_bf16 v[208:211], a[56:59], a[140:143], v[208:211]
  ds_read_b64_tr_b16 a[48:49], v9 offset:16640
  v_mfma_f32_16x16x32_bf16 v[212:215], a[56:59], a[196:199], v[212:215]
  ds_read_b64_tr_b16 a[50:51], v9 offset:18688
  s_waitcnt lgkmcnt(10)
  v_mfma_f32_16x16x32_bf16 v[216:219], a[60:63], a[140:143], v[216:219]
  ds_read_b64_tr_b16 a[52:53], v10 offset:16640
  v_mfma_f32_16x16x32_bf16 v[220:223], a[60:63], a[196:199], v[220:223]
  ds_read_b64_tr_b16 a[54:55], v10 offset:18688
  s_waitcnt lgkmcnt(10)
  v_mfma_f32_16x16x32_bf16 v[224:227], a[32:35], a[140:143], v[224:227]
  ds_read_b64_tr_b16 a[56:57], v11 offset:16640
  v_mfma_f32_16x16x32_bf16 v[228:231], a[32:35], a[196:199], v[228:231]
  ds_read_b64_tr_b16 a[58:59], v11 offset:18688
  s_waitcnt lgkmcnt(10)
  v_mfma_f32_16x16x32_bf16 v[232:235], a[36:39], a[140:143], v[232:235]
  ds_read_b64_tr_b16 a[60:61], v12 offset:16640
  v_mfma_f32_16x16x32_bf16 v[236:239], a[36:39], a[196:199], v[236:239]
  ds_read_b64_tr_b16 a[62:63], v12 offset:18688
  buffer_store_dwordx4 v[136:139], v22, s[20:23], s53 offen offset:2048 sc1
  s_waitcnt lgkmcnt(10)
  v_mfma_f32_16x16x32_bf16 v[240:243], a[40:43], a[140:143], v[240:243]
  v_add_u32 v5, 0xfffe0000, v5
  ds_read_b64_tr_b16 a[32:33], v5 offset:0
  v_mfma_f32_16x16x32_bf16 v[244:247], a[40:43], a[196:199], v[244:247]
  ds_read_b64_tr_b16 a[34:35], v5 offset:2048
  s_waitcnt lgkmcnt(10)
  v_mfma_f32_16x16x32_bf16 v[248:251], a[44:47], a[140:143], v[248:251]
  v_add_u32 v6, 0xfffe0000, v6
  ds_read_b64_tr_b16 a[36:37], v6 offset:0
  v_mfma_f32_16x16x32_bf16 v[252:255], a[44:47], a[196:199], v[252:255]
  ds_read_b64_tr_b16 a[38:39], v6 offset:2048
  s_waitcnt lgkmcnt(10)
  v_mfma_f32_16x16x32_bf16 a[0:3], a[48:51], a[140:143], a[0:3]
  v_add_u32 v7, 0xfffe0000, v7
  ds_read_b64_tr_b16 a[40:41], v7 offset:0
  v_mfma_f32_16x16x32_bf16 a[4:7], a[48:51], a[196:199], a[4:7]
  ds_read_b64_tr_b16 a[42:43], v7 offset:2048
  s_waitcnt lgkmcnt(10)
  v_mfma_f32_16x16x32_bf16 a[8:11], a[52:55], a[140:143], a[8:11]
  v_add_u32 v8, 0xfffe0000, v8
  ds_read_b64_tr_b16 a[44:45], v8 offset:0
  v_mfma_f32_16x16x32_bf16 a[12:15], a[52:55], a[196:199], a[12:15]
  ds_read_b64_tr_b16 a[46:47], v8 offset:2048
  buffer_store_dwordx4 v[140:143], v22, s[20:23], s53 offen offset:3072 sc1
  s_waitcnt lgkmcnt(10)
  v_mfma_f32_16x16x32_bf16 a[16:19], a[56:59], a[140:143], a[16:19]
  v_add_u32 v9, 0xfffe0000, v9
  ds_read_b64_tr_b16 a[48:49], v9 offset:0
  v_mfma_f32_16x16x32_bf16 a[20:23], a[56:59], a[196:199], a[20:23]
  ds_read_b64_tr_b16 a[50:51], v9 offset:2048
  s_waitcnt lgkmcnt(10)
  v_mfma_f32_16x16x32_bf16 a[24:27], a[60:63], a[140:143], a[24:27]
  v_add_u32 v10, 0xfffe0000, v10
  ds_read_b64_tr_b16 a[52:53], v10 offset:0
  v_mfma_f32_16x16x32_bf16 a[28:31], a[60:63], a[196:199], a[28:31]
  ds_read_b64_tr_b16 a[54:55], v10 offset:2048
  s_waitcnt vmcnt(54)
  v_add_u32 v11, 0xfffe0000, v11
  v_add_u32 v12, 0xfffe0000, v12
  s_waitcnt lgkmcnt(10)
  v_mfma_f32_16x16x32_bf16 v[160:163], a[32:35], a[144:147], v[160:163]
  ds_read_b64_tr_b16 a[56:57], v11 offset:0
  v_mfma_f32_16x16x32_bf16 v[164:167], a[32:35], a[200:203], v[164:167]
  ds_read_b64_tr_b16 a[58:59], v11 offset:2048
  s_waitcnt lgkmcnt(10)
  v_mfma_f32_16x16x32_bf16 v[168:171], a[36:39], a[144:147], v[168:171]
  ds_read_b64_tr_b16 a[60:61], v12 offset:0
  v_mfma_f32_16x16x32_bf16 v[172:175], a[36:39], a[200:203], v[172:175]
  ds_read_b64_tr_b16 a[62:63], v12 offset:2048
  buffer_store_dwordx4 v[144:147], v22, s[20:23], s54 offen offset:2048 sc1
  s_waitcnt lgkmcnt(10)
  v_mfma_f32_16x16x32_bf16 v[176:179], a[40:43], a[144:147], v[176:179]
  ds_read_b64_tr_b16 a[32:33], v5 offset:256
  v_mfma_f32_16x16x32_bf16 v[180:183], a[40:43], a[200:203], v[180:183]
  ds_read_b64_tr_b16 a[34:35], v5 offset:2304
  s_waitcnt lgkmcnt(10)
  v_mfma_f32_16x16x32_bf16 v[184:187], a[44:47], a[144:147], v[184:187]
  ds_read_b64_tr_b16 a[36:37], v6 offset:256
  v_mfma_f32_16x16x32_bf16 v[188:191], a[44:47], a[200:203], v[188:191]
  ds_read_b64_tr_b16 a[38:39], v6 offset:2304
  s_waitcnt lgkmcnt(10)
  v_mfma_f32_16x16x32_bf16 v[192:195], a[48:51], a[144:147], v[192:195]
  ds_read_b64_tr_b16 a[40:41], v7 offset:256
  v_mfma_f32_16x16x32_bf16 v[196:199], a[48:51], a[200:203], v[196:199]
  ds_read_b64_tr_b16 a[42:43], v7 offset:2304
  s_waitcnt lgkmcnt(10)
  v_mfma_f32_16x16x32_bf16 v[200:203], a[52:55], a[144:147], v[200:203]
  ds_read_b64_tr_b16 a[44:45], v8 offset:256
  v_mfma_f32_16x16x32_bf16 v[204:207], a[52:55], a[200:203], v[204:207]
  ds_read_b64_tr_b16 a[46:47], v8 offset:2304
  buffer_store_dwordx4 v[148:151], v22, s[20:23], s54 offen offset:3072 sc1
  s_waitcnt lgkmcnt(10)
  v_mfma_f32_16x16x32_bf16 v[208:211], a[56:59], a[144:147], v[208:211]
  ds_read_b64_tr_b16 a[48:49], v9 offset:256
  v_mfma_f32_16x16x32_bf16 v[212:215], a[56:59], a[200:203], v[212:215]
  ds_read_b64_tr_b16 a[50:51], v9 offset:2304
  s_waitcnt lgkmcnt(10)
  v_mfma_f32_16x16x32_bf16 v[216:219], a[60:63], a[144:147], v[216:219]
  ds_read_b64_tr_b16 a[52:53], v10 offset:256
  v_mfma_f32_16x16x32_bf16 v[220:223], a[60:63], a[200:203], v[220:223]
  ds_read_b64_tr_b16 a[54:55], v10 offset:2304
  s_waitcnt lgkmcnt(10)
  v_mfma_f32_16x16x32_bf16 v[224:227], a[32:35], a[144:147], v[224:227]
  ds_read_b64_tr_b16 a[56:57], v11 offset:256
  v_mfma_f32_16x16x32_bf16 v[228:231], a[32:35], a[200:203], v[228:231]
  ds_read_b64_tr_b16 a[58:59], v11 offset:2304
  s_waitcnt lgkmcnt(10)
  v_mfma_f32_16x16x32_bf16 v[232:235], a[36:39], a[144:147], v[232:235]
  ds_read_b64_tr_b16 a[60:61], v12 offset:256
  v_mfma_f32_16x16x32_bf16 v[236:239], a[36:39], a[200:203], v[236:239]
  ds_read_b64_tr_b16 a[62:63], v12 offset:2304
  buffer_store_dwordx4 v[152:155], v22, s[20:23], s55 offen offset:2048 sc1
  s_waitcnt lgkmcnt(10)
  v_mfma_f32_16x16x32_bf16 v[240:243], a[40:43], a[144:147], v[240:243]
  ds_read_b64_tr_b16 a[32:33], v5 offset:16384
  v_mfma_f32_16x16x32_bf16 v[244:247], a[40:43], a[200:203], v[244:247]
  ds_read_b64_tr_b16 a[34:35], v5 offset:18432
  s_waitcnt lgkmcnt(10)
  v_mfma_f32_16x16x32_bf16 v[248:251], a[44:47], a[144:147], v[248:251]
  ds_read_b64_tr_b16 a[36:37], v6 offset:16384
  v_mfma_f32_16x16x32_bf16 v[252:255], a[44:47], a[200:203], v[252:255]
  ds_read_b64_tr_b16 a[38:39], v6 offset:18432
  s_waitcnt lgkmcnt(10)
  v_mfma_f32_16x16x32_bf16 a[0:3], a[48:51], a[144:147], a[0:3]
  ds_read_b64_tr_b16 a[40:41], v7 offset:16384
  v_mfma_f32_16x16x32_bf16 a[4:7], a[48:51], a[200:203], a[4:7]
  ds_read_b64_tr_b16 a[42:43], v7 offset:18432
  s_waitcnt lgkmcnt(10)
  v_mfma_f32_16x16x32_bf16 a[8:11], a[52:55], a[144:147], a[8:11]
  ds_read_b64_tr_b16 a[44:45], v8 offset:16384
  v_mfma_f32_16x16x32_bf16 a[12:15], a[52:55], a[200:203], a[12:15]
  ds_read_b64_tr_b16 a[46:47], v8 offset:18432
  buffer_store_dwordx4 v[156:159], v22, s[20:23], s55 offen offset:3072 sc1
  s_waitcnt lgkmcnt(10)
  v_mfma_f32_16x16x32_bf16 a[16:19], a[56:59], a[144:147], a[16:19]
  ds_read_b64_tr_b16 a[48:49], v9 offset:16384
  v_mfma_f32_16x16x32_bf16 a[20:23], a[56:59], a[200:203], a[20:23]
  ds_read_b64_tr_b16 a[50:51], v9 offset:18432
  s_waitcnt lgkmcnt(10)
  v_mfma_f32_16x16x32_bf16 a[24:27], a[60:63], a[144:147], a[24:27]
  ds_read_b64_tr_b16 a[52:53], v10 offset:16384
  v_mfma_f32_16x16x32_bf16 a[28:31], a[60:63], a[200:203], a[28:31]
  ds_read_b64_tr_b16 a[54:55], v10 offset:18432
  s_waitcnt vmcnt(16)
  s_barrier
  s_waitcnt lgkmcnt(10)
  v_mfma_f32_16x16x32_bf16 v[160:163], a[32:35], a[148:151], v[160:163]
  ds_read_b64_tr_b16 a[56:57], v11 offset:16384
  v_mfma_f32_16x16x32_bf16 v[164:167], a[32:35], a[204:207], v[164:167]
  ds_read_b64_tr_b16 a[58:59], v11 offset:18432
  s_waitcnt lgkmcnt(10)
  v_mfma_f32_16x16x32_bf16 v[168:171], a[36:39], a[148:151], v[168:171]
  ds_read_b64_tr_b16 a[60:61], v12 offset:16384
  v_mfma_f32_16x16x32_bf16 v[172:175], a[36:39], a[204:207], v[172:175]
  ds_read_b64_tr_b16 a[62:63], v12 offset:18432
  s_waitcnt lgkmcnt(10)
  v_mfma_f32_16x16x32_bf16 v[176:179], a[40:43], a[148:151], v[176:179]
  ds_read_b64_tr_b16 a[32:33], v5 offset:16640
  v_mfma_f32_16x16x32_bf16 v[180:183], a[40:43], a[204:207], v[180:183]
  ds_read_b64_tr_b16 a[34:35], v5 offset:18688
  s_waitcnt lgkmcnt(10)
  v_mfma_f32_16x16x32_bf16 v[184:187], a[44:47], a[148:151], v[184:187]
  ds_read_b64_tr_b16 a[36:37], v6 offset:16640
  v_mfma_f32_16x16x32_bf16 v[188:191], a[44:47], a[204:207], v[188:191]
  ds_read_b64_tr_b16 a[38:39], v6 offset:18688
  s_waitcnt lgkmcnt(10)
  v_mfma_f32_16x16x32_bf16 v[192:195], a[48:51], a[148:151], v[192:195]
  ds_read_b64_tr_b16 a[40:41], v7 offset:16640
  v_mfma_f32_16x16x32_bf16 v[196:199], a[48:51], a[204:207], v[196:199]
  ds_read_b64_tr_b16 a[42:43], v7 offset:18688
  s_waitcnt lgkmcnt(10)
  v_mfma_f32_16x16x32_bf16 v[200:203], a[52:55], a[148:151], v[200:203]
  ds_read_b64_tr_b16 a[44:45], v8 offset:16640
  v_mfma_f32_16x16x32_bf16 v[204:207], a[52:55], a[204:207], v[204:207]
  ds_read_b64_tr_b16 a[46:47], v8 offset:18688
  s_waitcnt lgkmcnt(10)
  v_mfma_f32_16x16x32_bf16 v[208:211], a[56:59], a[148:151], v[208:211]
  ds_read_b64_tr_b16 a[48:49], v9 offset:16640
  v_mfma_f32_16x16x32_bf16 v[212:215], a[56:59], a[204:207], v[212:215]
  ds_read_b64_tr_b16 a[50:51], v9 offset:18688
  s_waitcnt lgkmcnt(10)
  v_mfma_f32_16x16x32_bf16 v[216:219], a[60:63], a[148:151], v[216:219]
  ds_read_b64_tr_b16 a[52:53], v10 offset:16640
  v_mfma_f32_16x16x32_bf16 v[220:223], a[60:63], a[204:207], v[220:223]
  ds_read_b64_tr_b16 a[54:55], v10 offset:18688
  s_waitcnt lgkmcnt(10)
  v_mfma_f32_16x16x32_bf16 v[224:227], a[32:35], a[148:151], v[224:227]
  ds_read_b64_tr_b16 a[56:57], v11 offset:16640
  v_mfma_f32_16x16x32_bf16 v[228:231], a[32:35], a[204:207], v[228:231]
  ds_read_b64_tr_b16 a[58:59], v11 offset:18688
  s_waitcnt lgkmcnt(10)
  v_mfma_f32_16x16x32_bf16 v[232:235], a[36:39], a[148:151], v[232:235]
  ds_read_b64_tr_b16 a[60:61], v12 offset:16640
  v_mfma_f32_16x16x32_bf16 v[236:239], a[36:39], a[204:207], v[236:239]
  ds_read_b64_tr_b16 a[62:63], v12 offset:18688
  s_waitcnt lgkmcnt(10)
  v_mfma_f32_16x16x32_bf16 v[240:243], a[40:43], a[148:151], v[240:243]
  ds_read_b64_tr_b16 a[32:33], v5 offset:32768
  v_mfma_f32_16x16x32_bf16 v[244:247], a[40:43], a[204:207], v[244:247]
  ds_read_b64_tr_b16 a[34:35], v5 offset:34816
  s_waitcnt lgkmcnt(10)
  v_mfma_f32_16x16x32_bf16 v[248:251], a[44:47], a[148:151], v[248:251]
  ds_read_b64_tr_b16 a[36:37], v6 offset:32768
  v_mfma_f32_16x16x32_bf16 v[252:255], a[44:47], a[204:207], v[252:255]
  ds_read_b64_tr_b16 a[38:39], v6 offset:34816
  s_waitcnt lgkmcnt(10)
  v_mfma_f32_16x16x32_bf16 a[0:3], a[48:51], a[148:151], a[0:3]
  ds_read_b64_tr_b16 a[40:41], v7 offset:32768
  v_mfma_f32_16x16x32_bf16 a[4:7], a[48:51], a[204:207], a[4:7]
  ds_read_b64_tr_b16 a[42:43], v7 offset:34816
  s_waitcnt lgkmcnt(10)
  v_mfma_f32_16x16x32_bf16 a[8:11], a[52:55], a[148:151], a[8:11]
  ds_read_b64_tr_b16 a[44:45], v8 offset:32768
  v_mfma_f32_16x16x32_bf16 a[12:15], a[52:55], a[204:207], a[12:15]
  ds_read_b64_tr_b16 a[46:47], v8 offset:34816
  s_waitcnt lgkmcnt(10)
  v_mfma_f32_16x16x32_bf16 a[16:19], a[56:59], a[148:151], a[16:19]
  ds_read_b64_tr_b16 a[48:49], v9 offset:32768
  v_mfma_f32_16x16x32_bf16 a[20:23], a[56:59], a[204:207], a[20:23]
  ds_read_b64_tr_b16 a[50:51], v9 offset:34816
  s_waitcnt lgkmcnt(10)
  v_mfma_f32_16x16x32_bf16 a[24:27], a[60:63], a[148:151], a[24:27]
  ds_read_b64_tr_b16 a[52:53], v10 offset:32768
  v_mfma_f32_16x16x32_bf16 a[28:31], a[60:63], a[204:207], a[28:31]
  ds_read_b64_tr_b16 a[54:55], v10 offset:34816
  s_waitcnt lgkmcnt(10)
  v_mfma_f32_16x16x32_bf16 v[160:163], a[32:35], a[152:155], v[160:163]
  ds_read_b64_tr_b16 a[56:57], v11 offset:32768
  v_mfma_f32_16x16x32_bf16 v[164:167], a[32:35], a[208:211], v[164:167]
  ds_read_b64_tr_b16 a[58:59], v11 offset:34816
  s_waitcnt lgkmcnt(10)
  v_mfma_f32_16x16x32_bf16 v[168:171], a[36:39], a[152:155], v[168:171]
  ds_read_b64_tr_b16 a[60:61], v12 offset:32768
  v_mfma_f32_16x16x32_bf16 v[172:175], a[36:39], a[208:211], v[172:175]
  ds_read_b64_tr_b16 a[62:63], v12 offset:34816
  s_waitcnt lgkmcnt(10)
  v_mfma_f32_16x16x32_bf16 v[176:179], a[40:43], a[152:155], v[176:179]
  ds_read_b64_tr_b16 a[32:33], v5 offset:33024
  v_mfma_f32_16x16x32_bf16 v[180:183], a[40:43], a[208:211], v[180:183]
  ds_read_b64_tr_b16 a[34:35], v5 offset:35072
  s_waitcnt lgkmcnt(10)
  v_mfma_f32_16x16x32_bf16 v[184:187], a[44:47], a[152:155], v[184:187]
  ds_read_b64_tr_b16 a[36:37], v6 offset:33024
  v_mfma_f32_16x16x32_bf16 v[188:191], a[44:47], a[208:211], v[188:191]
  ds_read_b64_tr_b16 a[38:39], v6 offset:35072
  s_waitcnt lgkmcnt(10)
  v_mfma_f32_16x16x32_bf16 v[192:195], a[48:51], a[152:155], v[192:195]
  ds_read_b64_tr_b16 a[40:41], v7 offset:33024
  v_mfma_f32_16x16x32_bf16 v[196:199], a[48:51], a[208:211], v[196:199]
  ds_read_b64_tr_b16 a[42:43], v7 offset:35072
  s_waitcnt lgkmcnt(10)
  v_mfma_f32_16x16x32_bf16 v[200:203], a[52:55], a[152:155], v[200:203]
  ds_read_b64_tr_b16 a[44:45], v8 offset:33024
  v_mfma_f32_16x16x32_bf16 v[204:207], a[52:55], a[208:211], v[204:207]
  ds_read_b64_tr_b16 a[46:47], v8 offset:35072
  s_waitcnt lgkmcnt(10)
  v_mfma_f32_16x16x32_bf16 v[208:211], a[56:59], a[152:155], v[208:211]
  ds_read_b64_tr_b16 a[48:49], v9 offset:33024
  v_mfma_f32_16x16x32_bf16 v[212:215], a[56:59], a[208:211], v[212:215]
  ds_read_b64_tr_b16 a[50:51], v9 offset:35072
  s_waitcnt lgkmcnt(10)
  v_mfma_f32_16x16x32_bf16 v[216:219], a[60:63], a[152:155], v[216:219]
  ds_read_b64_tr_b16 a[52:53], v10 offset:33024
  v_mfma_f32_16x16x32_bf16 v[220:223], a[60:63], a[208:211], v[220:223]
  ds_read_b64_tr_b16 a[54:55], v10 offset:35072
  s_waitcnt lgkmcnt(10)
  v_mfma_f32_16x16x32_bf16 v[224:227], a[32:35], a[152:155], v[224:227]
  ds_read_b64_tr_b16 a[56:57], v11 offset:33024
  v_mfma_f32_16x16x32_bf16 v[228:231], a[32:35], a[208:211], v[228:231]
  ds_read_b64_tr_b16 a[58:59], v11 offset:35072
  s_waitcnt lgkmcnt(10)
  v_mfma_f32_16x16x32_bf16 v[232:235], a[36:39], a[152:155], v[232:235]
  ds_read_b64_tr_b16 a[60:61], v12 offset:33024
  v_mfma_f32_16x16x32_bf16 v[236:239], a[36:39], a[208:211], v[236:239]
  ds_read_b64_tr_b16 a[62:63], v12 offset:35072
  s_waitcnt lgkmcnt(10)
  v_mfma_f32_16x16x32_bf16 v[240:243], a[40:43], a[152:155], v[240:243]
  ds_read_b64_tr_b16 a[32:33], v5 offset:49152
  v_mfma_f32_16x16x32_bf16 v[244:247], a[40:43], a[208:211], v[244:247]
  ds_read_b64_tr_b16 a[34:35], v5 offset:51200
  s_waitcnt lgkmcnt(10)
  v_mfma_f32_16x16x32_bf16 v[248:251], a[44:47], a[152:155], v[248:251]
  ds_read_b64_tr_b16 a[36:37], v6 offset:49152
  v_mfma_f32_16x16x32_bf16 v[252:255], a[44:47], a[208:211], v[252:255]
  ds_read_b64_tr_b16 a[38:39], v6 offset:51200
  s_waitcnt lgkmcnt(10)
  v_mfma_f32_16x16x32_bf16 a[0:3], a[48:51], a[152:155], a[0:3]
  ds_read_b64_tr_b16 a[40:41], v7 offset:49152
  v_mfma_f32_16x16x32_bf16 a[4:7], a[48:51], a[208:211], a[4:7]
  ds_read_b64_tr_b16 a[42:43], v7 offset:51200
  s_waitcnt lgkmcnt(10)
  v_mfma_f32_16x16x32_bf16 a[8:11], a[52:55], a[152:155], a[8:11]
  ds_read_b64_tr_b16 a[44:45], v8 offset:49152
  v_mfma_f32_16x16x32_bf16 a[12:15], a[52:55], a[208:211], a[12:15]
  ds_read_b64_tr_b16 a[46:47], v8 offset:51200
  s_waitcnt lgkmcnt(10)
  v_mfma_f32_16x16x32_bf16 a[16:19], a[56:59], a[152:155], a[16:19]
  ds_read_b64_tr_b16 a[48:49], v9 offset:49152
  v_mfma_f32_16x16x32_bf16 a[20:23], a[56:59], a[208:211], a[20:23]
  ds_read_b64_tr_b16 a[50:51], v9 offset:51200
  s_waitcnt lgkmcnt(10)
  v_mfma_f32_16x16x32_bf16 a[24:27], a[60:63], a[152:155], a[24:27]
  ds_read_b64_tr_b16 a[52:53], v10 offset:49152
  v_mfma_f32_16x16x32_bf16 a[28:31], a[60:63], a[208:211], a[28:31]
  ds_read_b64_tr_b16 a[54:55], v10 offset:51200
  s_waitcnt lgkmcnt(10)
  v_mfma_f32_16x16x32_bf16 v[160:163], a[32:35], a[156:159], v[160:163]
  ds_read_b64_tr_b16 a[56:57], v11 offset:49152
  v_mfma_f32_16x16x32_bf16 v[164:167], a[32:35], a[212:215], v[164:167]
  ds_read_b64_tr_b16 a[58:59], v11 offset:51200
  s_waitcnt lgkmcnt(10)
  v_mfma_f32_16x16x32_bf16 v[168:171], a[36:39], a[156:159], v[168:171]
  ds_read_b64_tr_b16 a[60:61], v12 offset:49152
  v_mfma_f32_16x16x32_bf16 v[172:175], a[36:39], a[212:215], v[172:175]
  ds_read_b64_tr_b16 a[62:63], v12 offset:51200
  s_waitcnt lgkmcnt(10)
  v_mfma_f32_16x16x32_bf16 v[176:179], a[40:43], a[156:159], v[176:179]
  ds_read_b64_tr_b16 a[32:33], v5 offset:49408
  v_mfma_f32_16x16x32_bf16 v[180:183], a[40:43], a[212:215], v[180:183]
  ds_read_b64_tr_b16 a[34:35], v5 offset:51456
  s_waitcnt lgkmcnt(10)
  v_mfma_f32_16x16x32_bf16 v[184:187], a[44:47], a[156:159], v[184:187]
  ds_read_b64_tr_b16 a[36:37], v6 offset:49408
  v_mfma_f32_16x16x32_bf16 v[188:191], a[44:47], a[212:215], v[188:191]
  ds_read_b64_tr_b16 a[38:39], v6 offset:51456
  s_waitcnt lgkmcnt(10)
  v_mfma_f32_16x16x32_bf16 v[192:195], a[48:51], a[156:159], v[192:195]
  ds_read_b64_tr_b16 a[40:41], v7 offset:49408
  v_mfma_f32_16x16x32_bf16 v[196:199], a[48:51], a[212:215], v[196:199]
  ds_read_b64_tr_b16 a[42:43], v7 offset:51456
  s_waitcnt lgkmcnt(10)
  v_mfma_f32_16x16x32_bf16 v[200:203], a[52:55], a[156:159], v[200:203]
  ds_read_b64_tr_b16 a[44:45], v8 offset:49408
  v_mfma_f32_16x16x32_bf16 v[204:207], a[52:55], a[212:215], v[204:207]
  ds_read_b64_tr_b16 a[46:47], v8 offset:51456
  s_waitcnt lgkmcnt(10)
  v_mfma_f32_16x16x32_bf16 v[208:211], a[56:59], a[156:159], v[208:211]
  ds_read_b64_tr_b16 a[48:49], v9 offset:49408
  v_mfma_f32_16x16x32_bf16 v[212:215], a[56:59], a[212:215], v[212:215]
  ds_read_b64_tr_b16 a[50:51], v9 offset:51456
  s_waitcnt lgkmcnt(10)
  v_mfma_f32_16x16x32_bf16 v[216:219], a[60:63], a[156:159], v[216:219]
  ds_read_b64_tr_b16 a[52:53], v10 offset:49408
  v_mfma_f32_16x16x32_bf16 v[220:223], a[60:63], a[212:215], v[220:223]
  ds_read_b64_tr_b16 a[54:55], v10 offset:51456
  s_waitcnt lgkmcnt(10)
  v_mfma_f32_16x16x32_bf16 v[224:227], a[32:35], a[156:159], v[224:227]
  ds_read_b64_tr_b16 a[56:57], v11 offset:49408
  v_mfma_f32_16x16x32_bf16 v[228:231], a[32:35], a[212:215], v[228:231]
  ds_read_b64_tr_b16 a[58:59], v11 offset:51456
  s_waitcnt lgkmcnt(10)
  v_mfma_f32_16x16x32_bf16 v[232:235], a[36:39], a[156:159], v[232:235]
  ds_read_b64_tr_b16 a[60:61], v12 offset:49408
  v_mfma_f32_16x16x32_bf16 v[236:239], a[36:39], a[212:215], v[236:239]
  ds_read_b64_tr_b16 a[62:63], v12 offset:51456
  s_waitcnt lgkmcnt(10)
  v_mfma_f32_16x16x32_bf16 v[240:243], a[40:43], a[156:159], v[240:243]
  v_add_u32 v5, 0x10000, v5
  ds_read_b64_tr_b16 a[32:33], v5 offset:0
  v_mfma_f32_16x16x32_bf16 v[244:247], a[40:43], a[212:215], v[244:247]
  ds_read_b64_tr_b16 a[34:35], v5 offset:2048
  s_waitcnt lgkmcnt(10)
  v_mfma_f32_16x16x32_bf16 v[248:251], a[44:47], a[156:159], v[248:251]
  v_add_u32 v6, 0x10000, v6
  ds_read_b64_tr_b16 a[36:37], v6 offset:0
  v_mfma_f32_16x16x32_bf16 v[252:255], a[44:47], a[212:215], v[252:255]
  ds_read_b64_tr_b16 a[38:39], v6 offset:2048
  s_waitcnt lgkmcnt(10)
  v_mfma_f32_16x16x32_bf16 a[0:3], a[48:51], a[156:159], a[0:3]
  v_add_u32 v7, 0x10000, v7
  ds_read_b64_tr_b16 a[40:41], v7 offset:0
  v_mfma_f32_16x16x32_bf16 a[4:7], a[48:51], a[212:215], a[4:7]
  ds_read_b64_tr_b16 a[42:43], v7 offset:2048
  s_waitcnt lgkmcnt(10)
  v_mfma_f32_16x16x32_bf16 a[8:11], a[52:55], a[156:159], a[8:11]
  v_add_u32 v8, 0x10000, v8
  ds_read_b64_tr_b16 a[44:45], v8 offset:0
  v_mfma_f32_16x16x32_bf16 a[12:15], a[52:55], a[212:215], a[12:15]
  ds_read_b64_tr_b16 a[46:47], v8 offset:2048
  s_waitcnt lgkmcnt(10)
  v_mfma_f32_16x16x32_bf16 a[16:19], a[56:59], a[156:159], a[16:19]
  v_add_u32 v9, 0x10000, v9
  ds_read_b64_tr_b16 a[48:49], v9 offset:0
  v_mfma_f32_16x16x32_bf16 a[20:23], a[56:59], a[212:215], a[20:23]
  ds_read_b64_tr_b16 a[50:51], v9 offset:2048
  s_waitcnt lgkmcnt(10)
  v_mfma_f32_16x16x32_bf16 a[24:27], a[60:63], a[156:159], a[24:27]
  v_add_u32 v10, 0x10000, v10
  ds_read_b64_tr_b16 a[52:53], v10 offset:0
  v_mfma_f32_16x16x32_bf16 a[28:31], a[60:63], a[212:215], a[28:31]
  ds_read_b64_tr_b16 a[54:55], v10 offset:2048
  s_waitcnt vmcnt(0)
  s_barrier
  s_cmp_eq_u32 s28, 0
  s_cbranch_scc0 k1_K_kvflag
  s_mov_b64 exec, 1
  v_mov_b32 v24, 1
  v_mov_b32 v25, s96
  buffer_store_dword v24, v25, s[40:43], 0 offen sc1
  s_mov_b64 exec, -1
k1_K_kvflag:
  s_lshl_b32 s67, s65, 7
  v_and_b32 v26, 15, v0
  v_lshl_add_u32 v26, v26, 2, s67
  v_add_u32 v11, 0x10000, v11
  v_add_u32 v12, 0x10000, v12
  s_waitcnt lgkmcnt(10)
  v_mfma_f32_16x16x32_bf16 v[160:163], a[32:35], a[160:163], v[160:163]
  ds_read_b64_tr_b16 a[56:57], v11 offset:0
  v_mfma_f32_16x16x32_bf16 v[164:167], a[32:35], a[216:219], v[164:167]
  ds_read_b64_tr_b16 a[58:59], v11 offset:2048
  s_waitcnt lgkmcnt(10)
  v_mfma_f32_16x16x32_bf16 v[168:171], a[36:39], a[160:163], v[168:171]
  ds_read_b64_tr_b16 a[60:61], v12 offset:0
  v_mfma_f32_16x16x32_bf16 v[172:175], a[36:39], a[216:219], v[172:175]
  ds_read_b64_tr_b16 a[62:63], v12 offset:2048
  s_waitcnt lgkmcnt(10)
  v_mfma_f32_16x16x32_bf16 v[176:179], a[40:43], a[160:163], v[176:179]
  ds_read_b64_tr_b16 a[32:33], v5 offset:256
  v_mfma_f32_16x16x32_bf16 v[180:183], a[40:43], a[216:219], v[180:183]
  ds_read_b64_tr_b16 a[34:35], v5 offset:2304
  s_waitcnt lgkmcnt(10)
  v_mfma_f32_16x16x32_bf16 v[184:187], a[44:47], a[160:163], v[184:187]
  ds_read_b64_tr_b16 a[36:37], v6 offset:256
  v_mfma_f32_16x16x32_bf16 v[188:191], a[44:47], a[216:219], v[188:191]
  ds_read_b64_tr_b16 a[38:39], v6 offset:2304
  s_waitcnt lgkmcnt(10)
  v_mfma_f32_16x16x32_bf16 v[192:195], a[48:51], a[160:163], v[192:195]
  ds_read_b64_tr_b16 a[40:41], v7 offset:256
  v_mfma_f32_16x16x32_bf16 v[196:199], a[48:51], a[216:219], v[196:199]
  ds_read_b64_tr_b16 a[42:43], v7 offset:2304
  s_waitcnt lgkmcnt(10)
  v_mfma_f32_16x16x32_bf16 v[200:203], a[52:55], a[160:163], v[200:203]
  ds_read_b64_tr_b16 a[44:45], v8 offset:256
  v_mfma_f32_16x16x32_bf16 v[204:207], a[52:55], a[216:219], v[204:207]
  ds_read_b64_tr_b16 a[46:47], v8 offset:2304
  s_waitcnt lgkmcnt(10)
  v_mfma_f32_16x16x32_bf16 v[208:211], a[56:59], a[160:163], v[208:211]
  ds_read_b64_tr_b16 a[48:49], v9 offset:256
  v_mfma_f32_16x16x32_bf16 v[212:215], a[56:59], a[216:219], v[212:215]
  ds_read_b64_tr_b16 a[50:51], v9 offset:2304
  s_waitcnt lgkmcnt(10)
  v_mfma_f32_16x16x32_bf16 v[216:219], a[60:63], a[160:163], v[216:219]
  ds_read_b64_tr_b16 a[52:53], v10 offset:256
  v_mfma_f32_16x16x32_bf16 v[220:223], a[60:63], a[216:219], v[220:223]
  ds_read_b64_tr_b16 a[54:55], v10 offset:2304
  s_waitcnt lgkmcnt(10)
  v_mfma_f32_16x16x32_bf16 v[224:227], a[32:35], a[160:163], v[224:227]
  ds_read_b64_tr_b16 a[56:57], v11 offset:256
  v_mfma_f32_16x16x32_bf16 v[228:231], a[32:35], a[216:219], v[228:231]
  ds_read_b64_tr_b16 a[58:59], v11 offset:2304
  s_waitcnt lgkmcnt(10)
  v_mfma_f32_16x16x32_bf16 v[232:235], a[36:39], a[160:163], v[232:235]
  ds_read_b64_tr_b16 a[60:61], v12 offset:256
  v_mfma_f32_16x16x32_bf16 v[236:239], a[36:39], a[216:219], v[236:239]
  ds_read_b64_tr_b16 a[62:63], v12 offset:2304
  s_waitcnt lgkmcnt(10)
  v_mfma_f32_16x16x32_bf16 v[240:243], a[40:43], a[160:163], v[240:243]
  ds_read_b64_tr_b16 a[32:33], v5 offset:16384
  v_mfma_f32_16x16x32_bf16 v[244:247], a[40:43], a[216:219], v[244:247]
  ds_read_b64_tr_b16 a[34:35], v5 offset:18432
  s_waitcnt lgkmcnt(10)
  v_mfma_f32_16x16x32_bf16 v[248:251], a[44:47], a[160:163], v[248:251]
  ds_read_b64_tr_b16 a[36:37], v6 offset:16384
  v_mfma_f32_16x16x32_bf16 v[252:255], a[44:47], a[216:219], v[252:255]
  ds_read_b64_tr_b16 a[38:39], v6 offset:18432
  s_waitcnt lgkmcnt(10)
  v_mfma_f32_16x16x32_bf16 a[0:3], a[48:51], a[160:163], a[0:3]
  ds_read_b64_tr_b16 a[40:41], v7 offset:16384
  v_mfma_f32_16x16x32_bf16 a[4:7], a[48:51], a[216:219], a[4:7]
  ds_read_b64_tr_b16 a[42:43], v7 offset:18432
  s_waitcnt lgkmcnt(10)
  v_mfma_f32_16x16x32_bf16 a[8:11], a[52:55], a[160:163], a[8:11]
  ds_read_b64_tr_b16 a[44:45], v8 offset:16384
  v_mfma_f32_16x16x32_bf16 a[12:15], a[52:55], a[216:219], a[12:15]
  ds_read_b64_tr_b16 a[46:47], v8 offset:18432
  s_waitcnt lgkmcnt(10)
  v_mfma_f32_16x16x32_bf16 a[16:19], a[56:59], a[160:163], a[16:19]
  ds_read_b64_tr_b16 a[48:49], v9 offset:16384
  v_mfma_f32_16x16x32_bf16 a[20:23], a[56:59], a[216:219], a[20:23]
  ds_read_b64_tr_b16 a[50:51], v9 offset:18432
  s_waitcnt lgkmcnt(10)
  v_mfma_f32_16x16x32_bf16 a[24:27], a[60:63], a[160:163], a[24:27]
  ds_read_b64_tr_b16 a[52:53], v10 offset:16384
  v_mfma_f32_16x16x32_bf16 a[28:31], a[60:63], a[216:219], a[28:31]
  ds_read_b64_tr_b16 a[54:55], v10 offset:18432
  buffer_load_dword v27, v26, s[40:43], 0 offen sc1
  s_waitcnt lgkmcnt(10)
  v_mfma_f32_16x16x32_bf16 v[160:163], a[32:35], a[164:167], v[160:163]
  ds_read_b64_tr_b16 a[56:57], v11 offset:16384
  v_mfma_f32_16x16x32_bf16 v[164:167], a[32:35], a[220:223], v[164:167]
  ds_read_b64_tr_b16 a[58:59], v11 offset:18432
  s_waitcnt lgkmcnt(10)
  v_mfma_f32_16x16x32_bf16 v[168:171], a[36:39], a[164:167], v[168:171]
  ds_read_b64_tr_b16 a[60:61], v12 offset:16384
  v_mfma_f32_16x16x32_bf16 v[172:175], a[36:39], a[220:223], v[172:175]
  ds_read_b64_tr_b16 a[62:63], v12 offset:18432
  s_waitcnt lgkmcnt(10)
  v_mfma_f32_16x16x32_bf16 v[176:179], a[40:43], a[164:167], v[176:179]
  ds_read_b64_tr_b16 a[32:33], v5 offset:16640
  v_mfma_f32_16x16x32_bf16 v[180:183], a[40:43], a[220:223], v[180:183]
  ds_read_b64_tr_b16 a[34:35], v5 offset:18688
  s_waitcnt lgkmcnt(10)
  v_mfma_f32_16x16x32_bf16 v[184:187], a[44:47], a[164:167], v[184:187]
  ds_read_b64_tr_b16 a[36:37], v6 offset:16640
  v_mfma_f32_16x16x32_bf16 v[188:191], a[44:47], a[220:223], v[188:191]
  ds_read_b64_tr_b16 a[38:39], v6 offset:18688
  s_waitcnt lgkmcnt(10)
  v_mfma_f32_16x16x32_bf16 v[192:195], a[48:51], a[164:167], v[192:195]
  ds_read_b64_tr_b16 a[40:41], v7 offset:16640
  v_mfma_f32_16x16x32_bf16 v[196:199], a[48:51], a[220:223], v[196:199]
  ds_read_b64_tr_b16 a[42:43], v7 offset:18688
  s_waitcnt lgkmcnt(10)
  v_mfma_f32_16x16x32_bf16 v[200:203], a[52:55], a[164:167], v[200:203]
  ds_read_b64_tr_b16 a[44:45], v8 offset:16640
  v_mfma_f32_16x16x32_bf16 v[204:207], a[52:55], a[220:223], v[204:207]
  ds_read_b64_tr_b16 a[46:47], v8 offset:18688
  s_waitcnt lgkmcnt(10)
  v_mfma_f32_16x16x32_bf16 v[208:211], a[56:59], a[164:167], v[208:211]
  ds_read_b64_tr_b16 a[48:49], v9 offset:16640
  v_mfma_f32_16x16x32_bf16 v[212:215], a[56:59], a[220:223], v[212:215]
  ds_read_b64_tr_b16 a[50:51], v9 offset:18688
  s_waitcnt lgkmcnt(10)
  v_mfma_f32_16x16x32_bf16 v[216:219], a[60:63], a[164:167], v[216:219]
  ds_read_b64_tr_b16 a[52:53], v10 offset:16640
  v_mfma_f32_16x16x32_bf16 v[220:223], a[60:63], a[220:223], v[220:223]
  ds_read_b64_tr_b16 a[54:55], v10 offset:18688
  s_waitcnt lgkmcnt(10)
  v_mfma_f32_16x16x32_bf16 v[224:227], a[32:35], a[164:167], v[224:227]
  ds_read_b64_tr_b16 a[56:57], v11 offset:16640
  v_mfma_f32_16x16x32_bf16 v[228:231], a[32:35], a[220:223], v[228:231]
  ds_read_b64_tr_b16 a[58:59], v11 offset:18688
  s_waitcnt lgkmcnt(10)
  v_mfma_f32_16x16x32_bf16 v[232:235], a[36:39], a[164:167], v[232:235]
  ds_read_b64_tr_b16 a[60:61], v12 offset:16640
  v_mfma_f32_16x16x32_bf16 v[236:239], a[36:39], a[220:223], v[236:239]
  ds_read_b64_tr_b16 a[62:63], v12 offset:18688
  s_waitcnt lgkmcnt(10)
  v_mfma_f32_16x16x32_bf16 v[240:243], a[40:43], a[164:167], v[240:243]
  v_mfma_f32_16x16x32_bf16 v[244:247], a[40:43], a[220:223], v[244:247]
  s_waitcnt lgkmcnt(8)
  v_mfma_f32_16x16x32_bf16 v[248:251], a[44:47], a[164:167], v[248:251]
  v_mfma_f32_16x16x32_bf16 v[252:255], a[44:47], a[220:223], v[252:255]
  s_waitcnt lgkmcnt(6)
  v_mfma_f32_16x16x32_bf16 a[0:3], a[48:51], a[164:167], a[0:3]
  v_mfma_f32_16x16x32_bf16 a[4:7], a[48:51], a[220:223], a[4:7]
  s_waitcnt lgkmcnt(4)
  v_mfma_f32_16x16x32_bf16 a[8:11], a[52:55], a[164:167], a[8:11]
  v_mfma_f32_16x16x32_bf16 a[12:15], a[52:55], a[220:223], a[12:15]
  s_waitcnt lgkmcnt(2)
  v_mfma_f32_16x16x32_bf16 a[16:19], a[56:59], a[164:167], a[16:19]
  v_mfma_f32_16x16x32_bf16 a[20:23], a[56:59], a[220:223], a[20:23]
  s_waitcnt lgkmcnt(0)
  v_mfma_f32_16x16x32_bf16 a[24:27], a[60:63], a[164:167], a[24:27]
  v_mfma_f32_16x16x32_bf16 a[28:31], a[60:63], a[220:223], a[28:31]
  s_branch k1_q
k1_V:
  v_add_u32 v4, s32, v2
  ds_read_b128 a[32:35], v4 offset:0
  ds_read_b128 a[36:39], v4 offset:2048
  ds_read_b128 a[40:43], v4 offset:4096
  ds_read_b128 a[44:47], v4 offset:6144
  ds_read_b128 a[48:51], v4 offset:8192
  ds_read_b128 a[52:55], v4 offset:10240
  ds_read_b128 a[56:59], v4 offset:12288
  ds_read_b128 a[60:63], v4 offset:14336
  ds_read_b64_tr_b16 a[96:97], v5 offset:0
  ds_read_b64_tr_b16 a[98:99], v5 offset:2048
  ds_read_b64_tr_b16 a[100:101], v6 offset:0
  ds_read_b64_tr_b16 a[102:103], v6 offset:2048
  s_mov_b32 s51, s69
  v_add_u32 v4, s32, v3
  s_waitcnt lgkmcnt(2)
  v_mfma_f32_16x16x32_bf16 v[32:35], a[32:35], a[96:99], 0
  ds_read_b64_tr_b16 a[104:105], v7 offset:0
  v_mfma_f32_16x16x32_bf16 v[160:163], a[36:39], a[96:99], 0
  ds_read_b64_tr_b16 a[106:107], v7 offset:2048
  v_mfma_f32_16x16x32_bf16 v[36:39], a[40:43], a[96:99], 0
  ds_read_b128 a[64:67], v4 offset:0
  v_mfma_f32_16x16x32_bf16 v[164:167], a[44:47], a[96:99], 0
  ds_read_b128 a[68:71], v4 offset:2048
  v_mfma_f32_16x16x32_bf16 v[40:43], a[48:51], a[96:99], 0
  v_mfma_f32_16x16x32_bf16 v[168:171], a[52:55], a[96:99], 0
  v_mfma_f32_16x16x32_bf16 v[44:47], a[56:59], a[96:99], 0
  v_mfma_f32_16x16x32_bf16 v[172:175], a[60:63], a[96:99], 0
  s_waitcnt lgkmcnt(4)
  v_mfma_f32_16x16x32_bf16 v[48:51], a[32:35], a[100:103], 0
  ds_read_b64_tr_b16 a[108:109], v8 offset:0
  v_mfma_f32_16x16x32_bf16 v[176:179], a[36:39], a[100:103], 0
  ds_read_b64_tr_b16 a[110:111], v8 offset:2048
  v_mfma_f32_16x16x32_bf16 v[52:55], a[40:43], a[100:103], 0
  ds_read_b128 a[72:75], v4 offset:4096
  v_mfma_f32_16x16x32_bf16 v[180:183], a[44:47], a[100:103], 0
  ds_read_b128 a[76:79], v4 offset:6144
  v_mfma_f32_16x16x32_bf16 v[56:59], a[48:51], a[100:103], 0
  v_mfma_f32_16x16x32_bf16 v[184:187], a[52:55], a[100:103], 0
  v_mfma_f32_16x16x32_bf16 v[60:63], a[56:59], a[100:103], 0
  v_mfma_f32_16x16x32_bf16 v[188:191], a[60:63], a[100:103], 0
  s_waitcnt lgkmcnt(6)
  v_mfma_f32_16x16x32_bf16 v[64:67], a[32:35], a[104:107], 0
  ds_read_b64_tr_b16 a[96:97], v9 offset:0
  v_mfma_f32_16x16x32_bf16 v[192:195], a[36:39], a[104:107], 0
  ds_read_b64_tr_b16 a[98:99], v9 offset:2048
  v_mfma_f32_16x16x32_bf16 v[68:71], a[40:43], a[104:107], 0
  ds_read_b128 a[80:83], v4 offset:8192
  v_mfma_f32_16x16x32_bf16 v[196:199], a[44:47], a[104:107], 0
  ds_read_b128 a[84:87], v4 offset:10240
  v_mfma_f32_16x16x32_bf16 v[72:75], a[48:51], a[104:107], 0
  v_mfma_f32_16x16x32_bf16 v[200:203], a[52:55], a[104:107], 0
  v_mfma_f32_16x16x32_bf16 v[76:79], a[56:59], a[104:107], 0
  v_mfma_f32_16x16x32_bf16 v[204:207], a[60:63], a[104:107], 0
  s_waitcnt lgkmcnt(6)
  v_mfma_f32_16x16x32_bf16 v[80:83], a[32:35], a[108:111], 0
  ds_read_b64_tr_b16 a[100:101], v10 offset:0
  v_mfma_f32_16x16x32_bf16 v[208:211], a[36:39], a[108:111], 0
  ds_read_b64_tr_b16 a[102:103], v10 offset:2048
  v_mfma_f32_16x16x32_bf16 v[84:87], a[40:43], a[108:111], 0
  ds_read_b128 a[88:91], v4 offset:12288
  v_mfma_f32_16x16x32_bf16 v[212:215], a[44:47], a[108:111], 0
  ds_read_b128 a[92:95], v4 offset:14336
  v_mfma_f32_16x16x32_bf16 v[88:91], a[48:51], a[108:111], 0
  v_mfma_f32_16x16x32_bf16 v[216:219], a[52:55], a[108:111], 0
  v_mfma_f32_16x16x32_bf16 v[92:95], a[56:59], a[108:111], 0
  s_add_u32 m0, s48, 49152
  v_mfma_f32_16x16x32_bf16 v[220:223], a[60:63], a[108:111], 0
  s_waitcnt lgkmcnt(6)
  v_mfma_f32_16x16x32_bf16 v[96:99], a[32:35], a[96:99], 0
  ds_read_b64_tr_b16 a[104:105], v11 offset:0
  v_mfma_f32_16x16x32_bf16 v[224:227], a[36:39], a[96:99], 0
  ds_read_b64_tr_b16 a[106:107], v11 offset:2048
  v_mfma_f32_16x16x32_bf16 v[100:103], a[40:43], a[96:99], 0
  buffer_load_dwordx4 v17, s[8:11], s35 offen offset:0 lds
  v_mfma_f32_16x16x32_bf16 v[228:231], a[44:47], a[96:99], 0
  v_mfma_f32_16x16x32_bf16 v[104:107], a[48:51], a[96:99], 0
  v_mfma_f32_16x16x32_bf16 v[232:235], a[52:55], a[96:99], 0
  buffer_load_dwordx4 v18, s[8:11], s35 offen offset:1024 lds
  v_mfma_f32_16x16x32_bf16 v[108:111], a[56:59], a[96:99], 0
  v_mfma_f32_16x16x32_bf16 v[236:239], a[60:63], a[96:99], 0
  s_waitcnt lgkmcnt(4)
  v_mfma_f32_16x16x32_bf16 v[112:115], a[32:35], a[100:103], 0
  ds_read_b64_tr_b16 a[108:109], v12 offset:0
  buffer_load_dwordx4 v19, s[8:11], s35 offen offset:2048 lds
  v_mfma_f32_16x16x32_bf16 v[240:243], a[36:39], a[100:103], 0
  ds_read_b64_tr_b16 a[110:111], v12 offset:2048
  v_mfma_f32_16x16x32_bf16 v[116:119], a[40:43], a[100:103], 0
  v_mfma_f32_16x16x32_bf16 v[244:247], a[44:47], a[100:103], 0
  buffer_load_dwordx4 v20, s[8:11], s35 offen offset:3072 lds
  v_mfma_f32_16x16x32_bf16 v[120:123], a[48:51], a[100:103], 0
  v_mfma_f32_16x16x32_bf16 v[248:251], a[52:55], a[100:103], 0
  s_add_u32 s35, s35, 0x40000
  v_mfma_f32_16x16x32_bf16 v[124:127], a[56:59], a[100:103], 0
  s_add_u32 m0, s33, 4096
  v_mfma_f32_16x16x32_bf16 v[252:255], a[60:63], a[100:103], 0
  s_waitcnt lgkmcnt(2)
  v_mfma_f32_16x16x32_bf16 v[128:131], a[32:35], a[104:107], 0
  ds_read_b64_tr_b16 a[96:97], v5 offset:16384
  v_mfma_f32_16x16x32_bf16 a[0:3], a[36:39], a[104:107], 0
  ds_read_b64_tr_b16 a[98:99], v5 offset:18432
  buffer_load_dwordx4 v13, s[4:7], s57 offen offset:0 lds
  v_mfma_f32_16x16x32_bf16 v[132:135], a[40:43], a[104:107], 0
  v_mfma_f32_16x16x32_bf16 a[4:7], a[44:47], a[104:107], 0
  v_mfma_f32_16x16x32_bf16 v[136:139], a[48:51], a[104:107], 0
  buffer_load_dwordx4 v14, s[4:7], s57 offen offset:1024 lds
  v_mfma_f32_16x16x32_bf16 a[8:11], a[52:55], a[104:107], 0
  v_mfma_f32_16x16x32_bf16 v[140:143], a[56:59], a[104:107], 0
  v_mfma_f32_16x16x32_bf16 a[12:15], a[60:63], a[104:107], 0
  buffer_load_dwordx4 v15, s[4:7], s57 offen offset:2048 lds
  s_waitcnt lgkmcnt(2)
  v_mfma_f32_16x16x32_bf16 v[144:147], a[32:35], a[108:111], 0
  ds_read_b64_tr_b16 a[100:101], v6 offset:16384
  v_mfma_f32_16x16x32_bf16 a[16:19], a[36:39], a[108:111], 0
  ds_read_b64_tr_b16 a[102:103], v6 offset:18432
  v_mfma_f32_16x16x32_bf16 v[148:151], a[40:43], a[108:111], 0
  buffer_load_dwordx4 v16, s[4:7], s57 offen offset:3072 lds
  v_mfma_f32_16x16x32_bf16 a[20:23], a[44:47], a[108:111], 0
  v_mfma_f32_16x16x32_bf16 v[152:155], a[48:51], a[108:111], 0
  v_mfma_f32_16x16x32_bf16 a[24:27], a[52:55], a[108:111], 0
  v_mfma_f32_16x16x32_bf16 v[156:159], a[56:59], a[108:111], 0
  buffer_load_dword a254, v28, s[12:15], s51 offen
  v_mfma_f32_16x16x32_bf16 a[28:31], a[60:63], a[108:111], 0
  s_waitcnt vmcnt(20)
  s_barrier
  s_add_u32 s33, s32, s49
  s_add_u32 s32, s32, 0x8000
  s_cmp_eq_u32 s32, 0x18000
  s_cselect_b32 s32, 0, s32
  s_add_u32 s34, s34, 128
  s_mov_b32 s56, s34
  s_add_u32 s57, s34, 0x10000
  v_add_u32 v4, s32, v2
  s_waitcnt lgkmcnt(2)
  v_mfma_f32_16x16x32_bf16 v[32:35], a[64:67], a[96:99], v[32:35]
  ds_read_b64_tr_b16 a[104:105], v7 offset:16384
  v_mfma_f32_16x16x32_bf16 v[160:163], a[68:71], a[96:99], v[160:163]
  ds_read_b64_tr_b16 a[106:107], v7 offset:18432
  v_mfma_f32_16x16x32_bf16 v[36:39], a[72:75], a[96:99], v[36:39]
  ds_read_b128 a[32:35], v4 offset:0
  v_mfma_f32_16x16x32_bf16 v[164:167], a[76:79], a[96:99], v[164:167]
  ds_read_b128 a[36:39], v4 offset:2048
  v_mfma_f32_16x16x32_bf16 v[40:43], a[80:83], a[96:99], v[40:43]
  v_mfma_f32_16x16x32_bf16 v[168:171], a[84:87], a[96:99], v[168:171]
  v_mfma_f32_16x16x32_bf16 v[44:47], a[88:91], a[96:99], v[44:47]
  v_mfma_f32_16x16x32_bf16 v[172:175], a[92:95], a[96:99], v[172:175]
  s_waitcnt lgkmcnt(4)
  v_mfma_f32_16x16x32_bf16 v[48:51], a[64:67], a[100:103], v[48:51]
  ds_read_b64_tr_b16 a[108:109], v8 offset:16384
  v_mfma_f32_16x16x32_bf16 v[176:179], a[68:71], a[100:103], v[176:179]
  ds_read_b64_tr_b16 a[110:111], v8 offset:18432
  v_mfma_f32_16x16x32_bf16 v[52:55], a[72:75], a[100:103], v[52:55]
  ds_read_b128 a[40:43], v4 offset:4096
  v_mfma_f32_16x16x32_bf16 v[180:183], a[76:79], a[100:103], v[180:183]
  ds_read_b128 a[44:47], v4 offset:6144
  v_mfma_f32_16x16x32_bf16 v[56:59], a[80:83], a[100:103], v[56:59]
  v_mfma_f32_16x16x32_bf16 v[184:187], a[84:87], a[100:103], v[184:187]
  v_mfma_f32_16x16x32_bf16 v[60:63], a[88:91], a[100:103], v[60:63]
  v_mfma_f32_16x16x32_bf16 v[188:191], a[92:95], a[100:103], v[188:191]
  s_waitcnt lgkmcnt(6)
  v_mfma_f32_16x16x32_bf16 v[64:67], a[64:67], a[104:107], v[64:67]
  ds_read_b64_tr_b16 a[96:97], v9 offset:16384
  v_mfma_f32_16x16x32_bf16 v[192:195], a[68:71], a[104:107], v[192:195]
  ds_read_b64_tr_b16 a[98:99], v9 offset:18432
  v_mfma_f32_16x16x32_bf16 v[68:71], a[72:75], a[104:107], v[68:71]
  ds_read_b128 a[48:51], v4 offset:8192
  v_mfma_f32_16x16x32_bf16 v[196:199], a[76:79], a[104:107], v[196:199]
  ds_read_b128 a[52:55], v4 offset:10240
  v_mfma_f32_16x16x32_bf16 v[72:75], a[80:83], a[104:107], v[72:75]
  v_mfma_f32_16x16x32_bf16 v[200:203], a[84:87], a[104:107], v[200:203]
  v_mfma_f32_16x16x32_bf16 v[76:79], a[88:91], a[104:107], v[76:79]
  v_mfma_f32_16x16x32_bf16 v[204:207], a[92:95], a[104:107], v[204:207]
  s_waitcnt lgkmcnt(6)
  v_mfma_f32_16x16x32_bf16 v[80:83], a[64:67], a[108:111], v[80:83]
  ds_read_b64_tr_b16 a[100:101], v10 offset:16384
  v_mfma_f32_16x16x32_bf16 v[208:211], a[68:71], a[108:111], v[208:211]
  ds_read_b64_tr_b16 a[102:103], v10 offset:18432
  v_mfma_f32_16x16x32_bf16 v[84:87], a[72:75], a[108:111], v[84:87]
  ds_read_b128 a[56:59], v4 offset:12288
  v_mfma_f32_16x16x32_bf16 v[212:215], a[76:79], a[108:111], v[212:215]
  ds_read_b128 a[60:63], v4 offset:14336
  v_mfma_f32_16x16x32_bf16 v[88:91], a[80:83], a[108:111], v[88:91]
  v_mfma_f32_16x16x32_bf16 v[216:219], a[84:87], a[108:111], v[216:219]
  v_mfma_f32_16x16x32_bf16 v[92:95], a[88:91], a[108:111], v[92:95]
  s_add_u32 m0, s48, 0
  v_mfma_f32_16x16x32_bf16 v[220:223], a[92:95], a[108:111], v[220:223]
  s_waitcnt lgkmcnt(6)
  v_mfma_f32_16x16x32_bf16 v[96:99], a[64:67], a[96:99], v[96:99]
  ds_read_b64_tr_b16 a[104:105], v11 offset:16384
  v_mfma_f32_16x16x32_bf16 v[224:227], a[68:71], a[96:99], v[224:227]
  ds_read_b64_tr_b16 a[106:107], v11 offset:18432
  v_mfma_f32_16x16x32_bf16 v[100:103], a[72:75], a[96:99], v[100:103]
  buffer_load_dwordx4 v17, s[8:11], s35 offen offset:0 lds
  v_mfma_f32_16x16x32_bf16 v[228:231], a[76:79], a[96:99], v[228:231]
  v_mfma_f32_16x16x32_bf16 v[104:107], a[80:83], a[96:99], v[104:107]
  v_mfma_f32_16x16x32_bf16 v[232:235], a[84:87], a[96:99], v[232:235]
  buffer_load_dwordx4 v18, s[8:11], s35 offen offset:1024 lds
  v_mfma_f32_16x16x32_bf16 v[108:111], a[88:91], a[96:99], v[108:111]
  v_mfma_f32_16x16x32_bf16 v[236:239], a[92:95], a[96:99], v[236:239]
  s_waitcnt lgkmcnt(4)
  v_mfma_f32_16x16x32_bf16 v[112:115], a[64:67], a[100:103], v[112:115]
  ds_read_b64_tr_b16 a[108:109], v12 offset:16384
  buffer_load_dwordx4 v19, s[8:11], s35 offen offset:2048 lds
  v_mfma_f32_16x16x32_bf16 v[240:243], a[68:71], a[100:103], v[240:243]
  ds_read_b64_tr_b16 a[110:111], v12 offset:18432
  v_mfma_f32_16x16x32_bf16 v[116:119], a[72:75], a[100:103], v[116:119]
  v_mfma_f32_16x16x32_bf16 v[244:247], a[76:79], a[100:103], v[244:247]
  buffer_load_dwordx4 v20, s[8:11], s35 offen offset:3072 lds
  v_mfma_f32_16x16x32_bf16 v[120:123], a[80:83], a[100:103], v[120:123]
  v_mfma_f32_16x16x32_bf16 v[248:251], a[84:87], a[100:103], v[248:251]
  s_add_u32 s35, s35, 0x40000
  v_mfma_f32_16x16x32_bf16 v[124:127], a[88:91], a[100:103], v[124:127]
  s_add_u32 m0, s33, 0
  v_mfma_f32_16x16x32_bf16 v[252:255], a[92:95], a[100:103], v[252:255]
  s_waitcnt lgkmcnt(2)
  v_mfma_f32_16x16x32_bf16 v[128:131], a[64:67], a[104:107], v[128:131]
  ds_read_b64_tr_b16 a[96:97], v5 offset:32768
  v_mfma_f32_16x16x32_bf16 a[0:3], a[68:71], a[104:107], a[0:3]
  ds_read_b64_tr_b16 a[98:99], v5 offset:34816
  buffer_load_dwordx4 v13, s[4:7], s56 offen offset:0 lds
  v_mfma_f32_16x16x32_bf16 v[132:135], a[72:75], a[104:107], v[132:135]
  v_mfma_f32_16x16x32_bf16 a[4:7], a[76:79], a[104:107], a[4:7]
  v_mfma_f32_16x16x32_bf16 v[136:139], a[80:83], a[104:107], v[136:139]
  buffer_load_dwordx4 v14, s[4:7], s56 offen offset:1024 lds
  v_mfma_f32_16x16x32_bf16 a[8:11], a[84:87], a[104:107], a[8:11]
  v_mfma_f32_16x16x32_bf16 v[140:143], a[88:91], a[104:107], v[140:143]
  v_mfma_f32_16x16x32_bf16 a[12:15], a[92:95], a[104:107], a[12:15]
  buffer_load_dwordx4 v15, s[4:7], s56 offen offset:2048 lds
  s_waitcnt lgkmcnt(2)
  v_mfma_f32_16x16x32_bf16 v[144:147], a[64:67], a[108:111], v[144:147]
  ds_read_b64_tr_b16 a[100:101], v6 offset:32768
  v_mfma_f32_16x16x32_bf16 a[16:19], a[68:71], a[108:111], a[16:19]
  ds_read_b64_tr_b16 a[102:103], v6 offset:34816
  v_mfma_f32_16x16x32_bf16 v[148:151], a[72:75], a[108:111], v[148:151]
  buffer_load_dwordx4 v16, s[4:7], s56 offen offset:3072 lds
  v_mfma_f32_16x16x32_bf16 a[20:23], a[76:79], a[108:111], a[20:23]
  v_mfma_f32_16x16x32_bf16 v[152:155], a[80:83], a[108:111], v[152:155]
  v_mfma_f32_16x16x32_bf16 a[24:27], a[84:87], a[108:111], a[24:27]
  v_mfma_f32_16x16x32_bf16 v[156:159], a[88:91], a[108:111], v[156:159]
  v_mfma_f32_16x16x32_bf16 a[28:31], a[92:95], a[108:111], a[28:31]
  s_waitcnt vmcnt(13)
  s_barrier
  v_add_u32 v4, s32, v3
  s_waitcnt lgkmcnt(2)
  v_mfma_f32_16x16x32_bf16 v[32:35], a[32:35], a[96:99], v[32:35]
  ds_read_b64_tr_b16 a[104:105], v7 offset:32768
  v_mfma_f32_16x16x32_bf16 v[160:163], a[36:39], a[96:99], v[160:163]
  ds_read_b64_tr_b16 a[106:107], v7 offset:34816
  v_mfma_f32_16x16x32_bf16 v[36:39], a[40:43], a[96:99], v[36:39]
  ds_read_b128 a[64:67], v4 offset:0
  v_mfma_f32_16x16x32_bf16 v[164:167], a[44:47], a[96:99], v[164:167]
  ds_read_b128 a[68:71], v4 offset:2048
  v_mfma_f32_16x16x32_bf16 v[40:43], a[48:51], a[96:99], v[40:43]
  v_mfma_f32_16x16x32_bf16 v[168:171], a[52:55], a[96:99], v[168:171]
  v_mfma_f32_16x16x32_bf16 v[44:47], a[56:59], a[96:99], v[44:47]
  v_mfma_f32_16x16x32_bf16 v[172:175], a[60:63], a[96:99], v[172:175]
  s_waitcnt lgkmcnt(4)
  v_mfma_f32_16x16x32_bf16 v[48:51], a[32:35], a[100:103], v[48:51]
  ds_read_b64_tr_b16 a[108:109], v8 offset:32768
  v_mfma_f32_16x16x32_bf16 v[176:179], a[36:39], a[100:103], v[176:179]
  ds_read_b64_tr_b16 a[110:111], v8 offset:34816
  v_mfma_f32_16x16x32_bf16 v[52:55], a[40:43], a[100:103], v[52:55]
  ds_read_b128 a[72:75], v4 offset:4096
  v_mfma_f32_16x16x32_bf16 v[180:183], a[44:47], a[100:103], v[180:183]
  ds_read_b128 a[76:79], v4 offset:6144
  v_mfma_f32_16x16x32_bf16 v[56:59], a[48:51], a[100:103], v[56:59]
  v_mfma_f32_16x16x32_bf16 v[184:187], a[52:55], a[100:103], v[184:187]
  v_mfma_f32_16x16x32_bf16 v[60:63], a[56:59], a[100:103], v[60:63]
  v_mfma_f32_16x16x32_bf16 v[188:191], a[60:63], a[100:103], v[188:191]
  s_waitcnt lgkmcnt(6)
  v_mfma_f32_16x16x32_bf16 v[64:67], a[32:35], a[104:107], v[64:67]
  ds_read_b64_tr_b16 a[96:97], v9 offset:32768
  v_mfma_f32_16x16x32_bf16 v[192:195], a[36:39], a[104:107], v[192:195]
  ds_read_b64_tr_b16 a[98:99], v9 offset:34816
  v_mfma_f32_16x16x32_bf16 v[68:71], a[40:43], a[104:107], v[68:71]
  ds_read_b128 a[80:83], v4 offset:8192
  v_mfma_f32_16x16x32_bf16 v[196:199], a[44:47], a[104:107], v[196:199]
  ds_read_b128 a[84:87], v4 offset:10240
  v_mfma_f32_16x16x32_bf16 v[72:75], a[48:51], a[104:107], v[72:75]
  v_mfma_f32_16x16x32_bf16 v[200:203], a[52:55], a[104:107], v[200:203]
  v_mfma_f32_16x16x32_bf16 v[76:79], a[56:59], a[104:107], v[76:79]
  v_mfma_f32_16x16x32_bf16 v[204:207], a[60:63], a[104:107], v[204:207]
  s_waitcnt lgkmcnt(6)
  v_mfma_f32_16x16x32_bf16 v[80:83], a[32:35], a[108:111], v[80:83]
  ds_read_b64_tr_b16 a[100:101], v10 offset:32768
  v_mfma_f32_16x16x32_bf16 v[208:211], a[36:39], a[108:111], v[208:211]
  ds_read_b64_tr_b16 a[102:103], v10 offset:34816
  v_mfma_f32_16x16x32_bf16 v[84:87], a[40:43], a[108:111], v[84:87]
  ds_read_b128 a[88:91], v4 offset:12288
  v_mfma_f32_16x16x32_bf16 v[212:215], a[44:47], a[108:111], v[212:215]
  ds_read_b128 a[92:95], v4 offset:14336
  v_mfma_f32_16x16x32_bf16 v[88:91], a[48:51], a[108:111], v[88:91]
  v_mfma_f32_16x16x32_bf16 v[216:219], a[52:55], a[108:111], v[216:219]
  v_mfma_f32_16x16x32_bf16 v[92:95], a[56:59], a[108:111], v[92:95]
  s_add_u32 m0, s48, 16384
  v_mfma_f32_16x16x32_bf16 v[220:223], a[60:63], a[108:111], v[220:223]
  s_waitcnt lgkmcnt(6)
  v_mfma_f32_16x16x32_bf16 v[96:99], a[32:35], a[96:99], v[96:99]
  ds_read_b64_tr_b16 a[104:105], v11 offset:32768
  v_mfma_f32_16x16x32_bf16 v[224:227], a[36:39], a[96:99], v[224:227]
  ds_read_b64_tr_b16 a[106:107], v11 offset:34816
  v_mfma_f32_16x16x32_bf16 v[100:103], a[40:43], a[96:99], v[100:103]
  buffer_load_dwordx4 v17, s[8:11], s35 offen offset:0 lds
  v_mfma_f32_16x16x32_bf16 v[228:231], a[44:47], a[96:99], v[228:231]
  v_mfma_f32_16x16x32_bf16 v[104:107], a[48:51], a[96:99], v[104:107]
  v_mfma_f32_16x16x32_bf16 v[232:235], a[52:55], a[96:99], v[232:235]
  buffer_load_dwordx4 v18, s[8:11], s35 offen offset:1024 lds
  v_mfma_f32_16x16x32_bf16 v[108:111], a[56:59], a[96:99], v[108:111]
  v_mfma_f32_16x16x32_bf16 v[236:239], a[60:63], a[96:99], v[236:239]
  s_waitcnt lgkmcnt(4)
  v_mfma_f32_16x16x32_bf16 v[112:115], a[32:35], a[100:103], v[112:115]
  ds_read_b64_tr_b16 a[108:109], v12 offset:32768
  buffer_load_dwordx4 v19, s[8:11], s35 offen offset:2048 lds
  v_mfma_f32_16x16x32_bf16 v[240:243], a[36:39], a[100:103], v[240:243]
  ds_read_b64_tr_b16 a[110:111], v12 offset:34816
  v_mfma_f32_16x16x32_bf16 v[116:119], a[40:43], a[100:103], v[116:119]
  v_mfma_f32_16x16x32_bf16 v[244:247], a[44:47], a[100:103], v[244:247]
  buffer_load_dwordx4 v20, s[8:11], s35 offen offset:3072 lds
  v_mfma_f32_16x16x32_bf16 v[120:123], a[48:51], a[100:103], v[120:123]
  v_mfma_f32_16x16x32_bf16 v[248:251], a[52:55], a[100:103], v[248:251]
  s_add_u32 s35, s35, 0x40000
  v_mfma_f32_16x16x32_bf16 v[124:127], a[56:59], a[100:103], v[124:127]
  s_add_u32 m0, s33, 4096
  v_mfma_f32_16x16x32_bf16 v[252:255], a[60:63], a[100:103], v[252:255]
  s_waitcnt lgkmcnt(2)
  v_mfma_f32_16x16x32_bf16 v[128:131], a[32:35], a[104:107], v[128:131]
  ds_read_b64_tr_b16 a[96:97], v5 offset:49152
  v_mfma_f32_16x16x32_bf16 a[0:3], a[36:39], a[104:107], a[0:3]
  ds_read_b64_tr_b16 a[98:99], v5 offset:51200
  buffer_load_dwordx4 v13, s[4:7], s57 offen offset:0 lds
  v_mfma_f32_16x16x32_bf16 v[132:135], a[40:43], a[104:107], v[132:135]
  v_mfma_f32_16x16x32_bf16 a[4:7], a[44:47], a[104:107], a[4:7]
  v_mfma_f32_16x16x32_bf16 v[136:139], a[48:51], a[104:107], v[136:139]
  buffer_load_dwordx4 v14, s[4:7], s57 offen offset:1024 lds
  v_mfma_f32_16x16x32_bf16 a[8:11], a[52:55], a[104:107], a[8:11]
  v_mfma_f32_16x16x32_bf16 v[140:143], a[56:59], a[104:107], v[140:143]
  v_mfma_f32_16x16x32_bf16 a[12:15], a[60:63], a[104:107], a[12:15]
  buffer_load_dwordx4 v15, s[4:7], s57 offen offset:2048 lds
  s_waitcnt lgkmcnt(2)
  v_mfma_f32_16x16x32_bf16 v[144:147], a[32:35], a[108:111], v[144:147]
  ds_read_b64_tr_b16 a[100:101], v6 offset:49152
  v_mfma_f32_16x16x32_bf16 a[16:19], a[36:39], a[108:111], a[16:19]
  ds_read_b64_tr_b16 a[102:103], v6 offset:51200
  v_mfma_f32_16x16x32_bf16 v[148:151], a[40:43], a[108:111], v[148:151]
  buffer_load_dwordx4 v16, s[4:7], s57 offen offset:3072 lds
  v_mfma_f32_16x16x32_bf16 a[20:23], a[44:47], a[108:111], a[20:23]
  v_mfma_f32_16x16x32_bf16 v[152:155], a[48:51], a[108:111], v[152:155]
  v_mfma_f32_16x16x32_bf16 a[24:27], a[52:55], a[108:111], a[24:27]
  v_mfma_f32_16x16x32_bf16 v[156:159], a[56:59], a[108:111], v[156:159]
  v_mfma_f32_16x16x32_bf16 a[28:31], a[60:63], a[108:111], a[28:31]
  s_waitcnt vmcnt(12)
  s_barrier
  s_add_u32 s33, s32, s49
  s_add_u32 s32, s32, 0x8000
  s_cmp_eq_u32 s32, 0x18000
  s_cselect_b32 s32, 0, s32
  s_add_u32 s34, s34, 128
  s_mov_b32 s56, s34
  s_add_u32 s57, s34, 0x10000
  v_add_u32 v4, s32, v2
  s_waitcnt lgkmcnt(2)
  v_mfma_f32_16x16x32_bf16 v[32:35], a[64:67], a[96:99], v[32:35]
  ds_read_b64_tr_b16 a[104:105], v7 offset:49152
  v_mfma_f32_16x16x32_bf16 v[160:163], a[68:71], a[96:99], v[160:163]
  ds_read_b64_tr_b16 a[106:107], v7 offset:51200
  v_mfma_f32_16x16x32_bf16 v[36:39], a[72:75], a[96:99], v[36:39]
  ds_read_b128 a[32:35], v4 offset:0
  v_mfma_f32_16x16x32_bf16 v[164:167], a[76:79], a[96:99], v[164:167]
  ds_read_b128 a[36:39], v4 offset:2048
  v_mfma_f32_16x16x32_bf16 v[40:43], a[80:83], a[96:99], v[40:43]
  v_mfma_f32_16x16x32_bf16 v[168:171], a[84:87], a[96:99], v[168:171]
  v_mfma_f32_16x16x32_bf16 v[44:47], a[88:91], a[96:99], v[44:47]
  v_mfma_f32_16x16x32_bf16 v[172:175], a[92:95], a[96:99], v[172:175]
  s_waitcnt lgkmcnt(4)
  v_mfma_f32_16x16x32_bf16 v[48:51], a[64:67], a[100:103], v[48:51]
  ds_read_b64_tr_b16 a[108:109], v8 offset:49152
  v_mfma_f32_16x16x32_bf16 v[176:179], a[68:71], a[100:103], v[176:179]
  ds_read_b64_tr_b16 a[110:111], v8 offset:51200
  v_mfma_f32_16x16x32_bf16 v[52:55], a[72:75], a[100:103], v[52:55]
  ds_read_b128 a[40:43], v4 offset:4096
  v_mfma_f32_16x16x32_bf16 v[180:183], a[76:79], a[100:103], v[180:183]
  ds_read_b128 a[44:47], v4 offset:6144
  v_mfma_f32_16x16x32_bf16 v[56:59], a[80:83], a[100:103], v[56:59]
  v_mfma_f32_16x16x32_bf16 v[184:187], a[84:87], a[100:103], v[184:187]
  v_mfma_f32_16x16x32_bf16 v[60:63], a[88:91], a[100:103], v[60:63]
  v_mfma_f32_16x16x32_bf16 v[188:191], a[92:95], a[100:103], v[188:191]
  s_waitcnt lgkmcnt(6)
  v_mfma_f32_16x16x32_bf16 v[64:67], a[64:67], a[104:107], v[64:67]
  ds_read_b64_tr_b16 a[96:97], v9 offset:49152
  v_mfma_f32_16x16x32_bf16 v[192:195], a[68:71], a[104:107], v[192:195]
  ds_read_b64_tr_b16 a[98:99], v9 offset:51200
  v_mfma_f32_16x16x32_bf16 v[68:71], a[72:75], a[104:107], v[68:71]
  ds_read_b128 a[48:51], v4 offset:8192
  v_mfma_f32_16x16x32_bf16 v[196:199], a[76:79], a[104:107], v[196:199]
  ds_read_b128 a[52:55], v4 offset:10240
  v_mfma_f32_16x16x32_bf16 v[72:75], a[80:83], a[104:107], v[72:75]
  v_mfma_f32_16x16x32_bf16 v[200:203], a[84:87], a[104:107], v[200:203]
  v_mfma_f32_16x16x32_bf16 v[76:79], a[88:91], a[104:107], v[76:79]
  v_mfma_f32_16x16x32_bf16 v[204:207], a[92:95], a[104:107], v[204:207]
  s_waitcnt lgkmcnt(6)
  v_mfma_f32_16x16x32_bf16 v[80:83], a[64:67], a[108:111], v[80:83]
  ds_read_b64_tr_b16 a[100:101], v10 offset:49152
  v_mfma_f32_16x16x32_bf16 v[208:211], a[68:71], a[108:111], v[208:211]
  ds_read_b64_tr_b16 a[102:103], v10 offset:51200
  v_mfma_f32_16x16x32_bf16 v[84:87], a[72:75], a[108:111], v[84:87]
  ds_read_b128 a[56:59], v4 offset:12288
  v_mfma_f32_16x16x32_bf16 v[212:215], a[76:79], a[108:111], v[212:215]
  ds_read_b128 a[60:63], v4 offset:14336
  v_mfma_f32_16x16x32_bf16 v[88:91], a[80:83], a[108:111], v[88:91]
  v_mfma_f32_16x16x32_bf16 v[216:219], a[84:87], a[108:111], v[216:219]
  v_mfma_f32_16x16x32_bf16 v[92:95], a[88:91], a[108:111], v[92:95]
  s_add_u32 m0, s48, 32768
  v_mfma_f32_16x16x32_bf16 v[220:223], a[92:95], a[108:111], v[220:223]
  s_waitcnt lgkmcnt(6)
  v_mfma_f32_16x16x32_bf16 v[96:99], a[64:67], a[96:99], v[96:99]
  ds_read_b64_tr_b16 a[104:105], v11 offset:49152
  v_mfma_f32_16x16x32_bf16 v[224:227], a[68:71], a[96:99], v[224:227]
  ds_read_b64_tr_b16 a[106:107], v11 offset:51200
  v_mfma_f32_16x16x32_bf16 v[100:103], a[72:75], a[96:99], v[100:103]
  buffer_load_dwordx4 v17, s[8:11], s35 offen offset:0 lds
  v_mfma_f32_16x16x32_bf16 v[228:231], a[76:79], a[96:99], v[228:231]
  v_mfma_f32_16x16x32_bf16 v[104:107], a[80:83], a[96:99], v[104:107]
  v_mfma_f32_16x16x32_bf16 v[232:235], a[84:87], a[96:99], v[232:235]
  buffer_load_dwordx4 v18, s[8:11], s35 offen offset:1024 lds
  v_mfma_f32_16x16x32_bf16 v[108:111], a[88:91], a[96:99], v[108:111]
  v_mfma_f32_16x16x32_bf16 v[236:239], a[92:95], a[96:99], v[236:239]
  s_waitcnt lgkmcnt(4)
  v_mfma_f32_16x16x32_bf16 v[112:115], a[64:67], a[100:103], v[112:115]
  ds_read_b64_tr_b16 a[108:109], v12 offset:49152
  buffer_load_dwordx4 v19, s[8:11], s35 offen offset:2048 lds
  v_mfma_f32_16x16x32_bf16 v[240:243], a[68:71], a[100:103], v[240:243]
  ds_read_b64_tr_b16 a[110:111], v12 offset:51200
  v_mfma_f32_16x16x32_bf16 v[116:119], a[72:75], a[100:103], v[116:119]
  v_mfma_f32_16x16x32_bf16 v[244:247], a[76:79], a[100:103], v[244:247]
  buffer_load_dwordx4 v20, s[8:11], s35 offen offset:3072 lds
  v_mfma_f32_16x16x32_bf16 v[120:123], a[80:83], a[100:103], v[120:123]
  v_mfma_f32_16x16x32_bf16 v[248:251], a[84:87], a[100:103], v[248:251]
  s_add_u32 s35, s35, 0x40000
  v_mfma_f32_16x16x32_bf16 v[124:127], a[88:91], a[100:103], v[124:127]
  s_add_u32 m0, s33, 0
  v_mfma_f32_16x16x32_bf16 v[252:255], a[92:95], a[100:103], v[252:255]
  s_waitcnt lgkmcnt(2)
  v_mfma_f32_16x16x32_bf16 v[128:131], a[64:67], a[104:107], v[128:131]
  ds_read_b64_tr_b16 a[96:97], v5 offset:0
  v_mfma_f32_16x16x32_bf16 a[0:3], a[68:71], a[104:107], a[0:3]
  ds_read_b64_tr_b16 a[98:99], v5 offset:2048
  buffer_load_dwordx4 v13, s[4:7], s56 offen offset:0 lds
  v_mfma_f32_16x16x32_bf16 v[132:135], a[72:75], a[104:107], v[132:135]
  v_mfma_f32_16x16x32_bf16 a[4:7], a[76:79], a[104:107], a[4:7]
  v_mfma_f32_16x16x32_bf16 v[136:139], a[80:83], a[104:107], v[136:139]
  buffer_load_dwordx4 v14, s[4:7], s56 offen offset:1024 lds
  v_mfma_f32_16x16x32_bf16 a[8:11], a[84:87], a[104:107], a[8:11]
  v_mfma_f32_16x16x32_bf16 v[140:143], a[88:91], a[104:107], v[140:143]
  v_mfma_f32_16x16x32_bf16 a[12:15], a[92:95], a[104:107], a[12:15]
  buffer_load_dwordx4 v15, s[4:7], s56 offen offset:2048 lds
  s_waitcnt lgkmcnt(2)
  v_mfma_f32_16x16x32_bf16 v[144:147], a[64:67], a[108:111], v[144:147]
  ds_read_b64_tr_b16 a[100:101], v6 offset:0
  v_mfma_f32_16x16x32_bf16 a[16:19], a[68:71], a[108:111], a[16:19]
  ds_read_b64_tr_b16 a[102:103], v6 offset:2048
  v_mfma_f32_16x16x32_bf16 v[148:151], a[72:75], a[108:111], v[148:151]
  buffer_load_dwordx4 v16, s[4:7], s56 offen offset:3072 lds
  v_mfma_f32_16x16x32_bf16 a[20:23], a[76:79], a[108:111], a[20:23]
  v_mfma_f32_16x16x32_bf16 v[152:155], a[80:83], a[108:111], v[152:155]
  v_mfma_f32_16x16x32_bf16 a[24:27], a[84:87], a[108:111], a[24:27]
  v_mfma_f32_16x16x32_bf16 v[156:159], a[88:91], a[108:111], v[156:159]
  v_mfma_f32_16x16x32_bf16 a[28:31], a[92:95], a[108:111], a[28:31]
  s_waitcnt vmcnt(12)
  s_barrier
  s_mov_b32 s50, 6
  v_mbcnt_lo_u32_b32 v23, -1, 0
  v_mbcnt_hi_u32_b32 v23, -1, v23
  v_and_b32 v23, 15, v23
  v_lshlrev_b32 v23, 4, v23
k1_V_loop:
  s_cmp_eq_u32 s50, 2
  s_cselect_b32 s51, 0, s69
  s_cmp_eq_u32 s50, s61
  s_cbranch_scc0 k1_V_nosig
  s_cmp_eq_u32 s28, 0
  s_cbranch_scc0 k1_V_nosig
  s_mov_b64 exec, 1
  v_mov_b32 v24, 1
  v_mov_b32 v25, s70
  buffer_store_byte v24, v25, s[36:39], 0 offen sc1
  s_mov_b64 exec, -1
k1_V_nosig:
  s_cmp_eq_u32 s50, 1
  s_cbranch_scc0 k1_V_nofl
  buffer_load_dwordx4 v[24:27], v23, s[36:39], 0 offen sc1
k1_V_nofl:
  v_add_u32 v4, s32, v3
  s_waitcnt lgkmcnt(2)
  v_mfma_f32_16x16x32_bf16 v[32:35], a[32:35], a[96:99], v[32:35]
  ds_read_b64_tr_b16 a[104:105], v7 offset:0
  v_mfma_f32_16x16x32_bf16 v[160:163], a[36:39], a[96:99], v[160:163]
  ds_read_b64_tr_b16 a[106:107], v7 offset:2048
  v_mfma_f32_16x16x32_bf16 v[36:39], a[40:43], a[96:99], v[36:39]
  ds_read_b128 a[64:67], v4 offset:0
  v_mfma_f32_16x16x32_bf16 v[164:167], a[44:47], a[96:99], v[164:167]
  ds_read_b128 a[68:71], v4 offset:2048
  v_mfma_f32_16x16x32_bf16 v[40:43], a[48:51], a[96:99], v[40:43]
  v_mfma_f32_16x16x32_bf16 v[168:171], a[52:55], a[96:99], v[168:171]
  v_mfma_f32_16x16x32_bf16 v[44:47], a[56:59], a[96:99], v[44:47]
  v_mfma_f32_16x16x32_bf16 v[172:175], a[60:63], a[96:99], v[172:175]
  s_waitcnt lgkmcnt(4)
  v_mfma_f32_16x16x32_bf16 v[48:51], a[32:35], a[100:103], v[48:51]
  ds_read_b64_tr_b16 a[108:109], v8 offset:0
  v_mfma_f32_16x16x32_bf16 v[176:179], a[36:39], a[100:103], v[176:179]
  ds_read_b64_tr_b16 a[110:111], v8 offset:2048
  v_mfma_f32_16x16x32_bf16 v[52:55], a[40:43], a[100:103], v[52:55]
  ds_read_b128 a[72:75], v4 offset:4096
  v_mfma_f32_16x16x32_bf16 v[180:183], a[44:47], a[100:103], v[180:183]
  ds_read_b128 a[76:79], v4 offset:6144
  v_mfma_f32_16x16x32_bf16 v[56:59], a[48:51], a[100:103], v[56:59]
  v_mfma_f32_16x16x32_bf16 v[184:187], a[52:55], a[100:103], v[184:187]
  v_mfma_f32_16x16x32_bf16 v[60:63], a[56:59], a[100:103], v[60:63]
  v_mfma_f32_16x16x32_bf16 v[188:191], a[60:63], a[100:103], v[188:191]
  s_waitcnt lgkmcnt(6)
  v_mfma_f32_16x16x32_bf16 v[64:67], a[32:35], a[104:107], v[64:67]
  ds_read_b64_tr_b16 a[96:97], v9 offset:0
  v_mfma_f32_16x16x32_bf16 v[192:195], a[36:39], a[104:107], v[192:195]
  ds_read_b64_tr_b16 a[98:99], v9 offset:2048
  v_mfma_f32_16x16x32_bf16 v[68:71], a[40:43], a[104:107], v[68:71]
  ds_read_b128 a[80:83], v4 offset:8192
  v_mfma_f32_16x16x32_bf16 v[196:199], a[44:47], a[104:107], v[196:199]
  ds_read_b128 a[84:87], v4 offset:10240
  v_mfma_f32_16x16x32_bf16 v[72:75], a[48:51], a[104:107], v[72:75]
  v_mfma_f32_16x16x32_bf16 v[200:203], a[52:55], a[104:107], v[200:203]
  v_mfma_f32_16x16x32_bf16 v[76:79], a[56:59], a[104:107], v[76:79]
  v_mfma_f32_16x16x32_bf16 v[204:207], a[60:63], a[104:107], v[204:207]
  s_waitcnt lgkmcnt(6)
  v_mfma_f32_16x16x32_bf16 v[80:83], a[32:35], a[108:111], v[80:83]
  ds_read_b64_tr_b16 a[100:101], v10 offset:0
  v_mfma_f32_16x16x32_bf16 v[208:211], a[36:39], a[108:111], v[208:211]
  ds_read_b64_tr_b16 a[102:103], v10 offset:2048
  v_mfma_f32_16x16x32_bf16 v[84:87], a[40:43], a[108:111], v[84:87]
  ds_read_b128 a[88:91], v4 offset:12288
  v_mfma_f32_16x16x32_bf16 v[212:215], a[44:47], a[108:111], v[212:215]
  ds_read_b128 a[92:95], v4 offset:14336
  v_mfma_f32_16x16x32_bf16 v[88:91], a[48:51], a[108:111], v[88:91]
  v_mfma_f32_16x16x32_bf16 v[216:219], a[52:55], a[108:111], v[216:219]
  v_mfma_f32_16x16x32_bf16 v[92:95], a[56:59], a[108:111], v[92:95]
  s_add_u32 m0, s48, 49152
  v_mfma_f32_16x16x32_bf16 v[220:223], a[60:63], a[108:111], v[220:223]
  s_waitcnt lgkmcnt(6)
  v_mfma_f32_16x16x32_bf16 v[96:99], a[32:35], a[96:99], v[96:99]
  ds_read_b64_tr_b16 a[104:105], v11 offset:0
  v_mfma_f32_16x16x32_bf16 v[224:227], a[36:39], a[96:99], v[224:227]
  ds_read_b64_tr_b16 a[106:107], v11 offset:2048
  v_mfma_f32_16x16x32_bf16 v[100:103], a[40:43], a[96:99], v[100:103]
  buffer_load_dwordx4 v17, s[8:11], s35 offen offset:0 lds
  v_mfma_f32_16x16x32_bf16 v[228:231], a[44:47], a[96:99], v[228:231]
  v_mfma_f32_16x16x32_bf16 v[104:107], a[48:51], a[96:99], v[104:107]
  v_mfma_f32_16x16x32_bf16 v[232:235], a[52:55], a[96:99], v[232:235]
  buffer_load_dwordx4 v18, s[8:11], s35 offen offset:1024 lds
  v_mfma_f32_16x16x32_bf16 v[108:111], a[56:59], a[96:99], v[108:111]
  v_mfma_f32_16x16x32_bf16 v[236:239], a[60:63], a[96:99], v[236:239]
  s_waitcnt lgkmcnt(4)
  v_mfma_f32_16x16x32_bf16 v[112:115], a[32:35], a[100:103], v[112:115]
  ds_read_b64_tr_b16 a[108:109], v12 offset:0
  buffer_load_dwordx4 v19, s[8:11], s35 offen offset:2048 lds
  v_mfma_f32_16x16x32_bf16 v[240:243], a[36:39], a[100:103], v[240:243]
  ds_read_b64_tr_b16 a[110:111], v12 offset:2048
  v_mfma_f32_16x16x32_bf16 v[116:119], a[40:43], a[100:103], v[116:119]
  v_mfma_f32_16x16x32_bf16 v[244:247], a[44:47], a[100:103], v[244:247]
  buffer_load_dwordx4 v20, s[8:11], s35 offen offset:3072 lds
  v_mfma_f32_16x16x32_bf16 v[120:123], a[48:51], a[100:103], v[120:123]
  v_mfma_f32_16x16x32_bf16 v[248:251], a[52:55], a[100:103], v[248:251]
  s_add_u32 s35, s35, 0x40000
  v_mfma_f32_16x16x32_bf16 v[124:127], a[56:59], a[100:103], v[124:127]
  s_add_u32 m0, s33, 4096
  v_mfma_f32_16x16x32_bf16 v[252:255], a[60:63], a[100:103], v[252:255]
  s_waitcnt lgkmcnt(2)
  v_mfma_f32_16x16x32_bf16 v[128:131], a[32:35], a[104:107], v[128:131]
  ds_read_b64_tr_b16 a[96:97], v5 offset:16384
  v_mfma_f32_16x16x32_bf16 a[0:3], a[36:39], a[104:107], a[0:3]
  ds_read_b64_tr_b16 a[98:99], v5 offset:18432
  buffer_load_dwordx4 v13, s[4:7], s57 offen offset:0 lds
  v_mfma_f32_16x16x32_bf16 v[132:135], a[40:43], a[104:107], v[132:135]
  v_mfma_f32_16x16x32_bf16 a[4:7], a[44:47], a[104:107], a[4:7]
  v_mfma_f32_16x16x32_bf16 v[136:139], a[48:51], a[104:107], v[136:139]
  buffer_load_dwordx4 v14, s[4:7], s57 offen offset:1024 lds
  v_mfma_f32_16x16x32_bf16 a[8:11], a[52:55], a[104:107], a[8:11]
  v_mfma_f32_16x16x32_bf16 v[140:143], a[56:59], a[104:107], v[140:143]
  v_mfma_f32_16x16x32_bf16 a[12:15], a[60:63], a[104:107], a[12:15]
  buffer_load_dwordx4 v15, s[4:7], s57 offen offset:2048 lds
  s_waitcnt lgkmcnt(2)
  v_mfma_f32_16x16x32_bf16 v[144:147], a[32:35], a[108:111], v[144:147]
  ds_read_b64_tr_b16 a[100:101], v6 offset:16384
  v_mfma_f32_16x16x32_bf16 a[16:19], a[36:39], a[108:111], a[16:19]
  ds_read_b64_tr_b16 a[102:103], v6 offset:18432
  v_mfma_f32_16x16x32_bf16 v[148:151], a[40:43], a[108:111], v[148:151]
  buffer_load_dwordx4 v16, s[4:7], s57 offen offset:3072 lds
  v_mfma_f32_16x16x32_bf16 a[20:23], a[44:47], a[108:111], a[20:23]
  v_mfma_f32_16x16x32_bf16 v[152:155], a[48:51], a[108:111], v[152:155]
  v_mfma_f32_16x16x32_bf16 a[24:27], a[52:55], a[108:111], a[24:27]
  v_mfma_f32_16x16x32_bf16 v[156:159], a[56:59], a[108:111], v[156:159]
  buffer_load_dword a254, v28, s[12:15], s51 offen
  v_mfma_f32_16x16x32_bf16 a[28:31], a[60:63], a[108:111], a[28:31]
  s_waitcnt vmcnt(13)
  s_barrier
  s_add_u32 s33, s32, s49
  s_add_u32 s32, s32, 0x8000
  s_cmp_eq_u32 s32, 0x18000
  s_cselect_b32 s32, 0, s32
  s_add_u32 s34, s34, 128
  s_mov_b32 s56, s34
  s_add_u32 s57, s34, 0x10000
  v_add_u32 v4, s32, v2
  s_waitcnt lgkmcnt(2)
  v_mfma_f32_16x16x32_bf16 v[32:35], a[64:67], a[96:99], v[32:35]
  ds_read_b64_tr_b16 a[104:105], v7 offset:16384
  v_mfma_f32_16x16x32_bf16 v[160:163], a[68:71], a[96:99], v[160:163]
  ds_read_b64_tr_b16 a[106:107], v7 offset:18432
  v_mfma_f32_16x16x32_bf16 v[36:39], a[72:75], a[96:99], v[36:39]
  ds_read_b128 a[32:35], v4 offset:0
  v_mfma_f32_16x16x32_bf16 v[164:167], a[76:79], a[96:99], v[164:167]
  ds_read_b128 a[36:39], v4 offset:2048
  v_mfma_f32_16x16x32_bf16 v[40:43], a[80:83], a[96:99], v[40:43]
  v_mfma_f32_16x16x32_bf16 v[168:171], a[84:87], a[96:99], v[168:171]
  v_mfma_f32_16x16x32_bf16 v[44:47], a[88:91], a[96:99], v[44:47]
  v_mfma_f32_16x16x32_bf16 v[172:175], a[92:95], a[96:99], v[172:175]
  s_waitcnt lgkmcnt(4)
  v_mfma_f32_16x16x32_bf16 v[48:51], a[64:67], a[100:103], v[48:51]
  ds_read_b64_tr_b16 a[108:109], v8 offset:16384
  v_mfma_f32_16x16x32_bf16 v[176:179], a[68:71], a[100:103], v[176:179]
  ds_read_b64_tr_b16 a[110:111], v8 offset:18432
  v_mfma_f32_16x16x32_bf16 v[52:55], a[72:75], a[100:103], v[52:55]
  ds_read_b128 a[40:43], v4 offset:4096
  v_mfma_f32_16x16x32_bf16 v[180:183], a[76:79], a[100:103], v[180:183]
  ds_read_b128 a[44:47], v4 offset:6144
  v_mfma_f32_16x16x32_bf16 v[56:59], a[80:83], a[100:103], v[56:59]
  v_mfma_f32_16x16x32_bf16 v[184:187], a[84:87], a[100:103], v[184:187]
  v_mfma_f32_16x16x32_bf16 v[60:63], a[88:91], a[100:103], v[60:63]
  v_mfma_f32_16x16x32_bf16 v[188:191], a[92:95], a[100:103], v[188:191]
  s_waitcnt lgkmcnt(6)
  v_mfma_f32_16x16x32_bf16 v[64:67], a[64:67], a[104:107], v[64:67]
  ds_read_b64_tr_b16 a[96:97], v9 offset:16384
  v_mfma_f32_16x16x32_bf16 v[192:195], a[68:71], a[104:107], v[192:195]
  ds_read_b64_tr_b16 a[98:99], v9 offset:18432
  v_mfma_f32_16x16x32_bf16 v[68:71], a[72:75], a[104:107], v[68:71]
  ds_read_b128 a[48:51], v4 offset:8192
  v_mfma_f32_16x16x32_bf16 v[196:199], a[76:79], a[104:107], v[196:199]
  ds_read_b128 a[52:55], v4 offset:10240
  v_mfma_f32_16x16x32_bf16 v[72:75], a[80:83], a[104:107], v[72:75]
  v_mfma_f32_16x16x32_bf16 v[200:203], a[84:87], a[104:107], v[200:203]
  v_mfma_f32_16x16x32_bf16 v[76:79], a[88:91], a[104:107], v[76:79]
  v_mfma_f32_16x16x32_bf16 v[204:207], a[92:95], a[104:107], v[204:207]
  s_waitcnt lgkmcnt(6)
  v_mfma_f32_16x16x32_bf16 v[80:83], a[64:67], a[108:111], v[80:83]
  ds_read_b64_tr_b16 a[100:101], v10 offset:16384
  v_mfma_f32_16x16x32_bf16 v[208:211], a[68:71], a[108:111], v[208:211]
  ds_read_b64_tr_b16 a[102:103], v10 offset:18432
  v_mfma_f32_16x16x32_bf16 v[84:87], a[72:75], a[108:111], v[84:87]
  ds_read_b128 a[56:59], v4 offset:12288
  v_mfma_f32_16x16x32_bf16 v[212:215], a[76:79], a[108:111], v[212:215]
  ds_read_b128 a[60:63], v4 offset:14336
  v_mfma_f32_16x16x32_bf16 v[88:91], a[80:83], a[108:111], v[88:91]
  v_mfma_f32_16x16x32_bf16 v[216:219], a[84:87], a[108:111], v[216:219]
  v_mfma_f32_16x16x32_bf16 v[92:95], a[88:91], a[108:111], v[92:95]
  s_add_u32 m0, s48, 0
  v_mfma_f32_16x16x32_bf16 v[220:223], a[92:95], a[108:111], v[220:223]
  s_waitcnt lgkmcnt(6)
  v_mfma_f32_16x16x32_bf16 v[96:99], a[64:67], a[96:99], v[96:99]
  ds_read_b64_tr_b16 a[104:105], v11 offset:16384
  v_mfma_f32_16x16x32_bf16 v[224:227], a[68:71], a[96:99], v[224:227]
  ds_read_b64_tr_b16 a[106:107], v11 offset:18432
  v_mfma_f32_16x16x32_bf16 v[100:103], a[72:75], a[96:99], v[100:103]
  buffer_load_dwordx4 v17, s[8:11], s35 offen offset:0 lds
  v_mfma_f32_16x16x32_bf16 v[228:231], a[76:79], a[96:99], v[228:231]
  v_mfma_f32_16x16x32_bf16 v[104:107], a[80:83], a[96:99], v[104:107]
  v_mfma_f32_16x16x32_bf16 v[232:235], a[84:87], a[96:99], v[232:235]
  buffer_load_dwordx4 v18, s[8:11], s35 offen offset:1024 lds
  v_mfma_f32_16x16x32_bf16 v[108:111], a[88:91], a[96:99], v[108:111]
  v_mfma_f32_16x16x32_bf16 v[236:239], a[92:95], a[96:99], v[236:239]
  s_waitcnt lgkmcnt(4)
  v_mfma_f32_16x16x32_bf16 v[112:115], a[64:67], a[100:103], v[112:115]
  ds_read_b64_tr_b16 a[108:109], v12 offset:16384
  buffer_load_dwordx4 v19, s[8:11], s35 offen offset:2048 lds
  v_mfma_f32_16x16x32_bf16 v[240:243], a[68:71], a[100:103], v[240:243]
  ds_read_b64_tr_b16 a[110:111], v12 offset:18432
  v_mfma_f32_16x16x32_bf16 v[116:119], a[72:75], a[100:103], v[116:119]
  v_mfma_f32_16x16x32_bf16 v[244:247], a[76:79], a[100:103], v[244:247]
  buffer_load_dwordx4 v20, s[8:11], s35 offen offset:3072 lds
  v_mfma_f32_16x16x32_bf16 v[120:123], a[80:83], a[100:103], v[120:123]
  v_mfma_f32_16x16x32_bf16 v[248:251], a[84:87], a[100:103], v[248:251]
  s_add_u32 s35, s35, 0x40000
  v_mfma_f32_16x16x32_bf16 v[124:127], a[88:91], a[100:103], v[124:127]
  s_add_u32 m0, s33, 0
  v_mfma_f32_16x16x32_bf16 v[252:255], a[92:95], a[100:103], v[252:255]
  s_waitcnt lgkmcnt(2)
  v_mfma_f32_16x16x32_bf16 v[128:131], a[64:67], a[104:107], v[128:131]
  ds_read_b64_tr_b16 a[96:97], v5 offset:32768
  v_mfma_f32_16x16x32_bf16 a[0:3], a[68:71], a[104:107], a[0:3]
  ds_read_b64_tr_b16 a[98:99], v5 offset:34816
  buffer_load_dwordx4 v13, s[4:7], s56 offen offset:0 lds
  v_mfma_f32_16x16x32_bf16 v[132:135], a[72:75], a[104:107], v[132:135]
  v_mfma_f32_16x16x32_bf16 a[4:7], a[76:79], a[104:107], a[4:7]
  v_mfma_f32_16x16x32_bf16 v[136:139], a[80:83], a[104:107], v[136:139]
  buffer_load_dwordx4 v14, s[4:7], s56 offen offset:1024 lds
  v_mfma_f32_16x16x32_bf16 a[8:11], a[84:87], a[104:107], a[8:11]
  v_mfma_f32_16x16x32_bf16 v[140:143], a[88:91], a[104:107], v[140:143]
  v_mfma_f32_16x16x32_bf16 a[12:15], a[92:95], a[104:107], a[12:15]
  buffer_load_dwordx4 v15, s[4:7], s56 offen offset:2048 lds
  s_waitcnt lgkmcnt(2)
  v_mfma_f32_16x16x32_bf16 v[144:147], a[64:67], a[108:111], v[144:147]
  ds_read_b64_tr_b16 a[100:101], v6 offset:32768
  v_mfma_f32_16x16x32_bf16 a[16:19], a[68:71], a[108:111], a[16:19]
  ds_read_b64_tr_b16 a[102:103], v6 offset:34816
  v_mfma_f32_16x16x32_bf16 v[148:151], a[72:75], a[108:111], v[148:151]
  buffer_load_dwordx4 v16, s[4:7], s56 offen offset:3072 lds
  v_mfma_f32_16x16x32_bf16 a[20:23], a[76:79], a[108:111], a[20:23]
  v_mfma_f32_16x16x32_bf16 v[152:155], a[80:83], a[108:111], v[152:155]
  v_mfma_f32_16x16x32_bf16 a[24:27], a[84:87], a[108:111], a[24:27]
  v_mfma_f32_16x16x32_bf16 v[156:159], a[88:91], a[108:111], v[156:159]
  v_mfma_f32_16x16x32_bf16 a[28:31], a[92:95], a[108:111], a[28:31]
  s_waitcnt vmcnt(13)
  s_barrier
  v_add_u32 v4, s32, v3
  s_waitcnt lgkmcnt(2)
  v_mfma_f32_16x16x32_bf16 v[32:35], a[32:35], a[96:99], v[32:35]
  ds_read_b64_tr_b16 a[104:105], v7 offset:32768
  v_mfma_f32_16x16x32_bf16 v[160:163], a[36:39], a[96:99], v[160:163]
  ds_read_b64_tr_b16 a[106:107], v7 offset:34816
  v_mfma_f32_16x16x32_bf16 v[36:39], a[40:43], a[96:99], v[36:39]
  ds_read_b128 a[64:67], v4 offset:0
  v_mfma_f32_16x16x32_bf16 v[164:167], a[44:47], a[96:99], v[164:167]
  ds_read_b128 a[68:71], v4 offset:2048
  v_mfma_f32_16x16x32_bf16 v[40:43], a[48:51], a[96:99], v[40:43]
  v_mfma_f32_16x16x32_bf16 v[168:171], a[52:55], a[96:99], v[168:171]
  v_mfma_f32_16x16x32_bf16 v[44:47], a[56:59], a[96:99], v[44:47]
  v_mfma_f32_16x16x32_bf16 v[172:175], a[60:63], a[96:99], v[172:175]
  s_waitcnt lgkmcnt(4)
  v_mfma_f32_16x16x32_bf16 v[48:51], a[32:35], a[100:103], v[48:51]
  ds_read_b64_tr_b16 a[108:109], v8 offset:32768
  v_mfma_f32_16x16x32_bf16 v[176:179], a[36:39], a[100:103], v[176:179]
  ds_read_b64_tr_b16 a[110:111], v8 offset:34816
  v_mfma_f32_16x16x32_bf16 v[52:55], a[40:43], a[100:103], v[52:55]
  ds_read_b128 a[72:75], v4 offset:4096
  v_mfma_f32_16x16x32_bf16 v[180:183], a[44:47], a[100:103], v[180:183]
  ds_read_b128 a[76:79], v4 offset:6144
  v_mfma_f32_16x16x32_bf16 v[56:59], a[48:51], a[100:103], v[56:59]
  v_mfma_f32_16x16x32_bf16 v[184:187], a[52:55], a[100:103], v[184:187]
  v_mfma_f32_16x16x32_bf16 v[60:63], a[56:59], a[100:103], v[60:63]
  v_mfma_f32_16x16x32_bf16 v[188:191], a[60:63], a[100:103], v[188:191]
  s_waitcnt lgkmcnt(6)
  v_mfma_f32_16x16x32_bf16 v[64:67], a[32:35], a[104:107], v[64:67]
  ds_read_b64_tr_b16 a[96:97], v9 offset:32768
  v_mfma_f32_16x16x32_bf16 v[192:195], a[36:39], a[104:107], v[192:195]
  ds_read_b64_tr_b16 a[98:99], v9 offset:34816
  v_mfma_f32_16x16x32_bf16 v[68:71], a[40:43], a[104:107], v[68:71]
  ds_read_b128 a[80:83], v4 offset:8192
  v_mfma_f32_16x16x32_bf16 v[196:199], a[44:47], a[104:107], v[196:199]
  ds_read_b128 a[84:87], v4 offset:10240
  v_mfma_f32_16x16x32_bf16 v[72:75], a[48:51], a[104:107], v[72:75]
  v_mfma_f32_16x16x32_bf16 v[200:203], a[52:55], a[104:107], v[200:203]
  v_mfma_f32_16x16x32_bf16 v[76:79], a[56:59], a[104:107], v[76:79]
  v_mfma_f32_16x16x32_bf16 v[204:207], a[60:63], a[104:107], v[204:207]
  s_waitcnt lgkmcnt(6)
  v_mfma_f32_16x16x32_bf16 v[80:83], a[32:35], a[108:111], v[80:83]
  ds_read_b64_tr_b16 a[100:101], v10 offset:32768
  v_mfma_f32_16x16x32_bf16 v[208:211], a[36:39], a[108:111], v[208:211]
  ds_read_b64_tr_b16 a[102:103], v10 offset:34816
  v_mfma_f32_16x16x32_bf16 v[84:87], a[40:43], a[108:111], v[84:87]
  ds_read_b128 a[88:91], v4 offset:12288
  v_mfma_f32_16x16x32_bf16 v[212:215], a[44:47], a[108:111], v[212:215]
  ds_read_b128 a[92:95], v4 offset:14336
  v_mfma_f32_16x16x32_bf16 v[88:91], a[48:51], a[108:111], v[88:91]
  v_mfma_f32_16x16x32_bf16 v[216:219], a[52:55], a[108:111], v[216:219]
  v_mfma_f32_16x16x32_bf16 v[92:95], a[56:59], a[108:111], v[92:95]
  s_add_u32 m0, s48, 16384
  v_mfma_f32_16x16x32_bf16 v[220:223], a[60:63], a[108:111], v[220:223]
  s_waitcnt lgkmcnt(6)
  v_mfma_f32_16x16x32_bf16 v[96:99], a[32:35], a[96:99], v[96:99]
  ds_read_b64_tr_b16 a[104:105], v11 offset:32768
  v_mfma_f32_16x16x32_bf16 v[224:227], a[36:39], a[96:99], v[224:227]
  ds_read_b64_tr_b16 a[106:107], v11 offset:34816
  v_mfma_f32_16x16x32_bf16 v[100:103], a[40:43], a[96:99], v[100:103]
  buffer_load_dwordx4 v17, s[8:11], s35 offen offset:0 lds
  v_mfma_f32_16x16x32_bf16 v[228:231], a[44:47], a[96:99], v[228:231]
  v_mfma_f32_16x16x32_bf16 v[104:107], a[48:51], a[96:99], v[104:107]
  v_mfma_f32_16x16x32_bf16 v[232:235], a[52:55], a[96:99], v[232:235]
  buffer_load_dwordx4 v18, s[8:11], s35 offen offset:1024 lds
  v_mfma_f32_16x16x32_bf16 v[108:111], a[56:59], a[96:99], v[108:111]
  v_mfma_f32_16x16x32_bf16 v[236:239], a[60:63], a[96:99], v[236:239]
  s_waitcnt lgkmcnt(4)
  v_mfma_f32_16x16x32_bf16 v[112:115], a[32:35], a[100:103], v[112:115]
  ds_read_b64_tr_b16 a[108:109], v12 offset:32768
  buffer_load_dwordx4 v19, s[8:11], s35 offen offset:2048 lds
  v_mfma_f32_16x16x32_bf16 v[240:243], a[36:39], a[100:103], v[240:243]
  ds_read_b64_tr_b16 a[110:111], v12 offset:34816
  v_mfma_f32_16x16x32_bf16 v[116:119], a[40:43], a[100:103], v[116:119]
  v_mfma_f32_16x16x32_bf16 v[244:247], a[44:47], a[100:103], v[244:247]
  buffer_load_dwordx4 v20, s[8:11], s35 offen offset:3072 lds
  v_mfma_f32_16x16x32_bf16 v[120:123], a[48:51], a[100:103], v[120:123]
  v_mfma_f32_16x16x32_bf16 v[248:251], a[52:55], a[100:103], v[248:251]
  s_add_u32 s35, s35, 0x40000
  v_mfma_f32_16x16x32_bf16 v[124:127], a[56:59], a[100:103], v[124:127]
  s_add_u32 m0, s33, 4096
  v_mfma_f32_16x16x32_bf16 v[252:255], a[60:63], a[100:103], v[252:255]
  s_waitcnt lgkmcnt(2)
  v_mfma_f32_16x16x32_bf16 v[128:131], a[32:35], a[104:107], v[128:131]
  ds_read_b64_tr_b16 a[96:97], v5 offset:49152
  v_mfma_f32_16x16x32_bf16 a[0:3], a[36:39], a[104:107], a[0:3]
  ds_read_b64_tr_b16 a[98:99], v5 offset:51200
  buffer_load_dwordx4 v13, s[4:7], s57 offen offset:0 lds
  v_mfma_f32_16x16x32_bf16 v[132:135], a[40:43], a[104:107], v[132:135]
  v_mfma_f32_16x16x32_bf16 a[4:7], a[44:47], a[104:107], a[4:7]
  v_mfma_f32_16x16x32_bf16 v[136:139], a[48:51], a[104:107], v[136:139]
  buffer_load_dwordx4 v14, s[4:7], s57 offen offset:1024 lds
  v_mfma_f32_16x16x32_bf16 a[8:11], a[52:55], a[104:107], a[8:11]
  v_mfma_f32_16x16x32_bf16 v[140:143], a[56:59], a[104:107], v[140:143]
  v_mfma_f32_16x16x32_bf16 a[12:15], a[60:63], a[104:107], a[12:15]
  buffer_load_dwordx4 v15, s[4:7], s57 offen offset:2048 lds
  s_waitcnt lgkmcnt(2)
  v_mfma_f32_16x16x32_bf16 v[144:147], a[32:35], a[108:111], v[144:147]
  ds_read_b64_tr_b16 a[100:101], v6 offset:49152
  v_mfma_f32_16x16x32_bf16 a[16:19], a[36:39], a[108:111], a[16:19]
  ds_read_b64_tr_b16 a[102:103], v6 offset:51200
  v_mfma_f32_16x16x32_bf16 v[148:151], a[40:43], a[108:111], v[148:151]
  buffer_load_dwordx4 v16, s[4:7], s57 offen offset:3072 lds
  v_mfma_f32_16x16x32_bf16 a[20:23], a[44:47], a[108:111], a[20:23]
  v_mfma_f32_16x16x32_bf16 v[152:155], a[48:51], a[108:111], v[152:155]
  v_mfma_f32_16x16x32_bf16 a[24:27], a[52:55], a[108:111], a[24:27]
  v_mfma_f32_16x16x32_bf16 v[156:159], a[56:59], a[108:111], v[156:159]
  v_mfma_f32_16x16x32_bf16 a[28:31], a[60:63], a[108:111], a[28:31]
  s_waitcnt vmcnt(12)
  s_barrier
  s_add_u32 s33, s32, s49
  s_add_u32 s32, s32, 0x8000
  s_cmp_eq_u32 s32, 0x18000
  s_cselect_b32 s32, 0, s32
  s_add_u32 s34, s34, 128
  s_mov_b32 s56, s34
  s_add_u32 s57, s34, 0x10000
  v_add_u32 v4, s32, v2
  s_waitcnt lgkmcnt(2)
  v_mfma_f32_16x16x32_bf16 v[32:35], a[64:67], a[96:99], v[32:35]
  ds_read_b64_tr_b16 a[104:105], v7 offset:49152
  v_mfma_f32_16x16x32_bf16 v[160:163], a[68:71], a[96:99], v[160:163]
  ds_read_b64_tr_b16 a[106:107], v7 offset:51200
  v_mfma_f32_16x16x32_bf16 v[36:39], a[72:75], a[96:99], v[36:39]
  ds_read_b128 a[32:35], v4 offset:0
  v_mfma_f32_16x16x32_bf16 v[164:167], a[76:79], a[96:99], v[164:167]
  ds_read_b128 a[36:39], v4 offset:2048
  v_mfma_f32_16x16x32_bf16 v[40:43], a[80:83], a[96:99], v[40:43]
  v_mfma_f32_16x16x32_bf16 v[168:171], a[84:87], a[96:99], v[168:171]
  v_mfma_f32_16x16x32_bf16 v[44:47], a[88:91], a[96:99], v[44:47]
  v_mfma_f32_16x16x32_bf16 v[172:175], a[92:95], a[96:99], v[172:175]
  s_waitcnt lgkmcnt(4)
  v_mfma_f32_16x16x32_bf16 v[48:51], a[64:67], a[100:103], v[48:51]
  ds_read_b64_tr_b16 a[108:109], v8 offset:49152
  v_mfma_f32_16x16x32_bf16 v[176:179], a[68:71], a[100:103], v[176:179]
  ds_read_b64_tr_b16 a[110:111], v8 offset:51200
  v_mfma_f32_16x16x32_bf16 v[52:55], a[72:75], a[100:103], v[52:55]
  ds_read_b128 a[40:43], v4 offset:4096
  v_mfma_f32_16x16x32_bf16 v[180:183], a[76:79], a[100:103], v[180:183]
  ds_read_b128 a[44:47], v4 offset:6144
  v_mfma_f32_16x16x32_bf16 v[56:59], a[80:83], a[100:103], v[56:59]
  v_mfma_f32_16x16x32_bf16 v[184:187], a[84:87], a[100:103], v[184:187]
  v_mfma_f32_16x16x32_bf16 v[60:63], a[88:91], a[100:103], v[60:63]
  v_mfma_f32_16x16x32_bf16 v[188:191], a[92:95], a[100:103], v[188:191]
  s_waitcnt lgkmcnt(6)
  v_mfma_f32_16x16x32_bf16 v[64:67], a[64:67], a[104:107], v[64:67]
  ds_read_b64_tr_b16 a[96:97], v9 offset:49152
  v_mfma_f32_16x16x32_bf16 v[192:195], a[68:71], a[104:107], v[192:195]
  ds_read_b64_tr_b16 a[98:99], v9 offset:51200
  v_mfma_f32_16x16x32_bf16 v[68:71], a[72:75], a[104:107], v[68:71]
  ds_read_b128 a[48:51], v4 offset:8192
  v_mfma_f32_16x16x32_bf16 v[196:199], a[76:79], a[104:107], v[196:199]
  ds_read_b128 a[52:55], v4 offset:10240
  v_mfma_f32_16x16x32_bf16 v[72:75], a[80:83], a[104:107], v[72:75]
  v_mfma_f32_16x16x32_bf16 v[200:203], a[84:87], a[104:107], v[200:203]
  v_mfma_f32_16x16x32_bf16 v[76:79], a[88:91], a[104:107], v[76:79]
  v_mfma_f32_16x16x32_bf16 v[204:207], a[92:95], a[104:107], v[204:207]
  s_waitcnt lgkmcnt(6)
  v_mfma_f32_16x16x32_bf16 v[80:83], a[64:67], a[108:111], v[80:83]
  ds_read_b64_tr_b16 a[100:101], v10 offset:49152
  v_mfma_f32_16x16x32_bf16 v[208:211], a[68:71], a[108:111], v[208:211]
  ds_read_b64_tr_b16 a[102:103], v10 offset:51200
  v_mfma_f32_16x16x32_bf16 v[84:87], a[72:75], a[108:111], v[84:87]
  ds_read_b128 a[56:59], v4 offset:12288
  v_mfma_f32_16x16x32_bf16 v[212:215], a[76:79], a[108:111], v[212:215]
  ds_read_b128 a[60:63], v4 offset:14336
  v_mfma_f32_16x16x32_bf16 v[88:91], a[80:83], a[108:111], v[88:91]
  v_mfma_f32_16x16x32_bf16 v[216:219], a[84:87], a[108:111], v[216:219]
  v_mfma_f32_16x16x32_bf16 v[92:95], a[88:91], a[108:111], v[92:95]
  s_add_u32 m0, s48, 32768
  v_mfma_f32_16x16x32_bf16 v[220:223], a[92:95], a[108:111], v[220:223]
  s_waitcnt lgkmcnt(6)
  v_mfma_f32_16x16x32_bf16 v[96:99], a[64:67], a[96:99], v[96:99]
  ds_read_b64_tr_b16 a[104:105], v11 offset:49152
  v_mfma_f32_16x16x32_bf16 v[224:227], a[68:71], a[96:99], v[224:227]
  ds_read_b64_tr_b16 a[106:107], v11 offset:51200
  v_mfma_f32_16x16x32_bf16 v[100:103], a[72:75], a[96:99], v[100:103]
  buffer_load_dwordx4 v17, s[8:11], s35 offen offset:0 lds
  v_mfma_f32_16x16x32_bf16 v[228:231], a[76:79], a[96:99], v[228:231]
  v_mfma_f32_16x16x32_bf16 v[104:107], a[80:83], a[96:99], v[104:107]
  v_mfma_f32_16x16x32_bf16 v[232:235], a[84:87], a[96:99], v[232:235]
  buffer_load_dwordx4 v18, s[8:11], s35 offen offset:1024 lds
  v_mfma_f32_16x16x32_bf16 v[108:111], a[88:91], a[96:99], v[108:111]
  v_mfma_f32_16x16x32_bf16 v[236:239], a[92:95], a[96:99], v[236:239]
  s_waitcnt lgkmcnt(4)
  v_mfma_f32_16x16x32_bf16 v[112:115], a[64:67], a[100:103], v[112:115]
  ds_read_b64_tr_b16 a[108:109], v12 offset:49152
  buffer_load_dwordx4 v19, s[8:11], s35 offen offset:2048 lds
  v_mfma_f32_16x16x32_bf16 v[240:243], a[68:71], a[100:103], v[240:243]
  ds_read_b64_tr_b16 a[110:111], v12 offset:51200
  v_mfma_f32_16x16x32_bf16 v[116:119], a[72:75], a[100:103], v[116:119]
  v_mfma_f32_16x16x32_bf16 v[244:247], a[76:79], a[100:103], v[244:247]
  buffer_load_dwordx4 v20, s[8:11], s35 offen offset:3072 lds
  v_mfma_f32_16x16x32_bf16 v[120:123], a[80:83], a[100:103], v[120:123]
  v_mfma_f32_16x16x32_bf16 v[248:251], a[84:87], a[100:103], v[248:251]
  s_add_u32 s35, s35, 0x40000
  v_mfma_f32_16x16x32_bf16 v[124:127], a[88:91], a[100:103], v[124:127]
  s_add_u32 m0, s33, 0
  v_mfma_f32_16x16x32_bf16 v[252:255], a[92:95], a[100:103], v[252:255]
  s_waitcnt lgkmcnt(2)
  v_mfma_f32_16x16x32_bf16 v[128:131], a[64:67], a[104:107], v[128:131]
  ds_read_b64_tr_b16 a[96:97], v5 offset:0
  v_mfma_f32_16x16x32_bf16 a[0:3], a[68:71], a[104:107], a[0:3]
  ds_read_b64_tr_b16 a[98:99], v5 offset:2048
  buffer_load_dwordx4 v13, s[4:7], s56 offen offset:0 lds
  v_mfma_f32_16x16x32_bf16 v[132:135], a[72:75], a[104:107], v[132:135]
  v_mfma_f32_16x16x32_bf16 a[4:7], a[76:79], a[104:107], a[4:7]
  v_mfma_f32_16x16x32_bf16 v[136:139], a[80:83], a[104:107], v[136:139]
  buffer_load_dwordx4 v14, s[4:7], s56 offen offset:1024 lds
  v_mfma_f32_16x16x32_bf16 a[8:11], a[84:87], a[104:107], a[8:11]
  v_mfma_f32_16x16x32_bf16 v[140:143], a[88:91], a[104:107], v[140:143]
  v_mfma_f32_16x16x32_bf16 a[12:15], a[92:95], a[104:107], a[12:15]
  buffer_load_dwordx4 v15, s[4:7], s56 offen offset:2048 lds
  s_waitcnt lgkmcnt(2)
  v_mfma_f32_16x16x32_bf16 v[144:147], a[64:67], a[108:111], v[144:147]
  ds_read_b64_tr_b16 a[100:101], v6 offset:0
  v_mfma_f32_16x16x32_bf16 a[16:19], a[68:71], a[108:111], a[16:19]
  ds_read_b64_tr_b16 a[102:103], v6 offset:2048
  v_mfma_f32_16x16x32_bf16 v[148:151], a[72:75], a[108:111], v[148:151]
  buffer_load_dwordx4 v16, s[4:7], s56 offen offset:3072 lds
  v_mfma_f32_16x16x32_bf16 a[20:23], a[76:79], a[108:111], a[20:23]
  v_mfma_f32_16x16x32_bf16 v[152:155], a[80:83], a[108:111], v[152:155]
  v_mfma_f32_16x16x32_bf16 a[24:27], a[84:87], a[108:111], a[24:27]
  v_mfma_f32_16x16x32_bf16 v[156:159], a[88:91], a[108:111], v[156:159]
  v_mfma_f32_16x16x32_bf16 a[28:31], a[92:95], a[108:111], a[28:31]
  s_waitcnt vmcnt(12)
  s_barrier
  s_sub_u32 s50, s50, 1
  s_cmp_lg_u32 s50, 0
  s_cbranch_scc1 k1_V_loop
  s_mov_b32 s68, 0
k1_V_poll:
  v_and_b32 v24, v24, v25
  v_and_b32 v26, v26, v27
  v_and_b32 v24, v24, v26
  v_cmp_ne_u32 vcc, 0x01010101, v24
  s_add_u32 s68, s68, 1
  s_cbranch_vccz k1_V_ok
  s_cmp_lt_u32 s68, 0x40000
  s_cbranch_scc0 k1_V_ok
  s_sleep 4
  buffer_load_dwordx4 v[24:27], v23, s[36:39], 0 offen sc1
  s_waitcnt vmcnt(0)
  s_branch k1_V_poll
k1_V_ok:
  v_add_u32 v4, s32, v3
  s_waitcnt lgkmcnt(2)
  v_mfma_f32_16x16x32_bf16 v[32:35], a[32:35], a[96:99], v[32:35]
  ds_read_b64_tr_b16 a[104:105], v7 offset:0
  v_mfma_f32_16x16x32_bf16 v[160:163], a[36:39], a[96:99], v[160:163]
  ds_read_b64_tr_b16 a[106:107], v7 offset:2048
  v_mfma_f32_16x16x32_bf16 v[36:39], a[40:43], a[96:99], v[36:39]
  ds_read_b128 a[64:67], v4 offset:0
  v_mfma_f32_16x16x32_bf16 v[164:167], a[44:47], a[96:99], v[164:167]
  ds_read_b128 a[68:71], v4 offset:2048
  s_add_u32 m0, s48, 49152
  v_mfma_f32_16x16x32_bf16 v[40:43], a[48:51], a[96:99], v[40:43]
  buffer_load_dwordx4 v17, s[8:11], s35 offen offset:0 lds
  v_mfma_f32_16x16x32_bf16 v[168:171], a[52:55], a[96:99], v[168:171]
  buffer_load_dwordx4 v18, s[8:11], s35 offen offset:1024 lds
  v_mfma_f32_16x16x32_bf16 v[44:47], a[56:59], a[96:99], v[44:47]
  buffer_load_dwordx4 v19, s[8:11], s35 offen offset:2048 lds
  v_mfma_f32_16x16x32_bf16 v[172:175], a[60:63], a[96:99], v[172:175]
  buffer_load_dwordx4 v20, s[8:11], s35 offen offset:3072 lds
  s_waitcnt lgkmcnt(4)
  v_mfma_f32_16x16x32_bf16 v[48:51], a[32:35], a[100:103], v[48:51]
  ds_read_b64_tr_b16 a[108:109], v8 offset:0
  s_mov_b32 s59, 0
  v_mfma_f32_16x16x32_bf16 v[176:179], a[36:39], a[100:103], v[176:179]
  ds_read_b64_tr_b16 a[110:111], v8 offset:2048
  buffer_load_dwordx4 a[112:115], v30, s[16:19], s59 offen offset:0 sc1
  v_mfma_f32_16x16x32_bf16 v[52:55], a[40:43], a[100:103], v[52:55]
  ds_read_b128 a[72:75], v4 offset:4096
  s_mov_b32 s59, 0
  v_mfma_f32_16x16x32_bf16 v[180:183], a[44:47], a[100:103], v[180:183]
  ds_read_b128 a[76:79], v4 offset:6144
  buffer_load_dwordx4 a[168:171], v31, s[16:19], s59 offen offset:0 sc1
  v_mfma_f32_16x16x32_bf16 v[56:59], a[48:51], a[100:103], v[56:59]
  s_mov_b32 s59, 0
  v_mfma_f32_16x16x32_bf16 v[184:187], a[52:55], a[100:103], v[184:187]
  buffer_load_dwordx4 a[116:119], v30, s[16:19], s59 offen offset:1024 sc1
  v_mfma_f32_16x16x32_bf16 v[60:63], a[56:59], a[100:103], v[60:63]
  s_mov_b32 s59, 0
  v_mfma_f32_16x16x32_bf16 v[188:191], a[60:63], a[100:103], v[188:191]
  buffer_load_dwordx4 a[172:175], v31, s[16:19], s59 offen offset:1024 sc1
  s_waitcnt lgkmcnt(6)
  v_mfma_f32_16x16x32_bf16 v[64:67], a[32:35], a[104:107], v[64:67]
  ds_read_b64_tr_b16 a[96:97], v9 offset:0
  s_mov_b32 s59, 0
  v_mfma_f32_16x16x32_bf16 v[192:195], a[36:39], a[104:107], v[192:195]
  ds_read_b64_tr_b16 a[98:99], v9 offset:2048
  buffer_load_dwordx4 a[120:123], v30, s[16:19], s59 offen offset:2048 sc1
  v_mfma_f32_16x16x32_bf16 v[68:71], a[40:43], a[104:107], v[68:71]
  ds_read_b128 a[80:83], v4 offset:8192
  s_mov_b32 s59, 0
  v_mfma_f32_16x16x32_bf16 v[196:199], a[44:47], a[104:107], v[196:199]
  ds_read_b128 a[84:87], v4 offset:10240
  buffer_load_dwordx4 a[176:179], v31, s[16:19], s59 offen offset:2048 sc1
  v_mfma_f32_16x16x32_bf16 v[72:75], a[48:51], a[104:107], v[72:75]
  v_mfma_f32_16x16x32_bf16 v[200:203], a[52:55], a[104:107], v[200:203]
  v_mfma_f32_16x16x32_bf16 v[76:79], a[56:59], a[104:107], v[76:79]
  v_mfma_f32_16x16x32_bf16 v[204:207], a[60:63], a[104:107], v[204:207]
  s_waitcnt lgkmcnt(6)
  v_mfma_f32_16x16x32_bf16 v[80:83], a[32:35], a[108:111], v[80:83]
  ds_read_b64_tr_b16 a[100:101], v10 offset:0
  v_mfma_f32_16x16x32_bf16 v[208:211], a[36:39], a[108:111], v[208:211]
  ds_read_b64_tr_b16 a[102:103], v10 offset:2048
  v_mfma_f32_16x16x32_bf16 v[84:87], a[40:43], a[108:111], v[84:87]
  ds_read_b128 a[88:91], v4 offset:12288
  v_mfma_f32_16x16x32_bf16 v[212:215], a[44:47], a[108:111], v[212:215]
  ds_read_b128 a[92:95], v4 offset:14336
  v_mfma_f32_16x16x32_bf16 v[88:91], a[48:51], a[108:111], v[88:91]
  v_mfma_f32_16x16x32_bf16 v[216:219], a[52:55], a[108:111], v[216:219]
  v_mfma_f32_16x16x32_bf16 v[92:95], a[56:59], a[108:111], v[92:95]
  v_mfma_f32_16x16x32_bf16 v[220:223], a[60:63], a[108:111], v[220:223]
  s_waitcnt lgkmcnt(6)
  v_mfma_f32_16x16x32_bf16 v[96:99], a[32:35], a[96:99], v[96:99]
  ds_read_b64_tr_b16 a[104:105], v11 offset:0
  v_mfma_f32_16x16x32_bf16 v[224:227], a[36:39], a[96:99], v[224:227]
  ds_read_b64_tr_b16 a[106:107], v11 offset:2048
  v_mfma_f32_16x16x32_bf16 v[100:103], a[40:43], a[96:99], v[100:103]
  v_mfma_f32_16x16x32_bf16 v[228:231], a[44:47], a[96:99], v[228:231]
  v_mfma_f32_16x16x32_bf16 v[104:107], a[48:51], a[96:99], v[104:107]
  v_mfma_f32_16x16x32_bf16 v[232:235], a[52:55], a[96:99], v[232:235]
  v_mfma_f32_16x16x32_bf16 v[108:111], a[56:59], a[96:99], v[108:111]
  v_mfma_f32_16x16x32_bf16 v[236:239], a[60:63], a[96:99], v[236:239]
  s_waitcnt lgkmcnt(4)
  v_mfma_f32_16x16x32_bf16 v[112:115], a[32:35], a[100:103], v[112:115]
  ds_read_b64_tr_b16 a[108:109], v12 offset:0
  v_mfma_f32_16x16x32_bf16 v[240:243], a[36:39], a[100:103], v[240:243]
  ds_read_b64_tr_b16 a[110:111], v12 offset:2048
  v_mfma_f32_16x16x32_bf16 v[116:119], a[40:43], a[100:103], v[116:119]
  v_mfma_f32_16x16x32_bf16 v[244:247], a[44:47], a[100:103], v[244:247]
  v_mfma_f32_16x16x32_bf16 v[120:123], a[48:51], a[100:103], v[120:123]
  v_mfma_f32_16x16x32_bf16 v[248:251], a[52:55], a[100:103], v[248:251]
  v_mfma_f32_16x16x32_bf16 v[124:127], a[56:59], a[100:103], v[124:127]
  v_mfma_f32_16x16x32_bf16 v[252:255], a[60:63], a[100:103], v[252:255]
  s_waitcnt lgkmcnt(2)
  v_mfma_f32_16x16x32_bf16 v[128:131], a[32:35], a[104:107], v[128:131]
  ds_read_b64_tr_b16 a[96:97], v5 offset:16384
  v_mfma_f32_16x16x32_bf16 a[0:3], a[36:39], a[104:107], a[0:3]
  ds_read_b64_tr_b16 a[98:99], v5 offset:18432
  v_mfma_f32_16x16x32_bf16 v[132:135], a[40:43], a[104:107], v[132:135]
  v_mfma_f32_16x16x32_bf16 a[4:7], a[44:47], a[104:107], a[4:7]
  v_mfma_f32_16x16x32_bf16 v[136:139], a[48:51], a[104:107], v[136:139]
  v_mfma_f32_16x16x32_bf16 a[8:11], a[52:55], a[104:107], a[8:11]
  v_mfma_f32_16x16x32_bf16 v[140:143], a[56:59], a[104:107], v[140:143]
  v_mfma_f32_16x16x32_bf16 a[12:15], a[60:63], a[104:107], a[12:15]
  s_waitcnt lgkmcnt(2)
  v_mfma_f32_16x16x32_bf16 v[144:147], a[32:35], a[108:111], v[144:147]
  ds_read_b64_tr_b16 a[100:101], v6 offset:16384
  v_mfma_f32_16x16x32_bf16 a[16:19], a[36:39], a[108:111], a[16:19]
  ds_read_b64_tr_b16 a[102:103], v6 offset:18432
  v_mfma_f32_16x16x32_bf16 v[148:151], a[40:43], a[108:111], v[148:151]
  v_mfma_f32_16x16x32_bf16 a[20:23], a[44:47], a[108:111], a[20:23]
  v_mfma_f32_16x16x32_bf16 v[152:155], a[48:51], a[108:111], v[152:155]
  v_mfma_f32_16x16x32_bf16 a[24:27], a[52:55], a[108:111], a[24:27]
  v_mfma_f32_16x16x32_bf16 v[156:159], a[56:59], a[108:111], v[156:159]
  v_mfma_f32_16x16x32_bf16 a[28:31], a[60:63], a[108:111], a[28:31]
  s_waitcnt vmcnt(10)
  s_barrier
  s_add_u32 s33, s32, s49
  s_add_u32 s32, s32, 0x8000
  s_cmp_eq_u32 s32, 0x18000
  s_cselect_b32 s32, 0, s32
  s_add_u32 s34, s34, 128
  s_mov_b32 s56, s34
  s_add_u32 s57, s34, 0x10000
  v_add_u32 v4, s32, v2
  s_waitcnt lgkmcnt(2)
  v_mfma_f32_16x16x32_bf16 v[32:35], a[64:67], a[96:99], v[32:35]
  ds_read_b64_tr_b16 a[104:105], v7 offset:16384
  v_mfma_f32_16x16x32_bf16 v[160:163], a[68:71], a[96:99], v[160:163]
  ds_read_b64_tr_b16 a[106:107], v7 offset:18432
  v_mfma_f32_16x16x32_bf16 v[36:39], a[72:75], a[96:99], v[36:39]
  ds_read_b128 a[32:35], v4 offset:0
  v_mfma_f32_16x16x32_bf16 v[164:167], a[76:79], a[96:99], v[164:167]
  ds_read_b128 a[36:39], v4 offset:2048
  s_add_u32 m0, s58, 32768
  v_mfma_f32_16x16x32_bf16 v[40:43], a[80:83], a[96:99], v[40:43]
  s_mov_b32 s59, 0
  v_mfma_f32_16x16x32_bf16 v[168:171], a[84:87], a[96:99], v[168:171]
  buffer_load_dwordx4 v17, s[12:15], s59 offen offset:0 lds
  v_mfma_f32_16x16x32_bf16 v[44:47], a[88:91], a[96:99], v[44:47]
  buffer_load_dwordx4 v18, s[12:15], s59 offen offset:1024 lds
  v_mfma_f32_16x16x32_bf16 v[172:175], a[92:95], a[96:99], v[172:175]
  buffer_load_dwordx4 v19, s[12:15], s59 offen offset:2048 lds
  s_waitcnt lgkmcnt(4)
  v_mfma_f32_16x16x32_bf16 v[48:51], a[64:67], a[100:103], v[48:51]
  ds_read_b64_tr_b16 a[108:109], v8 offset:16384
  buffer_load_dwordx4 v20, s[12:15], s59 offen offset:3072 lds
  v_mfma_f32_16x16x32_bf16 v[176:179], a[68:71], a[100:103], v[176:179]
  ds_read_b64_tr_b16 a[110:111], v8 offset:18432
  s_add_u32 m0, s58, 49152
  v_mfma_f32_16x16x32_bf16 v[52:55], a[72:75], a[100:103], v[52:55]
  ds_read_b128 a[40:43], v4 offset:4096
  s_mov_b32 s59, 262144
  v_mfma_f32_16x16x32_bf16 v[180:183], a[76:79], a[100:103], v[180:183]
  ds_read_b128 a[44:47], v4 offset:6144
  buffer_load_dwordx4 v17, s[12:15], s59 offen offset:0 lds
  v_mfma_f32_16x16x32_bf16 v[56:59], a[80:83], a[100:103], v[56:59]
  buffer_load_dwordx4 v18, s[12:15], s59 offen offset:1024 lds
  v_mfma_f32_16x16x32_bf16 v[184:187], a[84:87], a[100:103], v[184:187]
  buffer_load_dwordx4 v19, s[12:15], s59 offen offset:2048 lds
  v_mfma_f32_16x16x32_bf16 v[60:63], a[88:91], a[100:103], v[60:63]
  buffer_load_dwordx4 v20, s[12:15], s59 offen offset:3072 lds
  v_mfma_f32_16x16x32_bf16 v[188:191], a[92:95], a[100:103], v[188:191]
  s_mov_b32 s59, 0
  s_waitcnt lgkmcnt(6)
  v_mfma_f32_16x16x32_bf16 v[64:67], a[64:67], a[104:107], v[64:67]
  ds_read_b64_tr_b16 a[96:97], v9 offset:16384
  buffer_load_dwordx4 a[124:127], v30, s[16:19], s59 offen offset:3072 sc1
  v_mfma_f32_16x16x32_bf16 v[192:195], a[68:71], a[104:107], v[192:195]
  ds_read_b64_tr_b16 a[98:99], v9 offset:18432
  s_mov_b32 s59, 0
  v_mfma_f32_16x16x32_bf16 v[68:71], a[72:75], a[104:107], v[68:71]
  ds_read_b128 a[48:51], v4 offset:8192
  buffer_load_dwordx4 a[180:183], v31, s[16:19], s59 offen offset:3072 sc1
  v_mfma_f32_16x16x32_bf16 v[196:199], a[76:79], a[104:107], v[196:199]
  ds_read_b128 a[52:55], v4 offset:10240
  s_add_u32 m0, s58, 65536
  v_mfma_f32_16x16x32_bf16 v[72:75], a[80:83], a[104:107], v[72:75]
  s_mov_b32 s59, 524288
  v_mfma_f32_16x16x32_bf16 v[200:203], a[84:87], a[104:107], v[200:203]
  buffer_load_dwordx4 v17, s[12:15], s59 offen offset:0 lds
  v_mfma_f32_16x16x32_bf16 v[76:79], a[88:91], a[104:107], v[76:79]
  buffer_load_dwordx4 v18, s[12:15], s59 offen offset:1024 lds
  v_mfma_f32_16x16x32_bf16 v[204:207], a[92:95], a[104:107], v[204:207]
  buffer_load_dwordx4 v19, s[12:15], s59 offen offset:2048 lds
  s_waitcnt lgkmcnt(6)
  v_mfma_f32_16x16x32_bf16 v[80:83], a[64:67], a[108:111], v[80:83]
  ds_read_b64_tr_b16 a[100:101], v10 offset:16384
  buffer_load_dwordx4 v20, s[12:15], s59 offen offset:3072 lds
  v_mfma_f32_16x16x32_bf16 v[208:211], a[68:71], a[108:111], v[208:211]
  ds_read_b64_tr_b16 a[102:103], v10 offset:18432
  v_mfma_f32_16x16x32_bf16 v[84:87], a[72:75], a[108:111], v[84:87]
  ds_read_b128 a[56:59], v4 offset:12288
  v_mfma_f32_16x16x32_bf16 v[212:215], a[76:79], a[108:111], v[212:215]
  ds_read_b128 a[60:63], v4 offset:14336
  v_mfma_f32_16x16x32_bf16 v[88:91], a[80:83], a[108:111], v[88:91]
  v_mfma_f32_16x16x32_bf16 v[216:219], a[84:87], a[108:111], v[216:219]
  v_mfma_f32_16x16x32_bf16 v[92:95], a[88:91], a[108:111], v[92:95]
  v_mfma_f32_16x16x32_bf16 v[220:223], a[92:95], a[108:111], v[220:223]
  s_waitcnt lgkmcnt(6)
  v_mfma_f32_16x16x32_bf16 v[96:99], a[64:67], a[96:99], v[96:99]
  ds_read_b64_tr_b16 a[104:105], v11 offset:16384
  v_mfma_f32_16x16x32_bf16 v[224:227], a[68:71], a[96:99], v[224:227]
  ds_read_b64_tr_b16 a[106:107], v11 offset:18432
  v_mfma_f32_16x16x32_bf16 v[100:103], a[72:75], a[96:99], v[100:103]
  v_mfma_f32_16x16x32_bf16 v[228:231], a[76:79], a[96:99], v[228:231]
  v_mfma_f32_16x16x32_bf16 v[104:107], a[80:83], a[96:99], v[104:107]
  v_mfma_f32_16x16x32_bf16 v[232:235], a[84:87], a[96:99], v[232:235]
  v_mfma_f32_16x16x32_bf16 v[108:111], a[88:91], a[96:99], v[108:111]
  v_mfma_f32_16x16x32_bf16 v[236:239], a[92:95], a[96:99], v[236:239]
  s_waitcnt lgkmcnt(4)
  v_mfma_f32_16x16x32_bf16 v[112:115], a[64:67], a[100:103], v[112:115]
  ds_read_b64_tr_b16 a[108:109], v12 offset:16384
  v_mfma_f32_16x16x32_bf16 v[240:243], a[68:71], a[100:103], v[240:243]
  ds_read_b64_tr_b16 a[110:111], v12 offset:18432
  v_mfma_f32_16x16x32_bf16 v[116:119], a[72:75], a[100:103], v[116:119]
  v_mfma_f32_16x16x32_bf16 v[244:247], a[76:79], a[100:103], v[244:247]
  v_mfma_f32_16x16x32_bf16 v[120:123], a[80:83], a[100:103], v[120:123]
  v_mfma_f32_16x16x32_bf16 v[248:251], a[84:87], a[100:103], v[248:251]
  v_mfma_f32_16x16x32_bf16 v[124:127], a[88:91], a[100:103], v[124:127]
  v_mfma_f32_16x16x32_bf16 v[252:255], a[92:95], a[100:103], v[252:255]
  s_waitcnt lgkmcnt(2)
  v_mfma_f32_16x16x32_bf16 v[128:131], a[64:67], a[104:107], v[128:131]
  ds_read_b64_tr_b16 a[96:97], v5 offset:32768
  v_mfma_f32_16x16x32_bf16 a[0:3], a[68:71], a[104:107], a[0:3]
  ds_read_b64_tr_b16 a[98:99], v5 offset:34816
  v_mfma_f32_16x16x32_bf16 v[132:135], a[72:75], a[104:107], v[132:135]
  v_mfma_f32_16x16x32_bf16 a[4:7], a[76:79], a[104:107], a[4:7]
  v_mfma_f32_16x16x32_bf16 v[136:139], a[80:83], a[104:107], v[136:139]
  v_mfma_f32_16x16x32_bf16 a[8:11], a[84:87], a[104:107], a[8:11]
  v_mfma_f32_16x16x32_bf16 v[140:143], a[88:91], a[104:107], v[140:143]
  v_mfma_f32_16x16x32_bf16 a[12:15], a[92:95], a[104:107], a[12:15]
  s_waitcnt lgkmcnt(2)
  v_mfma_f32_16x16x32_bf16 v[144:147], a[64:67], a[108:111], v[144:147]
  ds_read_b64_tr_b16 a[100:101], v6 offset:32768
  v_mfma_f32_16x16x32_bf16 a[16:19], a[68:71], a[108:111], a[16:19]
  ds_read_b64_tr_b16 a[102:103], v6 offset:34816
  v_mfma_f32_16x16x32_bf16 v[148:151], a[72:75], a[108:111], v[148:151]
  v_mfma_f32_16x16x32_bf16 a[20:23], a[76:79], a[108:111], a[20:23]
  v_mfma_f32_16x16x32_bf16 v[152:155], a[80:83], a[108:111], v[152:155]
  v_mfma_f32_16x16x32_bf16 a[24:27], a[84:87], a[108:111], a[24:27]
  v_mfma_f32_16x16x32_bf16 v[156:159], a[88:91], a[108:111], v[156:159]
  v_mfma_f32_16x16x32_bf16 a[28:31], a[92:95], a[108:111], a[28:31]
  s_waitcnt vmcnt(20)
  s_barrier
  v_add_u32 v4, s32, v3
  s_waitcnt lgkmcnt(2)
  v_mfma_f32_16x16x32_bf16 v[32:35], a[32:35], a[96:99], v[32:35]
  ds_read_b64_tr_b16 a[104:105], v7 offset:32768
  v_mfma_f32_16x16x32_bf16 v[160:163], a[36:39], a[96:99], v[160:163]
  ds_read_b64_tr_b16 a[106:107], v7 offset:34816
  v_mfma_f32_16x16x32_bf16 v[36:39], a[40:43], a[96:99], v[36:39]
  ds_read_b128 a[64:67], v4 offset:0
  v_mfma_f32_16x16x32_bf16 v[164:167], a[44:47], a[96:99], v[164:167]
  ds_read_b128 a[68:71], v4 offset:2048
  s_add_u32 m0, s58, 81920
  v_mfma_f32_16x16x32_bf16 v[40:43], a[48:51], a[96:99], v[40:43]
  s_mov_b32 s59, 786432
  v_mfma_f32_16x16x32_bf16 v[168:171], a[52:55], a[96:99], v[168:171]
  buffer_load_dwordx4 v17, s[12:15], s59 offen offset:0 lds
  v_mfma_f32_16x16x32_bf16 v[44:47], a[56:59], a[96:99], v[44:47]
  buffer_load_dwordx4 v18, s[12:15], s59 offen offset:1024 lds
  v_mfma_f32_16x16x32_bf16 v[172:175], a[60:63], a[96:99], v[172:175]
  buffer_load_dwordx4 v19, s[12:15], s59 offen offset:2048 lds
  s_waitcnt lgkmcnt(4)
  v_mfma_f32_16x16x32_bf16 v[48:51], a[32:35], a[100:103], v[48:51]
  ds_read_b64_tr_b16 a[108:109], v8 offset:32768
  buffer_load_dwordx4 v20, s[12:15], s59 offen offset:3072 lds
  v_mfma_f32_16x16x32_bf16 v[176:179], a[36:39], a[100:103], v[176:179]
  ds_read_b64_tr_b16 a[110:111], v8 offset:34816
  s_mov_b32 s59, 4096
  v_mfma_f32_16x16x32_bf16 v[52:55], a[40:43], a[100:103], v[52:55]
  ds_read_b128 a[72:75], v4 offset:4096
  buffer_load_dwordx4 a[128:131], v30, s[16:19], s59 offen offset:0 sc1
  v_mfma_f32_16x16x32_bf16 v[180:183], a[44:47], a[100:103], v[180:183]
  ds_read_b128 a[76:79], v4 offset:6144
  s_mov_b32 s59, 4096
  v_mfma_f32_16x16x32_bf16 v[56:59], a[48:51], a[100:103], v[56:59]
  buffer_load_dwordx4 a[184:187], v31, s[16:19], s59 offen offset:0 sc1
  v_mfma_f32_16x16x32_bf16 v[184:187], a[52:55], a[100:103], v[184:187]
  s_mov_b32 s59, 4096
  v_mfma_f32_16x16x32_bf16 v[60:63], a[56:59], a[100:103], v[60:63]
  buffer_load_dwordx4 a[132:135], v30, s[16:19], s59 offen offset:1024 sc1
  v_mfma_f32_16x16x32_bf16 v[188:191], a[60:63], a[100:103], v[188:191]
  s_add_u32 m0, s58, 98304
  s_waitcnt lgkmcnt(6)
  v_mfma_f32_16x16x32_bf16 v[64:67], a[32:35], a[104:107], v[64:67]
  ds_read_b64_tr_b16 a[96:97], v9 offset:32768
  s_mov_b32 s59, 1048576
  v_mfma_f32_16x16x32_bf16 v[192:195], a[36:39], a[104:107], v[192:195]
  ds_read_b64_tr_b16 a[98:99], v9 offset:34816
  buffer_load_dwordx4 v17, s[12:15], s59 offen offset:0 lds
  v_mfma_f32_16x16x32_bf16 v[68:71], a[40:43], a[104:107], v[68:71]
  ds_read_b128 a[80:83], v4 offset:8192
  buffer_load_dwordx4 v18, s[12:15], s59 offen offset:1024 lds
  v_mfma_f32_16x16x32_bf16 v[196:199], a[44:47], a[104:107], v[196:199]
  ds_read_b128 a[84:87], v4 offset:10240
  buffer_load_dwordx4 v19, s[12:15], s59 offen offset:2048 lds
  v_mfma_f32_16x16x32_bf16 v[72:75], a[48:51], a[104:107], v[72:75]
  buffer_load_dwordx4 v20, s[12:15], s59 offen offset:3072 lds
  v_mfma_f32_16x16x32_bf16 v[200:203], a[52:55], a[104:107], v[200:203]
  s_add_u32 m0, s58, 114688
  v_mfma_f32_16x16x32_bf16 v[76:79], a[56:59], a[104:107], v[76:79]
  s_mov_b32 s59, 1310720
  v_mfma_f32_16x16x32_bf16 v[204:207], a[60:63], a[104:107], v[204:207]
  buffer_load_dwordx4 v17, s[12:15], s59 offen offset:0 lds
  s_waitcnt lgkmcnt(6)
  v_mfma_f32_16x16x32_bf16 v[80:83], a[32:35], a[108:111], v[80:83]
  ds_read_b64_tr_b16 a[100:101], v10 offset:32768
  buffer_load_dwordx4 v18, s[12:15], s59 offen offset:1024 lds
  v_mfma_f32_16x16x32_bf16 v[208:211], a[36:39], a[108:111], v[208:211]
  ds_read_b64_tr_b16 a[102:103], v10 offset:34816
  buffer_load_dwordx4 v19, s[12:15], s59 offen offset:2048 lds
  v_mfma_f32_16x16x32_bf16 v[84:87], a[40:43], a[108:111], v[84:87]
  ds_read_b128 a[88:91], v4 offset:12288
  buffer_load_dwordx4 v20, s[12:15], s59 offen offset:3072 lds
  v_mfma_f32_16x16x32_bf16 v[212:215], a[44:47], a[108:111], v[212:215]
  ds_read_b128 a[92:95], v4 offset:14336
  v_mfma_f32_16x16x32_bf16 v[88:91], a[48:51], a[108:111], v[88:91]
  v_mfma_f32_16x16x32_bf16 v[216:219], a[52:55], a[108:111], v[216:219]
  v_mfma_f32_16x16x32_bf16 v[92:95], a[56:59], a[108:111], v[92:95]
  v_mfma_f32_16x16x32_bf16 v[220:223], a[60:63], a[108:111], v[220:223]
  s_waitcnt lgkmcnt(6)
  v_mfma_f32_16x16x32_bf16 v[96:99], a[32:35], a[96:99], v[96:99]
  ds_read_b64_tr_b16 a[104:105], v11 offset:32768
  v_mfma_f32_16x16x32_bf16 v[224:227], a[36:39], a[96:99], v[224:227]
  ds_read_b64_tr_b16 a[106:107], v11 offset:34816
  v_mfma_f32_16x16x32_bf16 v[100:103], a[40:43], a[96:99], v[100:103]
  v_mfma_f32_16x16x32_bf16 v[228:231], a[44:47], a[96:99], v[228:231]
  v_mfma_f32_16x16x32_bf16 v[104:107], a[48:51], a[96:99], v[104:107]
  v_mfma_f32_16x16x32_bf16 v[232:235], a[52:55], a[96:99], v[232:235]
  v_mfma_f32_16x16x32_bf16 v[108:111], a[56:59], a[96:99], v[108:111]
  v_mfma_f32_16x16x32_bf16 v[236:239], a[60:63], a[96:99], v[236:239]
  s_waitcnt lgkmcnt(4)
  v_mfma_f32_16x16x32_bf16 v[112:115], a[32:35], a[100:103], v[112:115]
  ds_read_b64_tr_b16 a[108:109], v12 offset:32768
  v_mfma_f32_16x16x32_bf16 v[240:243], a[36:39], a[100:103], v[240:243]
  ds_read_b64_tr_b16 a[110:111], v12 offset:34816
  v_mfma_f32_16x16x32_bf16 v[116:119], a[40:43], a[100:103], v[116:119]
  v_mfma_f32_16x16x32_bf16 v[244:247], a[44:47], a[100:103], v[244:247]
  v_mfma_f32_16x16x32_bf16 v[120:123], a[48:51], a[100:103], v[120:123]
  v_mfma_f32_16x16x32_bf16 v[248:251], a[52:55], a[100:103], v[248:251]
  v_mfma_f32_16x16x32_bf16 v[124:127], a[56:59], a[100:103], v[124:127]
  v_mfma_f32_16x16x32_bf16 v[252:255], a[60:63], a[100:103], v[252:255]
  s_waitcnt lgkmcnt(2)
  v_mfma_f32_16x16x32_bf16 v[128:131], a[32:35], a[104:107], v[128:131]
  ds_read_b64_tr_b16 a[96:97], v5 offset:49152
  v_mfma_f32_16x16x32_bf16 a[0:3], a[36:39], a[104:107], a[0:3]
  ds_read_b64_tr_b16 a[98:99], v5 offset:51200
  v_mfma_f32_16x16x32_bf16 v[132:135], a[40:43], a[104:107], v[132:135]
  v_mfma_f32_16x16x32_bf16 a[4:7], a[44:47], a[104:107], a[4:7]
  v_mfma_f32_16x16x32_bf16 v[136:139], a[48:51], a[104:107], v[136:139]
  v_mfma_f32_16x16x32_bf16 a[8:11], a[52:55], a[104:107], a[8:11]
  v_mfma_f32_16x16x32_bf16 v[140:143], a[56:59], a[104:107], v[140:143]
  v_mfma_f32_16x16x32_bf16 a[12:15], a[60:63], a[104:107], a[12:15]
  s_waitcnt lgkmcnt(2)
  v_mfma_f32_16x16x32_bf16 v[144:147], a[32:35], a[108:111], v[144:147]
  ds_read_b64_tr_b16 a[100:101], v6 offset:49152
  v_mfma_f32_16x16x32_bf16 a[16:19], a[36:39], a[108:111], a[16:19]
  ds_read_b64_tr_b16 a[102:103], v6 offset:51200
  v_mfma_f32_16x16x32_bf16 v[148:151], a[40:43], a[108:111], v[148:151]
  v_mfma_f32_16x16x32_bf16 a[20:23], a[44:47], a[108:111], a[20:23]
  v_mfma_f32_16x16x32_bf16 v[152:155], a[48:51], a[108:111], v[152:155]
  v_mfma_f32_16x16x32_bf16 a[24:27], a[52:55], a[108:111], a[24:27]
  v_mfma_f32_16x16x32_bf16 v[156:159], a[56:59], a[108:111], v[156:159]
  v_mfma_f32_16x16x32_bf16 a[28:31], a[60:63], a[108:111], a[28:31]
  s_waitcnt vmcnt(29)
  s_barrier
  s_add_u32 s33, s32, s49
  s_add_u32 s32, s32, 0x8000
  s_cmp_eq_u32 s32, 0x18000
  s_cselect_b32 s32, 0, s32
  s_add_u32 s34, s34, 128
  s_mov_b32 s56, s34
  s_add_u32 s57, s34, 0x10000
  s_waitcnt lgkmcnt(2)
  v_mfma_f32_16x16x32_bf16 v[32:35], a[64:67], a[96:99], v[32:35]
  ds_read_b64_tr_b16 a[104:105], v7 offset:49152
  v_mfma_f32_16x16x32_bf16 v[160:163], a[68:71], a[96:99], v[160:163]
  ds_read_b64_tr_b16 a[106:107], v7 offset:51200
  v_mfma_f32_16x16x32_bf16 v[36:39], a[72:75], a[96:99], v[36:39]
  v_mfma_f32_16x16x32_bf16 v[164:167], a[76:79], a[96:99], v[164:167]
  s_add_u32 m0, s58, 131072
  v_mfma_f32_16x16x32_bf16 v[40:43], a[80:83], a[96:99], v[40:43]
  s_mov_b32 s59, 1572864
  v_mfma_f32_16x16x32_bf16 v[168:171], a[84:87], a[96:99], v[168:171]
  buffer_load_dwordx4 v17, s[12:15], s59 offen offset:0 lds
  v_mfma_f32_16x16x32_bf16 v[44:47], a[88:91], a[96:99], v[44:47]
  buffer_load_dwordx4 v18, s[12:15], s59 offen offset:1024 lds
  v_mfma_f32_16x16x32_bf16 v[172:175], a[92:95], a[96:99], v[172:175]
  buffer_load_dwordx4 v19, s[12:15], s59 offen offset:2048 lds
  s_waitcnt lgkmcnt(2)
  v_mfma_f32_16x16x32_bf16 v[48:51], a[64:67], a[100:103], v[48:51]
  ds_read_b64_tr_b16 a[108:109], v8 offset:49152
  buffer_load_dwordx4 v20, s[12:15], s59 offen offset:3072 lds
  v_mfma_f32_16x16x32_bf16 v[176:179], a[68:71], a[100:103], v[176:179]
  ds_read_b64_tr_b16 a[110:111], v8 offset:51200
  s_mov_b32 s59, 4096
  v_mfma_f32_16x16x32_bf16 v[52:55], a[72:75], a[100:103], v[52:55]
  buffer_load_dwordx4 a[188:191], v31, s[16:19], s59 offen offset:1024 sc1
  v_mfma_f32_16x16x32_bf16 v[180:183], a[76:79], a[100:103], v[180:183]
  s_mov_b32 s59, 4096
  v_mfma_f32_16x16x32_bf16 v[56:59], a[80:83], a[100:103], v[56:59]
  buffer_load_dwordx4 a[136:139], v30, s[16:19], s59 offen offset:2048 sc1
  v_mfma_f32_16x16x32_bf16 v[184:187], a[84:87], a[100:103], v[184:187]
  s_mov_b32 s59, 4096
  v_mfma_f32_16x16x32_bf16 v[60:63], a[88:91], a[100:103], v[60:63]
  buffer_load_dwordx4 a[192:195], v31, s[16:19], s59 offen offset:2048 sc1
  v_mfma_f32_16x16x32_bf16 v[188:191], a[92:95], a[100:103], v[188:191]
  s_add_u32 m0, s58, 0
  s_waitcnt lgkmcnt(2)
  v_mfma_f32_16x16x32_bf16 v[64:67], a[64:67], a[104:107], v[64:67]
  ds_read_b64_tr_b16 a[96:97], v9 offset:49152
  s_mov_b32 s59, 2097152
  v_mfma_f32_16x16x32_bf16 v[192:195], a[68:71], a[104:107], v[192:195]
  ds_read_b64_tr_b16 a[98:99], v9 offset:51200
  buffer_load_dwordx4 v17, s[12:15], s59 offen offset:0 lds
  v_mfma_f32_16x16x32_bf16 v[68:71], a[72:75], a[104:107], v[68:71]
  buffer_load_dwordx4 v18, s[12:15], s59 offen offset:1024 lds
  v_mfma_f32_16x16x32_bf16 v[196:199], a[76:79], a[104:107], v[196:199]
  buffer_load_dwordx4 v19, s[12:15], s59 offen offset:2048 lds
  v_mfma_f32_16x16x32_bf16 v[72:75], a[80:83], a[104:107], v[72:75]
  buffer_load_dwordx4 v20, s[12:15], s59 offen offset:3072 lds
  v_mfma_f32_16x16x32_bf16 v[200:203], a[84:87], a[104:107], v[200:203]
  v_mfma_f32_16x16x32_bf16 v[76:79], a[88:91], a[104:107], v[76:79]
  v_mfma_f32_16x16x32_bf16 v[204:207], a[92:95], a[104:107], v[204:207]
  s_waitcnt lgkmcnt(2)
  v_mfma_f32_16x16x32_bf16 v[80:83], a[64:67], a[108:111], v[80:83]
  ds_read_b64_tr_b16 a[100:101], v10 offset:49152
  v_mfma_f32_16x16x32_bf16 v[208:211], a[68:71], a[108:111], v[208:211]
  ds_read_b64_tr_b16 a[102:103], v10 offset:51200
  v_mfma_f32_16x16x32_bf16 v[84:87], a[72:75], a[108:111], v[84:87]
  v_mfma_f32_16x16x32_bf16 v[212:215], a[76:79], a[108:111], v[212:215]
  v_mfma_f32_16x16x32_bf16 v[88:91], a[80:83], a[108:111], v[88:91]
  v_mfma_f32_16x16x32_bf16 v[216:219], a[84:87], a[108:111], v[216:219]
  v_mfma_f32_16x16x32_bf16 v[92:95], a[88:91], a[108:111], v[92:95]
  v_mfma_f32_16x16x32_bf16 v[220:223], a[92:95], a[108:111], v[220:223]
  s_waitcnt lgkmcnt(2)
  v_mfma_f32_16x16x32_bf16 v[96:99], a[64:67], a[96:99], v[96:99]
  ds_read_b64_tr_b16 a[104:105], v11 offset:49152
  v_mfma_f32_16x16x32_bf16 v[224:227], a[68:71], a[96:99], v[224:227]
  ds_read_b64_tr_b16 a[106:107], v11 offset:51200
  v_mfma_f32_16x16x32_bf16 v[100:103], a[72:75], a[96:99], v[100:103]
  v_mfma_f32_16x16x32_bf16 v[228:231], a[76:79], a[96:99], v[228:231]
  v_mfma_f32_16x16x32_bf16 v[104:107], a[80:83], a[96:99], v[104:107]
  v_mfma_f32_16x16x32_bf16 v[232:235], a[84:87], a[96:99], v[232:235]
  v_mfma_f32_16x16x32_bf16 v[108:111], a[88:91], a[96:99], v[108:111]
  v_mfma_f32_16x16x32_bf16 v[236:239], a[92:95], a[96:99], v[236:239]
  s_waitcnt lgkmcnt(2)
  v_mfma_f32_16x16x32_bf16 v[112:115], a[64:67], a[100:103], v[112:115]
  ds_read_b64_tr_b16 a[108:109], v12 offset:49152
  v_mfma_f32_16x16x32_bf16 v[240:243], a[68:71], a[100:103], v[240:243]
  ds_read_b64_tr_b16 a[110:111], v12 offset:51200
  v_mfma_f32_16x16x32_bf16 v[116:119], a[72:75], a[100:103], v[116:119]
  v_mfma_f32_16x16x32_bf16 v[244:247], a[76:79], a[100:103], v[244:247]
  v_mfma_f32_16x16x32_bf16 v[120:123], a[80:83], a[100:103], v[120:123]
  v_mfma_f32_16x16x32_bf16 v[248:251], a[84:87], a[100:103], v[248:251]
  v_mfma_f32_16x16x32_bf16 v[124:127], a[88:91], a[100:103], v[124:127]
  v_mfma_f32_16x16x32_bf16 v[252:255], a[92:95], a[100:103], v[252:255]
  s_waitcnt lgkmcnt(2)
  v_mfma_f32_16x16x32_bf16 v[128:131], a[64:67], a[104:107], v[128:131]
  v_mfma_f32_16x16x32_bf16 a[0:3], a[68:71], a[104:107], a[0:3]
  v_mfma_f32_16x16x32_bf16 v[132:135], a[72:75], a[104:107], v[132:135]
  v_mfma_f32_16x16x32_bf16 a[4:7], a[76:79], a[104:107], a[4:7]
  v_mfma_f32_16x16x32_bf16 v[136:139], a[80:83], a[104:107], v[136:139]
  v_mfma_f32_16x16x32_bf16 a[8:11], a[84:87], a[104:107], a[8:11]
  v_mfma_f32_16x16x32_bf16 v[140:143], a[88:91], a[104:107], v[140:143]
  v_mfma_f32_16x16x32_bf16 a[12:15], a[92:95], a[104:107], a[12:15]
  s_waitcnt lgkmcnt(0)
  v_mfma_f32_16x16x32_bf16 v[144:147], a[64:67], a[108:111], v[144:147]
  v_mfma_f32_16x16x32_bf16 a[16:19], a[68:71], a[108:111], a[16:19]
  v_mfma_f32_16x16x32_bf16 v[148:151], a[72:75], a[108:111], v[148:151]
  v_mfma_f32_16x16x32_bf16 a[20:23], a[76:79], a[108:111], a[20:23]
  v_mfma_f32_16x16x32_bf16 v[152:155], a[80:83], a[108:111], v[152:155]
  v_mfma_f32_16x16x32_bf16 a[24:27], a[84:87], a[108:111], a[24:27]
  v_mfma_f32_16x16x32_bf16 v[156:159], a[88:91], a[108:111], v[156:159]
  v_mfma_f32_16x16x32_bf16 a[28:31], a[92:95], a[108:111], a[28:31]
  s_waitcnt vmcnt(26)
  s_barrier
  s_add_u32 m0, s58, 16384
  s_mov_b32 s59, 2359296
  buffer_load_dwordx4 v17, s[12:15], s59 offen offset:0 lds
  buffer_load_dwordx4 v18, s[12:15], s59 offen offset:1024 lds
  buffer_load_dwordx4 v19, s[12:15], s59 offen offset:2048 lds
  buffer_load_dwordx4 v20, s[12:15], s59 offen offset:3072 lds
  s_add_u32 m0, s58, 147456
  s_mov_b32 s59, 1835008
  buffer_load_dwordx4 v17, s[12:15], s59 offen offset:0 lds
  buffer_load_dwordx4 v18, s[12:15], s59 offen offset:1024 lds
  buffer_load_dwordx4 v19, s[12:15], s59 offen offset:2048 lds
  buffer_load_dwordx4 v20, s[12:15], s59 offen offset:3072 lds
  s_nop 3
  v_cvt_pk_bf16_f32 v32, v32, v33
  v_cvt_pk_bf16_f32 v33, v34, v35
  v_cvt_pk_bf16_f32 v34, v160, v161
  v_cvt_pk_bf16_f32 v35, v162, v163
  s_mov_b32 s59, 4096
  buffer_load_dwordx4 a[140:143], v30, s[16:19], s59 offen offset:3072 sc1
  v_cvt_pk_bf16_f32 v36, v36, v37
  v_cvt_pk_bf16_f32 v37, v38, v39
  v_cvt_pk_bf16_f32 v38, v164, v165
  v_cvt_pk_bf16_f32 v39, v166, v167
  v_cvt_pk_bf16_f32 v40, v40, v41
  v_cvt_pk_bf16_f32 v41, v42, v43
  v_cvt_pk_bf16_f32 v42, v168, v169
  v_cvt_pk_bf16_f32 v43, v170, v171
  s_mov_b32 s59, 4096
  buffer_load_dwordx4 a[196:199], v31, s[16:19], s59 offen offset:3072 sc1
  v_cvt_pk_bf16_f32 v44, v44, v45
  v_cvt_pk_bf16_f32 v45, v46, v47
  v_cvt_pk_bf16_f32 v46, v172, v173
  v_cvt_pk_bf16_f32 v47, v174, v175
  v_cvt_pk_bf16_f32 v48, v48, v49
  v_cvt_pk_bf16_f32 v49, v50, v51
  v_cvt_pk_bf16_f32 v50, v176, v177
  v_cvt_pk_bf16_f32 v51, v178, v179
  s_mov_b32 s59, 8192
  buffer_load_dwordx4 a[144:147], v30, s[16:19], s59 offen offset:0 sc1
  v_cvt_pk_bf16_f32 v52, v52, v53
  v_cvt_pk_bf16_f32 v53, v54, v55
  v_cvt_pk_bf16_f32 v54, v180, v181
  v_cvt_pk_bf16_f32 v55, v182, v183
  v_cvt_pk_bf16_f32 v56, v56, v57
  v_cvt_pk_bf16_f32 v57, v58, v59
  v_cvt_pk_bf16_f32 v58, v184, v185
  v_cvt_pk_bf16_f32 v59, v186, v187
  s_mov_b32 s59, 8192
  buffer_load_dwordx4 a[200:203], v31, s[16:19], s59 offen offset:0 sc1
  v_cvt_pk_bf16_f32 v60, v60, v61
  v_cvt_pk_bf16_f32 v61, v62, v63
  v_cvt_pk_bf16_f32 v62, v188, v189
  v_cvt_pk_bf16_f32 v63, v190, v191
  v_cvt_pk_bf16_f32 v64, v64, v65
  v_cvt_pk_bf16_f32 v65, v66, v67
  v_cvt_pk_bf16_f32 v66, v192, v193
  v_cvt_pk_bf16_f32 v67, v194, v195
  s_mov_b32 s59, 8192
  buffer_load_dwordx4 a[148:151], v30, s[16:19], s59 offen offset:1024 sc1
  v_cvt_pk_bf16_f32 v68, v68, v69
  v_cvt_pk_bf16_f32 v69, v70, v71
  v_cvt_pk_bf16_f32 v70, v196, v197
  v_cvt_pk_bf16_f32 v71, v198, v199
  v_cvt_pk_bf16_f32 v72, v72, v73
  v_cvt_pk_bf16_f32 v73, v74, v75
  v_cvt_pk_bf16_f32 v74, v200, v201
  v_cvt_pk_bf16_f32 v75, v202, v203
  s_mov_b32 s59, 8192
  buffer_load_dwordx4 a[204:207], v31, s[16:19], s59 offen offset:1024 sc1
  v_cvt_pk_bf16_f32 v76, v76, v77
  v_cvt_pk_bf16_f32 v77, v78, v79
  v_cvt_pk_bf16_f32 v78, v204, v205
  v_cvt_pk_bf16_f32 v79, v206, v207
  v_cvt_pk_bf16_f32 v80, v80, v81
  v_cvt_pk_bf16_f32 v81, v82, v83
  v_cvt_pk_bf16_f32 v82, v208, v209
  v_cvt_pk_bf16_f32 v83, v210, v211
  s_mov_b32 s59, 8192
  buffer_load_dwordx4 a[152:155], v30, s[16:19], s59 offen offset:2048 sc1
  v_cvt_pk_bf16_f32 v84, v84, v85
  v_cvt_pk_bf16_f32 v85, v86, v87
  v_cvt_pk_bf16_f32 v86, v212, v213
  v_cvt_pk_bf16_f32 v87, v214, v215
  v_cvt_pk_bf16_f32 v88, v88, v89
  v_cvt_pk_bf16_f32 v89, v90, v91
  v_cvt_pk_bf16_f32 v90, v216, v217
  v_cvt_pk_bf16_f32 v91, v218, v219
  s_mov_b32 s59, 8192
  buffer_load_dwordx4 a[208:211], v31, s[16:19], s59 offen offset:2048 sc1
  v_cvt_pk_bf16_f32 v92, v92, v93
  v_cvt_pk_bf16_f32 v93, v94, v95
  v_cvt_pk_bf16_f32 v94, v220, v221
  v_cvt_pk_bf16_f32 v95, v222, v223
  v_cvt_pk_bf16_f32 v96, v96, v97
  v_cvt_pk_bf16_f32 v97, v98, v99
  v_cvt_pk_bf16_f32 v98, v224, v225
  v_cvt_pk_bf16_f32 v99, v226, v227
  s_mov_b32 s59, 8192
  buffer_load_dwordx4 a[156:159], v30, s[16:19], s59 offen offset:3072 sc1
  v_cvt_pk_bf16_f32 v100, v100, v101
  v_cvt_pk_bf16_f32 v101, v102, v103
  v_cvt_pk_bf16_f32 v102, v228, v229
  v_cvt_pk_bf16_f32 v103, v230, v231
  v_cvt_pk_bf16_f32 v104, v104, v105
  v_cvt_pk_bf16_f32 v105, v106, v107
  v_cvt_pk_bf16_f32 v106, v232, v233
  v_cvt_pk_bf16_f32 v107, v234, v235
  s_mov_b32 s59, 8192
  buffer_load_dwordx4 a[212:215], v31, s[16:19], s59 offen offset:3072 sc1
  v_cvt_pk_bf16_f32 v108, v108, v109
  v_cvt_pk_bf16_f32 v109, v110, v111
  v_cvt_pk_bf16_f32 v110, v236, v237
  v_cvt_pk_bf16_f32 v111, v238, v239
  v_cvt_pk_bf16_f32 v112, v112, v113
  v_cvt_pk_bf16_f32 v113, v114, v115
  v_cvt_pk_bf16_f32 v114, v240, v241
  v_cvt_pk_bf16_f32 v115, v242, v243
  s_mov_b32 s59, 12288
  buffer_load_dwordx4 a[160:163], v30, s[16:19], s59 offen offset:0 sc1
  v_cvt_pk_bf16_f32 v116, v116, v117
  v_cvt_pk_bf16_f32 v117, v118, v119
  v_cvt_pk_bf16_f32 v118, v244, v245
  v_cvt_pk_bf16_f32 v119, v246, v247
  v_cvt_pk_bf16_f32 v120, v120, v121
  v_cvt_pk_bf16_f32 v121, v122, v123
  v_cvt_pk_bf16_f32 v122, v248, v249
  v_cvt_pk_bf16_f32 v123, v250, v251
  s_mov_b32 s59, 12288
  buffer_load_dwordx4 a[216:219], v31, s[16:19], s59 offen offset:0 sc1
  v_cvt_pk_bf16_f32 v124, v124, v125
  v_cvt_pk_bf16_f32 v125, v126, v127
  v_cvt_pk_bf16_f32 v126, v252, v253
  v_cvt_pk_bf16_f32 v127, v254, v255
  v_accvgpr_read_b32 v24, a0
  v_accvgpr_read_b32 v25, a1
  v_accvgpr_read_b32 v26, a2
  v_accvgpr_read_b32 v27, a3
  v_cvt_pk_bf16_f32 v128, v128, v129
  v_cvt_pk_bf16_f32 v129, v130, v131
  v_cvt_pk_bf16_f32 v130, v24, v25
  v_cvt_pk_bf16_f32 v131, v26, v27
  s_mov_b32 s59, 12288
  buffer_load_dwordx4 a[164:167], v30, s[16:19], s59 offen offset:1024 sc1
  v_accvgpr_read_b32 v24, a4
  v_accvgpr_read_b32 v25, a5
  v_accvgpr_read_b32 v26, a6
  v_accvgpr_read_b32 v27, a7
  v_cvt_pk_bf16_f32 v132, v132, v133
  v_cvt_pk_bf16_f32 v133, v134, v135
  v_cvt_pk_bf16_f32 v134, v24, v25
  v_cvt_pk_bf16_f32 v135, v26, v27
  v_accvgpr_read_b32 v24, a8
  v_accvgpr_read_b32 v25, a9
  v_accvgpr_read_b32 v26, a10
  v_accvgpr_read_b32 v27, a11
  v_cvt_pk_bf16_f32 v136, v136, v137
  v_cvt_pk_bf16_f32 v137, v138, v139
  v_cvt_pk_bf16_f32 v138, v24, v25
  v_cvt_pk_bf16_f32 v139, v26, v27
  s_mov_b32 s59, 12288
  buffer_load_dwordx4 a[220:223], v31, s[16:19], s59 offen offset:1024 sc1
  v_accvgpr_read_b32 v24, a12
  v_accvgpr_read_b32 v25, a13
  v_accvgpr_read_b32 v26, a14
  v_accvgpr_read_b32 v27, a15
  v_cvt_pk_bf16_f32 v140, v140, v141
  v_cvt_pk_bf16_f32 v141, v142, v143
  v_cvt_pk_bf16_f32 v142, v24, v25
  v_cvt_pk_bf16_f32 v143, v26, v27
  v_accvgpr_read_b32 v24, a16
  v_accvgpr_read_b32 v25, a17
  v_accvgpr_read_b32 v26, a18
  v_accvgpr_read_b32 v27, a19
  v_cvt_pk_bf16_f32 v144, v144, v145
  v_cvt_pk_bf16_f32 v145, v146, v147
  v_cvt_pk_bf16_f32 v146, v24, v25
  v_cvt_pk_bf16_f32 v147, v26, v27
  v_accvgpr_read_b32 v24, a20
  v_accvgpr_read_b32 v25, a21
  v_accvgpr_read_b32 v26, a22
  v_accvgpr_read_b32 v27, a23
  v_cvt_pk_bf16_f32 v148, v148, v149
  v_cvt_pk_bf16_f32 v149, v150, v151
  v_cvt_pk_bf16_f32 v150, v24, v25
  v_cvt_pk_bf16_f32 v151, v26, v27
  v_accvgpr_read_b32 v24, a24
  v_accvgpr_read_b32 v25, a25
  v_accvgpr_read_b32 v26, a26
  v_accvgpr_read_b32 v27, a27
  v_cvt_pk_bf16_f32 v152, v152, v153
  v_cvt_pk_bf16_f32 v153, v154, v155
  v_cvt_pk_bf16_f32 v154, v24, v25
  v_cvt_pk_bf16_f32 v155, v26, v27
  v_accvgpr_read_b32 v24, a28
  v_accvgpr_read_b32 v25, a29
  v_accvgpr_read_b32 v26, a30
  v_accvgpr_read_b32 v27, a31
  v_cvt_pk_bf16_f32 v156, v156, v157
  v_cvt_pk_bf16_f32 v157, v158, v159
  v_cvt_pk_bf16_f32 v158, v24, v25
  v_cvt_pk_bf16_f32 v159, v26, v27
  s_lshl_b32 s67, s30, 8
  s_add_u32 s67, s67, 98304
  v_subrev_u32 v5, s67, v5
  v_subrev_u32 v6, s67, v6
  v_subrev_u32 v7, s67, v7
  v_subrev_u32 v8, s67, v8
  v_subrev_u32 v9, s67, v9
  v_subrev_u32 v10, s67, v10
  v_subrev_u32 v11, s67, v11
  v_subrev_u32 v12, s67, v12
  s_waitcnt vmcnt(29)
  s_barrier
  ds_read_b64_tr_b16 a[32:33], v5 offset:32768
  ds_read_b64_tr_b16 a[34:35], v5 offset:34816
  ds_read_b64_tr_b16 a[36:37], v6 offset:32768
  ds_read_b64_tr_b16 a[38:39], v6 offset:34816
  ds_read_b64_tr_b16 a[40:41], v7 offset:32768
  ds_read_b64_tr_b16 a[42:43], v7 offset:34816
  ds_read_b64_tr_b16 a[44:45], v8 offset:32768
  ds_read_b64_tr_b16 a[46:47], v8 offset:34816
  ds_read_b64_tr_b16 a[48:49], v9 offset:32768
  ds_read_b64_tr_b16 a[50:51], v9 offset:34816
  ds_read_b64_tr_b16 a[52:53], v10 offset:32768
  ds_read_b64_tr_b16 a[54:55], v10 offset:34816
  s_waitcnt lgkmcnt(10)
  v_mfma_f32_16x16x32_bf16 v[160:163], a[32:35], a[112:115], 0
  ds_read_b64_tr_b16 a[56:57], v11 offset:32768
  v_mfma_f32_16x16x32_bf16 v[164:167], a[32:35], a[168:171], 0
  ds_read_b64_tr_b16 a[58:59], v11 offset:34816
  s_waitcnt lgkmcnt(10)
  v_mfma_f32_16x16x32_bf16 v[168:171], a[36:39], a[112:115], 0
  ds_read_b64_tr_b16 a[60:61], v12 offset:32768
  v_mfma_f32_16x16x32_bf16 v[172:175], a[36:39], a[168:171], 0
  ds_read_b64_tr_b16 a[62:63], v12 offset:34816
  buffer_store_dwordx4 v[32:35], v21, s[20:23], s52 offen offset:0 sc1
  s_waitcnt lgkmcnt(10)
  v_mfma_f32_16x16x32_bf16 v[176:179], a[40:43], a[112:115], 0
  ds_read_b64_tr_b16 a[32:33], v5 offset:33024
  v_mfma_f32_16x16x32_bf16 v[180:183], a[40:43], a[168:171], 0
  ds_read_b64_tr_b16 a[34:35], v5 offset:35072
  s_waitcnt lgkmcnt(10)
  v_mfma_f32_16x16x32_bf16 v[184:187], a[44:47], a[112:115], 0
  ds_read_b64_tr_b16 a[36:37], v6 offset:33024
  v_mfma_f32_16x16x32_bf16 v[188:191], a[44:47], a[168:171], 0
  ds_read_b64_tr_b16 a[38:39], v6 offset:35072
  s_waitcnt lgkmcnt(10)
  v_mfma_f32_16x16x32_bf16 v[192:195], a[48:51], a[112:115], 0
  ds_read_b64_tr_b16 a[40:41], v7 offset:33024
  v_mfma_f32_16x16x32_bf16 v[196:199], a[48:51], a[168:171], 0
  ds_read_b64_tr_b16 a[42:43], v7 offset:35072
  s_waitcnt lgkmcnt(10)
  v_mfma_f32_16x16x32_bf16 v[200:203], a[52:55], a[112:115], 0
  ds_read_b64_tr_b16 a[44:45], v8 offset:33024
  v_mfma_f32_16x16x32_bf16 v[204:207], a[52:55], a[168:171], 0
  ds_read_b64_tr_b16 a[46:47], v8 offset:35072
  buffer_store_dwordx4 v[36:39], v21, s[20:23], s53 offen offset:0 sc1
  s_waitcnt lgkmcnt(10)
  v_mfma_f32_16x16x32_bf16 v[208:211], a[56:59], a[112:115], 0
  ds_read_b64_tr_b16 a[48:49], v9 offset:33024
  v_mfma_f32_16x16x32_bf16 v[212:215], a[56:59], a[168:171], 0
  ds_read_b64_tr_b16 a[50:51], v9 offset:35072
  s_waitcnt lgkmcnt(10)
  v_mfma_f32_16x16x32_bf16 v[216:219], a[60:63], a[112:115], 0
  ds_read_b64_tr_b16 a[52:53], v10 offset:33024
  v_mfma_f32_16x16x32_bf16 v[220:223], a[60:63], a[168:171], 0
  ds_read_b64_tr_b16 a[54:55], v10 offset:35072
  s_waitcnt lgkmcnt(10)
  v_mfma_f32_16x16x32_bf16 v[224:227], a[32:35], a[112:115], 0
  ds_read_b64_tr_b16 a[56:57], v11 offset:33024
  v_mfma_f32_16x16x32_bf16 v[228:231], a[32:35], a[168:171], 0
  ds_read_b64_tr_b16 a[58:59], v11 offset:35072
  s_waitcnt lgkmcnt(10)
  v_mfma_f32_16x16x32_bf16 v[232:235], a[36:39], a[112:115], 0
  ds_read_b64_tr_b16 a[60:61], v12 offset:33024
  v_mfma_f32_16x16x32_bf16 v[236:239], a[36:39], a[168:171], 0
  ds_read_b64_tr_b16 a[62:63], v12 offset:35072
  buffer_store_dwordx4 v[40:43], v21, s[20:23], s54 offen offset:0 sc1
  s_waitcnt lgkmcnt(10)
  v_mfma_f32_16x16x32_bf16 v[240:243], a[40:43], a[112:115], 0
  ds_read_b64_tr_b16 a[32:33], v5 offset:49152
  v_mfma_f32_16x16x32_bf16 v[244:247], a[40:43], a[168:171], 0
  ds_read_b64_tr_b16 a[34:35], v5 offset:51200
  s_waitcnt lgkmcnt(10)
  v_mfma_f32_16x16x32_bf16 v[248:251], a[44:47], a[112:115], 0
  ds_read_b64_tr_b16 a[36:37], v6 offset:49152
  v_mfma_f32_16x16x32_bf16 v[252:255], a[44:47], a[168:171], 0
  ds_read_b64_tr_b16 a[38:39], v6 offset:51200
  s_waitcnt lgkmcnt(10)
  v_mfma_f32_16x16x32_bf16 a[0:3], a[48:51], a[112:115], 0
  ds_read_b64_tr_b16 a[40:41], v7 offset:49152
  v_mfma_f32_16x16x32_bf16 a[4:7], a[48:51], a[168:171], 0
  ds_read_b64_tr_b16 a[42:43], v7 offset:51200
  s_waitcnt lgkmcnt(10)
  v_mfma_f32_16x16x32_bf16 a[8:11], a[52:55], a[112:115], 0
  ds_read_b64_tr_b16 a[44:45], v8 offset:49152
  v_mfma_f32_16x16x32_bf16 a[12:15], a[52:55], a[168:171], 0
  ds_read_b64_tr_b16 a[46:47], v8 offset:51200
  buffer_store_dwordx4 v[44:47], v21, s[20:23], s55 offen offset:0 sc1
  s_waitcnt lgkmcnt(10)
  v_mfma_f32_16x16x32_bf16 a[16:19], a[56:59], a[112:115], 0
  ds_read_b64_tr_b16 a[48:49], v9 offset:49152
  v_mfma_f32_16x16x32_bf16 a[20:23], a[56:59], a[168:171], 0
  ds_read_b64_tr_b16 a[50:51], v9 offset:51200
  s_waitcnt lgkmcnt(10)
  v_mfma_f32_16x16x32_bf16 a[24:27], a[60:63], a[112:115], 0
  ds_read_b64_tr_b16 a[52:53], v10 offset:49152
  v_mfma_f32_16x16x32_bf16 a[28:31], a[60:63], a[168:171], 0
  ds_read_b64_tr_b16 a[54:55], v10 offset:51200
  s_waitcnt lgkmcnt(10)
  v_mfma_f32_16x16x32_bf16 v[160:163], a[32:35], a[116:119], v[160:163]
  ds_read_b64_tr_b16 a[56:57], v11 offset:49152
  v_mfma_f32_16x16x32_bf16 v[164:167], a[32:35], a[172:175], v[164:167]
  ds_read_b64_tr_b16 a[58:59], v11 offset:51200
  s_waitcnt lgkmcnt(10)
  v_mfma_f32_16x16x32_bf16 v[168:171], a[36:39], a[116:119], v[168:171]
  ds_read_b64_tr_b16 a[60:61], v12 offset:49152
  v_mfma_f32_16x16x32_bf16 v[172:175], a[36:39], a[172:175], v[172:175]
  ds_read_b64_tr_b16 a[62:63], v12 offset:51200
  buffer_store_dwordx4 v[48:51], v21, s[20:23], s52 offen offset:1024 sc1
  s_waitcnt lgkmcnt(10)
  v_mfma_f32_16x16x32_bf16 v[176:179], a[40:43], a[116:119], v[176:179]
  ds_read_b64_tr_b16 a[32:33], v5 offset:49408
  v_mfma_f32_16x16x32_bf16 v[180:183], a[40:43], a[172:175], v[180:183]
  ds_read_b64_tr_b16 a[34:35], v5 offset:51456
  s_waitcnt lgkmcnt(10)
  v_mfma_f32_16x16x32_bf16 v[184:187], a[44:47], a[116:119], v[184:187]
  ds_read_b64_tr_b16 a[36:37], v6 offset:49408
  v_mfma_f32_16x16x32_bf16 v[188:191], a[44:47], a[172:175], v[188:191]
  ds_read_b64_tr_b16 a[38:39], v6 offset:51456
  s_waitcnt lgkmcnt(10)
  v_mfma_f32_16x16x32_bf16 v[192:195], a[48:51], a[116:119], v[192:195]
  ds_read_b64_tr_b16 a[40:41], v7 offset:49408
  v_mfma_f32_16x16x32_bf16 v[196:199], a[48:51], a[172:175], v[196:199]
  ds_read_b64_tr_b16 a[42:43], v7 offset:51456
  s_waitcnt lgkmcnt(10)
  v_mfma_f32_16x16x32_bf16 v[200:203], a[52:55], a[116:119], v[200:203]
  ds_read_b64_tr_b16 a[44:45], v8 offset:49408
  v_mfma_f32_16x16x32_bf16 v[204:207], a[52:55], a[172:175], v[204:207]
  ds_read_b64_tr_b16 a[46:47], v8 offset:51456
  buffer_store_dwordx4 v[52:55], v21, s[20:23], s53 offen offset:1024 sc1
  s_waitcnt lgkmcnt(10)
  v_mfma_f32_16x16x32_bf16 v[208:211], a[56:59], a[116:119], v[208:211]
  ds_read_b64_tr_b16 a[48:49], v9 offset:49408
  v_mfma_f32_16x16x32_bf16 v[212:215], a[56:59], a[172:175], v[212:215]
  ds_read_b64_tr_b16 a[50:51], v9 offset:51456
  s_waitcnt lgkmcnt(10)
  v_mfma_f32_16x16x32_bf16 v[216:219], a[60:63], a[116:119], v[216:219]
  ds_read_b64_tr_b16 a[52:53], v10 offset:49408
  v_mfma_f32_16x16x32_bf16 v[220:223], a[60:63], a[172:175], v[220:223]
  ds_read_b64_tr_b16 a[54:55], v10 offset:51456
  s_waitcnt lgkmcnt(10)
  v_mfma_f32_16x16x32_bf16 v[224:227], a[32:35], a[116:119], v[224:227]
  ds_read_b64_tr_b16 a[56:57], v11 offset:49408
  v_mfma_f32_16x16x32_bf16 v[228:231], a[32:35], a[172:175], v[228:231]
  ds_read_b64_tr_b16 a[58:59], v11 offset:51456
  s_waitcnt lgkmcnt(10)
  v_mfma_f32_16x16x32_bf16 v[232:235], a[36:39], a[116:119], v[232:235]
  ds_read_b64_tr_b16 a[60:61], v12 offset:49408
  v_mfma_f32_16x16x32_bf16 v[236:239], a[36:39], a[172:175], v[236:239]
  ds_read_b64_tr_b16 a[62:63], v12 offset:51456
  buffer_store_dwordx4 v[56:59], v21, s[20:23], s54 offen offset:1024 sc1
  s_waitcnt lgkmcnt(10)
  v_mfma_f32_16x16x32_bf16 v[240:243], a[40:43], a[116:119], v[240:243]
  v_add_u32 v5, 0x10000, v5
  ds_read_b64_tr_b16 a[32:33], v5 offset:0
  v_mfma_f32_16x16x32_bf16 v[244:247], a[40:43], a[172:175], v[244:247]
  ds_read_b64_tr_b16 a[34:35], v5 offset:2048
  s_waitcnt lgkmcnt(10)
  v_mfma_f32_16x16x32_bf16 v[248:251], a[44:47], a[116:119], v[248:251]
  v_add_u32 v6, 0x10000, v6
  ds_read_b64_tr_b16 a[36:37], v6 offset:0
  v_mfma_f32_16x16x32_bf16 v[252:255], a[44:47], a[172:175], v[252:255]
  ds_read_b64_tr_b16 a[38:39], v6 offset:2048
  s_waitcnt lgkmcnt(10)
  v_mfma_f32_16x16x32_bf16 a[0:3], a[48:51], a[116:119], a[0:3]
  v_add_u32 v7, 0x10000, v7
  ds_read_b64_tr_b16 a[40:41], v7 offset:0
  v_mfma_f32_16x16x32_bf16 a[4:7], a[48:51], a[172:175], a[4:7]
  ds_read_b64_tr_b16 a[42:43], v7 offset:2048
  s_waitcnt lgkmcnt(10)
  v_mfma_f32_16x16x32_bf16 a[8:11], a[52:55], a[116:119], a[8:11]
  v_add_u32 v8, 0x10000, v8
  ds_read_b64_tr_b16 a[44:45], v8 offset:0
  v_mfma_f32_16x16x32_bf16 a[12:15], a[52:55], a[172:175], a[12:15]
  ds_read_b64_tr_b16 a[46:47], v8 offset:2048
  buffer_store_dwordx4 v[60:63], v21, s[20:23], s55 offen offset:1024 sc1
  s_waitcnt lgkmcnt(10)
  v_mfma_f32_16x16x32_bf16 a[16:19], a[56:59], a[116:119], a[16:19]
  v_add_u32 v9, 0x10000, v9
  ds_read_b64_tr_b16 a[48:49], v9 offset:0
  v_mfma_f32_16x16x32_bf16 a[20:23], a[56:59], a[172:175], a[20:23]
  ds_read_b64_tr_b16 a[50:51], v9 offset:2048
  s_waitcnt lgkmcnt(10)
  v_mfma_f32_16x16x32_bf16 a[24:27], a[60:63], a[116:119], a[24:27]
  v_add_u32 v10, 0x10000, v10
  ds_read_b64_tr_b16 a[52:53], v10 offset:0
  v_mfma_f32_16x16x32_bf16 a[28:31], a[60:63], a[172:175], a[28:31]
  ds_read_b64_tr_b16 a[54:55], v10 offset:2048
  v_add_u32 v11, 0x10000, v11
  v_add_u32 v12, 0x10000, v12
  s_waitcnt lgkmcnt(10)
  v_mfma_f32_16x16x32_bf16 v[160:163], a[32:35], a[120:123], v[160:163]
  ds_read_b64_tr_b16 a[56:57], v11 offset:0
  v_mfma_f32_16x16x32_bf16 v[164:167], a[32:35], a[176:179], v[164:167]
  ds_read_b64_tr_b16 a[58:59], v11 offset:2048
  s_waitcnt lgkmcnt(10)
  v_mfma_f32_16x16x32_bf16 v[168:171], a[36:39], a[120:123], v[168:171]
  ds_read_b64_tr_b16 a[60:61], v12 offset:0
  v_mfma_f32_16x16x32_bf16 v[172:175], a[36:39], a[176:179], v[172:175]
  ds_read_b64_tr_b16 a[62:63], v12 offset:2048
  buffer_store_dwordx4 v[64:67], v21, s[20:23], s52 offen offset:2048 sc1
  s_waitcnt lgkmcnt(10)
  v_mfma_f32_16x16x32_bf16 v[176:179], a[40:43], a[120:123], v[176:179]
  ds_read_b64_tr_b16 a[32:33], v5 offset:256
  v_mfma_f32_16x16x32_bf16 v[180:183], a[40:43], a[176:179], v[180:183]
  ds_read_b64_tr_b16 a[34:35], v5 offset:2304
  s_waitcnt lgkmcnt(10)
  v_mfma_f32_16x16x32_bf16 v[184:187], a[44:47], a[120:123], v[184:187]
  ds_read_b64_tr_b16 a[36:37], v6 offset:256
  v_mfma_f32_16x16x32_bf16 v[188:191], a[44:47], a[176:179], v[188:191]
  ds_read_b64_tr_b16 a[38:39], v6 offset:2304
  s_waitcnt lgkmcnt(10)
  v_mfma_f32_16x16x32_bf16 v[192:195], a[48:51], a[120:123], v[192:195]
  ds_read_b64_tr_b16 a[40:41], v7 offset:256
  v_mfma_f32_16x16x32_bf16 v[196:199], a[48:51], a[176:179], v[196:199]
  ds_read_b64_tr_b16 a[42:43], v7 offset:2304
  s_waitcnt lgkmcnt(10)
  v_mfma_f32_16x16x32_bf16 v[200:203], a[52:55], a[120:123], v[200:203]
  ds_read_b64_tr_b16 a[44:45], v8 offset:256
  v_mfma_f32_16x16x32_bf16 v[204:207], a[52:55], a[176:179], v[204:207]
  ds_read_b64_tr_b16 a[46:47], v8 offset:2304
  buffer_store_dwordx4 v[68:71], v21, s[20:23], s53 offen offset:2048 sc1
  s_waitcnt lgkmcnt(10)
  v_mfma_f32_16x16x32_bf16 v[208:211], a[56:59], a[120:123], v[208:211]
  ds_read_b64_tr_b16 a[48:49], v9 offset:256
  v_mfma_f32_16x16x32_bf16 v[212:215], a[56:59], a[176:179], v[212:215]
  ds_read_b64_tr_b16 a[50:51], v9 offset:2304
  s_waitcnt lgkmcnt(10)
  v_mfma_f32_16x16x32_bf16 v[216:219], a[60:63], a[120:123], v[216:219]
  ds_read_b64_tr_b16 a[52:53], v10 offset:256
  v_mfma_f32_16x16x32_bf16 v[220:223], a[60:63], a[176:179], v[220:223]
  ds_read_b64_tr_b16 a[54:55], v10 offset:2304
  s_waitcnt lgkmcnt(10)
  v_mfma_f32_16x16x32_bf16 v[224:227], a[32:35], a[120:123], v[224:227]
  ds_read_b64_tr_b16 a[56:57], v11 offset:256
  v_mfma_f32_16x16x32_bf16 v[228:231], a[32:35], a[176:179], v[228:231]
  ds_read_b64_tr_b16 a[58:59], v11 offset:2304
  s_waitcnt lgkmcnt(10)
  v_mfma_f32_16x16x32_bf16 v[232:235], a[36:39], a[120:123], v[232:235]
  ds_read_b64_tr_b16 a[60:61], v12 offset:256
  v_mfma_f32_16x16x32_bf16 v[236:239], a[36:39], a[176:179], v[236:239]
  ds_read_b64_tr_b16 a[62:63], v12 offset:2304
  buffer_store_dwordx4 v[72:75], v21, s[20:23], s54 offen offset:2048 sc1
  s_waitcnt lgkmcnt(10)
  v_mfma_f32_16x16x32_bf16 v[240:243], a[40:43], a[120:123], v[240:243]
  ds_read_b64_tr_b16 a[32:33], v5 offset:16384
  v_mfma_f32_16x16x32_bf16 v[244:247], a[40:43], a[176:179], v[244:247]
  ds_read_b64_tr_b16 a[34:35], v5 offset:18432
  s_waitcnt lgkmcnt(10)
  v_mfma_f32_16x16x32_bf16 v[248:251], a[44:47], a[120:123], v[248:251]
  ds_read_b64_tr_b16 a[36:37], v6 offset:16384
  v_mfma_f32_16x16x32_bf16 v[252:255], a[44:47], a[176:179], v[252:255]
  ds_read_b64_tr_b16 a[38:39], v6 offset:18432
  s_waitcnt lgkmcnt(10)
  v_mfma_f32_16x16x32_bf16 a[0:3], a[48:51], a[120:123], a[0:3]
  ds_read_b64_tr_b16 a[40:41], v7 offset:16384
  v_mfma_f32_16x16x32_bf16 a[4:7], a[48:51], a[176:179], a[4:7]
  ds_read_b64_tr_b16 a[42:43], v7 offset:18432
  s_waitcnt lgkmcnt(10)
  v_mfma_f32_16x16x32_bf16 a[8:11], a[52:55], a[120:123], a[8:11]
  ds_read_b64_tr_b16 a[44:45], v8 offset:16384
  v_mfma_f32_16x16x32_bf16 a[12:15], a[52:55], a[176:179], a[12:15]
  ds_read_b64_tr_b16 a[46:47], v8 offset:18432
  buffer_store_dwordx4 v[76:79], v21, s[20:23], s55 offen offset:2048 sc1
  s_waitcnt lgkmcnt(10)
  v_mfma_f32_16x16x32_bf16 a[16:19], a[56:59], a[120:123], a[16:19]
  ds_read_b64_tr_b16 a[48:49], v9 offset:16384
  v_mfma_f32_16x16x32_bf16 a[20:23], a[56:59], a[176:179], a[20:23]
  ds_read_b64_tr_b16 a[50:51], v9 offset:18432
  s_waitcnt lgkmcnt(10)
  v_mfma_f32_16x16x32_bf16 a[24:27], a[60:63], a[120:123], a[24:27]
  ds_read_b64_tr_b16 a[52:53], v10 offset:16384
  v_mfma_f32_16x16x32_bf16 a[28:31], a[60:63], a[176:179], a[28:31]
  ds_read_b64_tr_b16 a[54:55], v10 offset:18432
  s_waitcnt lgkmcnt(10)
  v_mfma_f32_16x16x32_bf16 v[160:163], a[32:35], a[124:127], v[160:163]
  ds_read_b64_tr_b16 a[56:57], v11 offset:16384
  v_mfma_f32_16x16x32_bf16 v[164:167], a[32:35], a[180:183], v[164:167]
  ds_read_b64_tr_b16 a[58:59], v11 offset:18432
  s_waitcnt lgkmcnt(10)
  v_mfma_f32_16x16x32_bf16 v[168:171], a[36:39], a[124:127], v[168:171]
  ds_read_b64_tr_b16 a[60:61], v12 offset:16384
  v_mfma_f32_16x16x32_bf16 v[172:175], a[36:39], a[180:183], v[172:175]
  ds_read_b64_tr_b16 a[62:63], v12 offset:18432
  buffer_store_dwordx4 v[80:83], v21, s[20:23], s52 offen offset:3072 sc1
  s_waitcnt lgkmcnt(10)
  v_mfma_f32_16x16x32_bf16 v[176:179], a[40:43], a[124:127], v[176:179]
  ds_read_b64_tr_b16 a[32:33], v5 offset:16640
  v_mfma_f32_16x16x32_bf16 v[180:183], a[40:43], a[180:183], v[180:183]
  ds_read_b64_tr_b16 a[34:35], v5 offset:18688
  s_waitcnt lgkmcnt(10)
  v_mfma_f32_16x16x32_bf16 v[184:187], a[44:47], a[124:127], v[184:187]
  ds_read_b64_tr_b16 a[36:37], v6 offset:16640
  v_mfma_f32_16x16x32_bf16 v[188:191], a[44:47], a[180:183], v[188:191]
  ds_read_b64_tr_b16 a[38:39], v6 offset:18688
  s_waitcnt lgkmcnt(10)
  v_mfma_f32_16x16x32_bf16 v[192:195], a[48:51], a[124:127], v[192:195]
  ds_read_b64_tr_b16 a[40:41], v7 offset:16640
  v_mfma_f32_16x16x32_bf16 v[196:199], a[48:51], a[180:183], v[196:199]
  ds_read_b64_tr_b16 a[42:43], v7 offset:18688
  s_waitcnt lgkmcnt(10)
  v_mfma_f32_16x16x32_bf16 v[200:203], a[52:55], a[124:127], v[200:203]
  ds_read_b64_tr_b16 a[44:45], v8 offset:16640
  v_mfma_f32_16x16x32_bf16 v[204:207], a[52:55], a[180:183], v[204:207]
  ds_read_b64_tr_b16 a[46:47], v8 offset:18688
  buffer_store_dwordx4 v[84:87], v21, s[20:23], s53 offen offset:3072 sc1
  s_waitcnt lgkmcnt(10)
  v_mfma_f32_16x16x32_bf16 v[208:211], a[56:59], a[124:127], v[208:211]
  ds_read_b64_tr_b16 a[48:49], v9 offset:16640
  v_mfma_f32_16x16x32_bf16 v[212:215], a[56:59], a[180:183], v[212:215]
  ds_read_b64_tr_b16 a[50:51], v9 offset:18688
  s_waitcnt lgkmcnt(10)
  v_mfma_f32_16x16x32_bf16 v[216:219], a[60:63], a[124:127], v[216:219]
  ds_read_b64_tr_b16 a[52:53], v10 offset:16640
  v_mfma_f32_16x16x32_bf16 v[220:223], a[60:63], a[180:183], v[220:223]
  ds_read_b64_tr_b16 a[54:55], v10 offset:18688
  s_waitcnt lgkmcnt(10)
  v_mfma_f32_16x16x32_bf16 v[224:227], a[32:35], a[124:127], v[224:227]
  ds_read_b64_tr_b16 a[56:57], v11 offset:16640
  v_mfma_f32_16x16x32_bf16 v[228:231], a[32:35], a[180:183], v[228:231]
  ds_read_b64_tr_b16 a[58:59], v11 offset:18688
  s_waitcnt lgkmcnt(10)
  v_mfma_f32_16x16x32_bf16 v[232:235], a[36:39], a[124:127], v[232:235]
  ds_read_b64_tr_b16 a[60:61], v12 offset:16640
  v_mfma_f32_16x16x32_bf16 v[236:239], a[36:39], a[180:183], v[236:239]
  ds_read_b64_tr_b16 a[62:63], v12 offset:18688
  buffer_store_dwordx4 v[88:91], v21, s[20:23], s54 offen offset:3072 sc1
  s_waitcnt lgkmcnt(10)
  v_mfma_f32_16x16x32_bf16 v[240:243], a[40:43], a[124:127], v[240:243]
  ds_read_b64_tr_b16 a[32:33], v5 offset:32768
  v_mfma_f32_16x16x32_bf16 v[244:247], a[40:43], a[180:183], v[244:247]
  ds_read_b64_tr_b16 a[34:35], v5 offset:34816
  s_waitcnt lgkmcnt(10)
  v_mfma_f32_16x16x32_bf16 v[248:251], a[44:47], a[124:127], v[248:251]
  ds_read_b64_tr_b16 a[36:37], v6 offset:32768
  v_mfma_f32_16x16x32_bf16 v[252:255], a[44:47], a[180:183], v[252:255]
  ds_read_b64_tr_b16 a[38:39], v6 offset:34816
  s_waitcnt lgkmcnt(10)
  v_mfma_f32_16x16x32_bf16 a[0:3], a[48:51], a[124:127], a[0:3]
  ds_read_b64_tr_b16 a[40:41], v7 offset:32768
  v_mfma_f32_16x16x32_bf16 a[4:7], a[48:51], a[180:183], a[4:7]
  ds_read_b64_tr_b16 a[42:43], v7 offset:34816
  s_waitcnt lgkmcnt(10)
  v_mfma_f32_16x16x32_bf16 a[8:11], a[52:55], a[124:127], a[8:11]
  ds_read_b64_tr_b16 a[44:45], v8 offset:32768
  v_mfma_f32_16x16x32_bf16 a[12:15], a[52:55], a[180:183], a[12:15]
  ds_read_b64_tr_b16 a[46:47], v8 offset:34816
  buffer_store_dwordx4 v[92:95], v21, s[20:23], s55 offen offset:3072 sc1
  s_waitcnt lgkmcnt(10)
  v_mfma_f32_16x16x32_bf16 a[16:19], a[56:59], a[124:127], a[16:19]
  ds_read_b64_tr_b16 a[48:49], v9 offset:32768
  v_mfma_f32_16x16x32_bf16 a[20:23], a[56:59], a[180:183], a[20:23]
  ds_read_b64_tr_b16 a[50:51], v9 offset:34816
  s_waitcnt lgkmcnt(10)
  v_mfma_f32_16x16x32_bf16 a[24:27], a[60:63], a[124:127], a[24:27]
  ds_read_b64_tr_b16 a[52:53], v10 offset:32768
  v_mfma_f32_16x16x32_bf16 a[28:31], a[60:63], a[180:183], a[28:31]
  ds_read_b64_tr_b16 a[54:55], v10 offset:34816
  s_waitcnt vmcnt(30)
  s_barrier
  s_waitcnt lgkmcnt(10)
  v_mfma_f32_16x16x32_bf16 v[160:163], a[32:35], a[128:131], v[160:163]
  ds_read_b64_tr_b16 a[56:57], v11 offset:32768
  v_mfma_f32_16x16x32_bf16 v[164:167], a[32:35], a[184:187], v[164:167]
  ds_read_b64_tr_b16 a[58:59], v11 offset:34816
  s_add_u32 m0, s58, 32768
  s_waitcnt lgkmcnt(10)
  v_mfma_f32_16x16x32_bf16 v[168:171], a[36:39], a[128:131], v[168:171]
  ds_read_b64_tr_b16 a[60:61], v12 offset:32768
  s_mov_b32 s59, 2621440
  v_mfma_f32_16x16x32_bf16 v[172:175], a[36:39], a[184:187], v[172:175]
  ds_read_b64_tr_b16 a[62:63], v12 offset:34816
  buffer_load_dwordx4 v17, s[12:15], s59 offen offset:0 lds
  s_waitcnt lgkmcnt(10)
  v_mfma_f32_16x16x32_bf16 v[176:179], a[40:43], a[128:131], v[176:179]
  ds_read_b64_tr_b16 a[32:33], v5 offset:33024
  buffer_load_dwordx4 v18, s[12:15], s59 offen offset:1024 lds
  v_mfma_f32_16x16x32_bf16 v[180:183], a[40:43], a[184:187], v[180:183]
  ds_read_b64_tr_b16 a[34:35], v5 offset:35072
  buffer_load_dwordx4 v19, s[12:15], s59 offen offset:2048 lds
  s_waitcnt lgkmcnt(10)
  v_mfma_f32_16x16x32_bf16 v[184:187], a[44:47], a[128:131], v[184:187]
  ds_read_b64_tr_b16 a[36:37], v6 offset:33024
  buffer_load_dwordx4 v20, s[12:15], s59 offen offset:3072 lds
  v_mfma_f32_16x16x32_bf16 v[188:191], a[44:47], a[184:187], v[188:191]
  ds_read_b64_tr_b16 a[38:39], v6 offset:35072
  s_add_u32 m0, s58, 49152
  s_waitcnt lgkmcnt(10)
  v_mfma_f32_16x16x32_bf16 v[192:195], a[48:51], a[128:131], v[192:195]
  ds_read_b64_tr_b16 a[40:41], v7 offset:33024
  s_mov_b32 s59, 2883584
  v_mfma_f32_16x16x32_bf16 v[196:199], a[48:51], a[184:187], v[196:199]
  ds_read_b64_tr_b16 a[42:43], v7 offset:35072
  buffer_load_dwordx4 v17, s[12:15], s59 offen offset:0 lds
  s_waitcnt lgkmcnt(10)
  v_mfma_f32_16x16x32_bf16 v[200:203], a[52:55], a[128:131], v[200:203]
  ds_read_b64_tr_b16 a[44:45], v8 offset:33024
  buffer_load_dwordx4 v18, s[12:15], s59 offen offset:1024 lds
  v_mfma_f32_16x16x32_bf16 v[204:207], a[52:55], a[184:187], v[204:207]
  ds_read_b64_tr_b16 a[46:47], v8 offset:35072
  buffer_load_dwordx4 v19, s[12:15], s59 offen offset:2048 lds
  s_waitcnt lgkmcnt(10)
  v_mfma_f32_16x16x32_bf16 v[208:211], a[56:59], a[128:131], v[208:211]
  ds_read_b64_tr_b16 a[48:49], v9 offset:33024
  buffer_load_dwordx4 v20, s[12:15], s59 offen offset:3072 lds
  v_mfma_f32_16x16x32_bf16 v[212:215], a[56:59], a[184:187], v[212:215]
  ds_read_b64_tr_b16 a[50:51], v9 offset:35072
  s_add_u32 m0, s58, 65536
  s_waitcnt lgkmcnt(10)
  v_mfma_f32_16x16x32_bf16 v[216:219], a[60:63], a[128:131], v[216:219]
  ds_read_b64_tr_b16 a[52:53], v10 offset:33024
  s_mov_b32 s59, 3145728
  v_mfma_f32_16x16x32_bf16 v[220:223], a[60:63], a[184:187], v[220:223]
  ds_read_b64_tr_b16 a[54:55], v10 offset:35072
  buffer_load_dwordx4 v17, s[12:15], s59 offen offset:0 lds
  s_waitcnt lgkmcnt(10)
  v_mfma_f32_16x16x32_bf16 v[224:227], a[32:35], a[128:131], v[224:227]
  ds_read_b64_tr_b16 a[56:57], v11 offset:33024
  buffer_load_dwordx4 v18, s[12:15], s59 offen offset:1024 lds
  v_mfma_f32_16x16x32_bf16 v[228:231], a[32:35], a[184:187], v[228:231]
  ds_read_b64_tr_b16 a[58:59], v11 offset:35072
  buffer_load_dwordx4 v19, s[12:15], s59 offen offset:2048 lds
  s_waitcnt lgkmcnt(10)
  v_mfma_f32_16x16x32_bf16 v[232:235], a[36:39], a[128:131], v[232:235]
  ds_read_b64_tr_b16 a[60:61], v12 offset:33024
  buffer_load_dwordx4 v20, s[12:15], s59 offen offset:3072 lds
  v_mfma_f32_16x16x32_bf16 v[236:239], a[36:39], a[184:187], v[236:239]
  ds_read_b64_tr_b16 a[62:63], v12 offset:35072
  s_add_u32 m0, s58, 81920
  s_waitcnt lgkmcnt(10)
  v_mfma_f32_16x16x32_bf16 v[240:243], a[40:43], a[128:131], v[240:243]
  ds_read_b64_tr_b16 a[32:33], v5 offset:49152
  s_mov_b32 s59, 3407872
  v_mfma_f32_16x16x32_bf16 v[244:247], a[40:43], a[184:187], v[244:247]
  ds_read_b64_tr_b16 a[34:35], v5 offset:51200
  buffer_load_dwordx4 v17, s[12:15], s59 offen offset:0 lds
  s_waitcnt lgkmcnt(10)
  v_mfma_f32_16x16x32_bf16 v[248:251], a[44:47], a[128:131], v[248:251]
  ds_read_b64_tr_b16 a[36:37], v6 offset:49152
  buffer_load_dwordx4 v18, s[12:15], s59 offen offset:1024 lds
  v_mfma_f32_16x16x32_bf16 v[252:255], a[44:47], a[184:187], v[252:255]
  ds_read_b64_tr_b16 a[38:39], v6 offset:51200
  buffer_load_dwordx4 v19, s[12:15], s59 offen offset:2048 lds
  s_waitcnt lgkmcnt(10)
  v_mfma_f32_16x16x32_bf16 a[0:3], a[48:51], a[128:131], a[0:3]
  ds_read_b64_tr_b16 a[40:41], v7 offset:49152
  buffer_load_dwordx4 v20, s[12:15], s59 offen offset:3072 lds
  v_mfma_f32_16x16x32_bf16 a[4:7], a[48:51], a[184:187], a[4:7]
  ds_read_b64_tr_b16 a[42:43], v7 offset:51200
  s_waitcnt lgkmcnt(10)
  v_mfma_f32_16x16x32_bf16 a[8:11], a[52:55], a[128:131], a[8:11]
  ds_read_b64_tr_b16 a[44:45], v8 offset:49152
  v_mfma_f32_16x16x32_bf16 a[12:15], a[52:55], a[184:187], a[12:15]
  ds_read_b64_tr_b16 a[46:47], v8 offset:51200
  s_waitcnt lgkmcnt(10)
  v_mfma_f32_16x16x32_bf16 a[16:19], a[56:59], a[128:131], a[16:19]
  ds_read_b64_tr_b16 a[48:49], v9 offset:49152
  v_mfma_f32_16x16x32_bf16 a[20:23], a[56:59], a[184:187], a[20:23]
  ds_read_b64_tr_b16 a[50:51], v9 offset:51200
  s_waitcnt lgkmcnt(10)
  v_mfma_f32_16x16x32_bf16 a[24:27], a[60:63], a[128:131], a[24:27]
  ds_read_b64_tr_b16 a[52:53], v10 offset:49152
  v_mfma_f32_16x16x32_bf16 a[28:31], a[60:63], a[184:187], a[28:31]
  ds_read_b64_tr_b16 a[54:55], v10 offset:51200
  s_waitcnt lgkmcnt(10)
  v_mfma_f32_16x16x32_bf16 v[160:163], a[32:35], a[132:135], v[160:163]
  ds_read_b64_tr_b16 a[56:57], v11 offset:49152
  v_mfma_f32_16x16x32_bf16 v[164:167], a[32:35], a[188:191], v[164:167]
  ds_read_b64_tr_b16 a[58:59], v11 offset:51200
  s_waitcnt lgkmcnt(10)
  v_mfma_f32_16x16x32_bf16 v[168:171], a[36:39], a[132:135], v[168:171]
  ds_read_b64_tr_b16 a[60:61], v12 offset:49152
  v_mfma_f32_16x16x32_bf16 v[172:175], a[36:39], a[188:191], v[172:175]
  ds_read_b64_tr_b16 a[62:63], v12 offset:51200
  buffer_store_dwordx4 v[96:99], v22, s[20:23], s52 offen offset:0 sc1
  s_waitcnt lgkmcnt(10)
  v_mfma_f32_16x16x32_bf16 v[176:179], a[40:43], a[132:135], v[176:179]
  ds_read_b64_tr_b16 a[32:33], v5 offset:49408
  v_mfma_f32_16x16x32_bf16 v[180:183], a[40:43], a[188:191], v[180:183]
  ds_read_b64_tr_b16 a[34:35], v5 offset:51456
  s_waitcnt lgkmcnt(10)
  v_mfma_f32_16x16x32_bf16 v[184:187], a[44:47], a[132:135], v[184:187]
  ds_read_b64_tr_b16 a[36:37], v6 offset:49408
  v_mfma_f32_16x16x32_bf16 v[188:191], a[44:47], a[188:191], v[188:191]
  ds_read_b64_tr_b16 a[38:39], v6 offset:51456
  s_waitcnt lgkmcnt(10)
  v_mfma_f32_16x16x32_bf16 v[192:195], a[48:51], a[132:135], v[192:195]
  ds_read_b64_tr_b16 a[40:41], v7 offset:49408
  v_mfma_f32_16x16x32_bf16 v[196:199], a[48:51], a[188:191], v[196:199]
  ds_read_b64_tr_b16 a[42:43], v7 offset:51456
  s_waitcnt lgkmcnt(10)
  v_mfma_f32_16x16x32_bf16 v[200:203], a[52:55], a[132:135], v[200:203]
  ds_read_b64_tr_b16 a[44:45], v8 offset:49408
  v_mfma_f32_16x16x32_bf16 v[204:207], a[52:55], a[188:191], v[204:207]
  ds_read_b64_tr_b16 a[46:47], v8 offset:51456
  buffer_store_dwordx4 v[100:103], v22, s[20:23], s53 offen offset:0 sc1
  s_waitcnt lgkmcnt(10)
  v_mfma_f32_16x16x32_bf16 v[208:211], a[56:59], a[132:135], v[208:211]
  ds_read_b64_tr_b16 a[48:49], v9 offset:49408
  v_mfma_f32_16x16x32_bf16 v[212:215], a[56:59], a[188:191], v[212:215]
  ds_read_b64_tr_b16 a[50:51], v9 offset:51456
  s_waitcnt lgkmcnt(10)
  v_mfma_f32_16x16x32_bf16 v[216:219], a[60:63], a[132:135], v[216:219]
  ds_read_b64_tr_b16 a[52:53], v10 offset:49408
  v_mfma_f32_16x16x32_bf16 v[220:223], a[60:63], a[188:191], v[220:223]
  ds_read_b64_tr_b16 a[54:55], v10 offset:51456
  s_waitcnt lgkmcnt(10)
  v_mfma_f32_16x16x32_bf16 v[224:227], a[32:35], a[132:135], v[224:227]
  ds_read_b64_tr_b16 a[56:57], v11 offset:49408
  v_mfma_f32_16x16x32_bf16 v[228:231], a[32:35], a[188:191], v[228:231]
  ds_read_b64_tr_b16 a[58:59], v11 offset:51456
  s_waitcnt lgkmcnt(10)
  v_mfma_f32_16x16x32_bf16 v[232:235], a[36:39], a[132:135], v[232:235]
  ds_read_b64_tr_b16 a[60:61], v12 offset:49408
  v_mfma_f32_16x16x32_bf16 v[236:239], a[36:39], a[188:191], v[236:239]
  ds_read_b64_tr_b16 a[62:63], v12 offset:51456
  buffer_store_dwordx4 v[104:107], v22, s[20:23], s54 offen offset:0 sc1
  s_waitcnt lgkmcnt(10)
  v_mfma_f32_16x16x32_bf16 v[240:243], a[40:43], a[132:135], v[240:243]
  v_add_u32 v5, 0x10000, v5
  ds_read_b64_tr_b16 a[32:33], v5 offset:0
  v_mfma_f32_16x16x32_bf16 v[244:247], a[40:43], a[188:191], v[244:247]
  ds_read_b64_tr_b16 a[34:35], v5 offset:2048
  s_waitcnt lgkmcnt(10)
  v_mfma_f32_16x16x32_bf16 v[248:251], a[44:47], a[132:135], v[248:251]
  v_add_u32 v6, 0x10000, v6
  ds_read_b64_tr_b16 a[36:37], v6 offset:0
  v_mfma_f32_16x16x32_bf16 v[252:255], a[44:47], a[188:191], v[252:255]
  ds_read_b64_tr_b16 a[38:39], v6 offset:2048
  s_waitcnt lgkmcnt(10)
  v_mfma_f32_16x16x32_bf16 a[0:3], a[48:51], a[132:135], a[0:3]
  v_add_u32 v7, 0x10000, v7
  ds_read_b64_tr_b16 a[40:41], v7 offset:0
  v_mfma_f32_16x16x32_bf16 a[4:7], a[48:51], a[188:191], a[4:7]
  ds_read_b64_tr_b16 a[42:43], v7 offset:2048
  s_waitcnt lgkmcnt(10)
  v_mfma_f32_16x16x32_bf16 a[8:11], a[52:55], a[132:135], a[8:11]
  v_add_u32 v8, 0x10000, v8
  ds_read_b64_tr_b16 a[44:45], v8 offset:0
  v_mfma_f32_16x16x32_bf16 a[12:15], a[52:55], a[188:191], a[12:15]
  ds_read_b64_tr_b16 a[46:47], v8 offset:2048
  buffer_store_dwordx4 v[108:111], v22, s[20:23], s55 offen offset:0 sc1
  s_waitcnt lgkmcnt(10)
  v_mfma_f32_16x16x32_bf16 a[16:19], a[56:59], a[132:135], a[16:19]
  v_add_u32 v9, 0x10000, v9
  ds_read_b64_tr_b16 a[48:49], v9 offset:0
  v_mfma_f32_16x16x32_bf16 a[20:23], a[56:59], a[188:191], a[20:23]
  ds_read_b64_tr_b16 a[50:51], v9 offset:2048
  s_waitcnt lgkmcnt(10)
  v_mfma_f32_16x16x32_bf16 a[24:27], a[60:63], a[132:135], a[24:27]
  v_add_u32 v10, 0x10000, v10
  ds_read_b64_tr_b16 a[52:53], v10 offset:0
  v_mfma_f32_16x16x32_bf16 a[28:31], a[60:63], a[188:191], a[28:31]
  ds_read_b64_tr_b16 a[54:55], v10 offset:2048
  v_add_u32 v11, 0x10000, v11
  v_add_u32 v12, 0x10000, v12
  s_waitcnt lgkmcnt(10)
  v_mfma_f32_16x16x32_bf16 v[160:163], a[32:35], a[136:139], v[160:163]
  ds_read_b64_tr_b16 a[56:57], v11 offset:0
  v_mfma_f32_16x16x32_bf16 v[164:167], a[32:35], a[192:195], v[164:167]
  ds_read_b64_tr_b16 a[58:59], v11 offset:2048
  s_waitcnt lgkmcnt(10)
  v_mfma_f32_16x16x32_bf16 v[168:171], a[36:39], a[136:139], v[168:171]
  ds_read_b64_tr_b16 a[60:61], v12 offset:0
  v_mfma_f32_16x16x32_bf16 v[172:175], a[36:39], a[192:195], v[172:175]
  ds_read_b64_tr_b16 a[62:63], v12 offset:2048
  buffer_store_dwordx4 v[112:115], v22, s[20:23], s52 offen offset:1024 sc1
  s_waitcnt lgkmcnt(10)
  v_mfma_f32_16x16x32_bf16 v[176:179], a[40:43], a[136:139], v[176:179]
  ds_read_b64_tr_b16 a[32:33], v5 offset:256
  v_mfma_f32_16x16x32_bf16 v[180:183], a[40:43], a[192:195], v[180:183]
  ds_read_b64_tr_b16 a[34:35], v5 offset:2304
  s_waitcnt lgkmcnt(10)
  v_mfma_f32_16x16x32_bf16 v[184:187], a[44:47], a[136:139], v[184:187]
  ds_read_b64_tr_b16 a[36:37], v6 offset:256
  v_mfma_f32_16x16x32_bf16 v[188:191], a[44:47], a[192:195], v[188:191]
  ds_read_b64_tr_b16 a[38:39], v6 offset:2304
  s_waitcnt lgkmcnt(10)
  v_mfma_f32_16x16x32_bf16 v[192:195], a[48:51], a[136:139], v[192:195]
  ds_read_b64_tr_b16 a[40:41], v7 offset:256
  v_mfma_f32_16x16x32_bf16 v[196:199], a[48:51], a[192:195], v[196:199]
  ds_read_b64_tr_b16 a[42:43], v7 offset:2304
  s_waitcnt lgkmcnt(10)
  v_mfma_f32_16x16x32_bf16 v[200:203], a[52:55], a[136:139], v[200:203]
  ds_read_b64_tr_b16 a[44:45], v8 offset:256
  v_mfma_f32_16x16x32_bf16 v[204:207], a[52:55], a[192:195], v[204:207]
  ds_read_b64_tr_b16 a[46:47], v8 offset:2304
  buffer_store_dwordx4 v[116:119], v22, s[20:23], s53 offen offset:1024 sc1
  s_waitcnt lgkmcnt(10)
  v_mfma_f32_16x16x32_bf16 v[208:211], a[56:59], a[136:139], v[208:211]
  ds_read_b64_tr_b16 a[48:49], v9 offset:256
  v_mfma_f32_16x16x32_bf16 v[212:215], a[56:59], a[192:195], v[212:215]
  ds_read_b64_tr_b16 a[50:51], v9 offset:2304
  s_waitcnt lgkmcnt(10)
  v_mfma_f32_16x16x32_bf16 v[216:219], a[60:63], a[136:139], v[216:219]
  ds_read_b64_tr_b16 a[52:53], v10 offset:256
  v_mfma_f32_16x16x32_bf16 v[220:223], a[60:63], a[192:195], v[220:223]
  ds_read_b64_tr_b16 a[54:55], v10 offset:2304
  s_waitcnt lgkmcnt(10)
  v_mfma_f32_16x16x32_bf16 v[224:227], a[32:35], a[136:139], v[224:227]
  ds_read_b64_tr_b16 a[56:57], v11 offset:256
  v_mfma_f32_16x16x32_bf16 v[228:231], a[32:35], a[192:195], v[228:231]
  ds_read_b64_tr_b16 a[58:59], v11 offset:2304
  s_waitcnt lgkmcnt(10)
  v_mfma_f32_16x16x32_bf16 v[232:235], a[36:39], a[136:139], v[232:235]
  ds_read_b64_tr_b16 a[60:61], v12 offset:256
  v_mfma_f32_16x16x32_bf16 v[236:239], a[36:39], a[192:195], v[236:239]
  ds_read_b64_tr_b16 a[62:63], v12 offset:2304
  buffer_store_dwordx4 v[120:123], v22, s[20:23], s54 offen offset:1024 sc1
  s_waitcnt lgkmcnt(10)
  v_mfma_f32_16x16x32_bf16 v[240:243], a[40:43], a[136:139], v[240:243]
  ds_read_b64_tr_b16 a[32:33], v5 offset:16384
  v_mfma_f32_16x16x32_bf16 v[244:247], a[40:43], a[192:195], v[244:247]
  ds_read_b64_tr_b16 a[34:35], v5 offset:18432
  s_waitcnt lgkmcnt(10)
  v_mfma_f32_16x16x32_bf16 v[248:251], a[44:47], a[136:139], v[248:251]
  ds_read_b64_tr_b16 a[36:37], v6 offset:16384
  v_mfma_f32_16x16x32_bf16 v[252:255], a[44:47], a[192:195], v[252:255]
  ds_read_b64_tr_b16 a[38:39], v6 offset:18432
  s_waitcnt lgkmcnt(10)
  v_mfma_f32_16x16x32_bf16 a[0:3], a[48:51], a[136:139], a[0:3]
  ds_read_b64_tr_b16 a[40:41], v7 offset:16384
  v_mfma_f32_16x16x32_bf16 a[4:7], a[48:51], a[192:195], a[4:7]
  ds_read_b64_tr_b16 a[42:43], v7 offset:18432
  s_waitcnt lgkmcnt(10)
  v_mfma_f32_16x16x32_bf16 a[8:11], a[52:55], a[136:139], a[8:11]
  ds_read_b64_tr_b16 a[44:45], v8 offset:16384
  v_mfma_f32_16x16x32_bf16 a[12:15], a[52:55], a[192:195], a[12:15]
  ds_read_b64_tr_b16 a[46:47], v8 offset:18432
  buffer_store_dwordx4 v[124:127], v22, s[20:23], s55 offen offset:1024 sc1
  s_waitcnt lgkmcnt(10)
  v_mfma_f32_16x16x32_bf16 a[16:19], a[56:59], a[136:139], a[16:19]
  ds_read_b64_tr_b16 a[48:49], v9 offset:16384
  v_mfma_f32_16x16x32_bf16 a[20:23], a[56:59], a[192:195], a[20:23]
  ds_read_b64_tr_b16 a[50:51], v9 offset:18432
  s_waitcnt lgkmcnt(10)
  v_mfma_f32_16x16x32_bf16 a[24:27], a[60:63], a[136:139], a[24:27]
  ds_read_b64_tr_b16 a[52:53], v10 offset:16384
  v_mfma_f32_16x16x32_bf16 a[28:31], a[60:63], a[192:195], a[28:31]
  ds_read_b64_tr_b16 a[54:55], v10 offset:18432
  s_waitcnt vmcnt(52)
  s_waitcnt lgkmcnt(10)
  v_mfma_f32_16x16x32_bf16 v[160:163], a[32:35], a[140:143], v[160:163]
  ds_read_b64_tr_b16 a[56:57], v11 offset:16384
  v_mfma_f32_16x16x32_bf16 v[164:167], a[32:35], a[196:199], v[164:167]
  ds_read_b64_tr_b16 a[58:59], v11 offset:18432
  s_waitcnt lgkmcnt(10)
  v_mfma_f32_16x16x32_bf16 v[168:171], a[36:39], a[140:143], v[168:171]
  ds_read_b64_tr_b16 a[60:61], v12 offset:16384
  v_mfma_f32_16x16x32_bf16 v[172:175], a[36:39], a[196:199], v[172:175]
  ds_read_b64_tr_b16 a[62:63], v12 offset:18432
  buffer_store_dwordx4 v[128:131], v22, s[20:23], s52 offen offset:2048 sc1
  s_waitcnt lgkmcnt(10)
  v_mfma_f32_16x16x32_bf16 v[176:179], a[40:43], a[140:143], v[176:179]
  ds_read_b64_tr_b16 a[32:33], v5 offset:16640
  v_mfma_f32_16x16x32_bf16 v[180:183], a[40:43], a[196:199], v[180:183]
  ds_read_b64_tr_b16 a[34:35], v5 offset:18688
  s_waitcnt lgkmcnt(10)
  v_mfma_f32_16x16x32_bf16 v[184:187], a[44:47], a[140:143], v[184:187]
  ds_read_b64_tr_b16 a[36:37], v6 offset:16640
  v_mfma_f32_16x16x32_bf16 v[188:191], a[44:47], a[196:199], v[188:191]
  ds_read_b64_tr_b16 a[38:39], v6 offset:18688
  s_waitcnt lgkmcnt(10)
  v_mfma_f32_16x16x32_bf16 v[192:195], a[48:51], a[140:143], v[192:195]
  ds_read_b64_tr_b16 a[40:41], v7 offset:16640
  v_mfma_f32_16x16x32_bf16 v[196:199], a[48:51], a[196:199], v[196:199]
  ds_read_b64_tr_b16 a[42:43], v7 offset:18688
  s_waitcnt lgkmcnt(10)
  v_mfma_f32_16x16x32_bf16 v[200:203], a[52:55], a[140:143], v[200:203]
  ds_read_b64_tr_b16 a[44:45], v8 offset:16640
  v_mfma_f32_16x16x32_bf16 v[204:207], a[52:55], a[196:199], v[204:207]
  ds_read_b64_tr_b16 a[46:47], v8 offset:18688
  buffer_store_dwordx4 v[132:135], v22, s[20:23], s53 offen offset:2048 sc1
  s_waitcnt lgkmcnt(10)
  v_mfma_f32_16x16x32_bf16 v[208:211], a[56:59], a[140:143], v[208:211]
  ds_read_b64_tr_b16 a[48:49], v9 offset:16640
  v_mfma_f32_16x16x32_bf16 v[212:215], a[56:59], a[196:199], v[212:215]
  ds_read_b64_tr_b16 a[50:51], v9 offset:18688
  s_waitcnt lgkmcnt(10)
  v_mfma_f32_16x16x32_bf16 v[216:219], a[60:63], a[140:143], v[216:219]
  ds_read_b64_tr_b16 a[52:53], v10 offset:16640
  v_mfma_f32_16x16x32_bf16 v[220:223], a[60:63], a[196:199], v[220:223]
  ds_read_b64_tr_b16 a[54:55], v10 offset:18688
  s_waitcnt lgkmcnt(10)
  v_mfma_f32_16x16x32_bf16 v[224:227], a[32:35], a[140:143], v[224:227]
  ds_read_b64_tr_b16 a[56:57], v11 offset:16640
  v_mfma_f32_16x16x32_bf16 v[228:231], a[32:35], a[196:199], v[228:231]
  ds_read_b64_tr_b16 a[58:59], v11 offset:18688
  s_waitcnt lgkmcnt(10)
  v_mfma_f32_16x16x32_bf16 v[232:235], a[36:39], a[140:143], v[232:235]
  ds_read_b64_tr_b16 a[60:61], v12 offset:16640
  v_mfma_f32_16x16x32_bf16 v[236:239], a[36:39], a[196:199], v[236:239]
  ds_read_b64_tr_b16 a[62:63], v12 offset:18688
  buffer_store_dwordx4 v[136:139], v22, s[20:23], s54 offen offset:2048 sc1
  s_waitcnt lgkmcnt(10)
  v_mfma_f32_16x16x32_bf16 v[240:243], a[40:43], a[140:143], v[240:243]
  v_add_u32 v5, 0xfffe0000, v5
  ds_read_b64_tr_b16 a[32:33], v5 offset:0
  v_mfma_f32_16x16x32_bf16 v[244:247], a[40:43], a[196:199], v[244:247]
  ds_read_b64_tr_b16 a[34:35], v5 offset:2048
  s_waitcnt lgkmcnt(10)
  v_mfma_f32_16x16x32_bf16 v[248:251], a[44:47], a[140:143], v[248:251]
  v_add_u32 v6, 0xfffe0000, v6
  ds_read_b64_tr_b16 a[36:37], v6 offset:0
  v_mfma_f32_16x16x32_bf16 v[252:255], a[44:47], a[196:199], v[252:255]
  ds_read_b64_tr_b16 a[38:39], v6 offset:2048
  s_waitcnt lgkmcnt(10)
  v_mfma_f32_16x16x32_bf16 a[0:3], a[48:51], a[140:143], a[0:3]
  v_add_u32 v7, 0xfffe0000, v7
  ds_read_b64_tr_b16 a[40:41], v7 offset:0
  v_mfma_f32_16x16x32_bf16 a[4:7], a[48:51], a[196:199], a[4:7]
  ds_read_b64_tr_b16 a[42:43], v7 offset:2048
  s_waitcnt lgkmcnt(10)
  v_mfma_f32_16x16x32_bf16 a[8:11], a[52:55], a[140:143], a[8:11]
  v_add_u32 v8, 0xfffe0000, v8
  ds_read_b64_tr_b16 a[44:45], v8 offset:0
  v_mfma_f32_16x16x32_bf16 a[12:15], a[52:55], a[196:199], a[12:15]
  ds_read_b64_tr_b16 a[46:47], v8 offset:2048
  buffer_store_dwordx4 v[140:143], v22, s[20:23], s55 offen offset:2048 sc1
  s_waitcnt lgkmcnt(10)
  v_mfma_f32_16x16x32_bf16 a[16:19], a[56:59], a[140:143], a[16:19]
  v_add_u32 v9, 0xfffe0000, v9
  ds_read_b64_tr_b16 a[48:49], v9 offset:0
  v_mfma_f32_16x16x32_bf16 a[20:23], a[56:59], a[196:199], a[20:23]
  ds_read_b64_tr_b16 a[50:51], v9 offset:2048
  s_waitcnt lgkmcnt(10)
  v_mfma_f32_16x16x32_bf16 a[24:27], a[60:63], a[140:143], a[24:27]
  v_add_u32 v10, 0xfffe0000, v10
  ds_read_b64_tr_b16 a[52:53], v10 offset:0
  v_mfma_f32_16x16x32_bf16 a[28:31], a[60:63], a[196:199], a[28:31]
  ds_read_b64_tr_b16 a[54:55], v10 offset:2048
  s_waitcnt vmcnt(54)
  v_add_u32 v11, 0xfffe0000, v11
  v_add_u32 v12, 0xfffe0000, v12
  s_waitcnt lgkmcnt(10)
  v_mfma_f32_16x16x32_bf16 v[160:163], a[32:35], a[144:147], v[160:163]
  ds_read_b64_tr_b16 a[56:57], v11 offset:0
  v_mfma_f32_16x16x32_bf16 v[164:167], a[32:35], a[200:203], v[164:167]
  ds_read_b64_tr_b16 a[58:59], v11 offset:2048
  s_waitcnt lgkmcnt(10)
  v_mfma_f32_16x16x32_bf16 v[168:171], a[36:39], a[144:147], v[168:171]
  ds_read_b64_tr_b16 a[60:61], v12 offset:0
  v_mfma_f32_16x16x32_bf16 v[172:175], a[36:39], a[200:203], v[172:175]
  ds_read_b64_tr_b16 a[62:63], v12 offset:2048
  buffer_store_dwordx4 v[144:147], v22, s[20:23], s52 offen offset:3072 sc1
  s_waitcnt lgkmcnt(10)
  v_mfma_f32_16x16x32_bf16 v[176:179], a[40:43], a[144:147], v[176:179]
  ds_read_b64_tr_b16 a[32:33], v5 offset:256
  v_mfma_f32_16x16x32_bf16 v[180:183], a[40:43], a[200:203], v[180:183]
  ds_read_b64_tr_b16 a[34:35], v5 offset:2304
  s_waitcnt lgkmcnt(10)
  v_mfma_f32_16x16x32_bf16 v[184:187], a[44:47], a[144:147], v[184:187]
  ds_read_b64_tr_b16 a[36:37], v6 offset:256
  v_mfma_f32_16x16x32_bf16 v[188:191], a[44:47], a[200:203], v[188:191]
  ds_read_b64_tr_b16 a[38:39], v6 offset:2304
  s_waitcnt lgkmcnt(10)
  v_mfma_f32_16x16x32_bf16 v[192:195], a[48:51], a[144:147], v[192:195]
  ds_read_b64_tr_b16 a[40:41], v7 offset:256
  v_mfma_f32_16x16x32_bf16 v[196:199], a[48:51], a[200:203], v[196:199]
  ds_read_b64_tr_b16 a[42:43], v7 offset:2304
  s_waitcnt lgkmcnt(10)
  v_mfma_f32_16x16x32_bf16 v[200:203], a[52:55], a[144:147], v[200:203]
  ds_read_b64_tr_b16 a[44:45], v8 offset:256
  v_mfma_f32_16x16x32_bf16 v[204:207], a[52:55], a[200:203], v[204:207]
  ds_read_b64_tr_b16 a[46:47], v8 offset:2304
  buffer_store_dwordx4 v[148:151], v22, s[20:23], s53 offen offset:3072 sc1
  s_waitcnt lgkmcnt(10)
  v_mfma_f32_16x16x32_bf16 v[208:211], a[56:59], a[144:147], v[208:211]
  ds_read_b64_tr_b16 a[48:49], v9 offset:256
  v_mfma_f32_16x16x32_bf16 v[212:215], a[56:59], a[200:203], v[212:215]
  ds_read_b64_tr_b16 a[50:51], v9 offset:2304
  s_waitcnt lgkmcnt(10)
  v_mfma_f32_16x16x32_bf16 v[216:219], a[60:63], a[144:147], v[216:219]
  ds_read_b64_tr_b16 a[52:53], v10 offset:256
  v_mfma_f32_16x16x32_bf16 v[220:223], a[60:63], a[200:203], v[220:223]
  ds_read_b64_tr_b16 a[54:55], v10 offset:2304
  s_waitcnt lgkmcnt(10)
  v_mfma_f32_16x16x32_bf16 v[224:227], a[32:35], a[144:147], v[224:227]
  ds_read_b64_tr_b16 a[56:57], v11 offset:256
  v_mfma_f32_16x16x32_bf16 v[228:231], a[32:35], a[200:203], v[228:231]
  ds_read_b64_tr_b16 a[58:59], v11 offset:2304
  s_waitcnt lgkmcnt(10)
  v_mfma_f32_16x16x32_bf16 v[232:235], a[36:39], a[144:147], v[232:235]
  ds_read_b64_tr_b16 a[60:61], v12 offset:256
  v_mfma_f32_16x16x32_bf16 v[236:239], a[36:39], a[200:203], v[236:239]
  ds_read_b64_tr_b16 a[62:63], v12 offset:2304
  buffer_store_dwordx4 v[152:155], v22, s[20:23], s54 offen offset:3072 sc1
  s_waitcnt lgkmcnt(10)
  v_mfma_f32_16x16x32_bf16 v[240:243], a[40:43], a[144:147], v[240:243]
  ds_read_b64_tr_b16 a[32:33], v5 offset:16384
  v_mfma_f32_16x16x32_bf16 v[244:247], a[40:43], a[200:203], v[244:247]
  ds_read_b64_tr_b16 a[34:35], v5 offset:18432
  s_waitcnt lgkmcnt(10)
  v_mfma_f32_16x16x32_bf16 v[248:251], a[44:47], a[144:147], v[248:251]
  ds_read_b64_tr_b16 a[36:37], v6 offset:16384
  v_mfma_f32_16x16x32_bf16 v[252:255], a[44:47], a[200:203], v[252:255]
  ds_read_b64_tr_b16 a[38:39], v6 offset:18432
  s_waitcnt lgkmcnt(10)
  v_mfma_f32_16x16x32_bf16 a[0:3], a[48:51], a[144:147], a[0:3]
  ds_read_b64_tr_b16 a[40:41], v7 offset:16384
  v_mfma_f32_16x16x32_bf16 a[4:7], a[48:51], a[200:203], a[4:7]
  ds_read_b64_tr_b16 a[42:43], v7 offset:18432
  s_waitcnt lgkmcnt(10)
  v_mfma_f32_16x16x32_bf16 a[8:11], a[52:55], a[144:147], a[8:11]
  ds_read_b64_tr_b16 a[44:45], v8 offset:16384
  v_mfma_f32_16x16x32_bf16 a[12:15], a[52:55], a[200:203], a[12:15]
  ds_read_b64_tr_b16 a[46:47], v8 offset:18432
  buffer_store_dwordx4 v[156:159], v22, s[20:23], s55 offen offset:3072 sc1
  s_waitcnt lgkmcnt(10)
  v_mfma_f32_16x16x32_bf16 a[16:19], a[56:59], a[144:147], a[16:19]
  ds_read_b64_tr_b16 a[48:49], v9 offset:16384
  v_mfma_f32_16x16x32_bf16 a[20:23], a[56:59], a[200:203], a[20:23]
  ds_read_b64_tr_b16 a[50:51], v9 offset:18432
  s_waitcnt lgkmcnt(10)
  v_mfma_f32_16x16x32_bf16 a[24:27], a[60:63], a[144:147], a[24:27]
  ds_read_b64_tr_b16 a[52:53], v10 offset:16384
  v_mfma_f32_16x16x32_bf16 a[28:31], a[60:63], a[200:203], a[28:31]
  ds_read_b64_tr_b16 a[54:55], v10 offset:18432
  s_waitcnt vmcnt(16)
  s_barrier
  s_waitcnt lgkmcnt(10)
  v_mfma_f32_16x16x32_bf16 v[160:163], a[32:35], a[148:151], v[160:163]
  ds_read_b64_tr_b16 a[56:57], v11 offset:16384
  v_mfma_f32_16x16x32_bf16 v[164:167], a[32:35], a[204:207], v[164:167]
  ds_read_b64_tr_b16 a[58:59], v11 offset:18432
  s_waitcnt lgkmcnt(10)
  v_mfma_f32_16x16x32_bf16 v[168:171], a[36:39], a[148:151], v[168:171]
  ds_read_b64_tr_b16 a[60:61], v12 offset:16384
  v_mfma_f32_16x16x32_bf16 v[172:175], a[36:39], a[204:207], v[172:175]
  ds_read_b64_tr_b16 a[62:63], v12 offset:18432
  s_waitcnt lgkmcnt(10)
  v_mfma_f32_16x16x32_bf16 v[176:179], a[40:43], a[148:151], v[176:179]
  ds_read_b64_tr_b16 a[32:33], v5 offset:16640
  v_mfma_f32_16x16x32_bf16 v[180:183], a[40:43], a[204:207], v[180:183]
  ds_read_b64_tr_b16 a[34:35], v5 offset:18688
  s_waitcnt lgkmcnt(10)
  v_mfma_f32_16x16x32_bf16 v[184:187], a[44:47], a[148:151], v[184:187]
  ds_read_b64_tr_b16 a[36:37], v6 offset:16640
  v_mfma_f32_16x16x32_bf16 v[188:191], a[44:47], a[204:207], v[188:191]
  ds_read_b64_tr_b16 a[38:39], v6 offset:18688
  s_waitcnt lgkmcnt(10)
  v_mfma_f32_16x16x32_bf16 v[192:195], a[48:51], a[148:151], v[192:195]
  ds_read_b64_tr_b16 a[40:41], v7 offset:16640
  v_mfma_f32_16x16x32_bf16 v[196:199], a[48:51], a[204:207], v[196:199]
  ds_read_b64_tr_b16 a[42:43], v7 offset:18688
  s_waitcnt lgkmcnt(10)
  v_mfma_f32_16x16x32_bf16 v[200:203], a[52:55], a[148:151], v[200:203]
  ds_read_b64_tr_b16 a[44:45], v8 offset:16640
  v_mfma_f32_16x16x32_bf16 v[204:207], a[52:55], a[204:207], v[204:207]
  ds_read_b64_tr_b16 a[46:47], v8 offset:18688
  s_waitcnt lgkmcnt(10)
  v_mfma_f32_16x16x32_bf16 v[208:211], a[56:59], a[148:151], v[208:211]
  ds_read_b64_tr_b16 a[48:49], v9 offset:16640
  v_mfma_f32_16x16x32_bf16 v[212:215], a[56:59], a[204:207], v[212:215]
  ds_read_b64_tr_b16 a[50:51], v9 offset:18688
  s_waitcnt lgkmcnt(10)
  v_mfma_f32_16x16x32_bf16 v[216:219], a[60:63], a[148:151], v[216:219]
  ds_read_b64_tr_b16 a[52:53], v10 offset:16640
  v_mfma_f32_16x16x32_bf16 v[220:223], a[60:63], a[204:207], v[220:223]
  ds_read_b64_tr_b16 a[54:55], v10 offset:18688
  s_waitcnt lgkmcnt(10)
  v_mfma_f32_16x16x32_bf16 v[224:227], a[32:35], a[148:151], v[224:227]
  ds_read_b64_tr_b16 a[56:57], v11 offset:16640
  v_mfma_f32_16x16x32_bf16 v[228:231], a[32:35], a[204:207], v[228:231]
  ds_read_b64_tr_b16 a[58:59], v11 offset:18688
  s_waitcnt lgkmcnt(10)
  v_mfma_f32_16x16x32_bf16 v[232:235], a[36:39], a[148:151], v[232:235]
  ds_read_b64_tr_b16 a[60:61], v12 offset:16640
  v_mfma_f32_16x16x32_bf16 v[236:239], a[36:39], a[204:207], v[236:239]
  ds_read_b64_tr_b16 a[62:63], v12 offset:18688
  s_waitcnt lgkmcnt(10)
  v_mfma_f32_16x16x32_bf16 v[240:243], a[40:43], a[148:151], v[240:243]
  ds_read_b64_tr_b16 a[32:33], v5 offset:32768
  v_mfma_f32_16x16x32_bf16 v[244:247], a[40:43], a[204:207], v[244:247]
  ds_read_b64_tr_b16 a[34:35], v5 offset:34816
  s_waitcnt lgkmcnt(10)
  v_mfma_f32_16x16x32_bf16 v[248:251], a[44:47], a[148:151], v[248:251]
  ds_read_b64_tr_b16 a[36:37], v6 offset:32768
  v_mfma_f32_16x16x32_bf16 v[252:255], a[44:47], a[204:207], v[252:255]
  ds_read_b64_tr_b16 a[38:39], v6 offset:34816
  s_waitcnt lgkmcnt(10)
  v_mfma_f32_16x16x32_bf16 a[0:3], a[48:51], a[148:151], a[0:3]
  ds_read_b64_tr_b16 a[40:41], v7 offset:32768
  v_mfma_f32_16x16x32_bf16 a[4:7], a[48:51], a[204:207], a[4:7]
  ds_read_b64_tr_b16 a[42:43], v7 offset:34816
  s_waitcnt lgkmcnt(10)
  v_mfma_f32_16x16x32_bf16 a[8:11], a[52:55], a[148:151], a[8:11]
  ds_read_b64_tr_b16 a[44:45], v8 offset:32768
  v_mfma_f32_16x16x32_bf16 a[12:15], a[52:55], a[204:207], a[12:15]
  ds_read_b64_tr_b16 a[46:47], v8 offset:34816
  s_waitcnt lgkmcnt(10)
  v_mfma_f32_16x16x32_bf16 a[16:19], a[56:59], a[148:151], a[16:19]
  ds_read_b64_tr_b16 a[48:49], v9 offset:32768
  v_mfma_f32_16x16x32_bf16 a[20:23], a[56:59], a[204:207], a[20:23]
  ds_read_b64_tr_b16 a[50:51], v9 offset:34816
  s_waitcnt lgkmcnt(10)
  v_mfma_f32_16x16x32_bf16 a[24:27], a[60:63], a[148:151], a[24:27]
  ds_read_b64_tr_b16 a[52:53], v10 offset:32768
  v_mfma_f32_16x16x32_bf16 a[28:31], a[60:63], a[204:207], a[28:31]
  ds_read_b64_tr_b16 a[54:55], v10 offset:34816
  s_waitcnt lgkmcnt(10)
  v_mfma_f32_16x16x32_bf16 v[160:163], a[32:35], a[152:155], v[160:163]
  ds_read_b64_tr_b16 a[56:57], v11 offset:32768
  v_mfma_f32_16x16x32_bf16 v[164:167], a[32:35], a[208:211], v[164:167]
  ds_read_b64_tr_b16 a[58:59], v11 offset:34816
  s_waitcnt lgkmcnt(10)
  v_mfma_f32_16x16x32_bf16 v[168:171], a[36:39], a[152:155], v[168:171]
  ds_read_b64_tr_b16 a[60:61], v12 offset:32768
  v_mfma_f32_16x16x32_bf16 v[172:175], a[36:39], a[208:211], v[172:175]
  ds_read_b64_tr_b16 a[62:63], v12 offset:34816
  s_waitcnt lgkmcnt(10)
  v_mfma_f32_16x16x32_bf16 v[176:179], a[40:43], a[152:155], v[176:179]
  ds_read_b64_tr_b16 a[32:33], v5 offset:33024
  v_mfma_f32_16x16x32_bf16 v[180:183], a[40:43], a[208:211], v[180:183]
  ds_read_b64_tr_b16 a[34:35], v5 offset:35072
  s_waitcnt lgkmcnt(10)
  v_mfma_f32_16x16x32_bf16 v[184:187], a[44:47], a[152:155], v[184:187]
  ds_read_b64_tr_b16 a[36:37], v6 offset:33024
  v_mfma_f32_16x16x32_bf16 v[188:191], a[44:47], a[208:211], v[188:191]
  ds_read_b64_tr_b16 a[38:39], v6 offset:35072
  s_waitcnt lgkmcnt(10)
  v_mfma_f32_16x16x32_bf16 v[192:195], a[48:51], a[152:155], v[192:195]
  ds_read_b64_tr_b16 a[40:41], v7 offset:33024
  v_mfma_f32_16x16x32_bf16 v[196:199], a[48:51], a[208:211], v[196:199]
  ds_read_b64_tr_b16 a[42:43], v7 offset:35072
  s_waitcnt lgkmcnt(10)
  v_mfma_f32_16x16x32_bf16 v[200:203], a[52:55], a[152:155], v[200:203]
  ds_read_b64_tr_b16 a[44:45], v8 offset:33024
  v_mfma_f32_16x16x32_bf16 v[204:207], a[52:55], a[208:211], v[204:207]
  ds_read_b64_tr_b16 a[46:47], v8 offset:35072
  s_waitcnt lgkmcnt(10)
  v_mfma_f32_16x16x32_bf16 v[208:211], a[56:59], a[152:155], v[208:211]
  ds_read_b64_tr_b16 a[48:49], v9 offset:33024
  v_mfma_f32_16x16x32_bf16 v[212:215], a[56:59], a[208:211], v[212:215]
  ds_read_b64_tr_b16 a[50:51], v9 offset:35072
  s_waitcnt lgkmcnt(10)
  v_mfma_f32_16x16x32_bf16 v[216:219], a[60:63], a[152:155], v[216:219]
  ds_read_b64_tr_b16 a[52:53], v10 offset:33024
  v_mfma_f32_16x16x32_bf16 v[220:223], a[60:63], a[208:211], v[220:223]
  ds_read_b64_tr_b16 a[54:55], v10 offset:35072
  s_waitcnt lgkmcnt(10)
  v_mfma_f32_16x16x32_bf16 v[224:227], a[32:35], a[152:155], v[224:227]
  ds_read_b64_tr_b16 a[56:57], v11 offset:33024
  v_mfma_f32_16x16x32_bf16 v[228:231], a[32:35], a[208:211], v[228:231]
  ds_read_b64_tr_b16 a[58:59], v11 offset:35072
  s_waitcnt lgkmcnt(10)
  v_mfma_f32_16x16x32_bf16 v[232:235], a[36:39], a[152:155], v[232:235]
  ds_read_b64_tr_b16 a[60:61], v12 offset:33024
  v_mfma_f32_16x16x32_bf16 v[236:239], a[36:39], a[208:211], v[236:239]
  ds_read_b64_tr_b16 a[62:63], v12 offset:35072
  s_waitcnt lgkmcnt(10)
  v_mfma_f32_16x16x32_bf16 v[240:243], a[40:43], a[152:155], v[240:243]
  ds_read_b64_tr_b16 a[32:33], v5 offset:49152
  v_mfma_f32_16x16x32_bf16 v[244:247], a[40:43], a[208:211], v[244:247]
  ds_read_b64_tr_b16 a[34:35], v5 offset:51200
  s_waitcnt lgkmcnt(10)
  v_mfma_f32_16x16x32_bf16 v[248:251], a[44:47], a[152:155], v[248:251]
  ds_read_b64_tr_b16 a[36:37], v6 offset:49152
  v_mfma_f32_16x16x32_bf16 v[252:255], a[44:47], a[208:211], v[252:255]
  ds_read_b64_tr_b16 a[38:39], v6 offset:51200
  s_waitcnt lgkmcnt(10)
  v_mfma_f32_16x16x32_bf16 a[0:3], a[48:51], a[152:155], a[0:3]
  ds_read_b64_tr_b16 a[40:41], v7 offset:49152
  v_mfma_f32_16x16x32_bf16 a[4:7], a[48:51], a[208:211], a[4:7]
  ds_read_b64_tr_b16 a[42:43], v7 offset:51200
  s_waitcnt lgkmcnt(10)
  v_mfma_f32_16x16x32_bf16 a[8:11], a[52:55], a[152:155], a[8:11]
  ds_read_b64_tr_b16 a[44:45], v8 offset:49152
  v_mfma_f32_16x16x32_bf16 a[12:15], a[52:55], a[208:211], a[12:15]
  ds_read_b64_tr_b16 a[46:47], v8 offset:51200
  s_waitcnt lgkmcnt(10)
  v_mfma_f32_16x16x32_bf16 a[16:19], a[56:59], a[152:155], a[16:19]
  ds_read_b64_tr_b16 a[48:49], v9 offset:49152
  v_mfma_f32_16x16x32_bf16 a[20:23], a[56:59], a[208:211], a[20:23]
  ds_read_b64_tr_b16 a[50:51], v9 offset:51200
  s_waitcnt lgkmcnt(10)
  v_mfma_f32_16x16x32_bf16 a[24:27], a[60:63], a[152:155], a[24:27]
  ds_read_b64_tr_b16 a[52:53], v10 offset:49152
  v_mfma_f32_16x16x32_bf16 a[28:31], a[60:63], a[208:211], a[28:31]
  ds_read_b64_tr_b16 a[54:55], v10 offset:51200
  s_waitcnt lgkmcnt(10)
  v_mfma_f32_16x16x32_bf16 v[160:163], a[32:35], a[156:159], v[160:163]
  ds_read_b64_tr_b16 a[56:57], v11 offset:49152
  v_mfma_f32_16x16x32_bf16 v[164:167], a[32:35], a[212:215], v[164:167]
  ds_read_b64_tr_b16 a[58:59], v11 offset:51200
  s_waitcnt lgkmcnt(10)
  v_mfma_f32_16x16x32_bf16 v[168:171], a[36:39], a[156:159], v[168:171]
  ds_read_b64_tr_b16 a[60:61], v12 offset:49152
  v_mfma_f32_16x16x32_bf16 v[172:175], a[36:39], a[212:215], v[172:175]
  ds_read_b64_tr_b16 a[62:63], v12 offset:51200
  s_waitcnt lgkmcnt(10)
  v_mfma_f32_16x16x32_bf16 v[176:179], a[40:43], a[156:159], v[176:179]
  ds_read_b64_tr_b16 a[32:33], v5 offset:49408
  v_mfma_f32_16x16x32_bf16 v[180:183], a[40:43], a[212:215], v[180:183]
  ds_read_b64_tr_b16 a[34:35], v5 offset:51456
  s_waitcnt lgkmcnt(10)
  v_mfma_f32_16x16x32_bf16 v[184:187], a[44:47], a[156:159], v[184:187]
  ds_read_b64_tr_b16 a[36:37], v6 offset:49408
  v_mfma_f32_16x16x32_bf16 v[188:191], a[44:47], a[212:215], v[188:191]
  ds_read_b64_tr_b16 a[38:39], v6 offset:51456
  s_waitcnt lgkmcnt(10)
  v_mfma_f32_16x16x32_bf16 v[192:195], a[48:51], a[156:159], v[192:195]
  ds_read_b64_tr_b16 a[40:41], v7 offset:49408
  v_mfma_f32_16x16x32_bf16 v[196:199], a[48:51], a[212:215], v[196:199]
  ds_read_b64_tr_b16 a[42:43], v7 offset:51456
  s_waitcnt lgkmcnt(10)
  v_mfma_f32_16x16x32_bf16 v[200:203], a[52:55], a[156:159], v[200:203]
  ds_read_b64_tr_b16 a[44:45], v8 offset:49408
  v_mfma_f32_16x16x32_bf16 v[204:207], a[52:55], a[212:215], v[204:207]
  ds_read_b64_tr_b16 a[46:47], v8 offset:51456
  s_waitcnt lgkmcnt(10)
  v_mfma_f32_16x16x32_bf16 v[208:211], a[56:59], a[156:159], v[208:211]
  ds_read_b64_tr_b16 a[48:49], v9 offset:49408
  v_mfma_f32_16x16x32_bf16 v[212:215], a[56:59], a[212:215], v[212:215]
  ds_read_b64_tr_b16 a[50:51], v9 offset:51456
  s_waitcnt lgkmcnt(10)
  v_mfma_f32_16x16x32_bf16 v[216:219], a[60:63], a[156:159], v[216:219]
  ds_read_b64_tr_b16 a[52:53], v10 offset:49408
  v_mfma_f32_16x16x32_bf16 v[220:223], a[60:63], a[212:215], v[220:223]
  ds_read_b64_tr_b16 a[54:55], v10 offset:51456
  s_waitcnt lgkmcnt(10)
  v_mfma_f32_16x16x32_bf16 v[224:227], a[32:35], a[156:159], v[224:227]
  ds_read_b64_tr_b16 a[56:57], v11 offset:49408
  v_mfma_f32_16x16x32_bf16 v[228:231], a[32:35], a[212:215], v[228:231]
  ds_read_b64_tr_b16 a[58:59], v11 offset:51456
  s_waitcnt lgkmcnt(10)
  v_mfma_f32_16x16x32_bf16 v[232:235], a[36:39], a[156:159], v[232:235]
  ds_read_b64_tr_b16 a[60:61], v12 offset:49408
  v_mfma_f32_16x16x32_bf16 v[236:239], a[36:39], a[212:215], v[236:239]
  ds_read_b64_tr_b16 a[62:63], v12 offset:51456
  s_waitcnt lgkmcnt(10)
  v_mfma_f32_16x16x32_bf16 v[240:243], a[40:43], a[156:159], v[240:243]
  v_add_u32 v5, 0x10000, v5
  ds_read_b64_tr_b16 a[32:33], v5 offset:0
  v_mfma_f32_16x16x32_bf16 v[244:247], a[40:43], a[212:215], v[244:247]
  ds_read_b64_tr_b16 a[34:35], v5 offset:2048
  s_waitcnt lgkmcnt(10)
  v_mfma_f32_16x16x32_bf16 v[248:251], a[44:47], a[156:159], v[248:251]
  v_add_u32 v6, 0x10000, v6
  ds_read_b64_tr_b16 a[36:37], v6 offset:0
  v_mfma_f32_16x16x32_bf16 v[252:255], a[44:47], a[212:215], v[252:255]
  ds_read_b64_tr_b16 a[38:39], v6 offset:2048
  s_waitcnt lgkmcnt(10)
  v_mfma_f32_16x16x32_bf16 a[0:3], a[48:51], a[156:159], a[0:3]
  v_add_u32 v7, 0x10000, v7
  ds_read_b64_tr_b16 a[40:41], v7 offset:0
  v_mfma_f32_16x16x32_bf16 a[4:7], a[48:51], a[212:215], a[4:7]
  ds_read_b64_tr_b16 a[42:43], v7 offset:2048
  s_waitcnt lgkmcnt(10)
  v_mfma_f32_16x16x32_bf16 a[8:11], a[52:55], a[156:159], a[8:11]
  v_add_u32 v8, 0x10000, v8
  ds_read_b64_tr_b16 a[44:45], v8 offset:0
  v_mfma_f32_16x16x32_bf16 a[12:15], a[52:55], a[212:215], a[12:15]
  ds_read_b64_tr_b16 a[46:47], v8 offset:2048
  s_waitcnt lgkmcnt(10)
  v_mfma_f32_16x16x32_bf16 a[16:19], a[56:59], a[156:159], a[16:19]
  v_add_u32 v9, 0x10000, v9
  ds_read_b64_tr_b16 a[48:49], v9 offset:0
  v_mfma_f32_16x16x32_bf16 a[20:23], a[56:59], a[212:215], a[20:23]
  ds_read_b64_tr_b16 a[50:51], v9 offset:2048
  s_waitcnt lgkmcnt(10)
  v_mfma_f32_16x16x32_bf16 a[24:27], a[60:63], a[156:159], a[24:27]
  v_add_u32 v10, 0x10000, v10
  ds_read_b64_tr_b16 a[52:53], v10 offset:0
  v_mfma_f32_16x16x32_bf16 a[28:31], a[60:63], a[212:215], a[28:31]
  ds_read_b64_tr_b16 a[54:55], v10 offset:2048
  s_waitcnt vmcnt(0)
  s_barrier
  s_cmp_eq_u32 s28, 0
  s_cbranch_scc0 k1_V_kvflag
  s_mov_b64 exec, 1
  v_mov_b32 v24, 1
  v_mov_b32 v25, s96
  buffer_store_dword v24, v25, s[40:43], 0 offen sc1
  s_mov_b64 exec, -1
k1_V_kvflag:
  s_lshl_b32 s67, s65, 7
  v_and_b32 v26, 15, v0
  v_lshl_add_u32 v26, v26, 2, s67
  v_add_u32 v11, 0x10000, v11
  v_add_u32 v12, 0x10000, v12
  s_waitcnt lgkmcnt(10)
  v_mfma_f32_16x16x32_bf16 v[160:163], a[32:35], a[160:163], v[160:163]
  ds_read_b64_tr_b16 a[56:57], v11 offset:0
  v_mfma_f32_16x16x32_bf16 v[164:167], a[32:35], a[216:219], v[164:167]
  ds_read_b64_tr_b16 a[58:59], v11 offset:2048
  s_waitcnt lgkmcnt(10)
  v_mfma_f32_16x16x32_bf16 v[168:171], a[36:39], a[160:163], v[168:171]
  ds_read_b64_tr_b16 a[60:61], v12 offset:0
  v_mfma_f32_16x16x32_bf16 v[172:175], a[36:39], a[216:219], v[172:175]
  ds_read_b64_tr_b16 a[62:63], v12 offset:2048
  s_waitcnt lgkmcnt(10)
  v_mfma_f32_16x16x32_bf16 v[176:179], a[40:43], a[160:163], v[176:179]
  ds_read_b64_tr_b16 a[32:33], v5 offset:256
  v_mfma_f32_16x16x32_bf16 v[180:183], a[40:43], a[216:219], v[180:183]
  ds_read_b64_tr_b16 a[34:35], v5 offset:2304
  s_waitcnt lgkmcnt(10)
  v_mfma_f32_16x16x32_bf16 v[184:187], a[44:47], a[160:163], v[184:187]
  ds_read_b64_tr_b16 a[36:37], v6 offset:256
  v_mfma_f32_16x16x32_bf16 v[188:191], a[44:47], a[216:219], v[188:191]
  ds_read_b64_tr_b16 a[38:39], v6 offset:2304
  s_waitcnt lgkmcnt(10)
  v_mfma_f32_16x16x32_bf16 v[192:195], a[48:51], a[160:163], v[192:195]
  ds_read_b64_tr_b16 a[40:41], v7 offset:256
  v_mfma_f32_16x16x32_bf16 v[196:199], a[48:51], a[216:219], v[196:199]
  ds_read_b64_tr_b16 a[42:43], v7 offset:2304
  s_waitcnt lgkmcnt(10)
  v_mfma_f32_16x16x32_bf16 v[200:203], a[52:55], a[160:163], v[200:203]
  ds_read_b64_tr_b16 a[44:45], v8 offset:256
  v_mfma_f32_16x16x32_bf16 v[204:207], a[52:55], a[216:219], v[204:207]
  ds_read_b64_tr_b16 a[46:47], v8 offset:2304
  s_waitcnt lgkmcnt(10)
  v_mfma_f32_16x16x32_bf16 v[208:211], a[56:59], a[160:163], v[208:211]
  ds_read_b64_tr_b16 a[48:49], v9 offset:256
  v_mfma_f32_16x16x32_bf16 v[212:215], a[56:59], a[216:219], v[212:215]
  ds_read_b64_tr_b16 a[50:51], v9 offset:2304
  s_waitcnt lgkmcnt(10)
  v_mfma_f32_16x16x32_bf16 v[216:219], a[60:63], a[160:163], v[216:219]
  ds_read_b64_tr_b16 a[52:53], v10 offset:256
  v_mfma_f32_16x16x32_bf16 v[220:223], a[60:63], a[216:219], v[220:223]
  ds_read_b64_tr_b16 a[54:55], v10 offset:2304
  s_waitcnt lgkmcnt(10)
  v_mfma_f32_16x16x32_bf16 v[224:227], a[32:35], a[160:163], v[224:227]
  ds_read_b64_tr_b16 a[56:57], v11 offset:256
  v_mfma_f32_16x16x32_bf16 v[228:231], a[32:35], a[216:219], v[228:231]
  ds_read_b64_tr_b16 a[58:59], v11 offset:2304
  s_waitcnt lgkmcnt(10)
  v_mfma_f32_16x16x32_bf16 v[232:235], a[36:39], a[160:163], v[232:235]
  ds_read_b64_tr_b16 a[60:61], v12 offset:256
  v_mfma_f32_16x16x32_bf16 v[236:239], a[36:39], a[216:219], v[236:239]
  ds_read_b64_tr_b16 a[62:63], v12 offset:2304
  s_waitcnt lgkmcnt(10)
  v_mfma_f32_16x16x32_bf16 v[240:243], a[40:43], a[160:163], v[240:243]
  ds_read_b64_tr_b16 a[32:33], v5 offset:16384
  v_mfma_f32_16x16x32_bf16 v[244:247], a[40:43], a[216:219], v[244:247]
  ds_read_b64_tr_b16 a[34:35], v5 offset:18432
  s_waitcnt lgkmcnt(10)
  v_mfma_f32_16x16x32_bf16 v[248:251], a[44:47], a[160:163], v[248:251]
  ds_read_b64_tr_b16 a[36:37], v6 offset:16384
  v_mfma_f32_16x16x32_bf16 v[252:255], a[44:47], a[216:219], v[252:255]
  ds_read_b64_tr_b16 a[38:39], v6 offset:18432
  s_waitcnt lgkmcnt(10)
  v_mfma_f32_16x16x32_bf16 a[0:3], a[48:51], a[160:163], a[0:3]
  ds_read_b64_tr_b16 a[40:41], v7 offset:16384
  v_mfma_f32_16x16x32_bf16 a[4:7], a[48:51], a[216:219], a[4:7]
  ds_read_b64_tr_b16 a[42:43], v7 offset:18432
  s_waitcnt lgkmcnt(10)
  v_mfma_f32_16x16x32_bf16 a[8:11], a[52:55], a[160:163], a[8:11]
  ds_read_b64_tr_b16 a[44:45], v8 offset:16384
  v_mfma_f32_16x16x32_bf16 a[12:15], a[52:55], a[216:219], a[12:15]
  ds_read_b64_tr_b16 a[46:47], v8 offset:18432
  s_waitcnt lgkmcnt(10)
  v_mfma_f32_16x16x32_bf16 a[16:19], a[56:59], a[160:163], a[16:19]
  ds_read_b64_tr_b16 a[48:49], v9 offset:16384
  v_mfma_f32_16x16x32_bf16 a[20:23], a[56:59], a[216:219], a[20:23]
  ds_read_b64_tr_b16 a[50:51], v9 offset:18432
  s_waitcnt lgkmcnt(10)
  v_mfma_f32_16x16x32_bf16 a[24:27], a[60:63], a[160:163], a[24:27]
  ds_read_b64_tr_b16 a[52:53], v10 offset:16384
  v_mfma_f32_16x16x32_bf16 a[28:31], a[60:63], a[216:219], a[28:31]
  ds_read_b64_tr_b16 a[54:55], v10 offset:18432
  buffer_load_dword v27, v26, s[40:43], 0 offen sc1
  s_waitcnt lgkmcnt(10)
  v_mfma_f32_16x16x32_bf16 v[160:163], a[32:35], a[164:167], v[160:163]
  ds_read_b64_tr_b16 a[56:57], v11 offset:16384
  v_mfma_f32_16x16x32_bf16 v[164:167], a[32:35], a[220:223], v[164:167]
  ds_read_b64_tr_b16 a[58:59], v11 offset:18432
  s_waitcnt lgkmcnt(10)
  v_mfma_f32_16x16x32_bf16 v[168:171], a[36:39], a[164:167], v[168:171]
  ds_read_b64_tr_b16 a[60:61], v12 offset:16384
  v_mfma_f32_16x16x32_bf16 v[172:175], a[36:39], a[220:223], v[172:175]
  ds_read_b64_tr_b16 a[62:63], v12 offset:18432
  s_waitcnt lgkmcnt(10)
  v_mfma_f32_16x16x32_bf16 v[176:179], a[40:43], a[164:167], v[176:179]
  ds_read_b64_tr_b16 a[32:33], v5 offset:16640
  v_mfma_f32_16x16x32_bf16 v[180:183], a[40:43], a[220:223], v[180:183]
  ds_read_b64_tr_b16 a[34:35], v5 offset:18688
  s_waitcnt lgkmcnt(10)
  v_mfma_f32_16x16x32_bf16 v[184:187], a[44:47], a[164:167], v[184:187]
  ds_read_b64_tr_b16 a[36:37], v6 offset:16640
  v_mfma_f32_16x16x32_bf16 v[188:191], a[44:47], a[220:223], v[188:191]
  ds_read_b64_tr_b16 a[38:39], v6 offset:18688
  s_waitcnt lgkmcnt(10)
  v_mfma_f32_16x16x32_bf16 v[192:195], a[48:51], a[164:167], v[192:195]
  ds_read_b64_tr_b16 a[40:41], v7 offset:16640
  v_mfma_f32_16x16x32_bf16 v[196:199], a[48:51], a[220:223], v[196:199]
  ds_read_b64_tr_b16 a[42:43], v7 offset:18688
  s_waitcnt lgkmcnt(10)
  v_mfma_f32_16x16x32_bf16 v[200:203], a[52:55], a[164:167], v[200:203]
  ds_read_b64_tr_b16 a[44:45], v8 offset:16640
  v_mfma_f32_16x16x32_bf16 v[204:207], a[52:55], a[220:223], v[204:207]
  ds_read_b64_tr_b16 a[46:47], v8 offset:18688
  s_waitcnt lgkmcnt(10)
  v_mfma_f32_16x16x32_bf16 v[208:211], a[56:59], a[164:167], v[208:211]
  ds_read_b64_tr_b16 a[48:49], v9 offset:16640
  v_mfma_f32_16x16x32_bf16 v[212:215], a[56:59], a[220:223], v[212:215]
  ds_read_b64_tr_b16 a[50:51], v9 offset:18688
  s_waitcnt lgkmcnt(10)
  v_mfma_f32_16x16x32_bf16 v[216:219], a[60:63], a[164:167], v[216:219]
  ds_read_b64_tr_b16 a[52:53], v10 offset:16640
  v_mfma_f32_16x16x32_bf16 v[220:223], a[60:63], a[220:223], v[220:223]
  ds_read_b64_tr_b16 a[54:55], v10 offset:18688
  s_waitcnt lgkmcnt(10)
  v_mfma_f32_16x16x32_bf16 v[224:227], a[32:35], a[164:167], v[224:227]
  ds_read_b64_tr_b16 a[56:57], v11 offset:16640
  v_mfma_f32_16x16x32_bf16 v[228:231], a[32:35], a[220:223], v[228:231]
  ds_read_b64_tr_b16 a[58:59], v11 offset:18688
  s_waitcnt lgkmcnt(10)
  v_mfma_f32_16x16x32_bf16 v[232:235], a[36:39], a[164:167], v[232:235]
  ds_read_b64_tr_b16 a[60:61], v12 offset:16640
  v_mfma_f32_16x16x32_bf16 v[236:239], a[36:39], a[220:223], v[236:239]
  ds_read_b64_tr_b16 a[62:63], v12 offset:18688
  s_waitcnt lgkmcnt(10)
  v_mfma_f32_16x16x32_bf16 v[240:243], a[40:43], a[164:167], v[240:243]
  v_mfma_f32_16x16x32_bf16 v[244:247], a[40:43], a[220:223], v[244:247]
  s_waitcnt lgkmcnt(8)
  v_mfma_f32_16x16x32_bf16 v[248:251], a[44:47], a[164:167], v[248:251]
  v_mfma_f32_16x16x32_bf16 v[252:255], a[44:47], a[220:223], v[252:255]
  s_waitcnt lgkmcnt(6)
  v_mfma_f32_16x16x32_bf16 a[0:3], a[48:51], a[164:167], a[0:3]
  v_mfma_f32_16x16x32_bf16 a[4:7], a[48:51], a[220:223], a[4:7]
  s_waitcnt lgkmcnt(4)
  v_mfma_f32_16x16x32_bf16 a[8:11], a[52:55], a[164:167], a[8:11]
  v_mfma_f32_16x16x32_bf16 a[12:15], a[52:55], a[220:223], a[12:15]
  s_waitcnt lgkmcnt(2)
  v_mfma_f32_16x16x32_bf16 a[16:19], a[56:59], a[164:167], a[16:19]
  v_mfma_f32_16x16x32_bf16 a[20:23], a[56:59], a[220:223], a[20:23]
  s_waitcnt lgkmcnt(0)
  v_mfma_f32_16x16x32_bf16 a[24:27], a[60:63], a[164:167], a[24:27]
  v_mfma_f32_16x16x32_bf16 a[28:31], a[60:63], a[220:223], a[28:31]
  s_branch k1_q
k1_q:
  s_barrier
  s_waitcnt vmcnt(0)
  v_cmp_ne_u32 vcc, 1, v27
  s_cbranch_vccz k1_kvok
  s_mov_b32 s67, 0
k1_kvpoll:
  buffer_load_dword v27, v26, s[40:43], 0 offen sc1
  s_waitcnt vmcnt(0)
  v_cmp_ne_u32 vcc, 1, v27
  s_add_u32 s67, s67, 1
  s_cbranch_vccz k1_kvpoll_ok
  s_cmp_lt_u32 s67, 262144
  s_cbranch_scc0 k1_kvpoll_ok
  s_sleep 1
  s_branch k1_kvpoll
k1_kvpoll_ok:
k1_kvok:
  s_mov_b32 s52, s98
  s_mov_b32 s53, s99
  s_and_b32 s60, s2, 7
  s_lshr_b32 s61, s2, 3
  s_lshr_b32 s62, s61, 4
  s_lshl_b32 s60, s60, 1
  s_add_u32 s29, s60, s62
  s_and_b32 s61, s61, 15
  s_and_b32 s63, s61, 7
  s_lshl_b32 s62, s63, 2
  s_sub_i32 s64, 28, s62
  s_max_i32 s64, s64, 4
  s_cmp_eq_u32 s63, 7
  s_cselect_b32 s64, 0, s64
  s_sub_u32 s30, 15, s63
  s_lshl_b32 s32, s30, 2
  s_add_u32 s32, s32, 4
  s_mov_b32 s33, s28
  s_cmp_ge_u32 s61, 8
  s_cbranch_scc1 k2_jobB
  s_mov_b32 s31, s64
  s_cmp_lg_u32 s64, 0
  s_cselect_b32 s43, 1, 0
  s_branch k2_jobdone
k2_jobB:
  s_mov_b32 s31, 0
  s_mov_b32 s30, s63
  s_lshl_b32 s32, s30, 2
  s_add_u32 s32, s32, 4
  s_cmp_lg_u32 s64, 0
  s_cselect_b32 s43, 4, 0
  s_cbranch_scc0 k2_jobdone
  s_sub_u32 s30, 15, s63
  s_mov_b32 s32, s64
  s_mov_b32 s33, 99
k2_jobdone:
  s_mov_b32 s65, 0
  s_lshl_b32 s60, s29, 20
  s_add_u32 s61, s60, 0
  s_add_u32 s4, s52, s61
  s_addc_u32 s5, s53, 0
  s_mov_b32 s6, 0x100000
  s_mov_b32 s7, 0x00020000
  s_add_u32 s61, s60, 16777216
  s_add_u32 s8, s52, s61
  s_addc_u32 s9, s53, 0
  s_mov_b32 s10, 0x100000
  s_mov_b32 s11, 0x00020000
  s_add_u32 s61, s60, 33554432
  s_add_u32 s12, s52, s61
  s_addc_u32 s13, s53, 0
  s_mov_b32 s14, 0x100000
  s_mov_b32 s15, 0x00020000
  s_lshl_b32 s37, s28, 12
  v_lshlrev_b32 v1, 4, v0
  v_add_u32 v5, s37, v1
  s_cmp_eq_u32 s43, 4
  s_cselect_b32 s66, 1, 0
  s_add_u32 s60, s31, 0
  s_lshl_b32 s61, s60, 14
  s_and_b32 s62, s61, 0xc000
  s_add_u32 s62, s62, s37
  s_add_u32 m0, s62, 0
  s_nop 0
  buffer_load_dwordx4 v5, s[4:7], s61 offen offset:0 sc1 lds
  buffer_load_dwordx4 v5, s[4:7], s61 offen offset:1024 sc1 lds
  buffer_load_dwordx4 v5, s[4:7], s61 offen offset:2048 sc1 lds
  buffer_load_dwordx4 v5, s[4:7], s61 offen offset:3072 sc1 lds
  s_add_u32 s60, s31, 1
  s_lshl_b32 s61, s60, 14
  s_and_b32 s62, s61, 0xc000
  s_add_u32 s62, s62, s37
  s_add_u32 m0, s62, 0
  s_nop 0
  buffer_load_dwordx4 v5, s[4:7], s61 offen offset:0 sc1 lds
  buffer_load_dwordx4 v5, s[4:7], s61 offen offset:1024 sc1 lds
  buffer_load_dwordx4 v5, s[4:7], s61 offen offset:2048 sc1 lds
  buffer_load_dwordx4 v5, s[4:7], s61 offen offset:3072 sc1 lds
  s_add_u32 s60, s31, 0
  s_lshl_b32 s61, s60, 14
  s_and_b32 s62, s61, 0xc000
  s_add_u32 s62, s62, s37
  s_add_u32 m0, s62, 65536
  s_nop 0
  buffer_load_dwordx4 v5, s[8:11], s61 offen offset:0 sc1 lds
  buffer_load_dwordx4 v5, s[8:11], s61 offen offset:1024 sc1 lds
  buffer_load_dwordx4 v5, s[8:11], s61 offen offset:2048 sc1 lds
  buffer_load_dwordx4 v5, s[8:11], s61 offen offset:3072 sc1 lds
  s_add_u32 s60, s31, 2
  s_lshl_b32 s61, s60, 14
  s_and_b32 s62, s61, 0xc000
  s_add_u32 s62, s62, s37
  s_add_u32 m0, s62, 0
  s_nop 0
  buffer_load_dwordx4 v5, s[4:7], s61 offen offset:0 sc1 lds
  buffer_load_dwordx4 v5, s[4:7], s61 offen offset:1024 sc1 lds
  buffer_load_dwordx4 v5, s[4:7], s61 offen offset:2048 sc1 lds
  buffer_load_dwordx4 v5, s[4:7], s61 offen offset:3072 sc1 lds
  s_add_u32 s60, s31, 1
  s_lshl_b32 s61, s60, 14
  s_and_b32 s62, s61, 0xc000
  s_add_u32 s62, s62, s37
  s_add_u32 m0, s62, 65536
  s_nop 0
  buffer_load_dwordx4 v5, s[8:11], s61 offen offset:0 sc1 lds
  buffer_load_dwordx4 v5, s[8:11], s61 offen offset:1024 sc1 lds
  buffer_load_dwordx4 v5, s[8:11], s61 offen offset:2048 sc1 lds
  buffer_load_dwordx4 v5, s[8:11], s61 offen offset:3072 sc1 lds
  s_add_u32 s60, s31, 3
  s_lshl_b32 s61, s60, 14
  s_and_b32 s62, s61, 0xc000
  s_add_u32 s62, s62, s37
  s_add_u32 m0, s62, 0
  s_nop 0
  buffer_load_dwordx4 v5, s[4:7], s61 offen offset:0 sc1 lds
  buffer_load_dwordx4 v5, s[4:7], s61 offen offset:1024 sc1 lds
  buffer_load_dwordx4 v5, s[4:7], s61 offen offset:2048 sc1 lds
  buffer_load_dwordx4 v5, s[4:7], s61 offen offset:3072 sc1 lds
  s_nop 7
  v_cvt_pk_bf16_f32 v32, v160, v161
  v_cvt_pk_bf16_f32 v33, v162, v163
  v_cvt_pk_bf16_f32 v34, v168, v169
  v_cvt_pk_bf16_f32 v35, v170, v171
  v_cvt_pk_bf16_f32 v36, v164, v165
  v_cvt_pk_bf16_f32 v37, v166, v167
  v_cvt_pk_bf16_f32 v38, v172, v173
  v_cvt_pk_bf16_f32 v39, v174, v175
  v_cvt_pk_bf16_f32 v40, v176, v177
  v_cvt_pk_bf16_f32 v41, v178, v179
  v_cvt_pk_bf16_f32 v42, v184, v185
  v_cvt_pk_bf16_f32 v43, v186, v187
  v_cvt_pk_bf16_f32 v44, v180, v181
  v_cvt_pk_bf16_f32 v45, v182, v183
  v_cvt_pk_bf16_f32 v46, v188, v189
  v_cvt_pk_bf16_f32 v47, v190, v191
  v_cvt_pk_bf16_f32 v48, v192, v193
  v_cvt_pk_bf16_f32 v49, v194, v195
  v_cvt_pk_bf16_f32 v50, v200, v201
  v_cvt_pk_bf16_f32 v51, v202, v203
  v_cvt_pk_bf16_f32 v52, v196, v197
  v_cvt_pk_bf16_f32 v53, v198, v199
  v_cvt_pk_bf16_f32 v54, v204, v205
  v_cvt_pk_bf16_f32 v55, v206, v207
  v_cvt_pk_bf16_f32 v56, v208, v209
  v_cvt_pk_bf16_f32 v57, v210, v211
  v_cvt_pk_bf16_f32 v58, v216, v217
  v_cvt_pk_bf16_f32 v59, v218, v219
  v_cvt_pk_bf16_f32 v60, v212, v213
  v_cvt_pk_bf16_f32 v61, v214, v215
  v_cvt_pk_bf16_f32 v62, v220, v221
  v_cvt_pk_bf16_f32 v63, v222, v223
  v_cvt_pk_bf16_f32 v64, v224, v225
  v_cvt_pk_bf16_f32 v65, v226, v227
  v_cvt_pk_bf16_f32 v66, v232, v233
  v_cvt_pk_bf16_f32 v67, v234, v235
  v_cvt_pk_bf16_f32 v68, v228, v229
  v_cvt_pk_bf16_f32 v69, v230, v231
  v_cvt_pk_bf16_f32 v70, v236, v237
  v_cvt_pk_bf16_f32 v71, v238, v239
  v_cvt_pk_bf16_f32 v72, v240, v241
  v_cvt_pk_bf16_f32 v73, v242, v243
  v_cvt_pk_bf16_f32 v74, v248, v249
  v_cvt_pk_bf16_f32 v75, v250, v251
  v_cvt_pk_bf16_f32 v76, v244, v245
  v_cvt_pk_bf16_f32 v77, v246, v247
  v_cvt_pk_bf16_f32 v78, v252, v253
  v_cvt_pk_bf16_f32 v79, v254, v255
  v_accvgpr_read_b32 v24, a0
  v_accvgpr_read_b32 v25, a1
  v_accvgpr_read_b32 v26, a2
  v_accvgpr_read_b32 v27, a3
  v_accvgpr_read_b32 v28, a8
  v_accvgpr_read_b32 v29, a9
  v_accvgpr_read_b32 v30, a10
  v_accvgpr_read_b32 v31, a11
  v_cvt_pk_bf16_f32 v80, v24, v25
  v_cvt_pk_bf16_f32 v81, v26, v27
  v_cvt_pk_bf16_f32 v82, v28, v29
  v_cvt_pk_bf16_f32 v83, v30, v31
  v_accvgpr_read_b32 v24, a4
  v_accvgpr_read_b32 v25, a5
  v_accvgpr_read_b32 v26, a6
  v_accvgpr_read_b32 v27, a7
  v_accvgpr_read_b32 v28, a12
  v_accvgpr_read_b32 v29, a13
  v_accvgpr_read_b32 v30, a14
  v_accvgpr_read_b32 v31, a15
  v_cvt_pk_bf16_f32 v84, v24, v25
  v_cvt_pk_bf16_f32 v85, v26, v27
  v_cvt_pk_bf16_f32 v86, v28, v29
  v_cvt_pk_bf16_f32 v87, v30, v31
  v_accvgpr_read_b32 v24, a16
  v_accvgpr_read_b32 v25, a17
  v_accvgpr_read_b32 v26, a18
  v_accvgpr_read_b32 v27, a19
  v_accvgpr_read_b32 v28, a24
  v_accvgpr_read_b32 v29, a25
  v_accvgpr_read_b32 v30, a26
  v_accvgpr_read_b32 v31, a27
  v_cvt_pk_bf16_f32 v88, v24, v25
  v_cvt_pk_bf16_f32 v89, v26, v27
  v_cvt_pk_bf16_f32 v90, v28, v29
  v_cvt_pk_bf16_f32 v91, v30, v31
  v_accvgpr_read_b32 v24, a20
  v_accvgpr_read_b32 v25, a21
  v_accvgpr_read_b32 v26, a22
  v_accvgpr_read_b32 v27, a23
  v_accvgpr_read_b32 v28, a28
  v_accvgpr_read_b32 v29, a29
  v_accvgpr_read_b32 v30, a30
  v_accvgpr_read_b32 v31, a31
  v_cvt_pk_bf16_f32 v92, v24, v25
  v_cvt_pk_bf16_f32 v93, v26, v27
  v_cvt_pk_bf16_f32 v94, v28, v29
  v_cvt_pk_bf16_f32 v95, v30, v31
  s_cmp_ge_u32 s97, 8
  s_cbranch_scc0 k1_q0
  s_cmp_lt_u32 s97, 15
  s_cbranch_scc0 k1_q0
  v_accvgpr_write_b32 a96, v32
  v_accvgpr_write_b32 a97, v33
  v_accvgpr_write_b32 a98, v34
  v_accvgpr_write_b32 a99, v35
  v_accvgpr_write_b32 a100, v36
  v_accvgpr_write_b32 a101, v37
  v_accvgpr_write_b32 a102, v38
  v_accvgpr_write_b32 a103, v39
  v_accvgpr_write_b32 a104, v40
  v_accvgpr_write_b32 a105, v41
  v_accvgpr_write_b32 a106, v42
  v_accvgpr_write_b32 a107, v43
  v_accvgpr_write_b32 a108, v44
  v_accvgpr_write_b32 a109, v45
  v_accvgpr_write_b32 a110, v46
  v_accvgpr_write_b32 a111, v47
  v_accvgpr_write_b32 a112, v48
  v_accvgpr_write_b32 a113, v49
  v_accvgpr_write_b32 a114, v50
  v_accvgpr_write_b32 a115, v51
  v_accvgpr_write_b32 a116, v52
  v_accvgpr_write_b32 a117, v53
  v_accvgpr_write_b32 a118, v54
  v_accvgpr_write_b32 a119, v55
  v_accvgpr_write_b32 a120, v56
  v_accvgpr_write_b32 a121, v57
  v_accvgpr_write_b32 a122, v58
  v_accvgpr_write_b32 a123, v59
  v_accvgpr_write_b32 a124, v60
  v_accvgpr_write_b32 a125, v61
  v_accvgpr_write_b32 a126, v62
  v_accvgpr_write_b32 a127, v63
  v_accvgpr_write_b32 a128, v64
  v_accvgpr_write_b32 a129, v65
  v_accvgpr_write_b32 a130, v66
  v_accvgpr_write_b32 a131, v67
  v_accvgpr_write_b32 a132, v68
  v_accvgpr_write_b32 a133, v69
  v_accvgpr_write_b32 a134, v70
  v_accvgpr_write_b32 a135, v71
  v_accvgpr_write_b32 a136, v72
  v_accvgpr_write_b32 a137, v73
  v_accvgpr_write_b32 a138, v74
  v_accvgpr_write_b32 a139, v75
  v_accvgpr_write_b32 a140, v76
  v_accvgpr_write_b32 a141, v77
  v_accvgpr_write_b32 a142, v78
  v_accvgpr_write_b32 a143, v79
  v_accvgpr_write_b32 a144, v80
  v_accvgpr_write_b32 a145, v81
  v_accvgpr_write_b32 a146, v82
  v_accvgpr_write_b32 a147, v83
  v_accvgpr_write_b32 a148, v84
  v_accvgpr_write_b32 a149, v85
  v_accvgpr_write_b32 a150, v86
  v_accvgpr_write_b32 a151, v87
  v_accvgpr_write_b32 a152, v88
  v_accvgpr_write_b32 a153, v89
  v_accvgpr_write_b32 a154, v90
  v_accvgpr_write_b32 a155, v91
  v_accvgpr_write_b32 a156, v92
  v_accvgpr_write_b32 a157, v93
  v_accvgpr_write_b32 a158, v94
  v_accvgpr_write_b32 a159, v95
  s_branch k1_qdone
k1_q0:
  v_accvgpr_write_b32 a0, v32
  v_accvgpr_write_b32 a1, v33
  v_accvgpr_write_b32 a2, v34
  v_accvgpr_write_b32 a3, v35
  v_accvgpr_write_b32 a4, v36
  v_accvgpr_write_b32 a5, v37
  v_accvgpr_write_b32 a6, v38
  v_accvgpr_write_b32 a7, v39
  v_accvgpr_write_b32 a8, v40
  v_accvgpr_write_b32 a9, v41
  v_accvgpr_write_b32 a10, v42
  v_accvgpr_write_b32 a11, v43
  v_accvgpr_write_b32 a12, v44
  v_accvgpr_write_b32 a13, v45
  v_accvgpr_write_b32 a14, v46
  v_accvgpr_write_b32 a15, v47
  v_accvgpr_write_b32 a16, v48
  v_accvgpr_write_b32 a17, v49
  v_accvgpr_write_b32 a18, v50
  v_accvgpr_write_b32 a19, v51
  v_accvgpr_write_b32 a20, v52
  v_accvgpr_write_b32 a21, v53
  v_accvgpr_write_b32 a22, v54
  v_accvgpr_write_b32 a23, v55
  v_accvgpr_write_b32 a24, v56
  v_accvgpr_write_b32 a25, v57
  v_accvgpr_write_b32 a26, v58
  v_accvgpr_write_b32 a27, v59
  v_accvgpr_write_b32 a28, v60
  v_accvgpr_write_b32 a29, v61
  v_accvgpr_write_b32 a30, v62
  v_accvgpr_write_b32 a31, v63
  v_accvgpr_write_b32 a32, v64
  v_accvgpr_write_b32 a33, v65
  v_accvgpr_write_b32 a34, v66
  v_accvgpr_write_b32 a35, v67
  v_accvgpr_write_b32 a36, v68
  v_accvgpr_write_b32 a37, v69
  v_accvgpr_write_b32 a38, v70
  v_accvgpr_write_b32 a39, v71
  v_accvgpr_write_b32 a40, v72
  v_accvgpr_write_b32 a41, v73
  v_accvgpr_write_b32 a42, v74
  v_accvgpr_write_b32 a43, v75
  v_accvgpr_write_b32 a44, v76
  v_accvgpr_write_b32 a45, v77
  v_accvgpr_write_b32 a46, v78
  v_accvgpr_write_b32 a47, v79
  v_accvgpr_write_b32 a48, v80
  v_accvgpr_write_b32 a49, v81
  v_accvgpr_write_b32 a50, v82
  v_accvgpr_write_b32 a51, v83
  v_accvgpr_write_b32 a52, v84
  v_accvgpr_write_b32 a53, v85
  v_accvgpr_write_b32 a54, v86
  v_accvgpr_write_b32 a55, v87
  v_accvgpr_write_b32 a56, v88
  v_accvgpr_write_b32 a57, v89
  v_accvgpr_write_b32 a58, v90
  v_accvgpr_write_b32 a59, v91
  v_accvgpr_write_b32 a60, v92
  v_accvgpr_write_b32 a61, v93
  v_accvgpr_write_b32 a62, v94
  v_accvgpr_write_b32 a63, v95
k1_qdone:
  s_load_dwordx2 s[54:55], s[0:1], 40
  s_waitcnt lgkmcnt(0)
  s_mul_i32 s61, s29, 229376
  s_add_u32 s16, s54, s61
  s_addc_u32 s17, s55, 0
  s_mov_b32 s18, 229376
  s_mov_b32 s19, 0x00020000
  s_mul_i32 s61, s29, 1835008
  s_add_u32 s61, s61, 50331648
  s_add_u32 s20, s52, s61
  s_addc_u32 s21, s53, 0
  s_mov_b32 s22, 1835008
  s_mov_b32 s23, 0x00020000
  s_add_u32 s56, s52, 101711872
  s_addc_u32 s57, s53, 0
  s_mov_b32 s58, 16384
  s_mov_b32 s59, 0x00020000
  s_lshl_b32 s61, s29, 3
  s_add_u32 s61, s61, s63
  s_mul_i32 s61, s61, 69632
  s_add_u32 s61, s61, 83886080
  s_add_u32 s24, s52, s61
  s_addc_u32 s25, s53, 0
  s_mov_b32 s26, 69632
  s_mov_b32 s27, 0x00020000
  s_mov_b32 s41, 0x41a00000
  s_mov_b32 s42, 0xff800000
  v_and_b32 v28, 15, v0
  v_lshrrev_b32 v29, 4, v0
  v_lshlrev_b32 v30, 2, v29
  v_sub_u32 v12, v28, v30
  v_lshrrev_b32 v31, 2, v28
  v_add_u32 v30, v30, v31
  v_lshrrev_b32 v31, 1, v30
  v_and_b32 v31, 3, v31
  v_lshlrev_b32 v31, 5, v31
  v_lshlrev_b32 v30, 7, v30
  v_and_b32 v28, 3, v28
  v_lshl_add_u32 v30, v28, 3, v30
  v_xor_b32 v28, 0, v31
  v_add_u32 v13, v30, v28
  v_add_u32 v17, 0x10000, v13
  v_xor_b32 v28, 32, v31
  v_add_u32 v14, v30, v28
  v_add_u32 v18, 0x10000, v14
  v_xor_b32 v28, 64, v31
  v_add_u32 v15, v30, v28
  v_add_u32 v19, 0x10000, v15
  v_xor_b32 v28, 96, v31
  v_add_u32 v16, v30, v28
  v_add_u32 v20, 0x10000, v16
  v_lshrrev_b32 v28, 3, v0
  s_lshl_b32 s60, s28, 6
  v_add_u32 v28, s60, v28
  s_movk_i32 s60, 896
  v_mul_lo_u32 v28, v28, s60
  v_lshrrev_b32 v29, 4, v0
  v_lshlrev_b32 v29, 1, v29
  v_and_b32 v30, 7, v0
  v_xor_b32 v29, v29, v30
  v_lshl_add_u32 v28, v29, 4, v28
  v_add_u32 v21, 0, v28
  v_add_u32 v22, 6144, v28
  v_add_u32 v23, 12288, v28
  v_add_u32 v24, 18432, v28
  s_mul_i32 s60, s28, 17408
  v_add_u32 v8, s60, v1
  s_lshl_b32 s60, s29, 7
  s_lshl_b32 s61, s63, 2
  s_add_u32 s60, s60, s61
  s_add_u32 s60, s60, 4096
  v_mov_b32 v9, s60
  s_cmp_eq_u32 s43, 1
  s_cselect_b32 s67, 1, 0
  s_lshl_b32 s40, s28, 13
  s_mov_b32 s69, 0
  s_cmp_eq_u32 s43, 4
  s_cbranch_scc0 k2_noq1
  s_lshl_b32 s60, s29, 7
  s_lshl_b32 s61, s63, 2
  s_add_u32 s60, s60, s61
  s_add_u32 s60, s60, 2048
  v_mov_b32 v27, s60
  s_mov_b32 s60, 0
k2_qpoll1:
  buffer_load_dword v28, v27, s[56:59], 0 offen sc1
  s_waitcnt vmcnt(0)
  v_cmp_ne_u32 vcc, 1, v28
  s_add_u32 s60, s60, 1
  s_cbranch_vccz k2_qpoll1_ok
  s_cmp_lt_u32 s60, 262144
  s_cbranch_scc0 k2_qpoll1_ok
  s_sleep 1
  s_branch k2_qpoll1
k2_qpoll1_ok:
  s_lshl_b32 s60, s30, 2
  s_add_u32 s60, s60, s28
  s_lshl_b32 s60, s60, 14
  v_add_u32 v27, s60, v1
  s_cmp_eq_u32 s66, 1
  s_cbranch_scc0 k2_qskip1
  s_mov_b32 s61, 0
  buffer_load_dwordx4 a[0:3], v27, s[12:15], s61 offen offset:0 sc1
  buffer_load_dwordx4 a[4:7], v27, s[12:15], s61 offen offset:1024 sc1
  buffer_load_dwordx4 a[8:11], v27, s[12:15], s61 offen offset:2048 sc1
  buffer_load_dwordx4 a[12:15], v27, s[12:15], s61 offen offset:3072 sc1
  s_mov_b32 s61, 4096
  buffer_load_dwordx4 a[16:19], v27, s[12:15], s61 offen offset:0 sc1
  buffer_load_dwordx4 a[20:23], v27, s[12:15], s61 offen offset:1024 sc1
  buffer_load_dwordx4 a[24:27], v27, s[12:15], s61 offen offset:2048 sc1
  buffer_load_dwordx4 a[28:31], v27, s[12:15], s61 offen offset:3072 sc1
  s_mov_b32 s61, 8192
  buffer_load_dwordx4 a[32:35], v27, s[12:15], s61 offen offset:0 sc1
  buffer_load_dwordx4 a[36:39], v27, s[12:15], s61 offen offset:1024 sc1
  buffer_load_dwordx4 a[40:43], v27, s[12:15], s61 offen offset:2048 sc1
  buffer_load_dwordx4 a[44:47], v27, s[12:15], s61 offen offset:3072 sc1
  s_mov_b32 s61, 12288
  buffer_load_dwordx4 a[48:51], v27, s[12:15], s61 offen offset:0 sc1
  buffer_load_dwordx4 a[52:55], v27, s[12:15], s61 offen offset:1024 sc1
  buffer_load_dwordx4 a[56:59], v27, s[12:15], s61 offen offset:2048 sc1
  buffer_load_dwordx4 a[60:63], v27, s[12:15], s61 offen offset:3072 sc1
k2_qskip1:
  s_mov_b32 s69, 1
k2_noq1:
  s_lshl_b32 s60, s30, 2
  s_add_u32 s60, s60, s28
  s_lshl_b32 s60, s60, 14
  v_add_u32 v27, s60, v1
  s_branch k2_seg_post
k2_seg:
  s_lshl_b32 s60, s30, 2
  s_add_u32 s60, s60, s28
  s_lshl_b32 s60, s60, 14
  v_add_u32 v27, s60, v1
  s_cmp_eq_u32 s66, 1
  s_cbranch_scc0 k2_qskip
  s_mov_b32 s61, 0
  buffer_load_dwordx4 a[0:3], v27, s[12:15], s61 offen offset:0 sc1
  buffer_load_dwordx4 a[4:7], v27, s[12:15], s61 offen offset:1024 sc1
  buffer_load_dwordx4 a[8:11], v27, s[12:15], s61 offen offset:2048 sc1
  buffer_load_dwordx4 a[12:15], v27, s[12:15], s61 offen offset:3072 sc1
  s_mov_b32 s61, 4096
  buffer_load_dwordx4 a[16:19], v27, s[12:15], s61 offen offset:0 sc1
  buffer_load_dwordx4 a[20:23], v27, s[12:15], s61 offen offset:1024 sc1
  buffer_load_dwordx4 a[24:27], v27, s[12:15], s61 offen offset:2048 sc1
  buffer_load_dwordx4 a[28:31], v27, s[12:15], s61 offen offset:3072 sc1
  s_mov_b32 s61, 8192
  buffer_load_dwordx4 a[32:35], v27, s[12:15], s61 offen offset:0 sc1
  buffer_load_dwordx4 a[36:39], v27, s[12:15], s61 offen offset:1024 sc1
  buffer_load_dwordx4 a[40:43], v27, s[12:15], s61 offen offset:2048 sc1
  buffer_load_dwordx4 a[44:47], v27, s[12:15], s61 offen offset:3072 sc1
  s_mov_b32 s61, 12288
  buffer_load_dwordx4 a[48:51], v27, s[12:15], s61 offen offset:0 sc1
  buffer_load_dwordx4 a[52:55], v27, s[12:15], s61 offen offset:1024 sc1
  buffer_load_dwordx4 a[56:59], v27, s[12:15], s61 offen offset:2048 sc1
  buffer_load_dwordx4 a[60:63], v27, s[12:15], s61 offen offset:3072 sc1
k2_qskip:
  s_add_u32 s60, s31, 0
  s_lshl_b32 s61, s60, 14
  s_and_b32 s62, s61, 0xc000
  s_add_u32 s62, s62, s37
  s_add_u32 m0, s62, 0
  s_nop 0
  buffer_load_dwordx4 v5, s[4:7], s61 offen offset:0 sc1 lds
  buffer_load_dwordx4 v5, s[4:7], s61 offen offset:1024 sc1 lds
  buffer_load_dwordx4 v5, s[4:7], s61 offen offset:2048 sc1 lds
  buffer_load_dwordx4 v5, s[4:7], s61 offen offset:3072 sc1 lds
  s_add_u32 s60, s31, 1
  s_lshl_b32 s61, s60, 14
  s_and_b32 s62, s61, 0xc000
  s_add_u32 s62, s62, s37
  s_add_u32 m0, s62, 0
  s_nop 0
  buffer_load_dwordx4 v5, s[4:7], s61 offen offset:0 sc1 lds
  buffer_load_dwordx4 v5, s[4:7], s61 offen offset:1024 sc1 lds
  buffer_load_dwordx4 v5, s[4:7], s61 offen offset:2048 sc1 lds
  buffer_load_dwordx4 v5, s[4:7], s61 offen offset:3072 sc1 lds
  s_add_u32 s60, s31, 0
  s_lshl_b32 s61, s60, 14
  s_and_b32 s62, s61, 0xc000
  s_add_u32 s62, s62, s37
  s_add_u32 m0, s62, 65536
  s_nop 0
  buffer_load_dwordx4 v5, s[8:11], s61 offen offset:0 sc1 lds
  buffer_load_dwordx4 v5, s[8:11], s61 offen offset:1024 sc1 lds
  buffer_load_dwordx4 v5, s[8:11], s61 offen offset:2048 sc1 lds
  buffer_load_dwordx4 v5, s[8:11], s61 offen offset:3072 sc1 lds
  s_add_u32 s60, s31, 2
  s_lshl_b32 s61, s60, 14
  s_and_b32 s62, s61, 0xc000
  s_add_u32 s62, s62, s37
  s_add_u32 m0, s62, 0
  s_nop 0
  buffer_load_dwordx4 v5, s[4:7], s61 offen offset:0 sc1 lds
  buffer_load_dwordx4 v5, s[4:7], s61 offen offset:1024 sc1 lds
  buffer_load_dwordx4 v5, s[4:7], s61 offen offset:2048 sc1 lds
  buffer_load_dwordx4 v5, s[4:7], s61 offen offset:3072 sc1 lds
  s_add_u32 s60, s31, 1
  s_lshl_b32 s61, s60, 14
  s_and_b32 s62, s61, 0xc000
  s_add_u32 s62, s62, s37
  s_add_u32 m0, s62, 65536
  s_nop 0
  buffer_load_dwordx4 v5, s[8:11], s61 offen offset:0 sc1 lds
  buffer_load_dwordx4 v5, s[8:11], s61 offen offset:1024 sc1 lds
  buffer_load_dwordx4 v5, s[8:11], s61 offen offset:2048 sc1 lds
  buffer_load_dwordx4 v5, s[8:11], s61 offen offset:3072 sc1 lds
  s_add_u32 s60, s31, 3
  s_lshl_b32 s61, s60, 14
  s_and_b32 s62, s61, 0xc000
  s_add_u32 s62, s62, s37
  s_add_u32 m0, s62, 0
  s_nop 0
  buffer_load_dwordx4 v5, s[4:7], s61 offen offset:0 sc1 lds
  buffer_load_dwordx4 v5, s[4:7], s61 offen offset:1024 sc1 lds
  buffer_load_dwordx4 v5, s[4:7], s61 offen offset:2048 sc1 lds
  buffer_load_dwordx4 v5, s[4:7], s61 offen offset:3072 sc1 lds
k2_seg_post:
  s_cmp_eq_u32 s67, 1
  s_cbranch_scc0 k2_noqst
  s_mov_b32 s61, 0
  buffer_store_dwordx4 v[32:35], v27, s[12:15], s61 offen offset:0 sc1
  buffer_store_dwordx4 v[36:39], v27, s[12:15], s61 offen offset:1024 sc1
  buffer_store_dwordx4 v[40:43], v27, s[12:15], s61 offen offset:2048 sc1
  buffer_store_dwordx4 v[44:47], v27, s[12:15], s61 offen offset:3072 sc1
  s_mov_b32 s61, 4096
  buffer_store_dwordx4 v[48:51], v27, s[12:15], s61 offen offset:0 sc1
  buffer_store_dwordx4 v[52:55], v27, s[12:15], s61 offen offset:1024 sc1
  buffer_store_dwordx4 v[56:59], v27, s[12:15], s61 offen offset:2048 sc1
  buffer_store_dwordx4 v[60:63], v27, s[12:15], s61 offen offset:3072 sc1
  s_mov_b32 s61, 8192
  buffer_store_dwordx4 v[64:67], v27, s[12:15], s61 offen offset:0 sc1
  buffer_store_dwordx4 v[68:71], v27, s[12:15], s61 offen offset:1024 sc1
  buffer_store_dwordx4 v[72:75], v27, s[12:15], s61 offen offset:2048 sc1
  buffer_store_dwordx4 v[76:79], v27, s[12:15], s61 offen offset:3072 sc1
  s_mov_b32 s61, 12288
  buffer_store_dwordx4 v[80:83], v27, s[12:15], s61 offen offset:0 sc1
  buffer_store_dwordx4 v[84:87], v27, s[12:15], s61 offen offset:1024 sc1
  buffer_store_dwordx4 v[88:91], v27, s[12:15], s61 offen offset:2048 sc1
  buffer_store_dwordx4 v[92:95], v27, s[12:15], s61 offen offset:3072 sc1
k2_noqst:
  s_lshl_b32 s60, s30, 3
  s_lshl_b32 s61, s28, 1
  s_add_u32 s60, s60, s61
  s_mul_i32 s60, s60, 14336
  v_add_u32 v25, s60, v1
  v_add_u32 v26, 14336, v25
  v_mov_b32 v32, 0
  v_mov_b32 v33, 0
  v_mov_b32 v34, 0
  v_mov_b32 v35, 0
  v_mov_b32 v36, 0
  v_mov_b32 v37, 0
  v_mov_b32 v38, 0
  v_mov_b32 v39, 0
  v_mov_b32 v40, 0
  v_mov_b32 v41, 0
  v_mov_b32 v42, 0
  v_mov_b32 v43, 0
  v_mov_b32 v44, 0
  v_mov_b32 v45, 0
  v_mov_b32 v46, 0
  v_mov_b32 v47, 0
  v_mov_b32 v48, 0
  v_mov_b32 v49, 0
  v_mov_b32 v50, 0
  v_mov_b32 v51, 0
  v_mov_b32 v52, 0
  v_mov_b32 v53, 0
  v_mov_b32 v54, 0
  v_mov_b32 v55, 0
  v_mov_b32 v56, 0
  v_mov_b32 v57, 0
  v_mov_b32 v58, 0
  v_mov_b32 v59, 0
  v_mov_b32 v60, 0
  v_mov_b32 v61, 0
  v_mov_b32 v62, 0
  v_mov_b32 v63, 0
  v_mov_b32 v64, 0
  v_mov_b32 v65, 0
  v_mov_b32 v66, 0
  v_mov_b32 v67, 0
  v_mov_b32 v68, 0
  v_mov_b32 v69, 0
  v_mov_b32 v70, 0
  v_mov_b32 v71, 0
  v_mov_b32 v72, 0
  v_mov_b32 v73, 0
  v_mov_b32 v74, 0
  v_mov_b32 v75, 0
  v_mov_b32 v76, 0
  v_mov_b32 v77, 0
  v_mov_b32 v78, 0
  v_mov_b32 v79, 0
  v_mov_b32 v80, 0
  v_mov_b32 v81, 0
  v_mov_b32 v82, 0
  v_mov_b32 v83, 0
  v_mov_b32 v84, 0
  v_mov_b32 v85, 0
  v_mov_b32 v86, 0
  v_mov_b32 v87, 0
  v_mov_b32 v88, 0
  v_mov_b32 v89, 0
  v_mov_b32 v90, 0
  v_mov_b32 v91, 0
  v_mov_b32 v92, 0
  v_mov_b32 v93, 0
  v_mov_b32 v94, 0
  v_mov_b32 v95, 0
  v_mov_b32 v96, 0
  v_mov_b32 v97, 0
  v_mov_b32 v98, 0
  v_mov_b32 v99, 0
  v_mov_b32 v100, 0
  v_mov_b32 v101, 0
  v_mov_b32 v102, 0
  v_mov_b32 v103, 0
  v_mov_b32 v104, 0
  v_mov_b32 v105, 0
  v_mov_b32 v106, 0
  v_mov_b32 v107, 0
  v_mov_b32 v108, 0
  v_mov_b32 v109, 0
  v_mov_b32 v110, 0
  v_mov_b32 v111, 0
  v_mov_b32 v112, 0
  v_mov_b32 v113, 0
  v_mov_b32 v114, 0
  v_mov_b32 v115, 0
  v_mov_b32 v116, 0
  v_mov_b32 v117, 0
  v_mov_b32 v118, 0
  v_mov_b32 v119, 0
  v_mov_b32 v120, 0
  v_mov_b32 v121, 0
  v_mov_b32 v122, 0
  v_mov_b32 v123, 0
  v_mov_b32 v124, 0
  v_mov_b32 v125, 0
  v_mov_b32 v126, 0
  v_mov_b32 v127, 0
  v_mov_b32 v128, 0
  v_mov_b32 v129, 0
  v_mov_b32 v130, 0
  v_mov_b32 v131, 0
  v_mov_b32 v132, 0
  v_mov_b32 v133, 0
  v_mov_b32 v134, 0
  v_mov_b32 v135, 0
  v_mov_b32 v136, 0
  v_mov_b32 v137, 0
  v_mov_b32 v138, 0
  v_mov_b32 v139, 0
  v_mov_b32 v140, 0
  v_mov_b32 v141, 0
  v_mov_b32 v142, 0
  v_mov_b32 v143, 0
  v_mov_b32 v144, 0
  v_mov_b32 v145, 0
  v_mov_b32 v146, 0
  v_mov_b32 v147, 0
  v_mov_b32 v148, 0
  v_mov_b32 v149, 0
  v_mov_b32 v150, 0
  v_mov_b32 v151, 0
  v_mov_b32 v152, 0
  v_mov_b32 v153, 0
  v_mov_b32 v154, 0
  v_mov_b32 v155, 0
  v_mov_b32 v156, 0
  v_mov_b32 v157, 0
  v_mov_b32 v158, 0
  v_mov_b32 v159, 0
  v_mov_b32 v6, 0
  v_mov_b32 v7, 0
  s_lshl_b32 s34, s31, 14
  s_and_b32 s34, s34, 0xc000
  s_add_u32 s35, s31, 4
  s_lshl_b32 s35, s35, 14
  s_add_u32 s36, s31, 2
  s_lshl_b32 s36, s36, 14
  s_sub_u32 s38, s32, s31
  s_sub_u32 s38, s38, 4
  s_lshr_b32 s38, s38, 1
  s_or_b32 s60, s67, s69
  s_cmp_eq_u32 s60, 1
  s_cbranch_scc0 k2_now0
  s_waitcnt vmcnt(0)
k2_now0:
  s_mov_b32 s69, 0
  s_waitcnt vmcnt(20)
  s_barrier
  s_cmp_eq_u32 s67, 1
  s_cbranch_scc0 k2_noqf1
  s_mov_b32 s67, 0
  s_lshl_b32 s60, s29, 7
  s_lshl_b32 s61, s63, 2
  s_add_u32 s60, s60, s61
  s_add_u32 s60, s60, 2048
  s_cmp_eq_u32 s28, 0
  s_cbranch_scc0 k2_qflag1
  s_mov_b64 exec, 1
  v_mov_b32 v27, 1
  v_mov_b32 v28, s60
  buffer_store_dword v27, v28, s[56:59], 0 offen sc1
  s_mov_b64 exec, -1
k2_qflag1:
k2_noqf1:
  s_cmp_eq_u32 s65, 1
  s_cbranch_scc0 k2_nopub
  s_mov_b32 s65, 0
  s_cmp_eq_u32 s28, 0
  s_cbranch_scc0 k2_nopub
  v_mov_b32 v27, 1
  s_mov_b64 exec, 1
  buffer_store_dword v27, v9, s[56:59], 0 offen sc1
  s_mov_b64 exec, -1
k2_nopub:
  v_add_u32 v2, s34, v1
  ds_read_b128 a[64:67], v2 offset:0
  ds_read_b128 a[68:71], v2 offset:1024
  ds_read_b128 a[72:75], v2 offset:2048
  ds_read_b128 a[76:79], v2 offset:3072
  ds_read_b128 a[80:83], v2 offset:4096
  ds_read_b128 a[84:87], v2 offset:5120
  s_waitcnt lgkmcnt(5)
  v_mfma_f32_16x16x32_bf16 v[160:163], a[64:67], a[0:3], 0
  ds_read_b128 a[88:91], v2 offset:6144
  v_mfma_f32_16x16x32_bf16 v[164:167], a[64:67], a[4:7], 0
  s_waitcnt lgkmcnt(5)
  v_mfma_f32_16x16x32_bf16 v[168:171], a[68:71], a[0:3], 0
  ds_read_b128 a[92:95], v2 offset:7168
  v_mfma_f32_16x16x32_bf16 v[172:175], a[68:71], a[4:7], 0
  s_waitcnt lgkmcnt(5)
  v_mfma_f32_16x16x32_bf16 v[160:163], a[72:75], a[8:11], v[160:163]
  ds_read_b128 a[64:67], v2 offset:8192
  v_mfma_f32_16x16x32_bf16 v[164:167], a[72:75], a[12:15], v[164:167]
  s_waitcnt lgkmcnt(5)
  v_mfma_f32_16x16x32_bf16 v[168:171], a[76:79], a[8:11], v[168:171]
  ds_read_b128 a[68:71], v2 offset:9216
  v_mfma_f32_16x16x32_bf16 v[172:175], a[76:79], a[12:15], v[172:175]
  s_waitcnt lgkmcnt(5)
  v_mfma_f32_16x16x32_bf16 v[160:163], a[80:83], a[16:19], v[160:163]
  ds_read_b128 a[72:75], v2 offset:10240
  v_mfma_f32_16x16x32_bf16 v[164:167], a[80:83], a[20:23], v[164:167]
  s_waitcnt lgkmcnt(5)
  v_mfma_f32_16x16x32_bf16 v[168:171], a[84:87], a[16:19], v[168:171]
  ds_read_b128 a[76:79], v2 offset:11264
  v_mfma_f32_16x16x32_bf16 v[172:175], a[84:87], a[20:23], v[172:175]
  s_waitcnt lgkmcnt(5)
  v_mfma_f32_16x16x32_bf16 v[160:163], a[88:91], a[24:27], v[160:163]
  ds_read_b128 a[80:83], v2 offset:12288
  v_mfma_f32_16x16x32_bf16 v[164:167], a[88:91], a[28:31], v[164:167]
  s_waitcnt lgkmcnt(5)
  v_mfma_f32_16x16x32_bf16 v[168:171], a[92:95], a[24:27], v[168:171]
  ds_read_b128 a[84:87], v2 offset:13312
  v_mfma_f32_16x16x32_bf16 v[172:175], a[92:95], a[28:31], v[172:175]
  s_waitcnt lgkmcnt(5)
  v_mfma_f32_16x16x32_bf16 v[160:163], a[64:67], a[32:35], v[160:163]
  ds_read_b128 a[88:91], v2 offset:14336
  v_mfma_f32_16x16x32_bf16 v[164:167], a[64:67], a[36:39], v[164:167]
  s_waitcnt lgkmcnt(5)
  v_mfma_f32_16x16x32_bf16 v[168:171], a[68:71], a[32:35], v[168:171]
  ds_read_b128 a[92:95], v2 offset:15360
  v_mfma_f32_16x16x32_bf16 v[172:175], a[68:71], a[36:39], v[172:175]
  s_waitcnt lgkmcnt(5)
  v_mfma_f32_16x16x32_bf16 v[160:163], a[72:75], a[40:43], v[160:163]
  v_mfma_f32_16x16x32_bf16 v[164:167], a[72:75], a[44:47], v[164:167]
  s_waitcnt lgkmcnt(4)
  v_mfma_f32_16x16x32_bf16 v[168:171], a[76:79], a[40:43], v[168:171]
  v_mfma_f32_16x16x32_bf16 v[172:175], a[76:79], a[44:47], v[172:175]
  s_waitcnt lgkmcnt(3)
  v_mfma_f32_16x16x32_bf16 v[160:163], a[80:83], a[48:51], v[160:163]
  v_mfma_f32_16x16x32_bf16 v[164:167], a[80:83], a[52:55], v[164:167]
  s_waitcnt lgkmcnt(2)
  v_mfma_f32_16x16x32_bf16 v[168:171], a[84:87], a[48:51], v[168:171]
  v_mfma_f32_16x16x32_bf16 v[172:175], a[84:87], a[52:55], v[172:175]
  s_waitcnt lgkmcnt(1)
  v_mfma_f32_16x16x32_bf16 v[160:163], a[88:91], a[56:59], v[160:163]
  v_mfma_f32_16x16x32_bf16 v[164:167], a[88:91], a[60:63], v[164:167]
  s_waitcnt lgkmcnt(0)
  v_mfma_f32_16x16x32_bf16 v[168:171], a[92:95], a[56:59], v[168:171]
  v_mfma_f32_16x16x32_bf16 v[172:175], a[92:95], a[60:63], v[172:175]
  s_cmp_eq_u32 s67, 1
  s_cbranch_scc0 k2_noqw
  s_waitcnt vmcnt(0)
k2_noqw:
  s_waitcnt vmcnt(12)
  s_barrier
  s_cmp_eq_u32 s67, 1
  s_cbranch_scc0 k2_noqf
  s_mov_b32 s67, 0
  s_lshl_b32 s60, s29, 7
  s_lshl_b32 s61, s63, 2
  s_add_u32 s60, s60, s61
  s_add_u32 s60, s60, 2048
  s_cmp_eq_u32 s28, 0
  s_cbranch_scc0 k2_qflag
  s_mov_b64 exec, 1
  v_mov_b32 v27, 1
  v_mov_b32 v28, s60
  buffer_store_dword v27, v28, s[56:59], 0 offen sc1
  s_mov_b64 exec, -1
k2_qflag:
k2_noqf:
  s_cmp_eq_u32 s38, 0
  s_cbranch_scc0 k2_nomask0
  s_cmp_eq_u32 s33, 0
  s_cbranch_scc0 k2_nomask0
  s_nop 4
  v_cmp_gt_i32 s[44:45], 0, v12
  v_cmp_gt_i32 s[46:47], 1, v12
  v_cmp_gt_i32 s[48:49], 2, v12
  v_cmp_gt_i32 s[50:51], 3, v12
  v_mov_b32 v27, s42
  v_cndmask_b32 v160, v160, v27, s[44:45]
  v_cndmask_b32 v172, v172, v27, s[44:45]
  v_mov_b32 v168, s42
  v_cndmask_b32 v161, v161, v27, s[46:47]
  v_cndmask_b32 v173, v173, v27, s[46:47]
  v_mov_b32 v169, s42
  v_cndmask_b32 v162, v162, v27, s[48:49]
  v_cndmask_b32 v174, v174, v27, s[48:49]
  v_mov_b32 v170, s42
  v_cndmask_b32 v163, v163, v27, s[50:51]
  v_cndmask_b32 v175, v175, v27, s[50:51]
  v_mov_b32 v171, s42
k2_nomask0:
  s_nop 4
  v_max3_f32 v10, v160, v161, v162
  v_max3_f32 v10, v10, v163, v168
  v_max3_f32 v10, v10, v169, v170
  v_max_f32 v10, v10, v171
  v_mov_b32 v27, v10
  s_nop 1
  v_permlane16_swap_b32 v10, v27
  s_nop 1
  v_max_f32 v10, v10, v27
  v_mov_b32 v27, v10
  s_nop 1
  v_permlane32_swap_b32 v10, v27
  s_nop 1
  v_max_f32 v10, v10, v27
  v_sub_f32 v160, v160, v10
  v_sub_f32 v161, v161, v10
  v_sub_f32 v162, v162, v10
  v_sub_f32 v163, v163, v10
  v_sub_f32 v168, v168, v10
  v_sub_f32 v169, v169, v10
  v_sub_f32 v170, v170, v10
  v_sub_f32 v171, v171, v10
  v_sub_f32 v208, 0, v10
  v_sub_f32 v209, 0, v10
  v_sub_f32 v210, 0, v10
  v_sub_f32 v211, 0, v10
  v_max3_f32 v11, v164, v165, v166
  v_max3_f32 v11, v11, v167, v172
  v_max3_f32 v11, v11, v173, v174
  v_max_f32 v11, v11, v175
  v_mov_b32 v27, v11
  s_nop 1
  v_permlane16_swap_b32 v11, v27
  s_nop 1
  v_max_f32 v11, v11, v27
  v_mov_b32 v27, v11
  s_nop 1
  v_permlane32_swap_b32 v11, v27
  s_nop 1
  v_max_f32 v11, v11, v27
  v_sub_f32 v164, v164, v11
  v_sub_f32 v165, v165, v11
  v_sub_f32 v166, v166, v11
  v_sub_f32 v167, v167, v11
  v_sub_f32 v172, v172, v11
  v_sub_f32 v173, v173, v11
  v_sub_f32 v174, v174, v11
  v_sub_f32 v175, v175, v11
  v_sub_f32 v212, 0, v11
  v_sub_f32 v213, 0, v11
  v_sub_f32 v214, 0, v11
  v_sub_f32 v215, 0, v11
  s_add_u32 s39, s34, 0x4000
  s_and_b32 s39, s39, 0xc000
  v_add_u32 v2, s39, v1
  s_add_u32 s39, s34, 0x10000
  v_add_u32 v3, s39, v1
  s_add_u32 s39, s34, 0x8000
  s_and_b32 s39, s39, 0xc000
  s_add_u32 s39, s39, s37
  s_add_u32 m0, s39, 0x10000
  s_nop 0
  buffer_load_dwordx4 v5, s[8:11], s36 offen offset:0 sc1 lds
  buffer_load_dwordx4 v5, s[8:11], s36 offen offset:1024 sc1 lds
  buffer_load_dwordx4 v5, s[8:11], s36 offen offset:2048 sc1 lds
  buffer_load_dwordx4 v5, s[8:11], s36 offen offset:3072 sc1 lds
  s_cmp_eq_u32 s38, 0
  s_cbranch_scc1 k2_tail_entry
  s_add_u32 m0, s34, s37
  s_nop 0
  buffer_load_dwordx4 v5, s[4:7], s35 offen offset:0 sc1 lds
  buffer_load_dwordx4 v5, s[4:7], s35 offen offset:1024 sc1 lds
  buffer_load_dwordx4 v5, s[4:7], s35 offen offset:2048 sc1 lds
  buffer_load_dwordx4 v5, s[4:7], s35 offen offset:3072 sc1 lds
  ds_read_b128 a[64:67], v2 offset:0
  ds_read_b128 a[68:71], v2 offset:1024
  ds_read_b128 a[72:75], v2 offset:2048
  ds_read_b128 a[76:79], v2 offset:3072
  ds_read_b128 a[80:83], v2 offset:4096
  ds_read_b128 a[84:87], v2 offset:5120
  s_branch k2_mid
k2_tail_entry:
  ds_read_b128 a[64:67], v2 offset:0
  ds_read_b128 a[68:71], v2 offset:1024
  ds_read_b128 a[72:75], v2 offset:2048
  ds_read_b128 a[76:79], v2 offset:3072
  ds_read_b128 a[80:83], v2 offset:4096
  ds_read_b128 a[84:87], v2 offset:5120
  s_branch k2_tmid
k2_loop:
  s_add_u32 s39, s34, 0x4000
  s_and_b32 s39, s39, 0xc000
  v_add_u32 v2, s39, v1
  s_add_u32 s39, s34, 0x10000
  v_add_u32 v3, s39, v1
  s_waitcnt lgkmcnt(5)
  v_mfma_f32_16x16x32_bf16 v[32:35], a[64:67], v[200:203], v[32:35]
  ds_read_b128 a[88:91], v4 offset:6144
  v_mfma_f32_16x16x32_bf16 v[36:39], a[64:67], v[204:207], v[36:39]
  s_add_u32 s39, s34, 0x8000
  s_and_b32 s39, s39, 0xc000
  s_waitcnt lgkmcnt(5)
  v_mfma_f32_16x16x32_bf16 v[40:43], a[68:71], v[200:203], v[40:43]
  ds_read_b128 a[92:95], v4 offset:7168
  v_mfma_f32_16x16x32_bf16 v[44:47], a[68:71], v[204:207], v[44:47]
  s_add_u32 s39, s39, s37
  s_add_u32 m0, s39, 0x10000
  s_waitcnt lgkmcnt(5)
  v_mfma_f32_16x16x32_bf16 v[48:51], a[72:75], v[200:203], v[48:51]
  ds_read_b128 a[64:67], v4 offset:8192
  v_mfma_f32_16x16x32_bf16 v[52:55], a[72:75], v[204:207], v[52:55]
  buffer_load_dwordx4 v5, s[8:11], s36 offen offset:0 sc1 lds
  s_waitcnt lgkmcnt(5)
  v_mfma_f32_16x16x32_bf16 v[56:59], a[76:79], v[200:203], v[56:59]
  ds_read_b128 a[68:71], v4 offset:9216
  v_mfma_f32_16x16x32_bf16 v[60:63], a[76:79], v[204:207], v[60:63]
  buffer_load_dwordx4 v5, s[8:11], s36 offen offset:1024 sc1 lds
  s_waitcnt lgkmcnt(5)
  v_mfma_f32_16x16x32_bf16 v[64:67], a[80:83], v[200:203], v[64:67]
  ds_read_b128 a[72:75], v4 offset:10240
  v_mfma_f32_16x16x32_bf16 v[68:71], a[80:83], v[204:207], v[68:71]
  buffer_load_dwordx4 v5, s[8:11], s36 offen offset:2048 sc1 lds
  s_waitcnt lgkmcnt(5)
  v_mfma_f32_16x16x32_bf16 v[72:75], a[84:87], v[200:203], v[72:75]
  ds_read_b128 a[76:79], v4 offset:11264
  v_mfma_f32_16x16x32_bf16 v[76:79], a[84:87], v[204:207], v[76:79]
  buffer_load_dwordx4 v5, s[8:11], s36 offen offset:3072 sc1 lds
  v_max3_f32 v10, v160, v161, v162
  s_waitcnt lgkmcnt(5)
  v_mfma_f32_16x16x32_bf16 v[80:83], a[88:91], v[200:203], v[80:83]
  ds_read_b128 a[80:83], v4 offset:12288
  v_mfma_f32_16x16x32_bf16 v[84:87], a[88:91], v[204:207], v[84:87]
  s_add_u32 m0, s34, s37
  v_max3_f32 v10, v10, v163, v164
  s_waitcnt lgkmcnt(5)
  v_mfma_f32_16x16x32_bf16 v[88:91], a[92:95], v[200:203], v[88:91]
  ds_read_b128 a[84:87], v4 offset:13312
  v_mfma_f32_16x16x32_bf16 v[92:95], a[92:95], v[204:207], v[92:95]
  buffer_load_dwordx4 v5, s[4:7], s35 offen offset:0 sc1 lds
  v_max3_f32 v10, v10, v165, v166
  s_waitcnt lgkmcnt(5)
  v_mfma_f32_16x16x32_bf16 v[96:99], a[64:67], v[200:203], v[96:99]
  ds_read_b128 a[88:91], v4 offset:14336
  v_mfma_f32_16x16x32_bf16 v[100:103], a[64:67], v[204:207], v[100:103]
  buffer_load_dwordx4 v5, s[4:7], s35 offen offset:1024 sc1 lds
  v_max3_f32 v10, v10, v167, v168
  s_waitcnt lgkmcnt(5)
  v_mfma_f32_16x16x32_bf16 v[104:107], a[68:71], v[200:203], v[104:107]
  ds_read_b128 a[92:95], v4 offset:15360
  v_mfma_f32_16x16x32_bf16 v[108:111], a[68:71], v[204:207], v[108:111]
  buffer_load_dwordx4 v5, s[4:7], s35 offen offset:2048 sc1 lds
  v_max3_f32 v10, v10, v169, v170
  s_waitcnt lgkmcnt(5)
  v_mfma_f32_16x16x32_bf16 v[112:115], a[72:75], v[200:203], v[112:115]
  ds_read_b128 a[64:67], v2 offset:0
  v_mfma_f32_16x16x32_bf16 v[116:119], a[72:75], v[204:207], v[116:119]
  buffer_load_dwordx4 v5, s[4:7], s35 offen offset:3072 sc1 lds
  v_max3_f32 v10, v10, v171, v172
  s_waitcnt lgkmcnt(5)
  v_mfma_f32_16x16x32_bf16 v[120:123], a[76:79], v[200:203], v[120:123]
  ds_read_b128 a[68:71], v2 offset:1024
  v_mfma_f32_16x16x32_bf16 v[124:127], a[76:79], v[204:207], v[124:127]
  v_max3_f32 v10, v10, v173, v174
  s_waitcnt lgkmcnt(5)
  v_mfma_f32_16x16x32_bf16 v[128:131], a[80:83], v[200:203], v[128:131]
  ds_read_b128 a[72:75], v2 offset:2048
  v_mfma_f32_16x16x32_bf16 v[132:135], a[80:83], v[204:207], v[132:135]
  v_max_f32 v10, v10, v175
  s_waitcnt lgkmcnt(5)
  v_mfma_f32_16x16x32_bf16 v[136:139], a[84:87], v[200:203], v[136:139]
  ds_read_b128 a[76:79], v2 offset:3072
  v_mfma_f32_16x16x32_bf16 v[140:143], a[84:87], v[204:207], v[140:143]
  v_cmp_lt_f32 vcc, s41, v10
  s_waitcnt lgkmcnt(5)
  v_mfma_f32_16x16x32_bf16 v[144:147], a[88:91], v[200:203], v[144:147]
  ds_read_b128 a[80:83], v2 offset:4096
  v_mfma_f32_16x16x32_bf16 v[148:151], a[88:91], v[204:207], v[148:151]
  s_waitcnt lgkmcnt(5)
  v_mfma_f32_16x16x32_bf16 v[152:155], a[92:95], v[200:203], v[152:155]
  ds_read_b128 a[84:87], v2 offset:5120
  v_mfma_f32_16x16x32_bf16 v[156:159], a[92:95], v[204:207], v[156:159]
  s_cbranch_vccnz k2_m0_slow
k2_m0_back:
k2_mid:
  s_waitcnt lgkmcnt(5)
  v_mfma_f32_16x16x32_bf16 v[176:179], a[64:67], a[0:3], v[208:211]
  ds_read_b128 a[88:91], v2 offset:6144
  v_exp_f32 v160, v160
  v_exp_f32 v161, v161
  v_mfma_f32_16x16x32_bf16 v[180:183], a[64:67], a[4:7], v[212:215]
  v_add_f32 v6, v6, v160
  s_waitcnt lgkmcnt(5)
  v_mfma_f32_16x16x32_bf16 v[184:187], a[68:71], a[0:3], v[208:211]
  ds_read_b128 a[92:95], v2 offset:7168
  v_exp_f32 v162, v162
  v_mfma_f32_16x16x32_bf16 v[188:191], a[68:71], a[4:7], v[212:215]
  v_add_f32 v6, v6, v161
  v_exp_f32 v163, v163
  s_waitcnt lgkmcnt(5)
  v_mfma_f32_16x16x32_bf16 v[176:179], a[72:75], a[8:11], v[176:179]
  ds_read_b128 a[64:67], v2 offset:8192
  v_add_f32 v6, v6, v162
  v_mfma_f32_16x16x32_bf16 v[180:183], a[72:75], a[12:15], v[180:183]
  v_cvt_pk_bf16_f32 v192, v160, v161
  s_waitcnt lgkmcnt(5)
  v_mfma_f32_16x16x32_bf16 v[184:187], a[76:79], a[8:11], v[184:187]
  ds_read_b128 a[68:71], v2 offset:9216
  v_exp_f32 v168, v168
  v_mfma_f32_16x16x32_bf16 v[188:191], a[76:79], a[12:15], v[188:191]
  v_add_f32 v6, v6, v163
  v_exp_f32 v169, v169
  s_waitcnt lgkmcnt(5)
  v_mfma_f32_16x16x32_bf16 v[176:179], a[80:83], a[16:19], v[176:179]
  ds_read_b128 a[72:75], v2 offset:10240
  v_add_f32 v6, v6, v168
  v_mfma_f32_16x16x32_bf16 v[180:183], a[80:83], a[20:23], v[180:183]
  v_cvt_pk_bf16_f32 v193, v162, v163
  s_waitcnt lgkmcnt(5)
  v_mfma_f32_16x16x32_bf16 v[184:187], a[84:87], a[16:19], v[184:187]
  ds_read_b128 a[76:79], v2 offset:11264
  v_exp_f32 v170, v170
  v_add_f32 v6, v6, v169
  v_mfma_f32_16x16x32_bf16 v[188:191], a[84:87], a[20:23], v[188:191]
  v_exp_f32 v171, v171
  s_waitcnt lgkmcnt(5)
  v_mfma_f32_16x16x32_bf16 v[176:179], a[88:91], a[24:27], v[176:179]
  ds_read_b128 a[80:83], v2 offset:12288
  v_add_f32 v6, v6, v170
  v_mfma_f32_16x16x32_bf16 v[180:183], a[88:91], a[28:31], v[180:183]
  v_cvt_pk_bf16_f32 v194, v168, v169
  s_waitcnt lgkmcnt(5)
  v_mfma_f32_16x16x32_bf16 v[184:187], a[92:95], a[24:27], v[184:187]
  ds_read_b128 a[84:87], v2 offset:13312
  v_exp_f32 v164, v164
  v_add_f32 v6, v6, v171
  v_mfma_f32_16x16x32_bf16 v[188:191], a[92:95], a[28:31], v[188:191]
  v_exp_f32 v165, v165
  s_waitcnt lgkmcnt(5)
  v_mfma_f32_16x16x32_bf16 v[176:179], a[64:67], a[32:35], v[176:179]
  ds_read_b128 a[88:91], v2 offset:14336
  v_add_f32 v7, v7, v164
  v_mfma_f32_16x16x32_bf16 v[180:183], a[64:67], a[36:39], v[180:183]
  v_cvt_pk_bf16_f32 v195, v170, v171
  v_exp_f32 v166, v166
  s_waitcnt lgkmcnt(5)
  v_mfma_f32_16x16x32_bf16 v[184:187], a[68:71], a[32:35], v[184:187]
  ds_read_b128 a[92:95], v2 offset:15360
  v_add_f32 v7, v7, v165
  v_mfma_f32_16x16x32_bf16 v[188:191], a[68:71], a[36:39], v[188:191]
  v_exp_f32 v167, v167
  s_waitcnt lgkmcnt(5)
  v_mfma_f32_16x16x32_bf16 v[176:179], a[72:75], a[40:43], v[176:179]
  ds_read_b128 a[64:67], v3 offset:0
  v_add_f32 v7, v7, v166
  v_mfma_f32_16x16x32_bf16 v[180:183], a[72:75], a[44:47], v[180:183]
  v_cvt_pk_bf16_f32 v196, v164, v165
  v_exp_f32 v172, v172
  s_waitcnt lgkmcnt(5)
  v_mfma_f32_16x16x32_bf16 v[184:187], a[76:79], a[40:43], v[184:187]
  ds_read_b128 a[68:71], v3 offset:1024
  v_add_f32 v7, v7, v167
  v_mfma_f32_16x16x32_bf16 v[188:191], a[76:79], a[44:47], v[188:191]
  v_exp_f32 v173, v173
  s_waitcnt lgkmcnt(5)
  v_mfma_f32_16x16x32_bf16 v[176:179], a[80:83], a[48:51], v[176:179]
  ds_read_b128 a[72:75], v3 offset:2048
  v_add_f32 v7, v7, v172
  v_cvt_pk_bf16_f32 v197, v166, v167
  v_mfma_f32_16x16x32_bf16 v[180:183], a[80:83], a[52:55], v[180:183]
  v_exp_f32 v174, v174
  s_waitcnt lgkmcnt(5)
  v_mfma_f32_16x16x32_bf16 v[184:187], a[84:87], a[48:51], v[184:187]
  ds_read_b128 a[76:79], v3 offset:3072
  v_add_f32 v7, v7, v173
  v_mfma_f32_16x16x32_bf16 v[188:191], a[84:87], a[52:55], v[188:191]
  v_exp_f32 v175, v175
  s_waitcnt lgkmcnt(5)
  v_mfma_f32_16x16x32_bf16 v[176:179], a[88:91], a[56:59], v[176:179]
  ds_read_b128 a[80:83], v3 offset:4096
  v_add_f32 v7, v7, v174
  v_cvt_pk_bf16_f32 v198, v172, v173
  v_mfma_f32_16x16x32_bf16 v[180:183], a[88:91], a[60:63], v[180:183]
  s_nop 0
  s_waitcnt lgkmcnt(5)
  v_mfma_f32_16x16x32_bf16 v[184:187], a[92:95], a[56:59], v[184:187]
  ds_read_b128 a[84:87], v3 offset:5120
  v_add_f32 v7, v7, v175
  s_add_u32 s34, s34, 0x4000
  s_and_b32 s34, s34, 0xc000
  s_add_u32 s35, s35, 0x4000
  s_add_u32 s36, s36, 0x4000
  v_mfma_f32_16x16x32_bf16 v[188:191], a[92:95], a[60:63], v[188:191]
  v_cvt_pk_bf16_f32 v199, v174, v175
  s_waitcnt vmcnt(12)
  s_barrier
  s_add_u32 s39, s34, 0x4000
  s_and_b32 s39, s39, 0xc000
  v_add_u32 v2, s39, v1
  s_add_u32 s39, s34, 0x10000
  v_add_u32 v4, s39, v1
  s_waitcnt lgkmcnt(5)
  v_mfma_f32_16x16x32_bf16 v[32:35], a[64:67], v[192:195], v[32:35]
  ds_read_b128 a[88:91], v3 offset:6144
  v_mfma_f32_16x16x32_bf16 v[36:39], a[64:67], v[196:199], v[36:39]
  s_add_u32 s39, s34, 0x8000
  s_and_b32 s39, s39, 0xc000
  s_waitcnt lgkmcnt(5)
  v_mfma_f32_16x16x32_bf16 v[40:43], a[68:71], v[192:195], v[40:43]
  ds_read_b128 a[92:95], v3 offset:7168
  v_mfma_f32_16x16x32_bf16 v[44:47], a[68:71], v[196:199], v[44:47]
  s_add_u32 s39, s39, s37
  s_add_u32 m0, s39, 0x10000
  s_waitcnt lgkmcnt(5)
  v_mfma_f32_16x16x32_bf16 v[48:51], a[72:75], v[192:195], v[48:51]
  ds_read_b128 a[64:67], v3 offset:8192
  v_mfma_f32_16x16x32_bf16 v[52:55], a[72:75], v[196:199], v[52:55]
  buffer_load_dwordx4 v5, s[8:11], s36 offen offset:0 sc1 lds
  s_waitcnt lgkmcnt(5)
  v_mfma_f32_16x16x32_bf16 v[56:59], a[76:79], v[192:195], v[56:59]
  ds_read_b128 a[68:71], v3 offset:9216
  v_mfma_f32_16x16x32_bf16 v[60:63], a[76:79], v[196:199], v[60:63]
  buffer_load_dwordx4 v5, s[8:11], s36 offen offset:1024 sc1 lds
  s_waitcnt lgkmcnt(5)
  v_mfma_f32_16x16x32_bf16 v[64:67], a[80:83], v[192:195], v[64:67]
  ds_read_b128 a[72:75], v3 offset:10240
  v_mfma_f32_16x16x32_bf16 v[68:71], a[80:83], v[196:199], v[68:71]
  buffer_load_dwordx4 v5, s[8:11], s36 offen offset:2048 sc1 lds
  s_waitcnt lgkmcnt(5)
  v_mfma_f32_16x16x32_bf16 v[72:75], a[84:87], v[192:195], v[72:75]
  ds_read_b128 a[76:79], v3 offset:11264
  v_mfma_f32_16x16x32_bf16 v[76:79], a[84:87], v[196:199], v[76:79]
  buffer_load_dwordx4 v5, s[8:11], s36 offen offset:3072 sc1 lds
  v_max3_f32 v10, v176, v177, v178
  s_waitcnt lgkmcnt(5)
  v_mfma_f32_16x16x32_bf16 v[80:83], a[88:91], v[192:195], v[80:83]
  ds_read_b128 a[80:83], v3 offset:12288
  v_mfma_f32_16x16x32_bf16 v[84:87], a[88:91], v[196:199], v[84:87]
  s_add_u32 m0, s34, s37
  v_max3_f32 v10, v10, v179, v180
  s_waitcnt lgkmcnt(5)
  v_mfma_f32_16x16x32_bf16 v[88:91], a[92:95], v[192:195], v[88:91]
  ds_read_b128 a[84:87], v3 offset:13312
  v_mfma_f32_16x16x32_bf16 v[92:95], a[92:95], v[196:199], v[92:95]
  buffer_load_dwordx4 v5, s[4:7], s35 offen offset:0 sc1 lds
  v_max3_f32 v10, v10, v181, v182
  s_waitcnt lgkmcnt(5)
  v_mfma_f32_16x16x32_bf16 v[96:99], a[64:67], v[192:195], v[96:99]
  ds_read_b128 a[88:91], v3 offset:14336
  v_mfma_f32_16x16x32_bf16 v[100:103], a[64:67], v[196:199], v[100:103]
  buffer_load_dwordx4 v5, s[4:7], s35 offen offset:1024 sc1 lds
  v_max3_f32 v10, v10, v183, v184
  s_waitcnt lgkmcnt(5)
  v_mfma_f32_16x16x32_bf16 v[104:107], a[68:71], v[192:195], v[104:107]
  ds_read_b128 a[92:95], v3 offset:15360
  v_mfma_f32_16x16x32_bf16 v[108:111], a[68:71], v[196:199], v[108:111]
  buffer_load_dwordx4 v5, s[4:7], s35 offen offset:2048 sc1 lds
  v_max3_f32 v10, v10, v185, v186
  s_waitcnt lgkmcnt(5)
  v_mfma_f32_16x16x32_bf16 v[112:115], a[72:75], v[192:195], v[112:115]
  ds_read_b128 a[64:67], v2 offset:0
  v_mfma_f32_16x16x32_bf16 v[116:119], a[72:75], v[196:199], v[116:119]
  buffer_load_dwordx4 v5, s[4:7], s35 offen offset:3072 sc1 lds
  v_max3_f32 v10, v10, v187, v188
  s_waitcnt lgkmcnt(5)
  v_mfma_f32_16x16x32_bf16 v[120:123], a[76:79], v[192:195], v[120:123]
  ds_read_b128 a[68:71], v2 offset:1024
  v_mfma_f32_16x16x32_bf16 v[124:127], a[76:79], v[196:199], v[124:127]
  v_max3_f32 v10, v10, v189, v190
  s_waitcnt lgkmcnt(5)
  v_mfma_f32_16x16x32_bf16 v[128:131], a[80:83], v[192:195], v[128:131]
  ds_read_b128 a[72:75], v2 offset:2048
  v_mfma_f32_16x16x32_bf16 v[132:135], a[80:83], v[196:199], v[132:135]
  v_max_f32 v10, v10, v191
  s_waitcnt lgkmcnt(5)
  v_mfma_f32_16x16x32_bf16 v[136:139], a[84:87], v[192:195], v[136:139]
  ds_read_b128 a[76:79], v2 offset:3072
  v_mfma_f32_16x16x32_bf16 v[140:143], a[84:87], v[196:199], v[140:143]
  v_cmp_lt_f32 vcc, s41, v10
  s_waitcnt lgkmcnt(5)
  v_mfma_f32_16x16x32_bf16 v[144:147], a[88:91], v[192:195], v[144:147]
  ds_read_b128 a[80:83], v2 offset:4096
  v_mfma_f32_16x16x32_bf16 v[148:151], a[88:91], v[196:199], v[148:151]
  s_waitcnt lgkmcnt(5)
  v_mfma_f32_16x16x32_bf16 v[152:155], a[92:95], v[192:195], v[152:155]
  ds_read_b128 a[84:87], v2 offset:5120
  v_mfma_f32_16x16x32_bf16 v[156:159], a[92:95], v[196:199], v[156:159]
  s_cbranch_vccnz k2_m1_slow
k2_m1_back:
  s_waitcnt lgkmcnt(5)
  v_mfma_f32_16x16x32_bf16 v[160:163], a[64:67], a[0:3], v[208:211]
  ds_read_b128 a[88:91], v2 offset:6144
  v_exp_f32 v176, v176
  v_exp_f32 v177, v177
  v_mfma_f32_16x16x32_bf16 v[164:167], a[64:67], a[4:7], v[212:215]
  v_add_f32 v6, v6, v176
  s_waitcnt lgkmcnt(5)
  v_mfma_f32_16x16x32_bf16 v[168:171], a[68:71], a[0:3], v[208:211]
  ds_read_b128 a[92:95], v2 offset:7168
  v_exp_f32 v178, v178
  v_mfma_f32_16x16x32_bf16 v[172:175], a[68:71], a[4:7], v[212:215]
  v_add_f32 v6, v6, v177
  v_exp_f32 v179, v179
  s_waitcnt lgkmcnt(5)
  v_mfma_f32_16x16x32_bf16 v[160:163], a[72:75], a[8:11], v[160:163]
  ds_read_b128 a[64:67], v2 offset:8192
  v_add_f32 v6, v6, v178
  v_mfma_f32_16x16x32_bf16 v[164:167], a[72:75], a[12:15], v[164:167]
  v_cvt_pk_bf16_f32 v200, v176, v177
  s_waitcnt lgkmcnt(5)
  v_mfma_f32_16x16x32_bf16 v[168:171], a[76:79], a[8:11], v[168:171]
  ds_read_b128 a[68:71], v2 offset:9216
  v_exp_f32 v184, v184
  v_mfma_f32_16x16x32_bf16 v[172:175], a[76:79], a[12:15], v[172:175]
  v_add_f32 v6, v6, v179
  v_exp_f32 v185, v185
  s_waitcnt lgkmcnt(5)
  v_mfma_f32_16x16x32_bf16 v[160:163], a[80:83], a[16:19], v[160:163]
  ds_read_b128 a[72:75], v2 offset:10240
  v_add_f32 v6, v6, v184
  v_mfma_f32_16x16x32_bf16 v[164:167], a[80:83], a[20:23], v[164:167]
  v_cvt_pk_bf16_f32 v201, v178, v179
  s_waitcnt lgkmcnt(5)
  v_mfma_f32_16x16x32_bf16 v[168:171], a[84:87], a[16:19], v[168:171]
  ds_read_b128 a[76:79], v2 offset:11264
  v_exp_f32 v186, v186
  v_add_f32 v6, v6, v185
  v_mfma_f32_16x16x32_bf16 v[172:175], a[84:87], a[20:23], v[172:175]
  v_exp_f32 v187, v187
  s_waitcnt lgkmcnt(5)
  v_mfma_f32_16x16x32_bf16 v[160:163], a[88:91], a[24:27], v[160:163]
  ds_read_b128 a[80:83], v2 offset:12288
  v_add_f32 v6, v6, v186
  v_mfma_f32_16x16x32_bf16 v[164:167], a[88:91], a[28:31], v[164:167]
  v_cvt_pk_bf16_f32 v202, v184, v185
  s_waitcnt lgkmcnt(5)
  v_mfma_f32_16x16x32_bf16 v[168:171], a[92:95], a[24:27], v[168:171]
  ds_read_b128 a[84:87], v2 offset:13312
  v_exp_f32 v180, v180
  v_add_f32 v6, v6, v187
  v_mfma_f32_16x16x32_bf16 v[172:175], a[92:95], a[28:31], v[172:175]
  v_exp_f32 v181, v181
  s_waitcnt lgkmcnt(5)
  v_mfma_f32_16x16x32_bf16 v[160:163], a[64:67], a[32:35], v[160:163]
  ds_read_b128 a[88:91], v2 offset:14336
  v_add_f32 v7, v7, v180
  v_mfma_f32_16x16x32_bf16 v[164:167], a[64:67], a[36:39], v[164:167]
  v_cvt_pk_bf16_f32 v203, v186, v187
  v_exp_f32 v182, v182
  s_waitcnt lgkmcnt(5)
  v_mfma_f32_16x16x32_bf16 v[168:171], a[68:71], a[32:35], v[168:171]
  ds_read_b128 a[92:95], v2 offset:15360
  v_add_f32 v7, v7, v181
  v_mfma_f32_16x16x32_bf16 v[172:175], a[68:71], a[36:39], v[172:175]
  v_exp_f32 v183, v183
  s_waitcnt lgkmcnt(5)
  v_mfma_f32_16x16x32_bf16 v[160:163], a[72:75], a[40:43], v[160:163]
  ds_read_b128 a[64:67], v4 offset:0
  v_add_f32 v7, v7, v182
  v_mfma_f32_16x16x32_bf16 v[164:167], a[72:75], a[44:47], v[164:167]
  v_cvt_pk_bf16_f32 v204, v180, v181
  v_exp_f32 v188, v188
  s_waitcnt lgkmcnt(5)
  v_mfma_f32_16x16x32_bf16 v[168:171], a[76:79], a[40:43], v[168:171]
  ds_read_b128 a[68:71], v4 offset:1024
  v_add_f32 v7, v7, v183
  v_mfma_f32_16x16x32_bf16 v[172:175], a[76:79], a[44:47], v[172:175]
  v_exp_f32 v189, v189
  s_waitcnt lgkmcnt(5)
  v_mfma_f32_16x16x32_bf16 v[160:163], a[80:83], a[48:51], v[160:163]
  ds_read_b128 a[72:75], v4 offset:2048
  v_add_f32 v7, v7, v188
  v_cvt_pk_bf16_f32 v205, v182, v183
  v_mfma_f32_16x16x32_bf16 v[164:167], a[80:83], a[52:55], v[164:167]
  v_exp_f32 v190, v190
  s_waitcnt lgkmcnt(5)
  v_mfma_f32_16x16x32_bf16 v[168:171], a[84:87], a[48:51], v[168:171]
  ds_read_b128 a[76:79], v4 offset:3072
  v_add_f32 v7, v7, v189
  v_mfma_f32_16x16x32_bf16 v[172:175], a[84:87], a[52:55], v[172:175]
  v_exp_f32 v191, v191
  s_waitcnt lgkmcnt(5)
  v_mfma_f32_16x16x32_bf16 v[160:163], a[88:91], a[56:59], v[160:163]
  ds_read_b128 a[80:83], v4 offset:4096
  v_add_f32 v7, v7, v190
  v_cvt_pk_bf16_f32 v206, v188, v189
  v_mfma_f32_16x16x32_bf16 v[164:167], a[88:91], a[60:63], v[164:167]
  s_nop 0
  s_waitcnt lgkmcnt(5)
  v_mfma_f32_16x16x32_bf16 v[168:171], a[92:95], a[56:59], v[168:171]
  ds_read_b128 a[84:87], v4 offset:5120
  v_add_f32 v7, v7, v191
  s_add_u32 s34, s34, 0x4000
  s_and_b32 s34, s34, 0xc000
  s_add_u32 s35, s35, 0x4000
  s_add_u32 s36, s36, 0x4000
  v_mfma_f32_16x16x32_bf16 v[172:175], a[92:95], a[60:63], v[172:175]
  v_cvt_pk_bf16_f32 v207, v190, v191
  s_waitcnt vmcnt(12)
  s_barrier
  s_sub_u32 s38, s38, 1
  s_cmp_lg_u32 s38, 0
  s_cbranch_scc1 k2_loop
k2_t0:
  s_cmp_eq_u32 s33, 0
  s_cbranch_scc0 k2_t0_nomask
  s_nop 7
  v_cmp_gt_i32 s[44:45], 0, v12
  v_cmp_gt_i32 s[46:47], 1, v12
  v_cmp_gt_i32 s[48:49], 2, v12
  v_cmp_gt_i32 s[50:51], 3, v12
  v_mov_b32 v27, s42
  v_cndmask_b32 v160, v160, v27, s[44:45]
  v_cndmask_b32 v172, v172, v27, s[44:45]
  v_mov_b32 v168, s42
  v_cndmask_b32 v161, v161, v27, s[46:47]
  v_cndmask_b32 v173, v173, v27, s[46:47]
  v_mov_b32 v169, s42
  v_cndmask_b32 v162, v162, v27, s[48:49]
  v_cndmask_b32 v174, v174, v27, s[48:49]
  v_mov_b32 v170, s42
  v_cndmask_b32 v163, v163, v27, s[50:51]
  v_cndmask_b32 v175, v175, v27, s[50:51]
  v_mov_b32 v171, s42
k2_t0_nomask:
  s_add_u32 s39, s34, 0x4000
  s_and_b32 s39, s39, 0xc000
  v_add_u32 v2, s39, v1
  s_add_u32 s39, s34, 0x10000
  v_add_u32 v3, s39, v1
  s_waitcnt lgkmcnt(5)
  v_mfma_f32_16x16x32_bf16 v[32:35], a[64:67], v[200:203], v[32:35]
  ds_read_b128 a[88:91], v4 offset:6144
  v_mfma_f32_16x16x32_bf16 v[36:39], a[64:67], v[204:207], v[36:39]
  s_add_u32 s39, s34, 0x8000
  s_and_b32 s39, s39, 0xc000
  s_waitcnt lgkmcnt(5)
  v_mfma_f32_16x16x32_bf16 v[40:43], a[68:71], v[200:203], v[40:43]
  ds_read_b128 a[92:95], v4 offset:7168
  v_mfma_f32_16x16x32_bf16 v[44:47], a[68:71], v[204:207], v[44:47]
  s_add_u32 s39, s39, s37
  s_add_u32 m0, s39, 0x10000
  s_waitcnt lgkmcnt(5)
  v_mfma_f32_16x16x32_bf16 v[48:51], a[72:75], v[200:203], v[48:51]
  ds_read_b128 a[64:67], v4 offset:8192
  v_mfma_f32_16x16x32_bf16 v[52:55], a[72:75], v[204:207], v[52:55]
  buffer_load_dwordx4 v5, s[8:11], s36 offen offset:0 sc1 lds
  s_waitcnt lgkmcnt(5)
  v_mfma_f32_16x16x32_bf16 v[56:59], a[76:79], v[200:203], v[56:59]
  ds_read_b128 a[68:71], v4 offset:9216
  v_mfma_f32_16x16x32_bf16 v[60:63], a[76:79], v[204:207], v[60:63]
  buffer_load_dwordx4 v5, s[8:11], s36 offen offset:1024 sc1 lds
  s_waitcnt lgkmcnt(5)
  v_mfma_f32_16x16x32_bf16 v[64:67], a[80:83], v[200:203], v[64:67]
  ds_read_b128 a[72:75], v4 offset:10240
  v_mfma_f32_16x16x32_bf16 v[68:71], a[80:83], v[204:207], v[68:71]
  buffer_load_dwordx4 v5, s[8:11], s36 offen offset:2048 sc1 lds
  s_waitcnt lgkmcnt(5)
  v_mfma_f32_16x16x32_bf16 v[72:75], a[84:87], v[200:203], v[72:75]
  ds_read_b128 a[76:79], v4 offset:11264
  v_mfma_f32_16x16x32_bf16 v[76:79], a[84:87], v[204:207], v[76:79]
  buffer_load_dwordx4 v5, s[8:11], s36 offen offset:3072 sc1 lds
  v_max3_f32 v10, v160, v161, v162
  s_waitcnt lgkmcnt(5)
  v_mfma_f32_16x16x32_bf16 v[80:83], a[88:91], v[200:203], v[80:83]
  ds_read_b128 a[80:83], v4 offset:12288
  v_mfma_f32_16x16x32_bf16 v[84:87], a[88:91], v[204:207], v[84:87]
  v_max3_f32 v10, v10, v163, v164
  s_waitcnt lgkmcnt(5)
  v_mfma_f32_16x16x32_bf16 v[88:91], a[92:95], v[200:203], v[88:91]
  ds_read_b128 a[84:87], v4 offset:13312
  v_mfma_f32_16x16x32_bf16 v[92:95], a[92:95], v[204:207], v[92:95]
  v_max3_f32 v10, v10, v165, v166
  s_waitcnt lgkmcnt(5)
  v_mfma_f32_16x16x32_bf16 v[96:99], a[64:67], v[200:203], v[96:99]
  ds_read_b128 a[88:91], v4 offset:14336
  v_mfma_f32_16x16x32_bf16 v[100:103], a[64:67], v[204:207], v[100:103]
  v_max3_f32 v10, v10, v167, v168
  s_waitcnt lgkmcnt(5)
  v_mfma_f32_16x16x32_bf16 v[104:107], a[68:71], v[200:203], v[104:107]
  ds_read_b128 a[92:95], v4 offset:15360
  v_mfma_f32_16x16x32_bf16 v[108:111], a[68:71], v[204:207], v[108:111]
  v_max3_f32 v10, v10, v169, v170
  s_waitcnt lgkmcnt(5)
  v_mfma_f32_16x16x32_bf16 v[112:115], a[72:75], v[200:203], v[112:115]
  ds_read_b128 a[64:67], v2 offset:0
  v_mfma_f32_16x16x32_bf16 v[116:119], a[72:75], v[204:207], v[116:119]
  v_max3_f32 v10, v10, v171, v172
  s_waitcnt lgkmcnt(5)
  v_mfma_f32_16x16x32_bf16 v[120:123], a[76:79], v[200:203], v[120:123]
  ds_read_b128 a[68:71], v2 offset:1024
  v_mfma_f32_16x16x32_bf16 v[124:127], a[76:79], v[204:207], v[124:127]
  v_max3_f32 v10, v10, v173, v174
  s_waitcnt lgkmcnt(5)
  v_mfma_f32_16x16x32_bf16 v[128:131], a[80:83], v[200:203], v[128:131]
  ds_read_b128 a[72:75], v2 offset:2048
  v_mfma_f32_16x16x32_bf16 v[132:135], a[80:83], v[204:207], v[132:135]
  v_max_f32 v10, v10, v175
  s_waitcnt lgkmcnt(5)
  v_mfma_f32_16x16x32_bf16 v[136:139], a[84:87], v[200:203], v[136:139]
  ds_read_b128 a[76:79], v2 offset:3072
  v_mfma_f32_16x16x32_bf16 v[140:143], a[84:87], v[204:207], v[140:143]
  v_cmp_lt_f32 vcc, s41, v10
  s_waitcnt lgkmcnt(5)
  v_mfma_f32_16x16x32_bf16 v[144:147], a[88:91], v[200:203], v[144:147]
  ds_read_b128 a[80:83], v2 offset:4096
  v_mfma_f32_16x16x32_bf16 v[148:151], a[88:91], v[204:207], v[148:151]
  s_waitcnt lgkmcnt(5)
  v_mfma_f32_16x16x32_bf16 v[152:155], a[92:95], v[200:203], v[152:155]
  ds_read_b128 a[84:87], v2 offset:5120
  v_mfma_f32_16x16x32_bf16 v[156:159], a[92:95], v[204:207], v[156:159]
  s_cbranch_vccnz k2_t0_slow
k2_t0_back:
k2_tmid:
  s_waitcnt lgkmcnt(5)
  v_mfma_f32_16x16x32_bf16 v[176:179], a[64:67], a[0:3], v[208:211]
  ds_read_b128 a[88:91], v2 offset:6144
  v_exp_f32 v160, v160
  v_exp_f32 v161, v161
  v_mfma_f32_16x16x32_bf16 v[180:183], a[64:67], a[4:7], v[212:215]
  v_add_f32 v6, v6, v160
  s_waitcnt lgkmcnt(5)
  v_mfma_f32_16x16x32_bf16 v[184:187], a[68:71], a[0:3], v[208:211]
  ds_read_b128 a[92:95], v2 offset:7168
  v_exp_f32 v162, v162
  v_mfma_f32_16x16x32_bf16 v[188:191], a[68:71], a[4:7], v[212:215]
  v_add_f32 v6, v6, v161
  v_exp_f32 v163, v163
  s_waitcnt lgkmcnt(5)
  v_mfma_f32_16x16x32_bf16 v[176:179], a[72:75], a[8:11], v[176:179]
  ds_read_b128 a[64:67], v2 offset:8192
  v_add_f32 v6, v6, v162
  v_mfma_f32_16x16x32_bf16 v[180:183], a[72:75], a[12:15], v[180:183]
  v_cvt_pk_bf16_f32 v192, v160, v161
  s_waitcnt lgkmcnt(5)
  v_mfma_f32_16x16x32_bf16 v[184:187], a[76:79], a[8:11], v[184:187]
  ds_read_b128 a[68:71], v2 offset:9216
  v_exp_f32 v168, v168
  v_mfma_f32_16x16x32_bf16 v[188:191], a[76:79], a[12:15], v[188:191]
  v_add_f32 v6, v6, v163
  v_exp_f32 v169, v169
  s_waitcnt lgkmcnt(5)
  v_mfma_f32_16x16x32_bf16 v[176:179], a[80:83], a[16:19], v[176:179]
  ds_read_b128 a[72:75], v2 offset:10240
  v_add_f32 v6, v6, v168
  v_mfma_f32_16x16x32_bf16 v[180:183], a[80:83], a[20:23], v[180:183]
  v_cvt_pk_bf16_f32 v193, v162, v163
  s_waitcnt lgkmcnt(5)
  v_mfma_f32_16x16x32_bf16 v[184:187], a[84:87], a[16:19], v[184:187]
  ds_read_b128 a[76:79], v2 offset:11264
  v_exp_f32 v170, v170
  v_add_f32 v6, v6, v169
  v_mfma_f32_16x16x32_bf16 v[188:191], a[84:87], a[20:23], v[188:191]
  v_exp_f32 v171, v171
  s_waitcnt lgkmcnt(5)
  v_mfma_f32_16x16x32_bf16 v[176:179], a[88:91], a[24:27], v[176:179]
  ds_read_b128 a[80:83], v2 offset:12288
  v_add_f32 v6, v6, v170
  v_mfma_f32_16x16x32_bf16 v[180:183], a[88:91], a[28:31], v[180:183]
  v_cvt_pk_bf16_f32 v194, v168, v169
  s_waitcnt lgkmcnt(5)
  v_mfma_f32_16x16x32_bf16 v[184:187], a[92:95], a[24:27], v[184:187]
  ds_read_b128 a[84:87], v2 offset:13312
  v_exp_f32 v164, v164
  v_add_f32 v6, v6, v171
  v_mfma_f32_16x16x32_bf16 v[188:191], a[92:95], a[28:31], v[188:191]
  v_exp_f32 v165, v165
  s_waitcnt lgkmcnt(5)
  v_mfma_f32_16x16x32_bf16 v[176:179], a[64:67], a[32:35], v[176:179]
  ds_read_b128 a[88:91], v2 offset:14336
  v_add_f32 v7, v7, v164
  v_mfma_f32_16x16x32_bf16 v[180:183], a[64:67], a[36:39], v[180:183]
  v_cvt_pk_bf16_f32 v195, v170, v171
  v_exp_f32 v166, v166
  s_waitcnt lgkmcnt(5)
  v_mfma_f32_16x16x32_bf16 v[184:187], a[68:71], a[32:35], v[184:187]
  ds_read_b128 a[92:95], v2 offset:15360
  v_add_f32 v7, v7, v165
  v_mfma_f32_16x16x32_bf16 v[188:191], a[68:71], a[36:39], v[188:191]
  v_exp_f32 v167, v167
  s_waitcnt lgkmcnt(5)
  v_mfma_f32_16x16x32_bf16 v[176:179], a[72:75], a[40:43], v[176:179]
  ds_read_b128 a[64:67], v3 offset:0
  v_add_f32 v7, v7, v166
  v_mfma_f32_16x16x32_bf16 v[180:183], a[72:75], a[44:47], v[180:183]
  v_cvt_pk_bf16_f32 v196, v164, v165
  v_exp_f32 v172, v172
  s_waitcnt lgkmcnt(5)
  v_mfma_f32_16x16x32_bf16 v[184:187], a[76:79], a[40:43], v[184:187]
  ds_read_b128 a[68:71], v3 offset:1024
  v_add_f32 v7, v7, v167
  v_mfma_f32_16x16x32_bf16 v[188:191], a[76:79], a[44:47], v[188:191]
  v_exp_f32 v173, v173
  s_waitcnt lgkmcnt(5)
  v_mfma_f32_16x16x32_bf16 v[176:179], a[80:83], a[48:51], v[176:179]
  ds_read_b128 a[72:75], v3 offset:2048
  v_add_f32 v7, v7, v172
  v_cvt_pk_bf16_f32 v197, v166, v167
  v_mfma_f32_16x16x32_bf16 v[180:183], a[80:83], a[52:55], v[180:183]
  v_exp_f32 v174, v174
  s_waitcnt lgkmcnt(5)
  v_mfma_f32_16x16x32_bf16 v[184:187], a[84:87], a[48:51], v[184:187]
  ds_read_b128 a[76:79], v3 offset:3072
  v_add_f32 v7, v7, v173
  v_mfma_f32_16x16x32_bf16 v[188:191], a[84:87], a[52:55], v[188:191]
  v_exp_f32 v175, v175
  s_waitcnt lgkmcnt(5)
  v_mfma_f32_16x16x32_bf16 v[176:179], a[88:91], a[56:59], v[176:179]
  ds_read_b128 a[80:83], v3 offset:4096
  v_add_f32 v7, v7, v174
  v_cvt_pk_bf16_f32 v198, v172, v173
  v_mfma_f32_16x16x32_bf16 v[180:183], a[88:91], a[60:63], v[180:183]
  s_nop 0
  s_waitcnt lgkmcnt(5)
  v_mfma_f32_16x16x32_bf16 v[184:187], a[92:95], a[56:59], v[184:187]
  ds_read_b128 a[84:87], v3 offset:5120
  v_add_f32 v7, v7, v175
  s_add_u32 s34, s34, 0x4000
  s_and_b32 s34, s34, 0xc000
  s_add_u32 s35, s35, 0x4000
  s_add_u32 s36, s36, 0x4000
  v_mfma_f32_16x16x32_bf16 v[188:191], a[92:95], a[60:63], v[188:191]
  v_cvt_pk_bf16_f32 v199, v174, v175
  s_waitcnt vmcnt(8)
  s_barrier
k2_t1:
  s_cmp_ge_u32 s43, 3
  s_cbranch_scc1 k2_t1_nowo
  s_bitcmp1_b32 s32, 1
  s_cbranch_scc1 k2_t1_wo2
  s_add_u32 m0, s40, 0
  s_mov_b32 s62, 0
  buffer_load_dwordx4 v21, s[16:19], s62 offen offset:0 lds
  buffer_load_dwordx4 v22, s[16:19], s62 offen offset:1024 lds
  buffer_load_dwordx4 v23, s[16:19], s62 offen offset:2048 lds
  buffer_load_dwordx4 v24, s[16:19], s62 offen offset:3072 lds
  s_add_u32 m0, s40, 4096
  s_mov_b32 s62, 28672
  buffer_load_dwordx4 v21, s[16:19], s62 offen offset:0 lds
  buffer_load_dwordx4 v22, s[16:19], s62 offen offset:1024 lds
  buffer_load_dwordx4 v23, s[16:19], s62 offen offset:2048 lds
  buffer_load_dwordx4 v24, s[16:19], s62 offen offset:3072 lds
  s_branch k2_t1_nowo
k2_t1_wo2:
  s_add_u32 m0, s40, 32768
  s_mov_b32 s62, 128
  buffer_load_dwordx4 v21, s[16:19], s62 offen offset:0 lds
  buffer_load_dwordx4 v22, s[16:19], s62 offen offset:1024 lds
  buffer_load_dwordx4 v23, s[16:19], s62 offen offset:2048 lds
  buffer_load_dwordx4 v24, s[16:19], s62 offen offset:3072 lds
  s_add_u32 m0, s40, 36864
  s_mov_b32 s62, 28800
  buffer_load_dwordx4 v21, s[16:19], s62 offen offset:0 lds
  buffer_load_dwordx4 v22, s[16:19], s62 offen offset:1024 lds
  buffer_load_dwordx4 v23, s[16:19], s62 offen offset:2048 lds
  buffer_load_dwordx4 v24, s[16:19], s62 offen offset:3072 lds
k2_t1_nowo:
  s_cmp_ge_u32 s33, 1
  s_cbranch_scc0 k2_t1_part
  s_cmp_eq_u32 s33, 1
  s_cbranch_scc0 k2_t1_nomask
  s_nop 7
  v_cmp_gt_i32 s[44:45], 0, v12
  v_cmp_gt_i32 s[46:47], 1, v12
  v_cmp_gt_i32 s[48:49], 2, v12
  v_cmp_gt_i32 s[50:51], 3, v12
  v_mov_b32 v27, s42
  v_cndmask_b32 v176, v176, v27, s[44:45]
  v_cndmask_b32 v188, v188, v27, s[44:45]
  v_mov_b32 v184, s42
  v_cndmask_b32 v177, v177, v27, s[46:47]
  v_cndmask_b32 v189, v189, v27, s[46:47]
  v_mov_b32 v185, s42
  v_cndmask_b32 v178, v178, v27, s[48:49]
  v_cndmask_b32 v190, v190, v27, s[48:49]
  v_mov_b32 v186, s42
  v_cndmask_b32 v179, v179, v27, s[50:51]
  v_cndmask_b32 v191, v191, v27, s[50:51]
  v_mov_b32 v187, s42
k2_t1_nomask:
  s_add_u32 s39, s34, 0x4000
  s_and_b32 s39, s39, 0xc000
  v_add_u32 v2, s39, v1
  s_add_u32 s39, s34, 0x10000
  v_add_u32 v4, s39, v1
  s_waitcnt lgkmcnt(5)
  v_mfma_f32_16x16x32_bf16 v[32:35], a[64:67], v[192:195], v[32:35]
  ds_read_b128 a[88:91], v3 offset:6144
  v_mfma_f32_16x16x32_bf16 v[36:39], a[64:67], v[196:199], v[36:39]
  s_add_u32 s39, s34, 0x8000
  s_and_b32 s39, s39, 0xc000
  s_waitcnt lgkmcnt(5)
  v_mfma_f32_16x16x32_bf16 v[40:43], a[68:71], v[192:195], v[40:43]
  ds_read_b128 a[92:95], v3 offset:7168
  v_mfma_f32_16x16x32_bf16 v[44:47], a[68:71], v[196:199], v[44:47]
  s_add_u32 s39, s39, s37
  s_add_u32 m0, s39, 0x10000
  s_waitcnt lgkmcnt(5)
  v_mfma_f32_16x16x32_bf16 v[48:51], a[72:75], v[192:195], v[48:51]
  ds_read_b128 a[64:67], v3 offset:8192
  v_mfma_f32_16x16x32_bf16 v[52:55], a[72:75], v[196:199], v[52:55]
  buffer_load_dwordx4 v5, s[8:11], s36 offen offset:0 sc1 lds
  s_waitcnt lgkmcnt(5)
  v_mfma_f32_16x16x32_bf16 v[56:59], a[76:79], v[192:195], v[56:59]
  ds_read_b128 a[68:71], v3 offset:9216
  v_mfma_f32_16x16x32_bf16 v[60:63], a[76:79], v[196:199], v[60:63]
  buffer_load_dwordx4 v5, s[8:11], s36 offen offset:1024 sc1 lds
  s_waitcnt lgkmcnt(5)
  v_mfma_f32_16x16x32_bf16 v[64:67], a[80:83], v[192:195], v[64:67]
  ds_read_b128 a[72:75], v3 offset:10240
  v_mfma_f32_16x16x32_bf16 v[68:71], a[80:83], v[196:199], v[68:71]
  buffer_load_dwordx4 v5, s[8:11], s36 offen offset:2048 sc1 lds
  s_waitcnt lgkmcnt(5)
  v_mfma_f32_16x16x32_bf16 v[72:75], a[84:87], v[192:195], v[72:75]
  ds_read_b128 a[76:79], v3 offset:11264
  v_mfma_f32_16x16x32_bf16 v[76:79], a[84:87], v[196:199], v[76:79]
  buffer_load_dwordx4 v5, s[8:11], s36 offen offset:3072 sc1 lds
  v_max3_f32 v10, v176, v177, v178
  s_waitcnt lgkmcnt(5)
  v_mfma_f32_16x16x32_bf16 v[80:83], a[88:91], v[192:195], v[80:83]
  ds_read_b128 a[80:83], v3 offset:12288
  v_mfma_f32_16x16x32_bf16 v[84:87], a[88:91], v[196:199], v[84:87]
  v_max3_f32 v10, v10, v179, v180
  s_waitcnt lgkmcnt(5)
  v_mfma_f32_16x16x32_bf16 v[88:91], a[92:95], v[192:195], v[88:91]
  ds_read_b128 a[84:87], v3 offset:13312
  v_mfma_f32_16x16x32_bf16 v[92:95], a[92:95], v[196:199], v[92:95]
  v_max3_f32 v10, v10, v181, v182
  s_waitcnt lgkmcnt(5)
  v_mfma_f32_16x16x32_bf16 v[96:99], a[64:67], v[192:195], v[96:99]
  ds_read_b128 a[88:91], v3 offset:14336
  v_mfma_f32_16x16x32_bf16 v[100:103], a[64:67], v[196:199], v[100:103]
  v_max3_f32 v10, v10, v183, v184
  s_waitcnt lgkmcnt(5)
  v_mfma_f32_16x16x32_bf16 v[104:107], a[68:71], v[192:195], v[104:107]
  ds_read_b128 a[92:95], v3 offset:15360
  v_mfma_f32_16x16x32_bf16 v[108:111], a[68:71], v[196:199], v[108:111]
  v_max3_f32 v10, v10, v185, v186
  s_waitcnt lgkmcnt(5)
  v_mfma_f32_16x16x32_bf16 v[112:115], a[72:75], v[192:195], v[112:115]
  ds_read_b128 a[64:67], v2 offset:0
  v_mfma_f32_16x16x32_bf16 v[116:119], a[72:75], v[196:199], v[116:119]
  v_max3_f32 v10, v10, v187, v188
  s_waitcnt lgkmcnt(5)
  v_mfma_f32_16x16x32_bf16 v[120:123], a[76:79], v[192:195], v[120:123]
  ds_read_b128 a[68:71], v2 offset:1024
  v_mfma_f32_16x16x32_bf16 v[124:127], a[76:79], v[196:199], v[124:127]
  v_max3_f32 v10, v10, v189, v190
  s_waitcnt lgkmcnt(5)
  v_mfma_f32_16x16x32_bf16 v[128:131], a[80:83], v[192:195], v[128:131]
  ds_read_b128 a[72:75], v2 offset:2048
  v_mfma_f32_16x16x32_bf16 v[132:135], a[80:83], v[196:199], v[132:135]
  v_max_f32 v10, v10, v191
  s_waitcnt lgkmcnt(5)
  v_mfma_f32_16x16x32_bf16 v[136:139], a[84:87], v[192:195], v[136:139]
  ds_read_b128 a[76:79], v2 offset:3072
  v_mfma_f32_16x16x32_bf16 v[140:143], a[84:87], v[196:199], v[140:143]
  v_cmp_lt_f32 vcc, s41, v10
  s_waitcnt lgkmcnt(5)
  v_mfma_f32_16x16x32_bf16 v[144:147], a[88:91], v[192:195], v[144:147]
  ds_read_b128 a[80:83], v2 offset:4096
  v_mfma_f32_16x16x32_bf16 v[148:151], a[88:91], v[196:199], v[148:151]
  s_waitcnt lgkmcnt(5)
  v_mfma_f32_16x16x32_bf16 v[152:155], a[92:95], v[192:195], v[152:155]
  ds_read_b128 a[84:87], v2 offset:5120
  v_mfma_f32_16x16x32_bf16 v[156:159], a[92:95], v[196:199], v[156:159]
  s_cbranch_vccnz k2_t1_slow
k2_t1_back:
  s_waitcnt lgkmcnt(5)
  v_mfma_f32_16x16x32_bf16 v[160:163], a[64:67], a[0:3], v[208:211]
  ds_read_b128 a[88:91], v2 offset:6144
  v_exp_f32 v176, v176
  v_exp_f32 v177, v177
  v_mfma_f32_16x16x32_bf16 v[164:167], a[64:67], a[4:7], v[212:215]
  v_add_f32 v6, v6, v176
  s_waitcnt lgkmcnt(5)
  v_mfma_f32_16x16x32_bf16 v[168:171], a[68:71], a[0:3], v[208:211]
  ds_read_b128 a[92:95], v2 offset:7168
  v_exp_f32 v178, v178
  v_mfma_f32_16x16x32_bf16 v[172:175], a[68:71], a[4:7], v[212:215]
  v_add_f32 v6, v6, v177
  v_exp_f32 v179, v179
  s_waitcnt lgkmcnt(5)
  v_mfma_f32_16x16x32_bf16 v[160:163], a[72:75], a[8:11], v[160:163]
  ds_read_b128 a[64:67], v2 offset:8192
  v_add_f32 v6, v6, v178
  v_mfma_f32_16x16x32_bf16 v[164:167], a[72:75], a[12:15], v[164:167]
  v_cvt_pk_bf16_f32 v200, v176, v177
  s_waitcnt lgkmcnt(5)
  v_mfma_f32_16x16x32_bf16 v[168:171], a[76:79], a[8:11], v[168:171]
  ds_read_b128 a[68:71], v2 offset:9216
  v_exp_f32 v184, v184
  v_mfma_f32_16x16x32_bf16 v[172:175], a[76:79], a[12:15], v[172:175]
  v_add_f32 v6, v6, v179
  v_exp_f32 v185, v185
  s_waitcnt lgkmcnt(5)
  v_mfma_f32_16x16x32_bf16 v[160:163], a[80:83], a[16:19], v[160:163]
  ds_read_b128 a[72:75], v2 offset:10240
  v_add_f32 v6, v6, v184
  v_mfma_f32_16x16x32_bf16 v[164:167], a[80:83], a[20:23], v[164:167]
  v_cvt_pk_bf16_f32 v201, v178, v179
  s_waitcnt lgkmcnt(5)
  v_mfma_f32_16x16x32_bf16 v[168:171], a[84:87], a[16:19], v[168:171]
  ds_read_b128 a[76:79], v2 offset:11264
  v_exp_f32 v186, v186
  v_add_f32 v6, v6, v185
  v_mfma_f32_16x16x32_bf16 v[172:175], a[84:87], a[20:23], v[172:175]
  v_exp_f32 v187, v187
  s_waitcnt lgkmcnt(5)
  v_mfma_f32_16x16x32_bf16 v[160:163], a[88:91], a[24:27], v[160:163]
  ds_read_b128 a[80:83], v2 offset:12288
  v_add_f32 v6, v6, v186
  v_mfma_f32_16x16x32_bf16 v[164:167], a[88:91], a[28:31], v[164:167]
  v_cvt_pk_bf16_f32 v202, v184, v185
  s_waitcnt lgkmcnt(5)
  v_mfma_f32_16x16x32_bf16 v[168:171], a[92:95], a[24:27], v[168:171]
  ds_read_b128 a[84:87], v2 offset:13312
  v_exp_f32 v180, v180
  v_add_f32 v6, v6, v187
  v_mfma_f32_16x16x32_bf16 v[172:175], a[92:95], a[28:31], v[172:175]
  v_exp_f32 v181, v181
  s_waitcnt lgkmcnt(5)
  v_mfma_f32_16x16x32_bf16 v[160:163], a[64:67], a[32:35], v[160:163]
  ds_read_b128 a[88:91], v2 offset:14336
  v_add_f32 v7, v7, v180
  v_mfma_f32_16x16x32_bf16 v[164:167], a[64:67], a[36:39], v[164:167]
  v_cvt_pk_bf16_f32 v203, v186, v187
  v_exp_f32 v182, v182
  s_waitcnt lgkmcnt(5)
  v_mfma_f32_16x16x32_bf16 v[168:171], a[68:71], a[32:35], v[168:171]
  ds_read_b128 a[92:95], v2 offset:15360
  v_add_f32 v7, v7, v181
  v_mfma_f32_16x16x32_bf16 v[172:175], a[68:71], a[36:39], v[172:175]
  v_exp_f32 v183, v183
  s_waitcnt lgkmcnt(5)
  v_mfma_f32_16x16x32_bf16 v[160:163], a[72:75], a[40:43], v[160:163]
  ds_read_b128 a[64:67], v4 offset:0
  v_add_f32 v7, v7, v182
  v_mfma_f32_16x16x32_bf16 v[164:167], a[72:75], a[44:47], v[164:167]
  v_cvt_pk_bf16_f32 v204, v180, v181
  v_exp_f32 v188, v188
  s_waitcnt lgkmcnt(5)
  v_mfma_f32_16x16x32_bf16 v[168:171], a[76:79], a[40:43], v[168:171]
  ds_read_b128 a[68:71], v4 offset:1024
  v_add_f32 v7, v7, v183
  v_mfma_f32_16x16x32_bf16 v[172:175], a[76:79], a[44:47], v[172:175]
  v_exp_f32 v189, v189
  s_waitcnt lgkmcnt(5)
  v_mfma_f32_16x16x32_bf16 v[160:163], a[80:83], a[48:51], v[160:163]
  ds_read_b128 a[72:75], v4 offset:2048
  v_add_f32 v7, v7, v188
  v_cvt_pk_bf16_f32 v205, v182, v183
  v_mfma_f32_16x16x32_bf16 v[164:167], a[80:83], a[52:55], v[164:167]
  v_exp_f32 v190, v190
  s_waitcnt lgkmcnt(5)
  v_mfma_f32_16x16x32_bf16 v[168:171], a[84:87], a[48:51], v[168:171]
  ds_read_b128 a[76:79], v4 offset:3072
  v_add_f32 v7, v7, v189
  v_mfma_f32_16x16x32_bf16 v[172:175], a[84:87], a[52:55], v[172:175]
  v_exp_f32 v191, v191
  s_waitcnt lgkmcnt(5)
  v_mfma_f32_16x16x32_bf16 v[160:163], a[88:91], a[56:59], v[160:163]
  ds_read_b128 a[80:83], v4 offset:4096
  v_add_f32 v7, v7, v190
  v_cvt_pk_bf16_f32 v206, v188, v189
  v_mfma_f32_16x16x32_bf16 v[164:167], a[88:91], a[60:63], v[164:167]
  s_nop 0
  s_waitcnt lgkmcnt(5)
  v_mfma_f32_16x16x32_bf16 v[168:171], a[92:95], a[56:59], v[168:171]
  ds_read_b128 a[84:87], v4 offset:5120
  v_add_f32 v7, v7, v191
  s_add_u32 s34, s34, 0x4000
  s_and_b32 s34, s34, 0xc000
  s_add_u32 s35, s35, 0x4000
  s_add_u32 s36, s36, 0x4000
  v_mfma_f32_16x16x32_bf16 v[172:175], a[92:95], a[60:63], v[172:175]
  v_cvt_pk_bf16_f32 v207, v190, v191
  s_branch k2_t1_done
k2_t1_part:
  s_add_u32 s39, s34, 0x8000
  s_and_b32 s39, s39, 0xc000
  s_add_u32 s39, s39, s37
  s_add_u32 m0, s39, 0x10000
  s_nop 0
  buffer_load_dwordx4 v5, s[8:11], s36 offen offset:0 sc1 lds
  buffer_load_dwordx4 v5, s[8:11], s36 offen offset:1024 sc1 lds
  buffer_load_dwordx4 v5, s[8:11], s36 offen offset:2048 sc1 lds
  buffer_load_dwordx4 v5, s[8:11], s36 offen offset:3072 sc1 lds
  s_cmp_eq_u32 s33, 0
  s_cbranch_scc0 k2_t1_none
  s_waitcnt lgkmcnt(5)
  v_mfma_f32_16x16x32_bf16 v[32:35], a[64:67], v[192:195], v[32:35]
  ds_read_b128 a[88:91], v3 offset:6144
  v_mfma_f32_16x16x32_bf16 v[36:39], a[64:67], v[196:199], v[36:39]
  s_waitcnt lgkmcnt(5)
  v_mfma_f32_16x16x32_bf16 v[40:43], a[68:71], v[192:195], v[40:43]
  ds_read_b128 a[92:95], v3 offset:7168
  v_mfma_f32_16x16x32_bf16 v[44:47], a[68:71], v[196:199], v[44:47]
  s_waitcnt lgkmcnt(5)
  v_mfma_f32_16x16x32_bf16 v[48:51], a[72:75], v[192:195], v[48:51]
  ds_read_b128 a[64:67], v3 offset:8192
  v_mfma_f32_16x16x32_bf16 v[52:55], a[72:75], v[196:199], v[52:55]
  s_waitcnt lgkmcnt(5)
  v_mfma_f32_16x16x32_bf16 v[56:59], a[76:79], v[192:195], v[56:59]
  ds_read_b128 a[68:71], v3 offset:9216
  v_mfma_f32_16x16x32_bf16 v[60:63], a[76:79], v[196:199], v[60:63]
  s_waitcnt lgkmcnt(5)
  v_mfma_f32_16x16x32_bf16 v[64:67], a[80:83], v[192:195], v[64:67]
  ds_read_b128 a[72:75], v3 offset:10240
  v_mfma_f32_16x16x32_bf16 v[68:71], a[80:83], v[196:199], v[68:71]
  s_waitcnt lgkmcnt(5)
  v_mfma_f32_16x16x32_bf16 v[72:75], a[84:87], v[192:195], v[72:75]
  ds_read_b128 a[76:79], v3 offset:11264
  v_mfma_f32_16x16x32_bf16 v[76:79], a[84:87], v[196:199], v[76:79]
  s_waitcnt lgkmcnt(5)
  v_mfma_f32_16x16x32_bf16 v[80:83], a[88:91], v[192:195], v[80:83]
  ds_read_b128 a[80:83], v3 offset:12288
  v_mfma_f32_16x16x32_bf16 v[84:87], a[88:91], v[196:199], v[84:87]
  s_waitcnt lgkmcnt(5)
  v_mfma_f32_16x16x32_bf16 v[88:91], a[92:95], v[192:195], v[88:91]
  ds_read_b128 a[84:87], v3 offset:13312
  v_mfma_f32_16x16x32_bf16 v[92:95], a[92:95], v[196:199], v[92:95]
  s_waitcnt lgkmcnt(5)
  v_mfma_f32_16x16x32_bf16 v[96:99], a[64:67], v[192:195], v[96:99]
  ds_read_b128 a[88:91], v3 offset:14336
  v_mfma_f32_16x16x32_bf16 v[100:103], a[64:67], v[196:199], v[100:103]
  s_waitcnt lgkmcnt(5)
  v_mfma_f32_16x16x32_bf16 v[104:107], a[68:71], v[192:195], v[104:107]
  ds_read_b128 a[92:95], v3 offset:15360
  v_mfma_f32_16x16x32_bf16 v[108:111], a[68:71], v[196:199], v[108:111]
  s_waitcnt lgkmcnt(5)
  v_mfma_f32_16x16x32_bf16 v[112:115], a[72:75], v[192:195], v[112:115]
  v_mfma_f32_16x16x32_bf16 v[116:119], a[72:75], v[196:199], v[116:119]
  s_waitcnt lgkmcnt(4)
  v_mfma_f32_16x16x32_bf16 v[120:123], a[76:79], v[192:195], v[120:123]
  v_mfma_f32_16x16x32_bf16 v[124:127], a[76:79], v[196:199], v[124:127]
  s_waitcnt lgkmcnt(3)
  v_mfma_f32_16x16x32_bf16 v[128:131], a[80:83], v[192:195], v[128:131]
  v_mfma_f32_16x16x32_bf16 v[132:135], a[80:83], v[196:199], v[132:135]
  s_waitcnt lgkmcnt(2)
  v_mfma_f32_16x16x32_bf16 v[136:139], a[84:87], v[192:195], v[136:139]
  v_mfma_f32_16x16x32_bf16 v[140:143], a[84:87], v[196:199], v[140:143]
  s_waitcnt lgkmcnt(1)
  v_mfma_f32_16x16x32_bf16 v[144:147], a[88:91], v[192:195], v[144:147]
  v_mfma_f32_16x16x32_bf16 v[148:151], a[88:91], v[196:199], v[148:151]
  s_waitcnt lgkmcnt(0)
  v_mfma_f32_16x16x32_bf16 v[152:155], a[92:95], v[192:195], v[152:155]
  v_mfma_f32_16x16x32_bf16 v[156:159], a[92:95], v[196:199], v[156:159]
k2_t1_none:
  s_add_u32 s34, s34, 0x4000
  s_and_b32 s34, s34, 0xc000
  s_add_u32 s35, s35, 0x4000
  s_add_u32 s36, s36, 0x4000
k2_t1_done:
  s_cmp_ge_u32 s43, 3
  s_cbranch_scc1 k2_t1_w4
  s_waitcnt vmcnt(12)
  s_branch k2_t1_wd
k2_t1_w4:
  s_waitcnt vmcnt(4)
k2_t1_wd:
  s_barrier
k2_t2:
  s_cmp_ge_u32 s33, 2
  s_cbranch_scc0 k2_t2_part
  s_cmp_eq_u32 s33, 2
  s_cbranch_scc0 k2_t2_nomask
  s_nop 7
  v_cmp_gt_i32 s[44:45], 0, v12
  v_cmp_gt_i32 s[46:47], 1, v12
  v_cmp_gt_i32 s[48:49], 2, v12
  v_cmp_gt_i32 s[50:51], 3, v12
  v_mov_b32 v27, s42
  v_cndmask_b32 v160, v160, v27, s[44:45]
  v_cndmask_b32 v172, v172, v27, s[44:45]
  v_mov_b32 v168, s42
  v_cndmask_b32 v161, v161, v27, s[46:47]
  v_cndmask_b32 v173, v173, v27, s[46:47]
  v_mov_b32 v169, s42
  v_cndmask_b32 v162, v162, v27, s[48:49]
  v_cndmask_b32 v174, v174, v27, s[48:49]
  v_mov_b32 v170, s42
  v_cndmask_b32 v163, v163, v27, s[50:51]
  v_cndmask_b32 v175, v175, v27, s[50:51]
  v_mov_b32 v171, s42
k2_t2_nomask:
  s_add_u32 s39, s34, 0x4000
  s_and_b32 s39, s39, 0xc000
  v_add_u32 v2, s39, v1
  s_add_u32 s39, s34, 0x10000
  v_add_u32 v3, s39, v1
  s_waitcnt lgkmcnt(5)
  v_mfma_f32_16x16x32_bf16 v[32:35], a[64:67], v[200:203], v[32:35]
  ds_read_b128 a[88:91], v4 offset:6144
  v_mfma_f32_16x16x32_bf16 v[36:39], a[64:67], v[204:207], v[36:39]
  s_waitcnt lgkmcnt(5)
  v_mfma_f32_16x16x32_bf16 v[40:43], a[68:71], v[200:203], v[40:43]
  ds_read_b128 a[92:95], v4 offset:7168
  v_mfma_f32_16x16x32_bf16 v[44:47], a[68:71], v[204:207], v[44:47]
  s_waitcnt lgkmcnt(5)
  v_mfma_f32_16x16x32_bf16 v[48:51], a[72:75], v[200:203], v[48:51]
  ds_read_b128 a[64:67], v4 offset:8192
  v_mfma_f32_16x16x32_bf16 v[52:55], a[72:75], v[204:207], v[52:55]
  s_waitcnt lgkmcnt(5)
  v_mfma_f32_16x16x32_bf16 v[56:59], a[76:79], v[200:203], v[56:59]
  ds_read_b128 a[68:71], v4 offset:9216
  v_mfma_f32_16x16x32_bf16 v[60:63], a[76:79], v[204:207], v[60:63]
  s_waitcnt lgkmcnt(5)
  v_mfma_f32_16x16x32_bf16 v[64:67], a[80:83], v[200:203], v[64:67]
  ds_read_b128 a[72:75], v4 offset:10240
  v_mfma_f32_16x16x32_bf16 v[68:71], a[80:83], v[204:207], v[68:71]
  s_waitcnt lgkmcnt(5)
  v_mfma_f32_16x16x32_bf16 v[72:75], a[84:87], v[200:203], v[72:75]
  ds_read_b128 a[76:79], v4 offset:11264
  v_mfma_f32_16x16x32_bf16 v[76:79], a[84:87], v[204:207], v[76:79]
  v_max3_f32 v10, v160, v161, v162
  s_waitcnt lgkmcnt(5)
  v_mfma_f32_16x16x32_bf16 v[80:83], a[88:91], v[200:203], v[80:83]
  ds_read_b128 a[80:83], v4 offset:12288
  v_mfma_f32_16x16x32_bf16 v[84:87], a[88:91], v[204:207], v[84:87]
  v_max3_f32 v10, v10, v163, v164
  s_waitcnt lgkmcnt(5)
  v_mfma_f32_16x16x32_bf16 v[88:91], a[92:95], v[200:203], v[88:91]
  ds_read_b128 a[84:87], v4 offset:13312
  v_mfma_f32_16x16x32_bf16 v[92:95], a[92:95], v[204:207], v[92:95]
  v_max3_f32 v10, v10, v165, v166
  s_waitcnt lgkmcnt(5)
  v_mfma_f32_16x16x32_bf16 v[96:99], a[64:67], v[200:203], v[96:99]
  ds_read_b128 a[88:91], v4 offset:14336
  v_mfma_f32_16x16x32_bf16 v[100:103], a[64:67], v[204:207], v[100:103]
  v_max3_f32 v10, v10, v167, v168
  s_waitcnt lgkmcnt(5)
  v_mfma_f32_16x16x32_bf16 v[104:107], a[68:71], v[200:203], v[104:107]
  ds_read_b128 a[92:95], v4 offset:15360
  v_mfma_f32_16x16x32_bf16 v[108:111], a[68:71], v[204:207], v[108:111]
  v_max3_f32 v10, v10, v169, v170
  s_waitcnt lgkmcnt(5)
  v_mfma_f32_16x16x32_bf16 v[112:115], a[72:75], v[200:203], v[112:115]
  ds_read_b128 a[64:67], v2 offset:0
  v_mfma_f32_16x16x32_bf16 v[116:119], a[72:75], v[204:207], v[116:119]
  v_max3_f32 v10, v10, v171, v172
  s_waitcnt lgkmcnt(5)
  v_mfma_f32_16x16x32_bf16 v[120:123], a[76:79], v[200:203], v[120:123]
  ds_read_b128 a[68:71], v2 offset:1024
  v_mfma_f32_16x16x32_bf16 v[124:127], a[76:79], v[204:207], v[124:127]
  v_max3_f32 v10, v10, v173, v174
  s_waitcnt lgkmcnt(5)
  v_mfma_f32_16x16x32_bf16 v[128:131], a[80:83], v[200:203], v[128:131]
  ds_read_b128 a[72:75], v2 offset:2048
  v_mfma_f32_16x16x32_bf16 v[132:135], a[80:83], v[204:207], v[132:135]
  v_max_f32 v10, v10, v175
  s_waitcnt lgkmcnt(5)
  v_mfma_f32_16x16x32_bf16 v[136:139], a[84:87], v[200:203], v[136:139]
  ds_read_b128 a[76:79], v2 offset:3072
  v_mfma_f32_16x16x32_bf16 v[140:143], a[84:87], v[204:207], v[140:143]
  v_cmp_lt_f32 vcc, s41, v10
  s_waitcnt lgkmcnt(5)
  v_mfma_f32_16x16x32_bf16 v[144:147], a[88:91], v[200:203], v[144:147]
  ds_read_b128 a[80:83], v2 offset:4096
  v_mfma_f32_16x16x32_bf16 v[148:151], a[88:91], v[204:207], v[148:151]
  s_waitcnt lgkmcnt(5)
  v_mfma_f32_16x16x32_bf16 v[152:155], a[92:95], v[200:203], v[152:155]
  ds_read_b128 a[84:87], v2 offset:5120
  v_mfma_f32_16x16x32_bf16 v[156:159], a[92:95], v[204:207], v[156:159]
  s_cbranch_vccnz k2_t2_slow
k2_t2_back:
  s_waitcnt lgkmcnt(5)
  v_mfma_f32_16x16x32_bf16 v[176:179], a[64:67], a[0:3], v[208:211]
  ds_read_b128 a[88:91], v2 offset:6144
  v_exp_f32 v160, v160
  v_exp_f32 v161, v161
  v_mfma_f32_16x16x32_bf16 v[180:183], a[64:67], a[4:7], v[212:215]
  v_add_f32 v6, v6, v160
  s_waitcnt lgkmcnt(5)
  v_mfma_f32_16x16x32_bf16 v[184:187], a[68:71], a[0:3], v[208:211]
  ds_read_b128 a[92:95], v2 offset:7168
  v_exp_f32 v162, v162
  v_mfma_f32_16x16x32_bf16 v[188:191], a[68:71], a[4:7], v[212:215]
  v_add_f32 v6, v6, v161
  v_exp_f32 v163, v163
  s_waitcnt lgkmcnt(5)
  v_mfma_f32_16x16x32_bf16 v[176:179], a[72:75], a[8:11], v[176:179]
  ds_read_b128 a[64:67], v2 offset:8192
  v_add_f32 v6, v6, v162
  v_mfma_f32_16x16x32_bf16 v[180:183], a[72:75], a[12:15], v[180:183]
  v_cvt_pk_bf16_f32 v192, v160, v161
  s_waitcnt lgkmcnt(5)
  v_mfma_f32_16x16x32_bf16 v[184:187], a[76:79], a[8:11], v[184:187]
  ds_read_b128 a[68:71], v2 offset:9216
  v_exp_f32 v168, v168
  v_mfma_f32_16x16x32_bf16 v[188:191], a[76:79], a[12:15], v[188:191]
  v_add_f32 v6, v6, v163
  v_exp_f32 v169, v169
  s_waitcnt lgkmcnt(5)
  v_mfma_f32_16x16x32_bf16 v[176:179], a[80:83], a[16:19], v[176:179]
  ds_read_b128 a[72:75], v2 offset:10240
  v_add_f32 v6, v6, v168
  v_mfma_f32_16x16x32_bf16 v[180:183], a[80:83], a[20:23], v[180:183]
  v_cvt_pk_bf16_f32 v193, v162, v163
  s_waitcnt lgkmcnt(5)
  v_mfma_f32_16x16x32_bf16 v[184:187], a[84:87], a[16:19], v[184:187]
  ds_read_b128 a[76:79], v2 offset:11264
  v_exp_f32 v170, v170
  v_add_f32 v6, v6, v169
  v_mfma_f32_16x16x32_bf16 v[188:191], a[84:87], a[20:23], v[188:191]
  v_exp_f32 v171, v171
  s_waitcnt lgkmcnt(5)
  v_mfma_f32_16x16x32_bf16 v[176:179], a[88:91], a[24:27], v[176:179]
  ds_read_b128 a[80:83], v2 offset:12288
  v_add_f32 v6, v6, v170
  v_mfma_f32_16x16x32_bf16 v[180:183], a[88:91], a[28:31], v[180:183]
  v_cvt_pk_bf16_f32 v194, v168, v169
  s_waitcnt lgkmcnt(5)
  v_mfma_f32_16x16x32_bf16 v[184:187], a[92:95], a[24:27], v[184:187]
  ds_read_b128 a[84:87], v2 offset:13312
  v_exp_f32 v164, v164
  v_add_f32 v6, v6, v171
  v_mfma_f32_16x16x32_bf16 v[188:191], a[92:95], a[28:31], v[188:191]
  v_exp_f32 v165, v165
  s_waitcnt lgkmcnt(5)
  v_mfma_f32_16x16x32_bf16 v[176:179], a[64:67], a[32:35], v[176:179]
  ds_read_b128 a[88:91], v2 offset:14336
  v_add_f32 v7, v7, v164
  v_mfma_f32_16x16x32_bf16 v[180:183], a[64:67], a[36:39], v[180:183]
  v_cvt_pk_bf16_f32 v195, v170, v171
  v_exp_f32 v166, v166
  s_waitcnt lgkmcnt(5)
  v_mfma_f32_16x16x32_bf16 v[184:187], a[68:71], a[32:35], v[184:187]
  ds_read_b128 a[92:95], v2 offset:15360
  v_add_f32 v7, v7, v165
  v_mfma_f32_16x16x32_bf16 v[188:191], a[68:71], a[36:39], v[188:191]
  v_exp_f32 v167, v167
  s_waitcnt lgkmcnt(5)
  v_mfma_f32_16x16x32_bf16 v[176:179], a[72:75], a[40:43], v[176:179]
  ds_read_b128 a[64:67], v3 offset:0
  v_add_f32 v7, v7, v166
  v_mfma_f32_16x16x32_bf16 v[180:183], a[72:75], a[44:47], v[180:183]
  v_cvt_pk_bf16_f32 v196, v164, v165
  v_exp_f32 v172, v172
  s_waitcnt lgkmcnt(5)
  v_mfma_f32_16x16x32_bf16 v[184:187], a[76:79], a[40:43], v[184:187]
  ds_read_b128 a[68:71], v3 offset:1024
  v_add_f32 v7, v7, v167
  v_mfma_f32_16x16x32_bf16 v[188:191], a[76:79], a[44:47], v[188:191]
  v_exp_f32 v173, v173
  s_waitcnt lgkmcnt(5)
  v_mfma_f32_16x16x32_bf16 v[176:179], a[80:83], a[48:51], v[176:179]
  ds_read_b128 a[72:75], v3 offset:2048
  v_add_f32 v7, v7, v172
  v_cvt_pk_bf16_f32 v197, v166, v167
  v_mfma_f32_16x16x32_bf16 v[180:183], a[80:83], a[52:55], v[180:183]
  v_exp_f32 v174, v174
  s_waitcnt lgkmcnt(5)
  v_mfma_f32_16x16x32_bf16 v[184:187], a[84:87], a[48:51], v[184:187]
  ds_read_b128 a[76:79], v3 offset:3072
  v_add_f32 v7, v7, v173
  v_mfma_f32_16x16x32_bf16 v[188:191], a[84:87], a[52:55], v[188:191]
  v_exp_f32 v175, v175
  s_waitcnt lgkmcnt(5)
  v_mfma_f32_16x16x32_bf16 v[176:179], a[88:91], a[56:59], v[176:179]
  ds_read_b128 a[80:83], v3 offset:4096
  v_add_f32 v7, v7, v174
  v_cvt_pk_bf16_f32 v198, v172, v173
  v_mfma_f32_16x16x32_bf16 v[180:183], a[88:91], a[60:63], v[180:183]
  s_nop 0
  s_waitcnt lgkmcnt(5)
  v_mfma_f32_16x16x32_bf16 v[184:187], a[92:95], a[56:59], v[184:187]
  ds_read_b128 a[84:87], v3 offset:5120
  v_add_f32 v7, v7, v175
  s_add_u32 s34, s34, 0x4000
  s_and_b32 s34, s34, 0xc000
  s_add_u32 s35, s35, 0x4000
  s_add_u32 s36, s36, 0x4000
  v_mfma_f32_16x16x32_bf16 v[188:191], a[92:95], a[60:63], v[188:191]
  v_cvt_pk_bf16_f32 v199, v174, v175
  s_branch k2_t2_done
k2_t2_part:
  s_cmp_eq_u32 s33, 1
  s_cbranch_scc0 k2_t2_none
  s_waitcnt lgkmcnt(5)
  v_mfma_f32_16x16x32_bf16 v[32:35], a[64:67], v[200:203], v[32:35]
  ds_read_b128 a[88:91], v4 offset:6144
  v_mfma_f32_16x16x32_bf16 v[36:39], a[64:67], v[204:207], v[36:39]
  s_waitcnt lgkmcnt(5)
  v_mfma_f32_16x16x32_bf16 v[40:43], a[68:71], v[200:203], v[40:43]
  ds_read_b128 a[92:95], v4 offset:7168
  v_mfma_f32_16x16x32_bf16 v[44:47], a[68:71], v[204:207], v[44:47]
  s_waitcnt lgkmcnt(5)
  v_mfma_f32_16x16x32_bf16 v[48:51], a[72:75], v[200:203], v[48:51]
  ds_read_b128 a[64:67], v4 offset:8192
  v_mfma_f32_16x16x32_bf16 v[52:55], a[72:75], v[204:207], v[52:55]
  s_waitcnt lgkmcnt(5)
  v_mfma_f32_16x16x32_bf16 v[56:59], a[76:79], v[200:203], v[56:59]
  ds_read_b128 a[68:71], v4 offset:9216
  v_mfma_f32_16x16x32_bf16 v[60:63], a[76:79], v[204:207], v[60:63]
  s_waitcnt lgkmcnt(5)
  v_mfma_f32_16x16x32_bf16 v[64:67], a[80:83], v[200:203], v[64:67]
  ds_read_b128 a[72:75], v4 offset:10240
  v_mfma_f32_16x16x32_bf16 v[68:71], a[80:83], v[204:207], v[68:71]
  s_waitcnt lgkmcnt(5)
  v_mfma_f32_16x16x32_bf16 v[72:75], a[84:87], v[200:203], v[72:75]
  ds_read_b128 a[76:79], v4 offset:11264
  v_mfma_f32_16x16x32_bf16 v[76:79], a[84:87], v[204:207], v[76:79]
  s_waitcnt lgkmcnt(5)
  v_mfma_f32_16x16x32_bf16 v[80:83], a[88:91], v[200:203], v[80:83]
  ds_read_b128 a[80:83], v4 offset:12288
  v_mfma_f32_16x16x32_bf16 v[84:87], a[88:91], v[204:207], v[84:87]
  s_waitcnt lgkmcnt(5)
  v_mfma_f32_16x16x32_bf16 v[88:91], a[92:95], v[200:203], v[88:91]
  ds_read_b128 a[84:87], v4 offset:13312
  v_mfma_f32_16x16x32_bf16 v[92:95], a[92:95], v[204:207], v[92:95]
  s_waitcnt lgkmcnt(5)
  v_mfma_f32_16x16x32_bf16 v[96:99], a[64:67], v[200:203], v[96:99]
  ds_read_b128 a[88:91], v4 offset:14336
  v_mfma_f32_16x16x32_bf16 v[100:103], a[64:67], v[204:207], v[100:103]
  s_waitcnt lgkmcnt(5)
  v_mfma_f32_16x16x32_bf16 v[104:107], a[68:71], v[200:203], v[104:107]
  ds_read_b128 a[92:95], v4 offset:15360
  v_mfma_f32_16x16x32_bf16 v[108:111], a[68:71], v[204:207], v[108:111]
  s_waitcnt lgkmcnt(5)
  v_mfma_f32_16x16x32_bf16 v[112:115], a[72:75], v[200:203], v[112:115]
  v_mfma_f32_16x16x32_bf16 v[116:119], a[72:75], v[204:207], v[116:119]
  s_waitcnt lgkmcnt(4)
  v_mfma_f32_16x16x32_bf16 v[120:123], a[76:79], v[200:203], v[120:123]
  v_mfma_f32_16x16x32_bf16 v[124:127], a[76:79], v[204:207], v[124:127]
  s_waitcnt lgkmcnt(3)
  v_mfma_f32_16x16x32_bf16 v[128:131], a[80:83], v[200:203], v[128:131]
  v_mfma_f32_16x16x32_bf16 v[132:135], a[80:83], v[204:207], v[132:135]
  s_waitcnt lgkmcnt(2)
  v_mfma_f32_16x16x32_bf16 v[136:139], a[84:87], v[200:203], v[136:139]
  v_mfma_f32_16x16x32_bf16 v[140:143], a[84:87], v[204:207], v[140:143]
  s_waitcnt lgkmcnt(1)
  v_mfma_f32_16x16x32_bf16 v[144:147], a[88:91], v[200:203], v[144:147]
  v_mfma_f32_16x16x32_bf16 v[148:151], a[88:91], v[204:207], v[148:151]
  s_waitcnt lgkmcnt(0)
  v_mfma_f32_16x16x32_bf16 v[152:155], a[92:95], v[200:203], v[152:155]
  v_mfma_f32_16x16x32_bf16 v[156:159], a[92:95], v[204:207], v[156:159]
k2_t2_none:
  s_add_u32 s34, s34, 0x4000
  s_and_b32 s34, s34, 0xc000
  s_add_u32 s35, s35, 0x4000
  s_add_u32 s36, s36, 0x4000
k2_t2_done:
  s_cmp_eq_u32 s43, 1
  s_cbranch_scc0 k2_nopoll
  buffer_load_dword v27, v9, s[56:59], 0 offen sc1
  s_waitcnt vmcnt(0)
  v_readfirstlane_b32 s61, v27
  s_mov_b32 s68, 0
  s_nop 2
  s_cmp_eq_u32 s61, 1
  s_cbranch_scc0 k2_nopoll
  s_mov_b32 s61, 0
  buffer_load_dwordx4 a[96:99], v8, s[24:27], s61 offen offset:0 sc1
  buffer_load_dwordx4 a[100:103], v8, s[24:27], s61 offen offset:1024 sc1
  buffer_load_dwordx4 a[104:107], v8, s[24:27], s61 offen offset:2048 sc1
  buffer_load_dwordx4 a[108:111], v8, s[24:27], s61 offen offset:3072 sc1
  s_mov_b32 s61, 4096
  buffer_load_dwordx4 a[112:115], v8, s[24:27], s61 offen offset:0 sc1
  buffer_load_dwordx4 a[116:119], v8, s[24:27], s61 offen offset:1024 sc1
  buffer_load_dwordx4 a[120:123], v8, s[24:27], s61 offen offset:2048 sc1
  buffer_load_dwordx4 a[124:127], v8, s[24:27], s61 offen offset:3072 sc1
  s_mov_b32 s61, 8192
  buffer_load_dwordx4 a[128:131], v8, s[24:27], s61 offen offset:0 sc1
  buffer_load_dwordx4 a[132:135], v8, s[24:27], s61 offen offset:1024 sc1
  buffer_load_dwordx4 a[136:139], v8, s[24:27], s61 offen offset:2048 sc1
  buffer_load_dwordx4 a[140:143], v8, s[24:27], s61 offen offset:3072 sc1
  s_mov_b32 s61, 12288
  buffer_load_dwordx4 a[144:147], v8, s[24:27], s61 offen offset:0 sc1
  buffer_load_dwordx4 a[148:151], v8, s[24:27], s61 offen offset:1024 sc1
  buffer_load_dwordx4 a[152:155], v8, s[24:27], s61 offen offset:2048 sc1
  buffer_load_dwordx4 a[156:159], v8, s[24:27], s61 offen offset:3072 sc1
  s_mov_b32 s61, 16384
  buffer_load_dwordx4 a[160:163], v8, s[24:27], s61 offen offset:0 sc1
  s_mov_b32 s68, 1
  s_barrier
  s_branch k2_t3
k2_nopoll:
  s_waitcnt vmcnt(0)
  s_barrier
k2_t3:
  s_cmp_ge_u32 s43, 3
  s_cbranch_scc1 k2_t3_nowo
  s_bitcmp1_b32 s32, 1
  s_cbranch_scc1 k2_t3_wo2
  s_add_u32 m0, s40, 32768
  s_mov_b32 s62, 128
  buffer_load_dwordx4 v21, s[16:19], s62 offen offset:0 lds
  buffer_load_dwordx4 v22, s[16:19], s62 offen offset:1024 lds
  buffer_load_dwordx4 v23, s[16:19], s62 offen offset:2048 lds
  buffer_load_dwordx4 v24, s[16:19], s62 offen offset:3072 lds
  s_add_u32 m0, s40, 36864
  s_mov_b32 s62, 28800
  buffer_load_dwordx4 v21, s[16:19], s62 offen offset:0 lds
  buffer_load_dwordx4 v22, s[16:19], s62 offen offset:1024 lds
  buffer_load_dwordx4 v23, s[16:19], s62 offen offset:2048 lds
  buffer_load_dwordx4 v24, s[16:19], s62 offen offset:3072 lds
  s_branch k2_t3_nowo
k2_t3_wo2:
  s_add_u32 m0, s40, 0
  s_mov_b32 s62, 0
  buffer_load_dwordx4 v21, s[16:19], s62 offen offset:0 lds
  buffer_load_dwordx4 v22, s[16:19], s62 offen offset:1024 lds
  buffer_load_dwordx4 v23, s[16:19], s62 offen offset:2048 lds
  buffer_load_dwordx4 v24, s[16:19], s62 offen offset:3072 lds
  s_add_u32 m0, s40, 4096
  s_mov_b32 s62, 28672
  buffer_load_dwordx4 v21, s[16:19], s62 offen offset:0 lds
  buffer_load_dwordx4 v22, s[16:19], s62 offen offset:1024 lds
  buffer_load_dwordx4 v23, s[16:19], s62 offen offset:2048 lds
  buffer_load_dwordx4 v24, s[16:19], s62 offen offset:3072 lds
k2_t3_nowo:
  s_cmp_ge_u32 s33, 3
  s_cbranch_scc0 k2_t3_part
  s_cmp_eq_u32 s33, 3
  s_cbranch_scc0 k2_t3_nomask
  s_nop 7
  v_cmp_gt_i32 s[44:45], 0, v12
  v_cmp_gt_i32 s[46:47], 1, v12
  v_cmp_gt_i32 s[48:49], 2, v12
  v_cmp_gt_i32 s[50:51], 3, v12
  v_mov_b32 v27, s42
  v_cndmask_b32 v176, v176, v27, s[44:45]
  v_cndmask_b32 v188, v188, v27, s[44:45]
  v_mov_b32 v184, s42
  v_cndmask_b32 v177, v177, v27, s[46:47]
  v_cndmask_b32 v189, v189, v27, s[46:47]
  v_mov_b32 v185, s42
  v_cndmask_b32 v178, v178, v27, s[48:49]
  v_cndmask_b32 v190, v190, v27, s[48:49]
  v_mov_b32 v186, s42
  v_cndmask_b32 v179, v179, v27, s[50:51]
  v_cndmask_b32 v191, v191, v27, s[50:51]
  v_mov_b32 v187, s42
k2_t3_nomask:
  s_add_u32 s39, s34, 0x4000
  s_and_b32 s39, s39, 0xc000
  v_add_u32 v2, s39, v1
  s_add_u32 s39, s34, 0x10000
  v_add_u32 v4, s39, v1
  s_waitcnt lgkmcnt(5)
  v_mfma_f32_16x16x32_bf16 v[32:35], a[64:67], v[192:195], v[32:35]
  ds_read_b128 a[88:91], v3 offset:6144
  v_mfma_f32_16x16x32_bf16 v[36:39], a[64:67], v[196:199], v[36:39]
  s_waitcnt lgkmcnt(5)
  v_mfma_f32_16x16x32_bf16 v[40:43], a[68:71], v[192:195], v[40:43]
  ds_read_b128 a[92:95], v3 offset:7168
  v_mfma_f32_16x16x32_bf16 v[44:47], a[68:71], v[196:199], v[44:47]
  s_waitcnt lgkmcnt(5)
  v_mfma_f32_16x16x32_bf16 v[48:51], a[72:75], v[192:195], v[48:51]
  ds_read_b128 a[64:67], v3 offset:8192
  v_mfma_f32_16x16x32_bf16 v[52:55], a[72:75], v[196:199], v[52:55]
  s_waitcnt lgkmcnt(5)
  v_mfma_f32_16x16x32_bf16 v[56:59], a[76:79], v[192:195], v[56:59]
  ds_read_b128 a[68:71], v3 offset:9216
  v_mfma_f32_16x16x32_bf16 v[60:63], a[76:79], v[196:199], v[60:63]
  s_waitcnt lgkmcnt(5)
  v_mfma_f32_16x16x32_bf16 v[64:67], a[80:83], v[192:195], v[64:67]
  ds_read_b128 a[72:75], v3 offset:10240
  v_mfma_f32_16x16x32_bf16 v[68:71], a[80:83], v[196:199], v[68:71]
  s_waitcnt lgkmcnt(5)
  v_mfma_f32_16x16x32_bf16 v[72:75], a[84:87], v[192:195], v[72:75]
  ds_read_b128 a[76:79], v3 offset:11264
  v_mfma_f32_16x16x32_bf16 v[76:79], a[84:87], v[196:199], v[76:79]
  v_max3_f32 v10, v176, v177, v178
  s_waitcnt lgkmcnt(5)
  v_mfma_f32_16x16x32_bf16 v[80:83], a[88:91], v[192:195], v[80:83]
  ds_read_b128 a[80:83], v3 offset:12288
  v_mfma_f32_16x16x32_bf16 v[84:87], a[88:91], v[196:199], v[84:87]
  v_max3_f32 v10, v10, v179, v180
  s_waitcnt lgkmcnt(5)
  v_mfma_f32_16x16x32_bf16 v[88:91], a[92:95], v[192:195], v[88:91]
  ds_read_b128 a[84:87], v3 offset:13312
  v_mfma_f32_16x16x32_bf16 v[92:95], a[92:95], v[196:199], v[92:95]
  v_max3_f32 v10, v10, v181, v182
  s_waitcnt lgkmcnt(5)
  v_mfma_f32_16x16x32_bf16 v[96:99], a[64:67], v[192:195], v[96:99]
  ds_read_b128 a[88:91], v3 offset:14336
  v_mfma_f32_16x16x32_bf16 v[100:103], a[64:67], v[196:199], v[100:103]
  v_max3_f32 v10, v10, v183, v184
  s_waitcnt lgkmcnt(5)
  v_mfma_f32_16x16x32_bf16 v[104:107], a[68:71], v[192:195], v[104:107]
  ds_read_b128 a[92:95], v3 offset:15360
  v_mfma_f32_16x16x32_bf16 v[108:111], a[68:71], v[196:199], v[108:111]
  v_max3_f32 v10, v10, v185, v186
  s_waitcnt lgkmcnt(5)
  v_mfma_f32_16x16x32_bf16 v[112:115], a[72:75], v[192:195], v[112:115]
  v_mfma_f32_16x16x32_bf16 v[116:119], a[72:75], v[196:199], v[116:119]
  v_max3_f32 v10, v10, v187, v188
  s_waitcnt lgkmcnt(4)
  v_mfma_f32_16x16x32_bf16 v[120:123], a[76:79], v[192:195], v[120:123]
  v_mfma_f32_16x16x32_bf16 v[124:127], a[76:79], v[196:199], v[124:127]
  v_max3_f32 v10, v10, v189, v190
  s_waitcnt lgkmcnt(3)
  v_mfma_f32_16x16x32_bf16 v[128:131], a[80:83], v[192:195], v[128:131]
  v_mfma_f32_16x16x32_bf16 v[132:135], a[80:83], v[196:199], v[132:135]
  v_max_f32 v10, v10, v191
  s_waitcnt lgkmcnt(2)
  v_mfma_f32_16x16x32_bf16 v[136:139], a[84:87], v[192:195], v[136:139]
  v_mfma_f32_16x16x32_bf16 v[140:143], a[84:87], v[196:199], v[140:143]
  v_cmp_lt_f32 vcc, s41, v10
  s_waitcnt lgkmcnt(1)
  v_mfma_f32_16x16x32_bf16 v[144:147], a[88:91], v[192:195], v[144:147]
  v_mfma_f32_16x16x32_bf16 v[148:151], a[88:91], v[196:199], v[148:151]
  s_waitcnt lgkmcnt(0)
  v_mfma_f32_16x16x32_bf16 v[152:155], a[92:95], v[192:195], v[152:155]
  v_mfma_f32_16x16x32_bf16 v[156:159], a[92:95], v[196:199], v[156:159]
  s_cbranch_vccnz k2_t3_slow
k2_t3_back:
  ds_read_b128 a[64:67], v4 offset:0
  ds_read_b128 a[68:71], v4 offset:1024
  ds_read_b128 a[72:75], v4 offset:2048
  ds_read_b128 a[76:79], v4 offset:3072
  ds_read_b128 a[80:83], v4 offset:4096
  ds_read_b128 a[84:87], v4 offset:5120
  s_nop 1
  v_exp_f32 v176, v176
  v_exp_f32 v177, v177
  v_add_f32 v6, v6, v176
  v_exp_f32 v178, v178
  v_add_f32 v6, v6, v177
  v_exp_f32 v179, v179
  v_add_f32 v6, v6, v178
  v_cvt_pk_bf16_f32 v200, v176, v177
  v_exp_f32 v184, v184
  v_add_f32 v6, v6, v179
  v_exp_f32 v185, v185
  v_add_f32 v6, v6, v184
  v_cvt_pk_bf16_f32 v201, v178, v179
  v_exp_f32 v186, v186
  v_add_f32 v6, v6, v185
  v_exp_f32 v187, v187
  v_add_f32 v6, v6, v186
  v_cvt_pk_bf16_f32 v202, v184, v185
  v_exp_f32 v180, v180
  v_add_f32 v6, v6, v187
  v_exp_f32 v181, v181
  v_add_f32 v7, v7, v180
  v_cvt_pk_bf16_f32 v203, v186, v187
  v_exp_f32 v182, v182
  v_add_f32 v7, v7, v181
  v_exp_f32 v183, v183
  v_add_f32 v7, v7, v182
  v_cvt_pk_bf16_f32 v204, v180, v181
  v_exp_f32 v188, v188
  v_add_f32 v7, v7, v183
  v_exp_f32 v189, v189
  v_add_f32 v7, v7, v188
  v_cvt_pk_bf16_f32 v205, v182, v183
  v_exp_f32 v190, v190
  v_add_f32 v7, v7, v189
  v_exp_f32 v191, v191
  v_add_f32 v7, v7, v190
  v_cvt_pk_bf16_f32 v206, v188, v189
  s_nop 0
  v_add_f32 v7, v7, v191
  v_cvt_pk_bf16_f32 v207, v190, v191
  s_add_u32 s34, s34, 0x4000
  s_and_b32 s34, s34, 0xc000
  s_add_u32 s35, s35, 0x4000
  s_add_u32 s36, s36, 0x4000
  s_branch k2_t3_done
k2_t3_part:
  s_cmp_eq_u32 s33, 2
  s_cbranch_scc0 k2_t3_none
  s_waitcnt lgkmcnt(5)
  v_mfma_f32_16x16x32_bf16 v[32:35], a[64:67], v[192:195], v[32:35]
  ds_read_b128 a[88:91], v3 offset:6144
  v_mfma_f32_16x16x32_bf16 v[36:39], a[64:67], v[196:199], v[36:39]
  s_waitcnt lgkmcnt(5)
  v_mfma_f32_16x16x32_bf16 v[40:43], a[68:71], v[192:195], v[40:43]
  ds_read_b128 a[92:95], v3 offset:7168
  v_mfma_f32_16x16x32_bf16 v[44:47], a[68:71], v[196:199], v[44:47]
  s_waitcnt lgkmcnt(5)
  v_mfma_f32_16x16x32_bf16 v[48:51], a[72:75], v[192:195], v[48:51]
  ds_read_b128 a[64:67], v3 offset:8192
  v_mfma_f32_16x16x32_bf16 v[52:55], a[72:75], v[196:199], v[52:55]
  s_waitcnt lgkmcnt(5)
  v_mfma_f32_16x16x32_bf16 v[56:59], a[76:79], v[192:195], v[56:59]
  ds_read_b128 a[68:71], v3 offset:9216
  v_mfma_f32_16x16x32_bf16 v[60:63], a[76:79], v[196:199], v[60:63]
  s_waitcnt lgkmcnt(5)
  v_mfma_f32_16x16x32_bf16 v[64:67], a[80:83], v[192:195], v[64:67]
  ds_read_b128 a[72:75], v3 offset:10240
  v_mfma_f32_16x16x32_bf16 v[68:71], a[80:83], v[196:199], v[68:71]
  s_waitcnt lgkmcnt(5)
  v_mfma_f32_16x16x32_bf16 v[72:75], a[84:87], v[192:195], v[72:75]
  ds_read_b128 a[76:79], v3 offset:11264
  v_mfma_f32_16x16x32_bf16 v[76:79], a[84:87], v[196:199], v[76:79]
  s_waitcnt lgkmcnt(5)
  v_mfma_f32_16x16x32_bf16 v[80:83], a[88:91], v[192:195], v[80:83]
  ds_read_b128 a[80:83], v3 offset:12288
  v_mfma_f32_16x16x32_bf16 v[84:87], a[88:91], v[196:199], v[84:87]
  s_waitcnt lgkmcnt(5)
  v_mfma_f32_16x16x32_bf16 v[88:91], a[92:95], v[192:195], v[88:91]
  ds_read_b128 a[84:87], v3 offset:13312
  v_mfma_f32_16x16x32_bf16 v[92:95], a[92:95], v[196:199], v[92:95]
  s_waitcnt lgkmcnt(5)
  v_mfma_f32_16x16x32_bf16 v[96:99], a[64:67], v[192:195], v[96:99]
  ds_read_b128 a[88:91], v3 offset:14336
  v_mfma_f32_16x16x32_bf16 v[100:103], a[64:67], v[196:199], v[100:103]
  s_waitcnt lgkmcnt(5)
  v_mfma_f32_16x16x32_bf16 v[104:107], a[68:71], v[192:195], v[104:107]
  ds_read_b128 a[92:95], v3 offset:15360
  v_mfma_f32_16x16x32_bf16 v[108:111], a[68:71], v[196:199], v[108:111]
  s_waitcnt lgkmcnt(5)
  v_mfma_f32_16x16x32_bf16 v[112:115], a[72:75], v[192:195], v[112:115]
  v_mfma_f32_16x16x32_bf16 v[116:119], a[72:75], v[196:199], v[116:119]
  s_waitcnt lgkmcnt(4)
  v_mfma_f32_16x16x32_bf16 v[120:123], a[76:79], v[192:195], v[120:123]
  v_mfma_f32_16x16x32_bf16 v[124:127], a[76:79], v[196:199], v[124:127]
  s_waitcnt lgkmcnt(3)
  v_mfma_f32_16x16x32_bf16 v[128:131], a[80:83], v[192:195], v[128:131]
  v_mfma_f32_16x16x32_bf16 v[132:135], a[80:83], v[196:199], v[132:135]
  s_waitcnt lgkmcnt(2)
  v_mfma_f32_16x16x32_bf16 v[136:139], a[84:87], v[192:195], v[136:139]
  v_mfma_f32_16x16x32_bf16 v[140:143], a[84:87], v[196:199], v[140:143]
  s_waitcnt lgkmcnt(1)
  v_mfma_f32_16x16x32_bf16 v[144:147], a[88:91], v[192:195], v[144:147]
  v_mfma_f32_16x16x32_bf16 v[148:151], a[88:91], v[196:199], v[148:151]
  s_waitcnt lgkmcnt(0)
  v_mfma_f32_16x16x32_bf16 v[152:155], a[92:95], v[192:195], v[152:155]
  v_mfma_f32_16x16x32_bf16 v[156:159], a[92:95], v[196:199], v[156:159]
k2_t3_none:
  s_add_u32 s34, s34, 0x4000
  s_and_b32 s34, s34, 0xc000
  s_add_u32 s35, s35, 0x4000
  s_add_u32 s36, s36, 0x4000
k2_t3_done:
  s_barrier
  s_cmp_ge_u32 s33, 3
  s_cbranch_scc0 k2_fin
  s_waitcnt lgkmcnt(5)
  v_mfma_f32_16x16x32_bf16 v[32:35], a[64:67], v[200:203], v[32:35]
  ds_read_b128 a[88:91], v4 offset:6144
  v_mfma_f32_16x16x32_bf16 v[36:39], a[64:67], v[204:207], v[36:39]
  s_waitcnt lgkmcnt(5)
  v_mfma_f32_16x16x32_bf16 v[40:43], a[68:71], v[200:203], v[40:43]
  ds_read_b128 a[92:95], v4 offset:7168
  v_mfma_f32_16x16x32_bf16 v[44:47], a[68:71], v[204:207], v[44:47]
  s_waitcnt lgkmcnt(5)
  v_mfma_f32_16x16x32_bf16 v[48:51], a[72:75], v[200:203], v[48:51]
  ds_read_b128 a[64:67], v4 offset:8192
  v_mfma_f32_16x16x32_bf16 v[52:55], a[72:75], v[204:207], v[52:55]
  s_waitcnt lgkmcnt(5)
  v_mfma_f32_16x16x32_bf16 v[56:59], a[76:79], v[200:203], v[56:59]
  ds_read_b128 a[68:71], v4 offset:9216
  v_mfma_f32_16x16x32_bf16 v[60:63], a[76:79], v[204:207], v[60:63]
  s_waitcnt lgkmcnt(5)
  v_mfma_f32_16x16x32_bf16 v[64:67], a[80:83], v[200:203], v[64:67]
  ds_read_b128 a[72:75], v4 offset:10240
  v_mfma_f32_16x16x32_bf16 v[68:71], a[80:83], v[204:207], v[68:71]
  s_waitcnt lgkmcnt(5)
  v_mfma_f32_16x16x32_bf16 v[72:75], a[84:87], v[200:203], v[72:75]
  ds_read_b128 a[76:79], v4 offset:11264
  v_mfma_f32_16x16x32_bf16 v[76:79], a[84:87], v[204:207], v[76:79]
  s_waitcnt lgkmcnt(5)
  v_mfma_f32_16x16x32_bf16 v[80:83], a[88:91], v[200:203], v[80:83]
  ds_read_b128 a[80:83], v4 offset:12288
  v_mfma_f32_16x16x32_bf16 v[84:87], a[88:91], v[204:207], v[84:87]
  s_waitcnt lgkmcnt(5)
  v_mfma_f32_16x16x32_bf16 v[88:91], a[92:95], v[200:203], v[88:91]
  ds_read_b128 a[84:87], v4 offset:13312
  v_mfma_f32_16x16x32_bf16 v[92:95], a[92:95], v[204:207], v[92:95]
  s_waitcnt lgkmcnt(5)
  v_mfma_f32_16x16x32_bf16 v[96:99], a[64:67], v[200:203], v[96:99]
  ds_read_b128 a[88:91], v4 offset:14336
  v_mfma_f32_16x16x32_bf16 v[100:103], a[64:67], v[204:207], v[100:103]
  s_waitcnt lgkmcnt(5)
  v_mfma_f32_16x16x32_bf16 v[104:107], a[68:71], v[200:203], v[104:107]
  ds_read_b128 a[92:95], v4 offset:15360
  v_mfma_f32_16x16x32_bf16 v[108:111], a[68:71], v[204:207], v[108:111]
  s_waitcnt lgkmcnt(5)
  v_mfma_f32_16x16x32_bf16 v[112:115], a[72:75], v[200:203], v[112:115]
  v_mfma_f32_16x16x32_bf16 v[116:119], a[72:75], v[204:207], v[116:119]
  s_waitcnt lgkmcnt(4)
  v_mfma_f32_16x16x32_bf16 v[120:123], a[76:79], v[200:203], v[120:123]
  v_mfma_f32_16x16x32_bf16 v[124:127], a[76:79], v[204:207], v[124:127]
  s_waitcnt lgkmcnt(3)
  v_mfma_f32_16x16x32_bf16 v[128:131], a[80:83], v[200:203], v[128:131]
  v_mfma_f32_16x16x32_bf16 v[132:135], a[80:83], v[204:207], v[132:135]
  s_waitcnt lgkmcnt(2)
  v_mfma_f32_16x16x32_bf16 v[136:139], a[84:87], v[200:203], v[136:139]
  v_mfma_f32_16x16x32_bf16 v[140:143], a[84:87], v[204:207], v[140:143]
  s_waitcnt lgkmcnt(1)
  v_mfma_f32_16x16x32_bf16 v[144:147], a[88:91], v[200:203], v[144:147]
  v_mfma_f32_16x16x32_bf16 v[148:151], a[88:91], v[204:207], v[148:151]
  s_waitcnt lgkmcnt(0)
  v_mfma_f32_16x16x32_bf16 v[152:155], a[92:95], v[200:203], v[152:155]
  v_mfma_f32_16x16x32_bf16 v[156:159], a[92:95], v[204:207], v[156:159]
k2_fin:
  s_waitcnt lgkmcnt(0)
  s_barrier
  s_nop 7
  v_mov_b32 v27, v6
  s_nop 1
  v_permlane16_swap_b32 v6, v27
  s_nop 1
  v_add_f32 v6, v6, v27
  v_mov_b32 v27, v6
  s_nop 1
  v_permlane32_swap_b32 v6, v27
  s_nop 1
  v_add_f32 v6, v6, v27
  v_mov_b32 v27, v7
  s_nop 1
  v_permlane16_swap_b32 v7, v27
  s_nop 1
  v_add_f32 v7, v7, v27
  v_mov_b32 v27, v7
  s_nop 1
  v_permlane32_swap_b32 v7, v27
  s_nop 1
  v_add_f32 v7, v7, v27
  s_cmp_eq_u32 s43, 1
  s_cbranch_scc1 k2_merge
  s_cmp_eq_u32 s43, 4
  s_cbranch_scc1 k2_partial
  v_rcp_f32 v10, v6
  v_rcp_f32 v11, v7
  s_nop 0
  v_pk_mul_f32 v[32:33], v[32:33], v[10:11] op_sel:[0,0] op_sel_hi:[1,0]
  v_pk_mul_f32 v[34:35], v[34:35], v[10:11] op_sel:[0,0] op_sel_hi:[1,0]
  v_pk_mul_f32 v[40:41], v[40:41], v[10:11] op_sel:[0,0] op_sel_hi:[1,0]
  v_pk_mul_f32 v[42:43], v[42:43], v[10:11] op_sel:[0,0] op_sel_hi:[1,0]
  s_nop 0
  v_cvt_pk_bf16_f32 v32, v32, v33
  v_cvt_pk_bf16_f32 v33, v34, v35
  v_cvt_pk_bf16_f32 v34, v40, v41
  v_cvt_pk_bf16_f32 v35, v42, v43
  v_pk_mul_f32 v[36:37], v[36:37], v[10:11] op_sel:[0,1] op_sel_hi:[1,1]
  v_pk_mul_f32 v[38:39], v[38:39], v[10:11] op_sel:[0,1] op_sel_hi:[1,1]
  v_pk_mul_f32 v[44:45], v[44:45], v[10:11] op_sel:[0,1] op_sel_hi:[1,1]
  v_pk_mul_f32 v[46:47], v[46:47], v[10:11] op_sel:[0,1] op_sel_hi:[1,1]
  s_nop 0
  v_cvt_pk_bf16_f32 v36, v36, v37
  v_cvt_pk_bf16_f32 v37, v38, v39
  v_cvt_pk_bf16_f32 v38, v44, v45
  v_cvt_pk_bf16_f32 v39, v46, v47
  v_pk_mul_f32 v[48:49], v[48:49], v[10:11] op_sel:[0,0] op_sel_hi:[1,0]
  v_pk_mul_f32 v[50:51], v[50:51], v[10:11] op_sel:[0,0] op_sel_hi:[1,0]
  v_pk_mul_f32 v[56:57], v[56:57], v[10:11] op_sel:[0,0] op_sel_hi:[1,0]
  v_pk_mul_f32 v[58:59], v[58:59], v[10:11] op_sel:[0,0] op_sel_hi:[1,0]
  s_nop 0
  v_cvt_pk_bf16_f32 v48, v48, v49
  v_cvt_pk_bf16_f32 v49, v50, v51
  v_cvt_pk_bf16_f32 v50, v56, v57
  v_cvt_pk_bf16_f32 v51, v58, v59
  v_pk_mul_f32 v[52:53], v[52:53], v[10:11] op_sel:[0,1] op_sel_hi:[1,1]
  v_pk_mul_f32 v[54:55], v[54:55], v[10:11] op_sel:[0,1] op_sel_hi:[1,1]
  v_pk_mul_f32 v[60:61], v[60:61], v[10:11] op_sel:[0,1] op_sel_hi:[1,1]
  v_pk_mul_f32 v[62:63], v[62:63], v[10:11] op_sel:[0,1] op_sel_hi:[1,1]
  s_nop 0
  v_cvt_pk_bf16_f32 v52, v52, v53
  v_cvt_pk_bf16_f32 v53, v54, v55
  v_cvt_pk_bf16_f32 v54, v60, v61
  v_cvt_pk_bf16_f32 v55, v62, v63
  v_pk_mul_f32 v[64:65], v[64:65], v[10:11] op_sel:[0,0] op_sel_hi:[1,0]
  v_pk_mul_f32 v[66:67], v[66:67], v[10:11] op_sel:[0,0] op_sel_hi:[1,0]
  v_pk_mul_f32 v[72:73], v[72:73], v[10:11] op_sel:[0,0] op_sel_hi:[1,0]
  v_pk_mul_f32 v[74:75], v[74:75], v[10:11] op_sel:[0,0] op_sel_hi:[1,0]
  s_nop 0
  v_cvt_pk_bf16_f32 v64, v64, v65
  v_cvt_pk_bf16_f32 v65, v66, v67
  v_cvt_pk_bf16_f32 v66, v72, v73
  v_cvt_pk_bf16_f32 v67, v74, v75
  v_pk_mul_f32 v[68:69], v[68:69], v[10:11] op_sel:[0,1] op_sel_hi:[1,1]
  v_pk_mul_f32 v[70:71], v[70:71], v[10:11] op_sel:[0,1] op_sel_hi:[1,1]
  v_pk_mul_f32 v[76:77], v[76:77], v[10:11] op_sel:[0,1] op_sel_hi:[1,1]
  v_pk_mul_f32 v[78:79], v[78:79], v[10:11] op_sel:[0,1] op_sel_hi:[1,1]
  s_nop 0
  v_cvt_pk_bf16_f32 v68, v68, v69
  v_cvt_pk_bf16_f32 v69, v70, v71
  v_cvt_pk_bf16_f32 v70, v76, v77
  v_cvt_pk_bf16_f32 v71, v78, v79
  v_pk_mul_f32 v[80:81], v[80:81], v[10:11] op_sel:[0,0] op_sel_hi:[1,0]
  v_pk_mul_f32 v[82:83], v[82:83], v[10:11] op_sel:[0,0] op_sel_hi:[1,0]
  v_pk_mul_f32 v[88:89], v[88:89], v[10:11] op_sel:[0,0] op_sel_hi:[1,0]
  v_pk_mul_f32 v[90:91], v[90:91], v[10:11] op_sel:[0,0] op_sel_hi:[1,0]
  s_nop 0
  v_cvt_pk_bf16_f32 v80, v80, v81
  v_cvt_pk_bf16_f32 v81, v82, v83
  v_cvt_pk_bf16_f32 v82, v88, v89
  v_cvt_pk_bf16_f32 v83, v90, v91
  v_pk_mul_f32 v[84:85], v[84:85], v[10:11] op_sel:[0,1] op_sel_hi:[1,1]
  v_pk_mul_f32 v[86:87], v[86:87], v[10:11] op_sel:[0,1] op_sel_hi:[1,1]
  v_pk_mul_f32 v[92:93], v[92:93], v[10:11] op_sel:[0,1] op_sel_hi:[1,1]
  v_pk_mul_f32 v[94:95], v[94:95], v[10:11] op_sel:[0,1] op_sel_hi:[1,1]
  s_nop 0
  v_cvt_pk_bf16_f32 v84, v84, v85
  v_cvt_pk_bf16_f32 v85, v86, v87
  v_cvt_pk_bf16_f32 v86, v92, v93
  v_cvt_pk_bf16_f32 v87, v94, v95
  v_pk_mul_f32 v[96:97], v[96:97], v[10:11] op_sel:[0,0] op_sel_hi:[1,0]
  v_pk_mul_f32 v[98:99], v[98:99], v[10:11] op_sel:[0,0] op_sel_hi:[1,0]
  v_pk_mul_f32 v[104:105], v[104:105], v[10:11] op_sel:[0,0] op_sel_hi:[1,0]
  v_pk_mul_f32 v[106:107], v[106:107], v[10:11] op_sel:[0,0] op_sel_hi:[1,0]
  s_nop 0
  v_cvt_pk_bf16_f32 v96, v96, v97
  v_cvt_pk_bf16_f32 v97, v98, v99
  v_cvt_pk_bf16_f32 v98, v104, v105
  v_cvt_pk_bf16_f32 v99, v106, v107
  v_pk_mul_f32 v[100:101], v[100:101], v[10:11] op_sel:[0,1] op_sel_hi:[1,1]
  v_pk_mul_f32 v[102:103], v[102:103], v[10:11] op_sel:[0,1] op_sel_hi:[1,1]
  v_pk_mul_f32 v[108:109], v[108:109], v[10:11] op_sel:[0,1] op_sel_hi:[1,1]
  v_pk_mul_f32 v[110:111], v[110:111], v[10:11] op_sel:[0,1] op_sel_hi:[1,1]
  s_nop 0
  v_cvt_pk_bf16_f32 v100, v100, v101
  v_cvt_pk_bf16_f32 v101, v102, v103
  v_cvt_pk_bf16_f32 v102, v108, v109
  v_cvt_pk_bf16_f32 v103, v110, v111
  v_pk_mul_f32 v[112:113], v[112:113], v[10:11] op_sel:[0,0] op_sel_hi:[1,0]
  v_pk_mul_f32 v[114:115], v[114:115], v[10:11] op_sel:[0,0] op_sel_hi:[1,0]
  v_pk_mul_f32 v[120:121], v[120:121], v[10:11] op_sel:[0,0] op_sel_hi:[1,0]
  v_pk_mul_f32 v[122:123], v[122:123], v[10:11] op_sel:[0,0] op_sel_hi:[1,0]
  s_nop 0
  v_cvt_pk_bf16_f32 v112, v112, v113
  v_cvt_pk_bf16_f32 v113, v114, v115
  v_cvt_pk_bf16_f32 v114, v120, v121
  v_cvt_pk_bf16_f32 v115, v122, v123
  v_pk_mul_f32 v[116:117], v[116:117], v[10:11] op_sel:[0,1] op_sel_hi:[1,1]
  v_pk_mul_f32 v[118:119], v[118:119], v[10:11] op_sel:[0,1] op_sel_hi:[1,1]
  v_pk_mul_f32 v[124:125], v[124:125], v[10:11] op_sel:[0,1] op_sel_hi:[1,1]
  v_pk_mul_f32 v[126:127], v[126:127], v[10:11] op_sel:[0,1] op_sel_hi:[1,1]
  s_nop 0
  v_cvt_pk_bf16_f32 v116, v116, v117
  v_cvt_pk_bf16_f32 v117, v118, v119
  v_cvt_pk_bf16_f32 v118, v124, v125
  v_cvt_pk_bf16_f32 v119, v126, v127
  v_pk_mul_f32 v[128:129], v[128:129], v[10:11] op_sel:[0,0] op_sel_hi:[1,0]
  v_pk_mul_f32 v[130:131], v[130:131], v[10:11] op_sel:[0,0] op_sel_hi:[1,0]
  v_pk_mul_f32 v[136:137], v[136:137], v[10:11] op_sel:[0,0] op_sel_hi:[1,0]
  v_pk_mul_f32 v[138:139], v[138:139], v[10:11] op_sel:[0,0] op_sel_hi:[1,0]
  s_nop 0
  v_cvt_pk_bf16_f32 v128, v128, v129
  v_cvt_pk_bf16_f32 v129, v130, v131
  v_cvt_pk_bf16_f32 v130, v136, v137
  v_cvt_pk_bf16_f32 v131, v138, v139
  v_pk_mul_f32 v[132:133], v[132:133], v[10:11] op_sel:[0,1] op_sel_hi:[1,1]
  v_pk_mul_f32 v[134:135], v[134:135], v[10:11] op_sel:[0,1] op_sel_hi:[1,1]
  v_pk_mul_f32 v[140:141], v[140:141], v[10:11] op_sel:[0,1] op_sel_hi:[1,1]
  v_pk_mul_f32 v[142:143], v[142:143], v[10:11] op_sel:[0,1] op_sel_hi:[1,1]
  s_nop 0
  v_cvt_pk_bf16_f32 v132, v132, v133
  v_cvt_pk_bf16_f32 v133, v134, v135
  v_cvt_pk_bf16_f32 v134, v140, v141
  v_cvt_pk_bf16_f32 v135, v142, v143
  v_pk_mul_f32 v[144:145], v[144:145], v[10:11] op_sel:[0,0] op_sel_hi:[1,0]
  v_pk_mul_f32 v[146:147], v[146:147], v[10:11] op_sel:[0,0] op_sel_hi:[1,0]
  v_pk_mul_f32 v[152:153], v[152:153], v[10:11] op_sel:[0,0] op_sel_hi:[1,0]
  v_pk_mul_f32 v[154:155], v[154:155], v[10:11] op_sel:[0,0] op_sel_hi:[1,0]
  s_nop 0
  v_cvt_pk_bf16_f32 v144, v144, v145
  v_cvt_pk_bf16_f32 v145, v146, v147
  v_cvt_pk_bf16_f32 v146, v152, v153
  v_cvt_pk_bf16_f32 v147, v154, v155
  v_pk_mul_f32 v[148:149], v[148:149], v[10:11] op_sel:[0,1] op_sel_hi:[1,1]
  v_pk_mul_f32 v[150:151], v[150:151], v[10:11] op_sel:[0,1] op_sel_hi:[1,1]
  v_pk_mul_f32 v[156:157], v[156:157], v[10:11] op_sel:[0,1] op_sel_hi:[1,1]
  v_pk_mul_f32 v[158:159], v[158:159], v[10:11] op_sel:[0,1] op_sel_hi:[1,1]
  s_nop 0
  v_cvt_pk_bf16_f32 v148, v148, v149
  v_cvt_pk_bf16_f32 v149, v150, v151
  v_cvt_pk_bf16_f32 v150, v156, v157
  v_cvt_pk_bf16_f32 v151, v158, v159
  s_cmp_eq_u32 s43, 0
  s_cbranch_scc1 k2_oproj
  v_accvgpr_write_b32 a96, v32
  v_accvgpr_write_b32 a97, v33
  v_accvgpr_write_b32 a98, v34
  v_accvgpr_write_b32 a99, v35
  v_accvgpr_write_b32 a100, v36
  v_accvgpr_write_b32 a101, v37
  v_accvgpr_write_b32 a102, v38
  v_accvgpr_write_b32 a103, v39
  v_accvgpr_write_b32 a104, v48
  v_accvgpr_write_b32 a105, v49
  v_accvgpr_write_b32 a106, v50
  v_accvgpr_write_b32 a107, v51
  v_accvgpr_write_b32 a108, v52
  v_accvgpr_write_b32 a109, v53
  v_accvgpr_write_b32 a110, v54
  v_accvgpr_write_b32 a111, v55
  v_accvgpr_write_b32 a112, v64
  v_accvgpr_write_b32 a113, v65
  v_accvgpr_write_b32 a114, v66
  v_accvgpr_write_b32 a115, v67
  v_accvgpr_write_b32 a116, v68
  v_accvgpr_write_b32 a117, v69
  v_accvgpr_write_b32 a118, v70
  v_accvgpr_write_b32 a119, v71
  v_accvgpr_write_b32 a120, v80
  v_accvgpr_write_b32 a121, v81
  v_accvgpr_write_b32 a122, v82
  v_accvgpr_write_b32 a123, v83
  v_accvgpr_write_b32 a124, v84
  v_accvgpr_write_b32 a125, v85
  v_accvgpr_write_b32 a126, v86
  v_accvgpr_write_b32 a127, v87
  v_accvgpr_write_b32 a128, v96
  v_accvgpr_write_b32 a129, v97
  v_accvgpr_write_b32 a130, v98
  v_accvgpr_write_b32 a131, v99
  v_accvgpr_write_b32 a132, v100
  v_accvgpr_write_b32 a133, v101
  v_accvgpr_write_b32 a134, v102
  v_accvgpr_write_b32 a135, v103
  v_accvgpr_write_b32 a136, v112
  v_accvgpr_write_b32 a137, v113
  v_accvgpr_write_b32 a138, v114
  v_accvgpr_write_b32 a139, v115
  v_accvgpr_write_b32 a140, v116
  v_accvgpr_write_b32 a141, v117
  v_accvgpr_write_b32 a142, v118
  v_accvgpr_write_b32 a143, v119
  v_accvgpr_write_b32 a144, v128
  v_accvgpr_write_b32 a145, v129
  v_accvgpr_write_b32 a146, v130
  v_accvgpr_write_b32 a147, v131
  v_accvgpr_write_b32 a148, v132
  v_accvgpr_write_b32 a149, v133
  v_accvgpr_write_b32 a150, v134
  v_accvgpr_write_b32 a151, v135
  v_accvgpr_write_b32 a152, v144
  v_accvgpr_write_b32 a153, v145
  v_accvgpr_write_b32 a154, v146
  v_accvgpr_write_b32 a155, v147
  v_accvgpr_write_b32 a156, v148
  v_accvgpr_write_b32 a157, v149
  v_accvgpr_write_b32 a158, v150
  v_accvgpr_write_b32 a159, v151
  s_sub_u32 s30, 15, s63
  s_mov_b32 s31, 0
  s_mov_b32 s32, s64
  s_mov_b32 s33, 99
  s_mov_b32 s43, 2
  s_mov_b32 s66, 1
  s_lshl_b32 s60, s29, 7
  s_lshl_b32 s61, s63, 2
  s_add_u32 s60, s60, s61
  s_add_u32 s60, s60, 2048
  v_mov_b32 v27, s60
  s_mov_b32 s60, 0
k2_qpoll:
  buffer_load_dword v28, v27, s[56:59], 0 offen sc1
  s_waitcnt vmcnt(0)
  v_cmp_ne_u32 vcc, 1, v28
  s_add_u32 s60, s60, 1
  s_cbranch_vccz k2_qpoll_ok
  s_cmp_lt_u32 s60, 262144
  s_cbranch_scc0 k2_qpoll_ok
  s_sleep 1
  s_branch k2_qpoll
k2_qpoll_ok:
  s_branch k2_seg
k2_partial:
  v_cvt_pk_bf16_f32 v32, v32, v33
  v_cvt_pk_bf16_f32 v33, v34, v35
  v_cvt_pk_bf16_f32 v34, v40, v41
  v_cvt_pk_bf16_f32 v35, v42, v43
  s_mov_b32 s61, 0
  buffer_store_dwordx4 v[32:35], v8, s[24:27], s61 offen offset:0 sc1
  v_cvt_pk_bf16_f32 v36, v36, v37
  v_cvt_pk_bf16_f32 v37, v38, v39
  v_cvt_pk_bf16_f32 v38, v44, v45
  v_cvt_pk_bf16_f32 v39, v46, v47
  buffer_store_dwordx4 v[36:39], v8, s[24:27], s61 offen offset:1024 sc1
  v_cvt_pk_bf16_f32 v48, v48, v49
  v_cvt_pk_bf16_f32 v49, v50, v51
  v_cvt_pk_bf16_f32 v50, v56, v57
  v_cvt_pk_bf16_f32 v51, v58, v59
  buffer_store_dwordx4 v[48:51], v8, s[24:27], s61 offen offset:2048 sc1
  v_cvt_pk_bf16_f32 v52, v52, v53
  v_cvt_pk_bf16_f32 v53, v54, v55
  v_cvt_pk_bf16_f32 v54, v60, v61
  v_cvt_pk_bf16_f32 v55, v62, v63
  buffer_store_dwordx4 v[52:55], v8, s[24:27], s61 offen offset:3072 sc1
  v_cvt_pk_bf16_f32 v64, v64, v65
  v_cvt_pk_bf16_f32 v65, v66, v67
  v_cvt_pk_bf16_f32 v66, v72, v73
  v_cvt_pk_bf16_f32 v67, v74, v75
  s_mov_b32 s61, 4096
  buffer_store_dwordx4 v[64:67], v8, s[24:27], s61 offen offset:0 sc1
  v_cvt_pk_bf16_f32 v68, v68, v69
  v_cvt_pk_bf16_f32 v69, v70, v71
  v_cvt_pk_bf16_f32 v70, v76, v77
  v_cvt_pk_bf16_f32 v71, v78, v79
  buffer_store_dwordx4 v[68:71], v8, s[24:27], s61 offen offset:1024 sc1
  v_cvt_pk_bf16_f32 v80, v80, v81
  v_cvt_pk_bf16_f32 v81, v82, v83
  v_cvt_pk_bf16_f32 v82, v88, v89
  v_cvt_pk_bf16_f32 v83, v90, v91
  buffer_store_dwordx4 v[80:83], v8, s[24:27], s61 offen offset:2048 sc1
  v_cvt_pk_bf16_f32 v84, v84, v85
  v_cvt_pk_bf16_f32 v85, v86, v87
  v_cvt_pk_bf16_f32 v86, v92, v93
  v_cvt_pk_bf16_f32 v87, v94, v95
  buffer_store_dwordx4 v[84:87], v8, s[24:27], s61 offen offset:3072 sc1
  v_cvt_pk_bf16_f32 v96, v96, v97
  v_cvt_pk_bf16_f32 v97, v98, v99
  v_cvt_pk_bf16_f32 v98, v104, v105
  v_cvt_pk_bf16_f32 v99, v106, v107
  s_mov_b32 s61, 8192
  buffer_store_dwordx4 v[96:99], v8, s[24:27], s61 offen offset:0 sc1
  v_cvt_pk_bf16_f32 v100, v100, v101
  v_cvt_pk_bf16_f32 v101, v102, v103
  v_cvt_pk_bf16_f32 v102, v108, v109
  v_cvt_pk_bf16_f32 v103, v110, v111
  buffer_store_dwordx4 v[100:103], v8, s[24:27], s61 offen offset:1024 sc1
  v_cvt_pk_bf16_f32 v112, v112, v113
  v_cvt_pk_bf16_f32 v113, v114, v115
  v_cvt_pk_bf16_f32 v114, v120, v121
  v_cvt_pk_bf16_f32 v115, v122, v123
  buffer_store_dwordx4 v[112:115], v8, s[24:27], s61 offen offset:2048 sc1
  v_cvt_pk_bf16_f32 v116, v116, v117
  v_cvt_pk_bf16_f32 v117, v118, v119
  v_cvt_pk_bf16_f32 v118, v124, v125
  v_cvt_pk_bf16_f32 v119, v126, v127
  buffer_store_dwordx4 v[116:119], v8, s[24:27], s61 offen offset:3072 sc1
  v_cvt_pk_bf16_f32 v128, v128, v129
  v_cvt_pk_bf16_f32 v129, v130, v131
  v_cvt_pk_bf16_f32 v130, v136, v137
  v_cvt_pk_bf16_f32 v131, v138, v139
  s_mov_b32 s61, 12288
  buffer_store_dwordx4 v[128:131], v8, s[24:27], s61 offen offset:0 sc1
  v_cvt_pk_bf16_f32 v132, v132, v133
  v_cvt_pk_bf16_f32 v133, v134, v135
  v_cvt_pk_bf16_f32 v134, v140, v141
  v_cvt_pk_bf16_f32 v135, v142, v143
  buffer_store_dwordx4 v[132:135], v8, s[24:27], s61 offen offset:1024 sc1
  v_cvt_pk_bf16_f32 v144, v144, v145
  v_cvt_pk_bf16_f32 v145, v146, v147
  v_cvt_pk_bf16_f32 v146, v152, v153
  v_cvt_pk_bf16_f32 v147, v154, v155
  buffer_store_dwordx4 v[144:147], v8, s[24:27], s61 offen offset:2048 sc1
  v_cvt_pk_bf16_f32 v148, v148, v149
  v_cvt_pk_bf16_f32 v149, v150, v151
  v_cvt_pk_bf16_f32 v150, v156, v157
  v_cvt_pk_bf16_f32 v151, v158, v159
  buffer_store_dwordx4 v[148:151], v8, s[24:27], s61 offen offset:3072 sc1
  v_mov_b32 v28, v208
  v_mov_b32 v29, v6
  v_mov_b32 v30, v212
  v_mov_b32 v31, v7
  s_mov_b32 s61, 0x4000
  buffer_store_dwordx4 v[28:31], v8, s[24:27], s61 offen sc1
  s_mov_b32 s30, s63
  s_mov_b32 s65, 1
  s_mov_b32 s31, 0
  s_lshl_b32 s32, s30, 2
  s_add_u32 s32, s32, 4
  s_mov_b32 s33, s28
  s_mov_b32 s43, 0
  v_accvgpr_mov_b32 a0, a96
  v_accvgpr_mov_b32 a1, a97
  v_accvgpr_mov_b32 a2, a98
  v_accvgpr_mov_b32 a3, a99
  v_accvgpr_mov_b32 a4, a100
  v_accvgpr_mov_b32 a5, a101
  v_accvgpr_mov_b32 a6, a102
  v_accvgpr_mov_b32 a7, a103
  v_accvgpr_mov_b32 a8, a104
  v_accvgpr_mov_b32 a9, a105
  v_accvgpr_mov_b32 a10, a106
  v_accvgpr_mov_b32 a11, a107
  v_accvgpr_mov_b32 a12, a108
  v_accvgpr_mov_b32 a13, a109
  v_accvgpr_mov_b32 a14, a110
  v_accvgpr_mov_b32 a15, a111
  v_accvgpr_mov_b32 a16, a112
  v_accvgpr_mov_b32 a17, a113
  v_accvgpr_mov_b32 a18, a114
  v_accvgpr_mov_b32 a19, a115
  v_accvgpr_mov_b32 a20, a116
  v_accvgpr_mov_b32 a21, a117
  v_accvgpr_mov_b32 a22, a118
  v_accvgpr_mov_b32 a23, a119
  v_accvgpr_mov_b32 a24, a120
  v_accvgpr_mov_b32 a25, a121
  v_accvgpr_mov_b32 a26, a122
  v_accvgpr_mov_b32 a27, a123
  v_accvgpr_mov_b32 a28, a124
  v_accvgpr_mov_b32 a29, a125
  v_accvgpr_mov_b32 a30, a126
  v_accvgpr_mov_b32 a31, a127
  v_accvgpr_mov_b32 a32, a128
  v_accvgpr_mov_b32 a33, a129
  v_accvgpr_mov_b32 a34, a130
  v_accvgpr_mov_b32 a35, a131
  v_accvgpr_mov_b32 a36, a132
  v_accvgpr_mov_b32 a37, a133
  v_accvgpr_mov_b32 a38, a134
  v_accvgpr_mov_b32 a39, a135
  v_accvgpr_mov_b32 a40, a136
  v_accvgpr_mov_b32 a41, a137
  v_accvgpr_mov_b32 a42, a138
  v_accvgpr_mov_b32 a43, a139
  v_accvgpr_mov_b32 a44, a140
  v_accvgpr_mov_b32 a45, a141
  v_accvgpr_mov_b32 a46, a142
  v_accvgpr_mov_b32 a47, a143
  v_accvgpr_mov_b32 a48, a144
  v_accvgpr_mov_b32 a49, a145
  v_accvgpr_mov_b32 a50, a146
  v_accvgpr_mov_b32 a51, a147
  v_accvgpr_mov_b32 a52, a148
  v_accvgpr_mov_b32 a53, a149
  v_accvgpr_mov_b32 a54, a150
  v_accvgpr_mov_b32 a55, a151
  v_accvgpr_mov_b32 a56, a152
  v_accvgpr_mov_b32 a57, a153
  v_accvgpr_mov_b32 a58, a154
  v_accvgpr_mov_b32 a59, a155
  v_accvgpr_mov_b32 a60, a156
  v_accvgpr_mov_b32 a61, a157
  v_accvgpr_mov_b32 a62, a158
  v_accvgpr_mov_b32 a63, a159
  s_mov_b32 s66, 0
  s_branch k2_seg
  s_lshl_b32 s60, s30, 3
  s_lshl_b32 s61, s28, 1
  s_add_u32 s60, s60, s61
  s_mul_i32 s60, s60, 14336
  v_add_u32 v25, s60, v1
  v_add_u32 v26, 14336, v25
  v_accvgpr_read_b32 v32, a96
  v_accvgpr_read_b32 v33, a97
  v_accvgpr_read_b32 v34, a98
  v_accvgpr_read_b32 v35, a99
  v_accvgpr_read_b32 v36, a100
  v_accvgpr_read_b32 v37, a101
  v_accvgpr_read_b32 v38, a102
  v_accvgpr_read_b32 v39, a103
  v_accvgpr_read_b32 v48, a104
  v_accvgpr_read_b32 v49, a105
  v_accvgpr_read_b32 v50, a106
  v_accvgpr_read_b32 v51, a107
  v_accvgpr_read_b32 v52, a108
  v_accvgpr_read_b32 v53, a109
  v_accvgpr_read_b32 v54, a110
  v_accvgpr_read_b32 v55, a111
  v_accvgpr_read_b32 v64, a112
  v_accvgpr_read_b32 v65, a113
  v_accvgpr_read_b32 v66, a114
  v_accvgpr_read_b32 v67, a115
  v_accvgpr_read_b32 v68, a116
  v_accvgpr_read_b32 v69, a117
  v_accvgpr_read_b32 v70, a118
  v_accvgpr_read_b32 v71, a119
  v_accvgpr_read_b32 v80, a120
  v_accvgpr_read_b32 v81, a121
  v_accvgpr_read_b32 v82, a122
  v_accvgpr_read_b32 v83, a123
  v_accvgpr_read_b32 v84, a124
  v_accvgpr_read_b32 v85, a125
  v_accvgpr_read_b32 v86, a126
  v_accvgpr_read_b32 v87, a127
  v_accvgpr_read_b32 v96, a128
  v_accvgpr_read_b32 v97, a129
  v_accvgpr_read_b32 v98, a130
  v_accvgpr_read_b32 v99, a131
  v_accvgpr_read_b32 v100, a132
  v_accvgpr_read_b32 v101, a133
  v_accvgpr_read_b32 v102, a134
  v_accvgpr_read_b32 v103, a135
  v_accvgpr_read_b32 v112, a136
  v_accvgpr_read_b32 v113, a137
  v_accvgpr_read_b32 v114, a138
  v_accvgpr_read_b32 v115, a139
  v_accvgpr_read_b32 v116, a140
  v_accvgpr_read_b32 v117, a141
  v_accvgpr_read_b32 v118, a142
  v_accvgpr_read_b32 v119, a143
  v_accvgpr_read_b32 v128, a144
  v_accvgpr_read_b32 v129, a145
  v_accvgpr_read_b32 v130, a146
  v_accvgpr_read_b32 v131, a147
  v_accvgpr_read_b32 v132, a148
  v_accvgpr_read_b32 v133, a149
  v_accvgpr_read_b32 v134, a150
  v_accvgpr_read_b32 v135, a151
  v_accvgpr_read_b32 v144, a152
  v_accvgpr_read_b32 v145, a153
  v_accvgpr_read_b32 v146, a154
  v_accvgpr_read_b32 v147, a155
  v_accvgpr_read_b32 v148, a156
  v_accvgpr_read_b32 v149, a157
  v_accvgpr_read_b32 v150, a158
  v_accvgpr_read_b32 v151, a159
  s_waitcnt vmcnt(0)
  s_barrier
  s_cmp_eq_u32 s28, 0
  s_cbranch_scc0 k2_oproj
  v_mov_b32 v27, 1
  s_mov_b64 exec, 1
  buffer_store_dword v27, v9, s[56:59], 0 offen sc1
  s_mov_b64 exec, -1
  s_branch k2_oproj
k2_merge:
  s_cmp_eq_u32 s68, 1
  s_cbranch_scc1 k2_have
  s_mov_b32 s60, 0
k2_mpoll:
  buffer_load_dword v27, v9, s[56:59], 0 offen sc1
  s_waitcnt vmcnt(0)
  v_cmp_ne_u32 vcc, 1, v27
  s_add_u32 s60, s60, 1
  s_cbranch_vccz k2_mpoll_ok
  s_cmp_lt_u32 s60, 262144
  s_cbranch_scc0 k2_mpoll_ok
  s_sleep 1
  s_branch k2_mpoll
k2_mpoll_ok:
  s_mov_b32 s61, 0
  buffer_load_dwordx4 a[96:99], v8, s[24:27], s61 offen offset:0 sc1
  buffer_load_dwordx4 a[100:103], v8, s[24:27], s61 offen offset:1024 sc1
  buffer_load_dwordx4 a[104:107], v8, s[24:27], s61 offen offset:2048 sc1
  buffer_load_dwordx4 a[108:111], v8, s[24:27], s61 offen offset:3072 sc1
  s_mov_b32 s61, 4096
  buffer_load_dwordx4 a[112:115], v8, s[24:27], s61 offen offset:0 sc1
  buffer_load_dwordx4 a[116:119], v8, s[24:27], s61 offen offset:1024 sc1
  buffer_load_dwordx4 a[120:123], v8, s[24:27], s61 offen offset:2048 sc1
  buffer_load_dwordx4 a[124:127], v8, s[24:27], s61 offen offset:3072 sc1
  s_mov_b32 s61, 8192
  buffer_load_dwordx4 a[128:131], v8, s[24:27], s61 offen offset:0 sc1
  buffer_load_dwordx4 a[132:135], v8, s[24:27], s61 offen offset:1024 sc1
  buffer_load_dwordx4 a[136:139], v8, s[24:27], s61 offen offset:2048 sc1
  buffer_load_dwordx4 a[140:143], v8, s[24:27], s61 offen offset:3072 sc1
  s_mov_b32 s61, 12288
  buffer_load_dwordx4 a[144:147], v8, s[24:27], s61 offen offset:0 sc1
  buffer_load_dwordx4 a[148:151], v8, s[24:27], s61 offen offset:1024 sc1
  buffer_load_dwordx4 a[152:155], v8, s[24:27], s61 offen offset:2048 sc1
  buffer_load_dwordx4 a[156:159], v8, s[24:27], s61 offen offset:3072 sc1
  s_mov_b32 s61, 16384
  buffer_load_dwordx4 a[160:163], v8, s[24:27], s61 offen offset:0 sc1
k2_have:
  s_waitcnt vmcnt(0)
  v_accvgpr_read_b32 v28, a160
  v_accvgpr_read_b32 v29, a161
  v_accvgpr_read_b32 v30, a162
  v_accvgpr_read_b32 v31, a163
  v_min_f32 v27, v208, v28
  v_sub_f32 v216, v27, v208
  v_sub_f32 v218, v27, v28
  v_exp_f32 v216, v216
  v_exp_f32 v218, v218
  s_nop 0
  v_mul_f32 v27, v218, v29
  v_fma_f32 v27, v6, v216, v27
  v_rcp_f32 v27, v27
  s_nop 0
  v_mul_f32 v216, v216, v27
  v_mul_f32 v218, v218, v27
  v_min_f32 v27, v212, v30
  v_sub_f32 v217, v27, v212
  v_sub_f32 v219, v27, v30
  v_exp_f32 v217, v217
  v_exp_f32 v219, v219
  s_nop 0
  v_mul_f32 v27, v219, v31
  v_fma_f32 v27, v7, v217, v27
  v_rcp_f32 v27, v27
  s_nop 0
  v_mul_f32 v217, v217, v27
  v_mul_f32 v219, v219, v27
  s_mov_b32 s61, 0xffff0000
  v_accvgpr_read_b32 v220, a96
  v_accvgpr_read_b32 v221, a97
  v_accvgpr_read_b32 v222, a98
  v_accvgpr_read_b32 v223, a99
  v_lshlrev_b32 v224, 16, v220
  v_and_b32 v225, s61, v220
  v_lshlrev_b32 v226, 16, v221
  v_and_b32 v227, s61, v221
  v_lshlrev_b32 v228, 16, v222
  v_and_b32 v229, s61, v222
  v_lshlrev_b32 v230, 16, v223
  v_and_b32 v231, s61, v223
  v_pk_mul_f32 v[224:225], v[224:225], v[218:219] op_sel:[0,0] op_sel_hi:[1,0]
  v_pk_mul_f32 v[226:227], v[226:227], v[218:219] op_sel:[0,0] op_sel_hi:[1,0]
  v_pk_mul_f32 v[228:229], v[228:229], v[218:219] op_sel:[0,0] op_sel_hi:[1,0]
  v_pk_mul_f32 v[230:231], v[230:231], v[218:219] op_sel:[0,0] op_sel_hi:[1,0]
  v_pk_fma_f32 v[32:33], v[32:33], v[216:217], v[224:225] op_sel:[0,0,0] op_sel_hi:[1,0,1]
  v_pk_fma_f32 v[34:35], v[34:35], v[216:217], v[226:227] op_sel:[0,0,0] op_sel_hi:[1,0,1]
  v_pk_fma_f32 v[40:41], v[40:41], v[216:217], v[228:229] op_sel:[0,0,0] op_sel_hi:[1,0,1]
  v_pk_fma_f32 v[42:43], v[42:43], v[216:217], v[230:231] op_sel:[0,0,0] op_sel_hi:[1,0,1]
  s_nop 0
  v_cvt_pk_bf16_f32 v32, v32, v33
  v_cvt_pk_bf16_f32 v33, v34, v35
  v_cvt_pk_bf16_f32 v34, v40, v41
  v_cvt_pk_bf16_f32 v35, v42, v43
  v_accvgpr_read_b32 v220, a100
  v_accvgpr_read_b32 v221, a101
  v_accvgpr_read_b32 v222, a102
  v_accvgpr_read_b32 v223, a103
  v_lshlrev_b32 v224, 16, v220
  v_and_b32 v225, s61, v220
  v_lshlrev_b32 v226, 16, v221
  v_and_b32 v227, s61, v221
  v_lshlrev_b32 v228, 16, v222
  v_and_b32 v229, s61, v222
  v_lshlrev_b32 v230, 16, v223
  v_and_b32 v231, s61, v223
  v_pk_mul_f32 v[224:225], v[224:225], v[218:219] op_sel:[0,1] op_sel_hi:[1,1]
  v_pk_mul_f32 v[226:227], v[226:227], v[218:219] op_sel:[0,1] op_sel_hi:[1,1]
  v_pk_mul_f32 v[228:229], v[228:229], v[218:219] op_sel:[0,1] op_sel_hi:[1,1]
  v_pk_mul_f32 v[230:231], v[230:231], v[218:219] op_sel:[0,1] op_sel_hi:[1,1]
  v_pk_fma_f32 v[36:37], v[36:37], v[216:217], v[224:225] op_sel:[0,1,0] op_sel_hi:[1,1,1]
  v_pk_fma_f32 v[38:39], v[38:39], v[216:217], v[226:227] op_sel:[0,1,0] op_sel_hi:[1,1,1]
  v_pk_fma_f32 v[44:45], v[44:45], v[216:217], v[228:229] op_sel:[0,1,0] op_sel_hi:[1,1,1]
  v_pk_fma_f32 v[46:47], v[46:47], v[216:217], v[230:231] op_sel:[0,1,0] op_sel_hi:[1,1,1]
  s_nop 0
  v_cvt_pk_bf16_f32 v36, v36, v37
  v_cvt_pk_bf16_f32 v37, v38, v39
  v_cvt_pk_bf16_f32 v38, v44, v45
  v_cvt_pk_bf16_f32 v39, v46, v47
  v_accvgpr_read_b32 v220, a104
  v_accvgpr_read_b32 v221, a105
  v_accvgpr_read_b32 v222, a106
  v_accvgpr_read_b32 v223, a107
  v_lshlrev_b32 v224, 16, v220
  v_and_b32 v225, s61, v220
  v_lshlrev_b32 v226, 16, v221
  v_and_b32 v227, s61, v221
  v_lshlrev_b32 v228, 16, v222
  v_and_b32 v229, s61, v222
  v_lshlrev_b32 v230, 16, v223
  v_and_b32 v231, s61, v223
  v_pk_mul_f32 v[224:225], v[224:225], v[218:219] op_sel:[0,0] op_sel_hi:[1,0]
  v_pk_mul_f32 v[226:227], v[226:227], v[218:219] op_sel:[0,0] op_sel_hi:[1,0]
  v_pk_mul_f32 v[228:229], v[228:229], v[218:219] op_sel:[0,0] op_sel_hi:[1,0]
  v_pk_mul_f32 v[230:231], v[230:231], v[218:219] op_sel:[0,0] op_sel_hi:[1,0]
  v_pk_fma_f32 v[48:49], v[48:49], v[216:217], v[224:225] op_sel:[0,0,0] op_sel_hi:[1,0,1]
  v_pk_fma_f32 v[50:51], v[50:51], v[216:217], v[226:227] op_sel:[0,0,0] op_sel_hi:[1,0,1]
  v_pk_fma_f32 v[56:57], v[56:57], v[216:217], v[228:229] op_sel:[0,0,0] op_sel_hi:[1,0,1]
  v_pk_fma_f32 v[58:59], v[58:59], v[216:217], v[230:231] op_sel:[0,0,0] op_sel_hi:[1,0,1]
  s_nop 0
  v_cvt_pk_bf16_f32 v48, v48, v49
  v_cvt_pk_bf16_f32 v49, v50, v51
  v_cvt_pk_bf16_f32 v50, v56, v57
  v_cvt_pk_bf16_f32 v51, v58, v59
  v_accvgpr_read_b32 v220, a108
  v_accvgpr_read_b32 v221, a109
  v_accvgpr_read_b32 v222, a110
  v_accvgpr_read_b32 v223, a111
  v_lshlrev_b32 v224, 16, v220
  v_and_b32 v225, s61, v220
  v_lshlrev_b32 v226, 16, v221
  v_and_b32 v227, s61, v221
  v_lshlrev_b32 v228, 16, v222
  v_and_b32 v229, s61, v222
  v_lshlrev_b32 v230, 16, v223
  v_and_b32 v231, s61, v223
  v_pk_mul_f32 v[224:225], v[224:225], v[218:219] op_sel:[0,1] op_sel_hi:[1,1]
  v_pk_mul_f32 v[226:227], v[226:227], v[218:219] op_sel:[0,1] op_sel_hi:[1,1]
  v_pk_mul_f32 v[228:229], v[228:229], v[218:219] op_sel:[0,1] op_sel_hi:[1,1]
  v_pk_mul_f32 v[230:231], v[230:231], v[218:219] op_sel:[0,1] op_sel_hi:[1,1]
  v_pk_fma_f32 v[52:53], v[52:53], v[216:217], v[224:225] op_sel:[0,1,0] op_sel_hi:[1,1,1]
  v_pk_fma_f32 v[54:55], v[54:55], v[216:217], v[226:227] op_sel:[0,1,0] op_sel_hi:[1,1,1]
  v_pk_fma_f32 v[60:61], v[60:61], v[216:217], v[228:229] op_sel:[0,1,0] op_sel_hi:[1,1,1]
  v_pk_fma_f32 v[62:63], v[62:63], v[216:217], v[230:231] op_sel:[0,1,0] op_sel_hi:[1,1,1]
  s_nop 0
  v_cvt_pk_bf16_f32 v52, v52, v53
  v_cvt_pk_bf16_f32 v53, v54, v55
  v_cvt_pk_bf16_f32 v54, v60, v61
  v_cvt_pk_bf16_f32 v55, v62, v63
  v_accvgpr_read_b32 v220, a112
  v_accvgpr_read_b32 v221, a113
  v_accvgpr_read_b32 v222, a114
  v_accvgpr_read_b32 v223, a115
  v_lshlrev_b32 v224, 16, v220
  v_and_b32 v225, s61, v220
  v_lshlrev_b32 v226, 16, v221
  v_and_b32 v227, s61, v221
  v_lshlrev_b32 v228, 16, v222
  v_and_b32 v229, s61, v222
  v_lshlrev_b32 v230, 16, v223
  v_and_b32 v231, s61, v223
  v_pk_mul_f32 v[224:225], v[224:225], v[218:219] op_sel:[0,0] op_sel_hi:[1,0]
  v_pk_mul_f32 v[226:227], v[226:227], v[218:219] op_sel:[0,0] op_sel_hi:[1,0]
  v_pk_mul_f32 v[228:229], v[228:229], v[218:219] op_sel:[0,0] op_sel_hi:[1,0]
  v_pk_mul_f32 v[230:231], v[230:231], v[218:219] op_sel:[0,0] op_sel_hi:[1,0]
  v_pk_fma_f32 v[64:65], v[64:65], v[216:217], v[224:225] op_sel:[0,0,0] op_sel_hi:[1,0,1]
  v_pk_fma_f32 v[66:67], v[66:67], v[216:217], v[226:227] op_sel:[0,0,0] op_sel_hi:[1,0,1]
  v_pk_fma_f32 v[72:73], v[72:73], v[216:217], v[228:229] op_sel:[0,0,0] op_sel_hi:[1,0,1]
  v_pk_fma_f32 v[74:75], v[74:75], v[216:217], v[230:231] op_sel:[0,0,0] op_sel_hi:[1,0,1]
  s_nop 0
  v_cvt_pk_bf16_f32 v64, v64, v65
  v_cvt_pk_bf16_f32 v65, v66, v67
  v_cvt_pk_bf16_f32 v66, v72, v73
  v_cvt_pk_bf16_f32 v67, v74, v75
  v_accvgpr_read_b32 v220, a116
  v_accvgpr_read_b32 v221, a117
  v_accvgpr_read_b32 v222, a118
  v_accvgpr_read_b32 v223, a119
  v_lshlrev_b32 v224, 16, v220
  v_and_b32 v225, s61, v220
  v_lshlrev_b32 v226, 16, v221
  v_and_b32 v227, s61, v221
  v_lshlrev_b32 v228, 16, v222
  v_and_b32 v229, s61, v222
  v_lshlrev_b32 v230, 16, v223
  v_and_b32 v231, s61, v223
  v_pk_mul_f32 v[224:225], v[224:225], v[218:219] op_sel:[0,1] op_sel_hi:[1,1]
  v_pk_mul_f32 v[226:227], v[226:227], v[218:219] op_sel:[0,1] op_sel_hi:[1,1]
  v_pk_mul_f32 v[228:229], v[228:229], v[218:219] op_sel:[0,1] op_sel_hi:[1,1]
  v_pk_mul_f32 v[230:231], v[230:231], v[218:219] op_sel:[0,1] op_sel_hi:[1,1]
  v_pk_fma_f32 v[68:69], v[68:69], v[216:217], v[224:225] op_sel:[0,1,0] op_sel_hi:[1,1,1]
  v_pk_fma_f32 v[70:71], v[70:71], v[216:217], v[226:227] op_sel:[0,1,0] op_sel_hi:[1,1,1]
  v_pk_fma_f32 v[76:77], v[76:77], v[216:217], v[228:229] op_sel:[0,1,0] op_sel_hi:[1,1,1]
  v_pk_fma_f32 v[78:79], v[78:79], v[216:217], v[230:231] op_sel:[0,1,0] op_sel_hi:[1,1,1]
  s_nop 0
  v_cvt_pk_bf16_f32 v68, v68, v69
  v_cvt_pk_bf16_f32 v69, v70, v71
  v_cvt_pk_bf16_f32 v70, v76, v77
  v_cvt_pk_bf16_f32 v71, v78, v79
  v_accvgpr_read_b32 v220, a120
  v_accvgpr_read_b32 v221, a121
  v_accvgpr_read_b32 v222, a122
  v_accvgpr_read_b32 v223, a123
  v_lshlrev_b32 v224, 16, v220
  v_and_b32 v225, s61, v220
  v_lshlrev_b32 v226, 16, v221
  v_and_b32 v227, s61, v221
  v_lshlrev_b32 v228, 16, v222
  v_and_b32 v229, s61, v222
  v_lshlrev_b32 v230, 16, v223
  v_and_b32 v231, s61, v223
  v_pk_mul_f32 v[224:225], v[224:225], v[218:219] op_sel:[0,0] op_sel_hi:[1,0]
  v_pk_mul_f32 v[226:227], v[226:227], v[218:219] op_sel:[0,0] op_sel_hi:[1,0]
  v_pk_mul_f32 v[228:229], v[228:229], v[218:219] op_sel:[0,0] op_sel_hi:[1,0]
  v_pk_mul_f32 v[230:231], v[230:231], v[218:219] op_sel:[0,0] op_sel_hi:[1,0]
  v_pk_fma_f32 v[80:81], v[80:81], v[216:217], v[224:225] op_sel:[0,0,0] op_sel_hi:[1,0,1]
  v_pk_fma_f32 v[82:83], v[82:83], v[216:217], v[226:227] op_sel:[0,0,0] op_sel_hi:[1,0,1]
  v_pk_fma_f32 v[88:89], v[88:89], v[216:217], v[228:229] op_sel:[0,0,0] op_sel_hi:[1,0,1]
  v_pk_fma_f32 v[90:91], v[90:91], v[216:217], v[230:231] op_sel:[0,0,0] op_sel_hi:[1,0,1]
  s_nop 0
  v_cvt_pk_bf16_f32 v80, v80, v81
  v_cvt_pk_bf16_f32 v81, v82, v83
  v_cvt_pk_bf16_f32 v82, v88, v89
  v_cvt_pk_bf16_f32 v83, v90, v91
  v_accvgpr_read_b32 v220, a124
  v_accvgpr_read_b32 v221, a125
  v_accvgpr_read_b32 v222, a126
  v_accvgpr_read_b32 v223, a127
  v_lshlrev_b32 v224, 16, v220
  v_and_b32 v225, s61, v220
  v_lshlrev_b32 v226, 16, v221
  v_and_b32 v227, s61, v221
  v_lshlrev_b32 v228, 16, v222
  v_and_b32 v229, s61, v222
  v_lshlrev_b32 v230, 16, v223
  v_and_b32 v231, s61, v223
  v_pk_mul_f32 v[224:225], v[224:225], v[218:219] op_sel:[0,1] op_sel_hi:[1,1]
  v_pk_mul_f32 v[226:227], v[226:227], v[218:219] op_sel:[0,1] op_sel_hi:[1,1]
  v_pk_mul_f32 v[228:229], v[228:229], v[218:219] op_sel:[0,1] op_sel_hi:[1,1]
  v_pk_mul_f32 v[230:231], v[230:231], v[218:219] op_sel:[0,1] op_sel_hi:[1,1]
  v_pk_fma_f32 v[84:85], v[84:85], v[216:217], v[224:225] op_sel:[0,1,0] op_sel_hi:[1,1,1]
  v_pk_fma_f32 v[86:87], v[86:87], v[216:217], v[226:227] op_sel:[0,1,0] op_sel_hi:[1,1,1]
  v_pk_fma_f32 v[92:93], v[92:93], v[216:217], v[228:229] op_sel:[0,1,0] op_sel_hi:[1,1,1]
  v_pk_fma_f32 v[94:95], v[94:95], v[216:217], v[230:231] op_sel:[0,1,0] op_sel_hi:[1,1,1]
  s_nop 0
  v_cvt_pk_bf16_f32 v84, v84, v85
  v_cvt_pk_bf16_f32 v85, v86, v87
  v_cvt_pk_bf16_f32 v86, v92, v93
  v_cvt_pk_bf16_f32 v87, v94, v95
  v_accvgpr_read_b32 v220, a128
  v_accvgpr_read_b32 v221, a129
  v_accvgpr_read_b32 v222, a130
  v_accvgpr_read_b32 v223, a131
  v_lshlrev_b32 v224, 16, v220
  v_and_b32 v225, s61, v220
  v_lshlrev_b32 v226, 16, v221
  v_and_b32 v227, s61, v221
  v_lshlrev_b32 v228, 16, v222
  v_and_b32 v229, s61, v222
  v_lshlrev_b32 v230, 16, v223
  v_and_b32 v231, s61, v223
  v_pk_mul_f32 v[224:225], v[224:225], v[218:219] op_sel:[0,0] op_sel_hi:[1,0]
  v_pk_mul_f32 v[226:227], v[226:227], v[218:219] op_sel:[0,0] op_sel_hi:[1,0]
  v_pk_mul_f32 v[228:229], v[228:229], v[218:219] op_sel:[0,0] op_sel_hi:[1,0]
  v_pk_mul_f32 v[230:231], v[230:231], v[218:219] op_sel:[0,0] op_sel_hi:[1,0]
  v_pk_fma_f32 v[96:97], v[96:97], v[216:217], v[224:225] op_sel:[0,0,0] op_sel_hi:[1,0,1]
  v_pk_fma_f32 v[98:99], v[98:99], v[216:217], v[226:227] op_sel:[0,0,0] op_sel_hi:[1,0,1]
  v_pk_fma_f32 v[104:105], v[104:105], v[216:217], v[228:229] op_sel:[0,0,0] op_sel_hi:[1,0,1]
  v_pk_fma_f32 v[106:107], v[106:107], v[216:217], v[230:231] op_sel:[0,0,0] op_sel_hi:[1,0,1]
  s_nop 0
  v_cvt_pk_bf16_f32 v96, v96, v97
  v_cvt_pk_bf16_f32 v97, v98, v99
  v_cvt_pk_bf16_f32 v98, v104, v105
  v_cvt_pk_bf16_f32 v99, v106, v107
  v_accvgpr_read_b32 v220, a132
  v_accvgpr_read_b32 v221, a133
  v_accvgpr_read_b32 v222, a134
  v_accvgpr_read_b32 v223, a135
  v_lshlrev_b32 v224, 16, v220
  v_and_b32 v225, s61, v220
  v_lshlrev_b32 v226, 16, v221
  v_and_b32 v227, s61, v221
  v_lshlrev_b32 v228, 16, v222
  v_and_b32 v229, s61, v222
  v_lshlrev_b32 v230, 16, v223
  v_and_b32 v231, s61, v223
  v_pk_mul_f32 v[224:225], v[224:225], v[218:219] op_sel:[0,1] op_sel_hi:[1,1]
  v_pk_mul_f32 v[226:227], v[226:227], v[218:219] op_sel:[0,1] op_sel_hi:[1,1]
  v_pk_mul_f32 v[228:229], v[228:229], v[218:219] op_sel:[0,1] op_sel_hi:[1,1]
  v_pk_mul_f32 v[230:231], v[230:231], v[218:219] op_sel:[0,1] op_sel_hi:[1,1]
  v_pk_fma_f32 v[100:101], v[100:101], v[216:217], v[224:225] op_sel:[0,1,0] op_sel_hi:[1,1,1]
  v_pk_fma_f32 v[102:103], v[102:103], v[216:217], v[226:227] op_sel:[0,1,0] op_sel_hi:[1,1,1]
  v_pk_fma_f32 v[108:109], v[108:109], v[216:217], v[228:229] op_sel:[0,1,0] op_sel_hi:[1,1,1]
  v_pk_fma_f32 v[110:111], v[110:111], v[216:217], v[230:231] op_sel:[0,1,0] op_sel_hi:[1,1,1]
  s_nop 0
  v_cvt_pk_bf16_f32 v100, v100, v101
  v_cvt_pk_bf16_f32 v101, v102, v103
  v_cvt_pk_bf16_f32 v102, v108, v109
  v_cvt_pk_bf16_f32 v103, v110, v111
  v_accvgpr_read_b32 v220, a136
  v_accvgpr_read_b32 v221, a137
  v_accvgpr_read_b32 v222, a138
  v_accvgpr_read_b32 v223, a139
  v_lshlrev_b32 v224, 16, v220
  v_and_b32 v225, s61, v220
  v_lshlrev_b32 v226, 16, v221
  v_and_b32 v227, s61, v221
  v_lshlrev_b32 v228, 16, v222
  v_and_b32 v229, s61, v222
  v_lshlrev_b32 v230, 16, v223
  v_and_b32 v231, s61, v223
  v_pk_mul_f32 v[224:225], v[224:225], v[218:219] op_sel:[0,0] op_sel_hi:[1,0]
  v_pk_mul_f32 v[226:227], v[226:227], v[218:219] op_sel:[0,0] op_sel_hi:[1,0]
  v_pk_mul_f32 v[228:229], v[228:229], v[218:219] op_sel:[0,0] op_sel_hi:[1,0]
  v_pk_mul_f32 v[230:231], v[230:231], v[218:219] op_sel:[0,0] op_sel_hi:[1,0]
  v_pk_fma_f32 v[112:113], v[112:113], v[216:217], v[224:225] op_sel:[0,0,0] op_sel_hi:[1,0,1]
  v_pk_fma_f32 v[114:115], v[114:115], v[216:217], v[226:227] op_sel:[0,0,0] op_sel_hi:[1,0,1]
  v_pk_fma_f32 v[120:121], v[120:121], v[216:217], v[228:229] op_sel:[0,0,0] op_sel_hi:[1,0,1]
  v_pk_fma_f32 v[122:123], v[122:123], v[216:217], v[230:231] op_sel:[0,0,0] op_sel_hi:[1,0,1]
  s_nop 0
  v_cvt_pk_bf16_f32 v112, v112, v113
  v_cvt_pk_bf16_f32 v113, v114, v115
  v_cvt_pk_bf16_f32 v114, v120, v121
  v_cvt_pk_bf16_f32 v115, v122, v123
  v_accvgpr_read_b32 v220, a140
  v_accvgpr_read_b32 v221, a141
  v_accvgpr_read_b32 v222, a142
  v_accvgpr_read_b32 v223, a143
  v_lshlrev_b32 v224, 16, v220
  v_and_b32 v225, s61, v220
  v_lshlrev_b32 v226, 16, v221
  v_and_b32 v227, s61, v221
  v_lshlrev_b32 v228, 16, v222
  v_and_b32 v229, s61, v222
  v_lshlrev_b32 v230, 16, v223
  v_and_b32 v231, s61, v223
  v_pk_mul_f32 v[224:225], v[224:225], v[218:219] op_sel:[0,1] op_sel_hi:[1,1]
  v_pk_mul_f32 v[226:227], v[226:227], v[218:219] op_sel:[0,1] op_sel_hi:[1,1]
  v_pk_mul_f32 v[228:229], v[228:229], v[218:219] op_sel:[0,1] op_sel_hi:[1,1]
  v_pk_mul_f32 v[230:231], v[230:231], v[218:219] op_sel:[0,1] op_sel_hi:[1,1]
  v_pk_fma_f32 v[116:117], v[116:117], v[216:217], v[224:225] op_sel:[0,1,0] op_sel_hi:[1,1,1]
  v_pk_fma_f32 v[118:119], v[118:119], v[216:217], v[226:227] op_sel:[0,1,0] op_sel_hi:[1,1,1]
  v_pk_fma_f32 v[124:125], v[124:125], v[216:217], v[228:229] op_sel:[0,1,0] op_sel_hi:[1,1,1]
  v_pk_fma_f32 v[126:127], v[126:127], v[216:217], v[230:231] op_sel:[0,1,0] op_sel_hi:[1,1,1]
  s_nop 0
  v_cvt_pk_bf16_f32 v116, v116, v117
  v_cvt_pk_bf16_f32 v117, v118, v119
  v_cvt_pk_bf16_f32 v118, v124, v125
  v_cvt_pk_bf16_f32 v119, v126, v127
  v_accvgpr_read_b32 v220, a144
  v_accvgpr_read_b32 v221, a145
  v_accvgpr_read_b32 v222, a146
  v_accvgpr_read_b32 v223, a147
  v_lshlrev_b32 v224, 16, v220
  v_and_b32 v225, s61, v220
  v_lshlrev_b32 v226, 16, v221
  v_and_b32 v227, s61, v221
  v_lshlrev_b32 v228, 16, v222
  v_and_b32 v229, s61, v222
  v_lshlrev_b32 v230, 16, v223
  v_and_b32 v231, s61, v223
  v_pk_mul_f32 v[224:225], v[224:225], v[218:219] op_sel:[0,0] op_sel_hi:[1,0]
  v_pk_mul_f32 v[226:227], v[226:227], v[218:219] op_sel:[0,0] op_sel_hi:[1,0]
  v_pk_mul_f32 v[228:229], v[228:229], v[218:219] op_sel:[0,0] op_sel_hi:[1,0]
  v_pk_mul_f32 v[230:231], v[230:231], v[218:219] op_sel:[0,0] op_sel_hi:[1,0]
  v_pk_fma_f32 v[128:129], v[128:129], v[216:217], v[224:225] op_sel:[0,0,0] op_sel_hi:[1,0,1]
  v_pk_fma_f32 v[130:131], v[130:131], v[216:217], v[226:227] op_sel:[0,0,0] op_sel_hi:[1,0,1]
  v_pk_fma_f32 v[136:137], v[136:137], v[216:217], v[228:229] op_sel:[0,0,0] op_sel_hi:[1,0,1]
  v_pk_fma_f32 v[138:139], v[138:139], v[216:217], v[230:231] op_sel:[0,0,0] op_sel_hi:[1,0,1]
  s_nop 0
  v_cvt_pk_bf16_f32 v128, v128, v129
  v_cvt_pk_bf16_f32 v129, v130, v131
  v_cvt_pk_bf16_f32 v130, v136, v137
  v_cvt_pk_bf16_f32 v131, v138, v139
  v_accvgpr_read_b32 v220, a148
  v_accvgpr_read_b32 v221, a149
  v_accvgpr_read_b32 v222, a150
  v_accvgpr_read_b32 v223, a151
  v_lshlrev_b32 v224, 16, v220
  v_and_b32 v225, s61, v220
  v_lshlrev_b32 v226, 16, v221
  v_and_b32 v227, s61, v221
  v_lshlrev_b32 v228, 16, v222
  v_and_b32 v229, s61, v222
  v_lshlrev_b32 v230, 16, v223
  v_and_b32 v231, s61, v223
  v_pk_mul_f32 v[224:225], v[224:225], v[218:219] op_sel:[0,1] op_sel_hi:[1,1]
  v_pk_mul_f32 v[226:227], v[226:227], v[218:219] op_sel:[0,1] op_sel_hi:[1,1]
  v_pk_mul_f32 v[228:229], v[228:229], v[218:219] op_sel:[0,1] op_sel_hi:[1,1]
  v_pk_mul_f32 v[230:231], v[230:231], v[218:219] op_sel:[0,1] op_sel_hi:[1,1]
  v_pk_fma_f32 v[132:133], v[132:133], v[216:217], v[224:225] op_sel:[0,1,0] op_sel_hi:[1,1,1]
  v_pk_fma_f32 v[134:135], v[134:135], v[216:217], v[226:227] op_sel:[0,1,0] op_sel_hi:[1,1,1]
  v_pk_fma_f32 v[140:141], v[140:141], v[216:217], v[228:229] op_sel:[0,1,0] op_sel_hi:[1,1,1]
  v_pk_fma_f32 v[142:143], v[142:143], v[216:217], v[230:231] op_sel:[0,1,0] op_sel_hi:[1,1,1]
  s_nop 0
  v_cvt_pk_bf16_f32 v132, v132, v133
  v_cvt_pk_bf16_f32 v133, v134, v135
  v_cvt_pk_bf16_f32 v134, v140, v141
  v_cvt_pk_bf16_f32 v135, v142, v143
  v_accvgpr_read_b32 v220, a152
  v_accvgpr_read_b32 v221, a153
  v_accvgpr_read_b32 v222, a154
  v_accvgpr_read_b32 v223, a155
  v_lshlrev_b32 v224, 16, v220
  v_and_b32 v225, s61, v220
  v_lshlrev_b32 v226, 16, v221
  v_and_b32 v227, s61, v221
  v_lshlrev_b32 v228, 16, v222
  v_and_b32 v229, s61, v222
  v_lshlrev_b32 v230, 16, v223
  v_and_b32 v231, s61, v223
  v_pk_mul_f32 v[224:225], v[224:225], v[218:219] op_sel:[0,0] op_sel_hi:[1,0]
  v_pk_mul_f32 v[226:227], v[226:227], v[218:219] op_sel:[0,0] op_sel_hi:[1,0]
  v_pk_mul_f32 v[228:229], v[228:229], v[218:219] op_sel:[0,0] op_sel_hi:[1,0]
  v_pk_mul_f32 v[230:231], v[230:231], v[218:219] op_sel:[0,0] op_sel_hi:[1,0]
  v_pk_fma_f32 v[144:145], v[144:145], v[216:217], v[224:225] op_sel:[0,0,0] op_sel_hi:[1,0,1]
  v_pk_fma_f32 v[146:147], v[146:147], v[216:217], v[226:227] op_sel:[0,0,0] op_sel_hi:[1,0,1]
  v_pk_fma_f32 v[152:153], v[152:153], v[216:217], v[228:229] op_sel:[0,0,0] op_sel_hi:[1,0,1]
  v_pk_fma_f32 v[154:155], v[154:155], v[216:217], v[230:231] op_sel:[0,0,0] op_sel_hi:[1,0,1]
  s_nop 0
  v_cvt_pk_bf16_f32 v144, v144, v145
  v_cvt_pk_bf16_f32 v145, v146, v147
  v_cvt_pk_bf16_f32 v146, v152, v153
  v_cvt_pk_bf16_f32 v147, v154, v155
  v_accvgpr_read_b32 v220, a156
  v_accvgpr_read_b32 v221, a157
  v_accvgpr_read_b32 v222, a158
  v_accvgpr_read_b32 v223, a159
  v_lshlrev_b32 v224, 16, v220
  v_and_b32 v225, s61, v220
  v_lshlrev_b32 v226, 16, v221
  v_and_b32 v227, s61, v221
  v_lshlrev_b32 v228, 16, v222
  v_and_b32 v229, s61, v222
  v_lshlrev_b32 v230, 16, v223
  v_and_b32 v231, s61, v223
  v_pk_mul_f32 v[224:225], v[224:225], v[218:219] op_sel:[0,1] op_sel_hi:[1,1]
  v_pk_mul_f32 v[226:227], v[226:227], v[218:219] op_sel:[0,1] op_sel_hi:[1,1]
  v_pk_mul_f32 v[228:229], v[228:229], v[218:219] op_sel:[0,1] op_sel_hi:[1,1]
  v_pk_mul_f32 v[230:231], v[230:231], v[218:219] op_sel:[0,1] op_sel_hi:[1,1]
  v_pk_fma_f32 v[148:149], v[148:149], v[216:217], v[224:225] op_sel:[0,1,0] op_sel_hi:[1,1,1]
  v_pk_fma_f32 v[150:151], v[150:151], v[216:217], v[226:227] op_sel:[0,1,0] op_sel_hi:[1,1,1]
  v_pk_fma_f32 v[156:157], v[156:157], v[216:217], v[228:229] op_sel:[0,1,0] op_sel_hi:[1,1,1]
  v_pk_fma_f32 v[158:159], v[158:159], v[216:217], v[230:231] op_sel:[0,1,0] op_sel_hi:[1,1,1]
  s_nop 0
  v_cvt_pk_bf16_f32 v148, v148, v149
  v_cvt_pk_bf16_f32 v149, v150, v151
  v_cvt_pk_bf16_f32 v150, v156, v157
  v_cvt_pk_bf16_f32 v151, v158, v159
k2_oproj:
  s_add_u32 m0, s40, 65536
  s_mov_b32 s39, 256
  buffer_load_dwordx4 v21, s[16:19], s39 offen offset:0 lds
  buffer_load_dwordx4 v22, s[16:19], s39 offen offset:1024 lds
  buffer_load_dwordx4 v23, s[16:19], s39 offen offset:2048 lds
  buffer_load_dwordx4 v24, s[16:19], s39 offen offset:3072 lds
  s_add_u32 m0, s40, 69632
  s_mov_b32 s39, 28928
  buffer_load_dwordx4 v21, s[16:19], s39 offen offset:0 lds
  buffer_load_dwordx4 v22, s[16:19], s39 offen offset:1024 lds
  buffer_load_dwordx4 v23, s[16:19], s39 offen offset:2048 lds
  buffer_load_dwordx4 v24, s[16:19], s39 offen offset:3072 lds
  s_add_u32 m0, s40, 98304
  s_mov_b32 s39, 384
  buffer_load_dwordx4 v21, s[16:19], s39 offen offset:0 lds
  buffer_load_dwordx4 v22, s[16:19], s39 offen offset:1024 lds
  buffer_load_dwordx4 v23, s[16:19], s39 offen offset:2048 lds
  buffer_load_dwordx4 v24, s[16:19], s39 offen offset:3072 lds
  s_add_u32 m0, s40, 102400
  s_mov_b32 s39, 29056
  buffer_load_dwordx4 v21, s[16:19], s39 offen offset:0 lds
  buffer_load_dwordx4 v22, s[16:19], s39 offen offset:1024 lds
  buffer_load_dwordx4 v23, s[16:19], s39 offen offset:2048 lds
  buffer_load_dwordx4 v24, s[16:19], s39 offen offset:3072 lds
  s_waitcnt vmcnt(24)
  s_barrier
  ds_read_b64_tr_b16 a[64:65], v13 offset:0
  ds_read_b64_tr_b16 a[66:67], v13 offset:2048
  ds_read_b64_tr_b16 a[68:69], v13 offset:4096
  ds_read_b64_tr_b16 a[70:71], v13 offset:6144
  ds_read_b64_tr_b16 a[72:73], v13 offset:8192
  ds_read_b64_tr_b16 a[74:75], v13 offset:10240
  ds_read_b64_tr_b16 a[76:77], v13 offset:12288
  ds_read_b64_tr_b16 a[78:79], v13 offset:14336
  ds_read_b64_tr_b16 a[80:81], v13 offset:16384
  ds_read_b64_tr_b16 a[82:83], v13 offset:18432
  ds_read_b64_tr_b16 a[84:85], v13 offset:20480
  ds_read_b64_tr_b16 a[86:87], v13 offset:22528
  s_waitcnt lgkmcnt(10)
  v_mfma_f32_16x16x32_bf16 v[40:43], a[64:67], v[32:35], 0
  ds_read_b64_tr_b16 a[88:89], v13 offset:24576
  v_mfma_f32_16x16x32_bf16 v[44:47], a[64:67], v[36:39], 0
  ds_read_b64_tr_b16 a[90:91], v13 offset:26624
  s_waitcnt lgkmcnt(10)
  v_mfma_f32_16x16x32_bf16 v[40:43], a[68:71], v[48:51], v[40:43]
  ds_read_b64_tr_b16 a[92:93], v13 offset:28672
  v_mfma_f32_16x16x32_bf16 v[44:47], a[68:71], v[52:55], v[44:47]
  ds_read_b64_tr_b16 a[94:95], v13 offset:30720
  s_waitcnt lgkmcnt(10)
  v_mfma_f32_16x16x32_bf16 v[40:43], a[72:75], v[64:67], v[40:43]
  ds_read_b64_tr_b16 a[64:65], v14 offset:0
  v_mfma_f32_16x16x32_bf16 v[44:47], a[72:75], v[68:71], v[44:47]
  ds_read_b64_tr_b16 a[66:67], v14 offset:2048
  s_waitcnt lgkmcnt(10)
  v_mfma_f32_16x16x32_bf16 v[40:43], a[76:79], v[80:83], v[40:43]
  ds_read_b64_tr_b16 a[68:69], v14 offset:4096
  v_mfma_f32_16x16x32_bf16 v[44:47], a[76:79], v[84:87], v[44:47]
  ds_read_b64_tr_b16 a[70:71], v14 offset:6144
  s_waitcnt lgkmcnt(10)
  v_mfma_f32_16x16x32_bf16 v[40:43], a[80:83], v[96:99], v[40:43]
  ds_read_b64_tr_b16 a[72:73], v14 offset:8192
  v_mfma_f32_16x16x32_bf16 v[44:47], a[80:83], v[100:103], v[44:47]
  ds_read_b64_tr_b16 a[74:75], v14 offset:10240
  s_waitcnt lgkmcnt(10)
  v_mfma_f32_16x16x32_bf16 v[40:43], a[84:87], v[112:115], v[40:43]
  ds_read_b64_tr_b16 a[76:77], v14 offset:12288
  v_mfma_f32_16x16x32_bf16 v[44:47], a[84:87], v[116:119], v[44:47]
  ds_read_b64_tr_b16 a[78:79], v14 offset:14336
  s_waitcnt lgkmcnt(10)
  v_mfma_f32_16x16x32_bf16 v[40:43], a[88:91], v[128:131], v[40:43]
  ds_read_b64_tr_b16 a[80:81], v14 offset:16384
  v_mfma_f32_16x16x32_bf16 v[44:47], a[88:91], v[132:135], v[44:47]
  ds_read_b64_tr_b16 a[82:83], v14 offset:18432
  s_waitcnt lgkmcnt(10)
  v_mfma_f32_16x16x32_bf16 v[40:43], a[92:95], v[144:147], v[40:43]
  ds_read_b64_tr_b16 a[84:85], v14 offset:20480
  v_mfma_f32_16x16x32_bf16 v[44:47], a[92:95], v[148:151], v[44:47]
  ds_read_b64_tr_b16 a[86:87], v14 offset:22528
  s_waitcnt lgkmcnt(10)
  v_mfma_f32_16x16x32_bf16 v[56:59], a[64:67], v[32:35], 0
  ds_read_b64_tr_b16 a[88:89], v14 offset:24576
  v_mfma_f32_16x16x32_bf16 v[60:63], a[64:67], v[36:39], 0
  ds_read_b64_tr_b16 a[90:91], v14 offset:26624
  s_waitcnt lgkmcnt(10)
  v_mfma_f32_16x16x32_bf16 v[56:59], a[68:71], v[48:51], v[56:59]
  ds_read_b64_tr_b16 a[92:93], v14 offset:28672
  v_mfma_f32_16x16x32_bf16 v[60:63], a[68:71], v[52:55], v[60:63]
  ds_read_b64_tr_b16 a[94:95], v14 offset:30720
  s_waitcnt lgkmcnt(10)
  v_mfma_f32_16x16x32_bf16 v[56:59], a[72:75], v[64:67], v[56:59]
  ds_read_b64_tr_b16 a[64:65], v15 offset:0
  v_mfma_f32_16x16x32_bf16 v[60:63], a[72:75], v[68:71], v[60:63]
  ds_read_b64_tr_b16 a[66:67], v15 offset:2048
  s_waitcnt lgkmcnt(10)
  v_mfma_f32_16x16x32_bf16 v[56:59], a[76:79], v[80:83], v[56:59]
  ds_read_b64_tr_b16 a[68:69], v15 offset:4096
  v_mfma_f32_16x16x32_bf16 v[60:63], a[76:79], v[84:87], v[60:63]
  ds_read_b64_tr_b16 a[70:71], v15 offset:6144
  s_waitcnt lgkmcnt(10)
  v_mfma_f32_16x16x32_bf16 v[56:59], a[80:83], v[96:99], v[56:59]
  ds_read_b64_tr_b16 a[72:73], v15 offset:8192
  v_mfma_f32_16x16x32_bf16 v[60:63], a[80:83], v[100:103], v[60:63]
  ds_read_b64_tr_b16 a[74:75], v15 offset:10240
  s_waitcnt lgkmcnt(10)
  v_mfma_f32_16x16x32_bf16 v[56:59], a[84:87], v[112:115], v[56:59]
  ds_read_b64_tr_b16 a[76:77], v15 offset:12288
  v_mfma_f32_16x16x32_bf16 v[60:63], a[84:87], v[116:119], v[60:63]
  ds_read_b64_tr_b16 a[78:79], v15 offset:14336
  s_waitcnt lgkmcnt(10)
  v_mfma_f32_16x16x32_bf16 v[56:59], a[88:91], v[128:131], v[56:59]
  ds_read_b64_tr_b16 a[80:81], v15 offset:16384
  v_mfma_f32_16x16x32_bf16 v[60:63], a[88:91], v[132:135], v[60:63]
  ds_read_b64_tr_b16 a[82:83], v15 offset:18432
  s_waitcnt lgkmcnt(10)
  v_mfma_f32_16x16x32_bf16 v[56:59], a[92:95], v[144:147], v[56:59]
  ds_read_b64_tr_b16 a[84:85], v15 offset:20480
  v_mfma_f32_16x16x32_bf16 v[60:63], a[92:95], v[148:151], v[60:63]
  ds_read_b64_tr_b16 a[86:87], v15 offset:22528
  s_waitcnt lgkmcnt(10)
  v_mfma_f32_16x16x32_bf16 v[72:75], a[64:67], v[32:35], 0
  ds_read_b64_tr_b16 a[88:89], v15 offset:24576
  v_mfma_f32_16x16x32_bf16 v[76:79], a[64:67], v[36:39], 0
  ds_read_b64_tr_b16 a[90:91], v15 offset:26624
  s_waitcnt lgkmcnt(10)
  v_mfma_f32_16x16x32_bf16 v[72:75], a[68:71], v[48:51], v[72:75]
  ds_read_b64_tr_b16 a[92:93], v15 offset:28672
  v_mfma_f32_16x16x32_bf16 v[76:79], a[68:71], v[52:55], v[76:79]
  ds_read_b64_tr_b16 a[94:95], v15 offset:30720
  s_waitcnt lgkmcnt(10)
  v_mfma_f32_16x16x32_bf16 v[72:75], a[72:75], v[64:67], v[72:75]
  ds_read_b64_tr_b16 a[64:65], v16 offset:0
  v_mfma_f32_16x16x32_bf16 v[76:79], a[72:75], v[68:71], v[76:79]
  ds_read_b64_tr_b16 a[66:67], v16 offset:2048
  s_waitcnt lgkmcnt(10)
  v_mfma_f32_16x16x32_bf16 v[72:75], a[76:79], v[80:83], v[72:75]
  ds_read_b64_tr_b16 a[68:69], v16 offset:4096
  v_mfma_f32_16x16x32_bf16 v[76:79], a[76:79], v[84:87], v[76:79]
  ds_read_b64_tr_b16 a[70:71], v16 offset:6144
  s_waitcnt lgkmcnt(10)
  v_mfma_f32_16x16x32_bf16 v[72:75], a[80:83], v[96:99], v[72:75]
  ds_read_b64_tr_b16 a[72:73], v16 offset:8192
  v_mfma_f32_16x16x32_bf16 v[76:79], a[80:83], v[100:103], v[76:79]
  ds_read_b64_tr_b16 a[74:75], v16 offset:10240
  s_waitcnt lgkmcnt(10)
  v_mfma_f32_16x16x32_bf16 v[72:75], a[84:87], v[112:115], v[72:75]
  ds_read_b64_tr_b16 a[76:77], v16 offset:12288
  v_mfma_f32_16x16x32_bf16 v[76:79], a[84:87], v[116:119], v[76:79]
  ds_read_b64_tr_b16 a[78:79], v16 offset:14336
  s_waitcnt lgkmcnt(10)
  v_mfma_f32_16x16x32_bf16 v[72:75], a[88:91], v[128:131], v[72:75]
  ds_read_b64_tr_b16 a[80:81], v16 offset:16384
  v_mfma_f32_16x16x32_bf16 v[76:79], a[88:91], v[132:135], v[76:79]
  ds_read_b64_tr_b16 a[82:83], v16 offset:18432
  s_waitcnt lgkmcnt(10)
  v_mfma_f32_16x16x32_bf16 v[72:75], a[92:95], v[144:147], v[72:75]
  ds_read_b64_tr_b16 a[84:85], v16 offset:20480
  v_mfma_f32_16x16x32_bf16 v[76:79], a[92:95], v[148:151], v[76:79]
  ds_read_b64_tr_b16 a[86:87], v16 offset:22528
  s_waitcnt lgkmcnt(10)
  v_mfma_f32_16x16x32_bf16 v[88:91], a[64:67], v[32:35], 0
  ds_read_b64_tr_b16 a[88:89], v16 offset:24576
  v_mfma_f32_16x16x32_bf16 v[92:95], a[64:67], v[36:39], 0
  ds_read_b64_tr_b16 a[90:91], v16 offset:26624
  s_waitcnt lgkmcnt(10)
  v_mfma_f32_16x16x32_bf16 v[88:91], a[68:71], v[48:51], v[88:91]
  ds_read_b64_tr_b16 a[92:93], v16 offset:28672
  v_mfma_f32_16x16x32_bf16 v[92:95], a[68:71], v[52:55], v[92:95]
  ds_read_b64_tr_b16 a[94:95], v16 offset:30720
  s_waitcnt lgkmcnt(10)
  v_mfma_f32_16x16x32_bf16 v[88:91], a[72:75], v[64:67], v[88:91]
  v_mfma_f32_16x16x32_bf16 v[92:95], a[72:75], v[68:71], v[92:95]
  s_waitcnt lgkmcnt(8)
  v_mfma_f32_16x16x32_bf16 v[88:91], a[76:79], v[80:83], v[88:91]
  v_mfma_f32_16x16x32_bf16 v[92:95], a[76:79], v[84:87], v[92:95]
  s_waitcnt lgkmcnt(6)
  v_mfma_f32_16x16x32_bf16 v[88:91], a[80:83], v[96:99], v[88:91]
  v_mfma_f32_16x16x32_bf16 v[92:95], a[80:83], v[100:103], v[92:95]
  s_waitcnt lgkmcnt(4)
  v_mfma_f32_16x16x32_bf16 v[88:91], a[84:87], v[112:115], v[88:91]
  v_mfma_f32_16x16x32_bf16 v[92:95], a[84:87], v[116:119], v[92:95]
  s_waitcnt lgkmcnt(2)
  v_mfma_f32_16x16x32_bf16 v[88:91], a[88:91], v[128:131], v[88:91]
  v_mfma_f32_16x16x32_bf16 v[92:95], a[88:91], v[132:135], v[92:95]
  s_waitcnt lgkmcnt(0)
  v_mfma_f32_16x16x32_bf16 v[88:91], a[92:95], v[144:147], v[88:91]
  v_mfma_f32_16x16x32_bf16 v[92:95], a[92:95], v[148:151], v[92:95]
  s_waitcnt vmcnt(16)
  s_barrier
  s_add_u32 m0, s40, 0
  s_mov_b32 s39, 512
  buffer_load_dwordx4 v21, s[16:19], s39 offen offset:0 lds
  buffer_load_dwordx4 v22, s[16:19], s39 offen offset:1024 lds
  buffer_load_dwordx4 v23, s[16:19], s39 offen offset:2048 lds
  buffer_load_dwordx4 v24, s[16:19], s39 offen offset:3072 lds
  s_add_u32 m0, s40, 4096
  s_mov_b32 s39, 29184
  buffer_load_dwordx4 v21, s[16:19], s39 offen offset:0 lds
  buffer_load_dwordx4 v22, s[16:19], s39 offen offset:1024 lds
  buffer_load_dwordx4 v23, s[16:19], s39 offen offset:2048 lds
  buffer_load_dwordx4 v24, s[16:19], s39 offen offset:3072 lds
  ds_read_b64_tr_b16 a[64:65], v13 offset:32768
  ds_read_b64_tr_b16 a[66:67], v13 offset:34816
  ds_read_b64_tr_b16 a[68:69], v13 offset:36864
  ds_read_b64_tr_b16 a[70:71], v13 offset:38912
  ds_read_b64_tr_b16 a[72:73], v13 offset:40960
  ds_read_b64_tr_b16 a[74:75], v13 offset:43008
  ds_read_b64_tr_b16 a[76:77], v13 offset:45056
  ds_read_b64_tr_b16 a[78:79], v13 offset:47104
  ds_read_b64_tr_b16 a[80:81], v13 offset:49152
  ds_read_b64_tr_b16 a[82:83], v13 offset:51200
  ds_read_b64_tr_b16 a[84:85], v13 offset:53248
  ds_read_b64_tr_b16 a[86:87], v13 offset:55296
  s_waitcnt lgkmcnt(10)
  v_mfma_f32_16x16x32_bf16 v[104:107], a[64:67], v[32:35], 0
  ds_read_b64_tr_b16 a[88:89], v13 offset:57344
  v_mfma_f32_16x16x32_bf16 v[108:111], a[64:67], v[36:39], 0
  ds_read_b64_tr_b16 a[90:91], v13 offset:59392
  s_waitcnt lgkmcnt(10)
  v_mfma_f32_16x16x32_bf16 v[104:107], a[68:71], v[48:51], v[104:107]
  ds_read_b64_tr_b16 a[92:93], v13 offset:61440
  v_mfma_f32_16x16x32_bf16 v[108:111], a[68:71], v[52:55], v[108:111]
  ds_read_b64_tr_b16 a[94:95], v13 offset:63488
  s_waitcnt lgkmcnt(10)
  v_mfma_f32_16x16x32_bf16 v[104:107], a[72:75], v[64:67], v[104:107]
  ds_read_b64_tr_b16 a[64:65], v14 offset:32768
  s_mov_b32 s39, 0
  v_mfma_f32_16x16x32_bf16 v[108:111], a[72:75], v[68:71], v[108:111]
  ds_read_b64_tr_b16 a[66:67], v14 offset:34816
  s_waitcnt lgkmcnt(10)
  v_mfma_f32_16x16x32_bf16 v[104:107], a[76:79], v[80:83], v[104:107]
  ds_read_b64_tr_b16 a[68:69], v14 offset:36864
  v_cvt_pk_bf16_f32 v40, v40, v41
  v_mfma_f32_16x16x32_bf16 v[108:111], a[76:79], v[84:87], v[108:111]
  ds_read_b64_tr_b16 a[70:71], v14 offset:38912
  s_waitcnt lgkmcnt(10)
  v_mfma_f32_16x16x32_bf16 v[104:107], a[80:83], v[96:99], v[104:107]
  ds_read_b64_tr_b16 a[72:73], v14 offset:40960
  v_cvt_pk_bf16_f32 v41, v42, v43
  v_mfma_f32_16x16x32_bf16 v[108:111], a[80:83], v[100:103], v[108:111]
  ds_read_b64_tr_b16 a[74:75], v14 offset:43008
  s_waitcnt lgkmcnt(10)
  v_mfma_f32_16x16x32_bf16 v[104:107], a[84:87], v[112:115], v[104:107]
  ds_read_b64_tr_b16 a[76:77], v14 offset:45056
  v_cvt_pk_bf16_f32 v42, v56, v57
  v_mfma_f32_16x16x32_bf16 v[108:111], a[84:87], v[116:119], v[108:111]
  ds_read_b64_tr_b16 a[78:79], v14 offset:47104
  s_waitcnt lgkmcnt(10)
  v_mfma_f32_16x16x32_bf16 v[104:107], a[88:91], v[128:131], v[104:107]
  ds_read_b64_tr_b16 a[80:81], v14 offset:49152
  v_cvt_pk_bf16_f32 v43, v58, v59
  v_mfma_f32_16x16x32_bf16 v[108:111], a[88:91], v[132:135], v[108:111]
  ds_read_b64_tr_b16 a[82:83], v14 offset:51200
  s_waitcnt lgkmcnt(10)
  v_mfma_f32_16x16x32_bf16 v[104:107], a[92:95], v[144:147], v[104:107]
  ds_read_b64_tr_b16 a[84:85], v14 offset:53248
  buffer_store_dwordx4 v[40:43], v25, s[20:23], s39 offen offset:0 sc1
  v_mfma_f32_16x16x32_bf16 v[108:111], a[92:95], v[148:151], v[108:111]
  ds_read_b64_tr_b16 a[86:87], v14 offset:55296
  s_waitcnt lgkmcnt(10)
  v_mfma_f32_16x16x32_bf16 v[120:123], a[64:67], v[32:35], 0
  ds_read_b64_tr_b16 a[88:89], v14 offset:57344
  v_cvt_pk_bf16_f32 v44, v44, v45
  v_mfma_f32_16x16x32_bf16 v[124:127], a[64:67], v[36:39], 0
  ds_read_b64_tr_b16 a[90:91], v14 offset:59392
  s_waitcnt lgkmcnt(10)
  v_mfma_f32_16x16x32_bf16 v[120:123], a[68:71], v[48:51], v[120:123]
  ds_read_b64_tr_b16 a[92:93], v14 offset:61440
  v_cvt_pk_bf16_f32 v45, v46, v47
  v_mfma_f32_16x16x32_bf16 v[124:127], a[68:71], v[52:55], v[124:127]
  ds_read_b64_tr_b16 a[94:95], v14 offset:63488
  s_waitcnt lgkmcnt(10)
  v_mfma_f32_16x16x32_bf16 v[120:123], a[72:75], v[64:67], v[120:123]
  ds_read_b64_tr_b16 a[64:65], v15 offset:32768
  v_cvt_pk_bf16_f32 v46, v60, v61
  v_mfma_f32_16x16x32_bf16 v[124:127], a[72:75], v[68:71], v[124:127]
  ds_read_b64_tr_b16 a[66:67], v15 offset:34816
  s_waitcnt lgkmcnt(10)
  v_mfma_f32_16x16x32_bf16 v[120:123], a[76:79], v[80:83], v[120:123]
  ds_read_b64_tr_b16 a[68:69], v15 offset:36864
  v_cvt_pk_bf16_f32 v47, v62, v63
  v_mfma_f32_16x16x32_bf16 v[124:127], a[76:79], v[84:87], v[124:127]
  ds_read_b64_tr_b16 a[70:71], v15 offset:38912
  s_waitcnt lgkmcnt(10)
  v_mfma_f32_16x16x32_bf16 v[120:123], a[80:83], v[96:99], v[120:123]
  ds_read_b64_tr_b16 a[72:73], v15 offset:40960
  buffer_store_dwordx4 v[44:47], v26, s[20:23], s39 offen offset:0 sc1
  v_mfma_f32_16x16x32_bf16 v[124:127], a[80:83], v[100:103], v[124:127]
  ds_read_b64_tr_b16 a[74:75], v15 offset:43008
  s_waitcnt lgkmcnt(10)
  v_mfma_f32_16x16x32_bf16 v[120:123], a[84:87], v[112:115], v[120:123]
  ds_read_b64_tr_b16 a[76:77], v15 offset:45056
  v_cvt_pk_bf16_f32 v72, v72, v73
  v_mfma_f32_16x16x32_bf16 v[124:127], a[84:87], v[116:119], v[124:127]
  ds_read_b64_tr_b16 a[78:79], v15 offset:47104
  s_waitcnt lgkmcnt(10)
  v_mfma_f32_16x16x32_bf16 v[120:123], a[88:91], v[128:131], v[120:123]
  ds_read_b64_tr_b16 a[80:81], v15 offset:49152
  v_cvt_pk_bf16_f32 v73, v74, v75
  v_mfma_f32_16x16x32_bf16 v[124:127], a[88:91], v[132:135], v[124:127]
  ds_read_b64_tr_b16 a[82:83], v15 offset:51200
  s_waitcnt lgkmcnt(10)
  v_mfma_f32_16x16x32_bf16 v[120:123], a[92:95], v[144:147], v[120:123]
  ds_read_b64_tr_b16 a[84:85], v15 offset:53248
  v_cvt_pk_bf16_f32 v74, v88, v89
  v_mfma_f32_16x16x32_bf16 v[124:127], a[92:95], v[148:151], v[124:127]
  ds_read_b64_tr_b16 a[86:87], v15 offset:55296
  s_waitcnt lgkmcnt(10)
  v_mfma_f32_16x16x32_bf16 v[136:139], a[64:67], v[32:35], 0
  ds_read_b64_tr_b16 a[88:89], v15 offset:57344
  v_cvt_pk_bf16_f32 v75, v90, v91
  v_mfma_f32_16x16x32_bf16 v[140:143], a[64:67], v[36:39], 0
  ds_read_b64_tr_b16 a[90:91], v15 offset:59392
  s_waitcnt lgkmcnt(10)
  v_mfma_f32_16x16x32_bf16 v[136:139], a[68:71], v[48:51], v[136:139]
  ds_read_b64_tr_b16 a[92:93], v15 offset:61440
  buffer_store_dwordx4 v[72:75], v25, s[20:23], s39 offen offset:1024 sc1
  v_mfma_f32_16x16x32_bf16 v[140:143], a[68:71], v[52:55], v[140:143]
  ds_read_b64_tr_b16 a[94:95], v15 offset:63488
  s_waitcnt lgkmcnt(10)
  v_mfma_f32_16x16x32_bf16 v[136:139], a[72:75], v[64:67], v[136:139]
  ds_read_b64_tr_b16 a[64:65], v16 offset:32768
  v_cvt_pk_bf16_f32 v76, v76, v77
  v_mfma_f32_16x16x32_bf16 v[140:143], a[72:75], v[68:71], v[140:143]
  ds_read_b64_tr_b16 a[66:67], v16 offset:34816
  s_waitcnt lgkmcnt(10)
  v_mfma_f32_16x16x32_bf16 v[136:139], a[76:79], v[80:83], v[136:139]
  ds_read_b64_tr_b16 a[68:69], v16 offset:36864
  v_cvt_pk_bf16_f32 v77, v78, v79
  v_mfma_f32_16x16x32_bf16 v[140:143], a[76:79], v[84:87], v[140:143]
  ds_read_b64_tr_b16 a[70:71], v16 offset:38912
  s_waitcnt lgkmcnt(10)
  v_mfma_f32_16x16x32_bf16 v[136:139], a[80:83], v[96:99], v[136:139]
  ds_read_b64_tr_b16 a[72:73], v16 offset:40960
  v_cvt_pk_bf16_f32 v78, v92, v93
  v_mfma_f32_16x16x32_bf16 v[140:143], a[80:83], v[100:103], v[140:143]
  ds_read_b64_tr_b16 a[74:75], v16 offset:43008
  s_waitcnt lgkmcnt(10)
  v_mfma_f32_16x16x32_bf16 v[136:139], a[84:87], v[112:115], v[136:139]
  ds_read_b64_tr_b16 a[76:77], v16 offset:45056
  v_cvt_pk_bf16_f32 v79, v94, v95
  v_mfma_f32_16x16x32_bf16 v[140:143], a[84:87], v[116:119], v[140:143]
  ds_read_b64_tr_b16 a[78:79], v16 offset:47104
  s_waitcnt lgkmcnt(10)
  v_mfma_f32_16x16x32_bf16 v[136:139], a[88:91], v[128:131], v[136:139]
  ds_read_b64_tr_b16 a[80:81], v16 offset:49152
  buffer_store_dwordx4 v[76:79], v26, s[20:23], s39 offen offset:1024 sc1
  v_mfma_f32_16x16x32_bf16 v[140:143], a[88:91], v[132:135], v[140:143]
  ds_read_b64_tr_b16 a[82:83], v16 offset:51200
  s_waitcnt lgkmcnt(10)
  v_mfma_f32_16x16x32_bf16 v[136:139], a[92:95], v[144:147], v[136:139]
  ds_read_b64_tr_b16 a[84:85], v16 offset:53248
  v_mfma_f32_16x16x32_bf16 v[140:143], a[92:95], v[148:151], v[140:143]
  ds_read_b64_tr_b16 a[86:87], v16 offset:55296
  s_waitcnt lgkmcnt(10)
  v_mfma_f32_16x16x32_bf16 v[152:155], a[64:67], v[32:35], 0
  ds_read_b64_tr_b16 a[88:89], v16 offset:57344
  v_mfma_f32_16x16x32_bf16 v[156:159], a[64:67], v[36:39], 0
  ds_read_b64_tr_b16 a[90:91], v16 offset:59392
  s_waitcnt lgkmcnt(10)
  v_mfma_f32_16x16x32_bf16 v[152:155], a[68:71], v[48:51], v[152:155]
  ds_read_b64_tr_b16 a[92:93], v16 offset:61440
  v_mfma_f32_16x16x32_bf16 v[156:159], a[68:71], v[52:55], v[156:159]
  ds_read_b64_tr_b16 a[94:95], v16 offset:63488
  s_waitcnt lgkmcnt(10)
  v_mfma_f32_16x16x32_bf16 v[152:155], a[72:75], v[64:67], v[152:155]
  v_mfma_f32_16x16x32_bf16 v[156:159], a[72:75], v[68:71], v[156:159]
  s_waitcnt lgkmcnt(8)
  v_mfma_f32_16x16x32_bf16 v[152:155], a[76:79], v[80:83], v[152:155]
  v_mfma_f32_16x16x32_bf16 v[156:159], a[76:79], v[84:87], v[156:159]
  s_waitcnt lgkmcnt(6)
  v_mfma_f32_16x16x32_bf16 v[152:155], a[80:83], v[96:99], v[152:155]
  v_mfma_f32_16x16x32_bf16 v[156:159], a[80:83], v[100:103], v[156:159]
  s_waitcnt lgkmcnt(4)
  v_mfma_f32_16x16x32_bf16 v[152:155], a[84:87], v[112:115], v[152:155]
  v_mfma_f32_16x16x32_bf16 v[156:159], a[84:87], v[116:119], v[156:159]
  s_waitcnt lgkmcnt(2)
  v_mfma_f32_16x16x32_bf16 v[152:155], a[88:91], v[128:131], v[152:155]
  v_mfma_f32_16x16x32_bf16 v[156:159], a[88:91], v[132:135], v[156:159]
  s_waitcnt lgkmcnt(0)
  v_mfma_f32_16x16x32_bf16 v[152:155], a[92:95], v[144:147], v[152:155]
  v_mfma_f32_16x16x32_bf16 v[156:159], a[92:95], v[148:151], v[156:159]
  s_waitcnt vmcnt(20)
  s_barrier
  s_add_u32 m0, s40, 32768
  s_mov_b32 s39, 640
  buffer_load_dwordx4 v21, s[16:19], s39 offen offset:0 lds
  buffer_load_dwordx4 v22, s[16:19], s39 offen offset:1024 lds
  buffer_load_dwordx4 v23, s[16:19], s39 offen offset:2048 lds
  buffer_load_dwordx4 v24, s[16:19], s39 offen offset:3072 lds
  s_add_u32 m0, s40, 36864
  s_mov_b32 s39, 29312
  buffer_load_dwordx4 v21, s[16:19], s39 offen offset:0 lds
  buffer_load_dwordx4 v22, s[16:19], s39 offen offset:1024 lds
  buffer_load_dwordx4 v23, s[16:19], s39 offen offset:2048 lds
  buffer_load_dwordx4 v24, s[16:19], s39 offen offset:3072 lds
  ds_read_b64_tr_b16 a[64:65], v17 offset:0
  ds_read_b64_tr_b16 a[66:67], v17 offset:2048
  ds_read_b64_tr_b16 a[68:69], v17 offset:4096
  ds_read_b64_tr_b16 a[70:71], v17 offset:6144
  ds_read_b64_tr_b16 a[72:73], v17 offset:8192
  ds_read_b64_tr_b16 a[74:75], v17 offset:10240
  ds_read_b64_tr_b16 a[76:77], v17 offset:12288
  ds_read_b64_tr_b16 a[78:79], v17 offset:14336
  ds_read_b64_tr_b16 a[80:81], v17 offset:16384
  ds_read_b64_tr_b16 a[82:83], v17 offset:18432
  ds_read_b64_tr_b16 a[84:85], v17 offset:20480
  ds_read_b64_tr_b16 a[86:87], v17 offset:22528
  s_waitcnt lgkmcnt(10)
  v_mfma_f32_16x16x32_bf16 v[40:43], a[64:67], v[32:35], 0
  ds_read_b64_tr_b16 a[88:89], v17 offset:24576
  v_mfma_f32_16x16x32_bf16 v[44:47], a[64:67], v[36:39], 0
  ds_read_b64_tr_b16 a[90:91], v17 offset:26624
  s_waitcnt lgkmcnt(10)
  v_mfma_f32_16x16x32_bf16 v[40:43], a[68:71], v[48:51], v[40:43]
  ds_read_b64_tr_b16 a[92:93], v17 offset:28672
  v_mfma_f32_16x16x32_bf16 v[44:47], a[68:71], v[52:55], v[44:47]
  ds_read_b64_tr_b16 a[94:95], v17 offset:30720
  s_waitcnt lgkmcnt(10)
  v_mfma_f32_16x16x32_bf16 v[40:43], a[72:75], v[64:67], v[40:43]
  ds_read_b64_tr_b16 a[64:65], v18 offset:0
  s_mov_b32 s39, 2048
  v_mfma_f32_16x16x32_bf16 v[44:47], a[72:75], v[68:71], v[44:47]
  ds_read_b64_tr_b16 a[66:67], v18 offset:2048
  s_waitcnt lgkmcnt(10)
  v_mfma_f32_16x16x32_bf16 v[40:43], a[76:79], v[80:83], v[40:43]
  ds_read_b64_tr_b16 a[68:69], v18 offset:4096
  v_cvt_pk_bf16_f32 v104, v104, v105
  v_mfma_f32_16x16x32_bf16 v[44:47], a[76:79], v[84:87], v[44:47]
  ds_read_b64_tr_b16 a[70:71], v18 offset:6144
  s_waitcnt lgkmcnt(10)
  v_mfma_f32_16x16x32_bf16 v[40:43], a[80:83], v[96:99], v[40:43]
  ds_read_b64_tr_b16 a[72:73], v18 offset:8192
  v_cvt_pk_bf16_f32 v105, v106, v107
  v_mfma_f32_16x16x32_bf16 v[44:47], a[80:83], v[100:103], v[44:47]
  ds_read_b64_tr_b16 a[74:75], v18 offset:10240
  s_waitcnt lgkmcnt(10)
  v_mfma_f32_16x16x32_bf16 v[40:43], a[84:87], v[112:115], v[40:43]
  ds_read_b64_tr_b16 a[76:77], v18 offset:12288
  v_cvt_pk_bf16_f32 v106, v120, v121
  v_mfma_f32_16x16x32_bf16 v[44:47], a[84:87], v[116:119], v[44:47]
  ds_read_b64_tr_b16 a[78:79], v18 offset:14336
  s_waitcnt lgkmcnt(10)
  v_mfma_f32_16x16x32_bf16 v[40:43], a[88:91], v[128:131], v[40:43]
  ds_read_b64_tr_b16 a[80:81], v18 offset:16384
  v_cvt_pk_bf16_f32 v107, v122, v123
  v_mfma_f32_16x16x32_bf16 v[44:47], a[88:91], v[132:135], v[44:47]
  ds_read_b64_tr_b16 a[82:83], v18 offset:18432
  s_waitcnt lgkmcnt(10)
  v_mfma_f32_16x16x32_bf16 v[40:43], a[92:95], v[144:147], v[40:43]
  ds_read_b64_tr_b16 a[84:85], v18 offset:20480
  buffer_store_dwordx4 v[104:107], v25, s[20:23], s39 offen offset:0 sc1
  v_mfma_f32_16x16x32_bf16 v[44:47], a[92:95], v[148:151], v[44:47]
  ds_read_b64_tr_b16 a[86:87], v18 offset:22528
  s_waitcnt lgkmcnt(10)
  v_mfma_f32_16x16x32_bf16 v[56:59], a[64:67], v[32:35], 0
  ds_read_b64_tr_b16 a[88:89], v18 offset:24576
  v_cvt_pk_bf16_f32 v108, v108, v109
  v_mfma_f32_16x16x32_bf16 v[60:63], a[64:67], v[36:39], 0
  ds_read_b64_tr_b16 a[90:91], v18 offset:26624
  s_waitcnt lgkmcnt(10)
  v_mfma_f32_16x16x32_bf16 v[56:59], a[68:71], v[48:51], v[56:59]
  ds_read_b64_tr_b16 a[92:93], v18 offset:28672
  v_cvt_pk_bf16_f32 v109, v110, v111
  v_mfma_f32_16x16x32_bf16 v[60:63], a[68:71], v[52:55], v[60:63]
  ds_read_b64_tr_b16 a[94:95], v18 offset:30720
  s_waitcnt lgkmcnt(10)
  v_mfma_f32_16x16x32_bf16 v[56:59], a[72:75], v[64:67], v[56:59]
  ds_read_b64_tr_b16 a[64:65], v19 offset:0
  v_cvt_pk_bf16_f32 v110, v124, v125
  v_mfma_f32_16x16x32_bf16 v[60:63], a[72:75], v[68:71], v[60:63]
  ds_read_b64_tr_b16 a[66:67], v19 offset:2048
  s_waitcnt lgkmcnt(10)
  v_mfma_f32_16x16x32_bf16 v[56:59], a[76:79], v[80:83], v[56:59]
  ds_read_b64_tr_b16 a[68:69], v19 offset:4096
  v_cvt_pk_bf16_f32 v111, v126, v127
  v_mfma_f32_16x16x32_bf16 v[60:63], a[76:79], v[84:87], v[60:63]
  ds_read_b64_tr_b16 a[70:71], v19 offset:6144
  s_waitcnt lgkmcnt(10)
  v_mfma_f32_16x16x32_bf16 v[56:59], a[80:83], v[96:99], v[56:59]
  ds_read_b64_tr_b16 a[72:73], v19 offset:8192
  buffer_store_dwordx4 v[108:111], v26, s[20:23], s39 offen offset:0 sc1
  v_mfma_f32_16x16x32_bf16 v[60:63], a[80:83], v[100:103], v[60:63]
  ds_read_b64_tr_b16 a[74:75], v19 offset:10240
  s_waitcnt lgkmcnt(10)
  v_mfma_f32_16x16x32_bf16 v[56:59], a[84:87], v[112:115], v[56:59]
  ds_read_b64_tr_b16 a[76:77], v19 offset:12288
  v_cvt_pk_bf16_f32 v136, v136, v137
  v_mfma_f32_16x16x32_bf16 v[60:63], a[84:87], v[116:119], v[60:63]
  ds_read_b64_tr_b16 a[78:79], v19 offset:14336
  s_waitcnt lgkmcnt(10)
  v_mfma_f32_16x16x32_bf16 v[56:59], a[88:91], v[128:131], v[56:59]
  ds_read_b64_tr_b16 a[80:81], v19 offset:16384
  v_cvt_pk_bf16_f32 v137, v138, v139
  v_mfma_f32_16x16x32_bf16 v[60:63], a[88:91], v[132:135], v[60:63]
  ds_read_b64_tr_b16 a[82:83], v19 offset:18432
  s_waitcnt lgkmcnt(10)
  v_mfma_f32_16x16x32_bf16 v[56:59], a[92:95], v[144:147], v[56:59]
  ds_read_b64_tr_b16 a[84:85], v19 offset:20480
  v_cvt_pk_bf16_f32 v138, v152, v153
  v_mfma_f32_16x16x32_bf16 v[60:63], a[92:95], v[148:151], v[60:63]
  ds_read_b64_tr_b16 a[86:87], v19 offset:22528
  s_waitcnt lgkmcnt(10)
  v_mfma_f32_16x16x32_bf16 v[72:75], a[64:67], v[32:35], 0
  ds_read_b64_tr_b16 a[88:89], v19 offset:24576
  v_cvt_pk_bf16_f32 v139, v154, v155
  v_mfma_f32_16x16x32_bf16 v[76:79], a[64:67], v[36:39], 0
  ds_read_b64_tr_b16 a[90:91], v19 offset:26624
  s_waitcnt lgkmcnt(10)
  v_mfma_f32_16x16x32_bf16 v[72:75], a[68:71], v[48:51], v[72:75]
  ds_read_b64_tr_b16 a[92:93], v19 offset:28672
  buffer_store_dwordx4 v[136:139], v25, s[20:23], s39 offen offset:1024 sc1
  v_mfma_f32_16x16x32_bf16 v[76:79], a[68:71], v[52:55], v[76:79]
  ds_read_b64_tr_b16 a[94:95], v19 offset:30720
  s_waitcnt lgkmcnt(10)
  v_mfma_f32_16x16x32_bf16 v[72:75], a[72:75], v[64:67], v[72:75]
  ds_read_b64_tr_b16 a[64:65], v20 offset:0
  v_cvt_pk_bf16_f32 v140, v140, v141
  v_mfma_f32_16x16x32_bf16 v[76:79], a[72:75], v[68:71], v[76:79]
  ds_read_b64_tr_b16 a[66:67], v20 offset:2048
  s_waitcnt lgkmcnt(10)
  v_mfma_f32_16x16x32_bf16 v[72:75], a[76:79], v[80:83], v[72:75]
  ds_read_b64_tr_b16 a[68:69], v20 offset:4096
  v_cvt_pk_bf16_f32 v141, v142, v143
  v_mfma_f32_16x16x32_bf16 v[76:79], a[76:79], v[84:87], v[76:79]
  ds_read_b64_tr_b16 a[70:71], v20 offset:6144
  s_waitcnt lgkmcnt(10)
  v_mfma_f32_16x16x32_bf16 v[72:75], a[80:83], v[96:99], v[72:75]
  ds_read_b64_tr_b16 a[72:73], v20 offset:8192
  v_cvt_pk_bf16_f32 v142, v156, v157
  v_mfma_f32_16x16x32_bf16 v[76:79], a[80:83], v[100:103], v[76:79]
  ds_read_b64_tr_b16 a[74:75], v20 offset:10240
  s_waitcnt lgkmcnt(10)
  v_mfma_f32_16x16x32_bf16 v[72:75], a[84:87], v[112:115], v[72:75]
  ds_read_b64_tr_b16 a[76:77], v20 offset:12288
  v_cvt_pk_bf16_f32 v143, v158, v159
  v_mfma_f32_16x16x32_bf16 v[76:79], a[84:87], v[116:119], v[76:79]
  ds_read_b64_tr_b16 a[78:79], v20 offset:14336
  s_waitcnt lgkmcnt(10)
  v_mfma_f32_16x16x32_bf16 v[72:75], a[88:91], v[128:131], v[72:75]
  ds_read_b64_tr_b16 a[80:81], v20 offset:16384
  buffer_store_dwordx4 v[140:143], v26, s[20:23], s39 offen offset:1024 sc1
  v_mfma_f32_16x16x32_bf16 v[76:79], a[88:91], v[132:135], v[76:79]
  ds_read_b64_tr_b16 a[82:83], v20 offset:18432
  s_waitcnt lgkmcnt(10)
  v_mfma_f32_16x16x32_bf16 v[72:75], a[92:95], v[144:147], v[72:75]
  ds_read_b64_tr_b16 a[84:85], v20 offset:20480
  v_mfma_f32_16x16x32_bf16 v[76:79], a[92:95], v[148:151], v[76:79]
  ds_read_b64_tr_b16 a[86:87], v20 offset:22528
  s_waitcnt lgkmcnt(10)
  v_mfma_f32_16x16x32_bf16 v[88:91], a[64:67], v[32:35], 0
  ds_read_b64_tr_b16 a[88:89], v20 offset:24576
  v_mfma_f32_16x16x32_bf16 v[92:95], a[64:67], v[36:39], 0
  ds_read_b64_tr_b16 a[90:91], v20 offset:26624
  s_waitcnt lgkmcnt(10)
  v_mfma_f32_16x16x32_bf16 v[88:91], a[68:71], v[48:51], v[88:91]
  ds_read_b64_tr_b16 a[92:93], v20 offset:28672
  v_mfma_f32_16x16x32_bf16 v[92:95], a[68:71], v[52:55], v[92:95]
  ds_read_b64_tr_b16 a[94:95], v20 offset:30720
  s_waitcnt lgkmcnt(10)
  v_mfma_f32_16x16x32_bf16 v[88:91], a[72:75], v[64:67], v[88:91]
  v_mfma_f32_16x16x32_bf16 v[92:95], a[72:75], v[68:71], v[92:95]
  s_waitcnt lgkmcnt(8)
  v_mfma_f32_16x16x32_bf16 v[88:91], a[76:79], v[80:83], v[88:91]
  v_mfma_f32_16x16x32_bf16 v[92:95], a[76:79], v[84:87], v[92:95]
  s_waitcnt lgkmcnt(6)
  v_mfma_f32_16x16x32_bf16 v[88:91], a[80:83], v[96:99], v[88:91]
  v_mfma_f32_16x16x32_bf16 v[92:95], a[80:83], v[100:103], v[92:95]
  s_waitcnt lgkmcnt(4)
  v_mfma_f32_16x16x32_bf16 v[88:91], a[84:87], v[112:115], v[88:91]
  v_mfma_f32_16x16x32_bf16 v[92:95], a[84:87], v[116:119], v[92:95]
  s_waitcnt lgkmcnt(2)
  v_mfma_f32_16x16x32_bf16 v[88:91], a[88:91], v[128:131], v[88:91]
  v_mfma_f32_16x16x32_bf16 v[92:95], a[88:91], v[132:135], v[92:95]
  s_waitcnt lgkmcnt(0)
  v_mfma_f32_16x16x32_bf16 v[88:91], a[92:95], v[144:147], v[88:91]
  v_mfma_f32_16x16x32_bf16 v[92:95], a[92:95], v[148:151], v[92:95]
  s_waitcnt vmcnt(24)
  s_barrier
  s_add_u32 m0, s40, 65536
  s_mov_b32 s39, 768
  buffer_load_dwordx4 v21, s[16:19], s39 offen offset:0 lds
  buffer_load_dwordx4 v22, s[16:19], s39 offen offset:1024 lds
  buffer_load_dwordx4 v23, s[16:19], s39 offen offset:2048 lds
  buffer_load_dwordx4 v24, s[16:19], s39 offen offset:3072 lds
  s_add_u32 m0, s40, 69632
  s_mov_b32 s39, 29440
  buffer_load_dwordx4 v21, s[16:19], s39 offen offset:0 lds
  buffer_load_dwordx4 v22, s[16:19], s39 offen offset:1024 lds
  buffer_load_dwordx4 v23, s[16:19], s39 offen offset:2048 lds
  buffer_load_dwordx4 v24, s[16:19], s39 offen offset:3072 lds
  ds_read_b64_tr_b16 a[64:65], v17 offset:32768
  ds_read_b64_tr_b16 a[66:67], v17 offset:34816
  ds_read_b64_tr_b16 a[68:69], v17 offset:36864
  ds_read_b64_tr_b16 a[70:71], v17 offset:38912
  ds_read_b64_tr_b16 a[72:73], v17 offset:40960
  ds_read_b64_tr_b16 a[74:75], v17 offset:43008
  ds_read_b64_tr_b16 a[76:77], v17 offset:45056
  ds_read_b64_tr_b16 a[78:79], v17 offset:47104
  ds_read_b64_tr_b16 a[80:81], v17 offset:49152
  ds_read_b64_tr_b16 a[82:83], v17 offset:51200
  ds_read_b64_tr_b16 a[84:85], v17 offset:53248
  ds_read_b64_tr_b16 a[86:87], v17 offset:55296
  s_waitcnt lgkmcnt(10)
  v_mfma_f32_16x16x32_bf16 v[104:107], a[64:67], v[32:35], 0
  ds_read_b64_tr_b16 a[88:89], v17 offset:57344
  v_mfma_f32_16x16x32_bf16 v[108:111], a[64:67], v[36:39], 0
  ds_read_b64_tr_b16 a[90:91], v17 offset:59392
  s_waitcnt lgkmcnt(10)
  v_mfma_f32_16x16x32_bf16 v[104:107], a[68:71], v[48:51], v[104:107]
  ds_read_b64_tr_b16 a[92:93], v17 offset:61440
  v_mfma_f32_16x16x32_bf16 v[108:111], a[68:71], v[52:55], v[108:111]
  ds_read_b64_tr_b16 a[94:95], v17 offset:63488
  s_waitcnt lgkmcnt(10)
  v_mfma_f32_16x16x32_bf16 v[104:107], a[72:75], v[64:67], v[104:107]
  ds_read_b64_tr_b16 a[64:65], v18 offset:32768
  s_mov_b32 s39, 4096
  v_mfma_f32_16x16x32_bf16 v[108:111], a[72:75], v[68:71], v[108:111]
  ds_read_b64_tr_b16 a[66:67], v18 offset:34816
  s_waitcnt lgkmcnt(10)
  v_mfma_f32_16x16x32_bf16 v[104:107], a[76:79], v[80:83], v[104:107]
  ds_read_b64_tr_b16 a[68:69], v18 offset:36864
  v_cvt_pk_bf16_f32 v40, v40, v41
  v_mfma_f32_16x16x32_bf16 v[108:111], a[76:79], v[84:87], v[108:111]
  ds_read_b64_tr_b16 a[70:71], v18 offset:38912
  s_waitcnt lgkmcnt(10)
  v_mfma_f32_16x16x32_bf16 v[104:107], a[80:83], v[96:99], v[104:107]
  ds_read_b64_tr_b16 a[72:73], v18 offset:40960
  v_cvt_pk_bf16_f32 v41, v42, v43
  v_mfma_f32_16x16x32_bf16 v[108:111], a[80:83], v[100:103], v[108:111]
  ds_read_b64_tr_b16 a[74:75], v18 offset:43008
  s_waitcnt lgkmcnt(10)
  v_mfma_f32_16x16x32_bf16 v[104:107], a[84:87], v[112:115], v[104:107]
  ds_read_b64_tr_b16 a[76:77], v18 offset:45056
  v_cvt_pk_bf16_f32 v42, v56, v57
  v_mfma_f32_16x16x32_bf16 v[108:111], a[84:87], v[116:119], v[108:111]
  ds_read_b64_tr_b16 a[78:79], v18 offset:47104
  s_waitcnt lgkmcnt(10)
  v_mfma_f32_16x16x32_bf16 v[104:107], a[88:91], v[128:131], v[104:107]
  ds_read_b64_tr_b16 a[80:81], v18 offset:49152
  v_cvt_pk_bf16_f32 v43, v58, v59
  v_mfma_f32_16x16x32_bf16 v[108:111], a[88:91], v[132:135], v[108:111]
  ds_read_b64_tr_b16 a[82:83], v18 offset:51200
  s_waitcnt lgkmcnt(10)
  v_mfma_f32_16x16x32_bf16 v[104:107], a[92:95], v[144:147], v[104:107]
  ds_read_b64_tr_b16 a[84:85], v18 offset:53248
  buffer_store_dwordx4 v[40:43], v25, s[20:23], s39 offen offset:0 sc1
  v_mfma_f32_16x16x32_bf16 v[108:111], a[92:95], v[148:151], v[108:111]
  ds_read_b64_tr_b16 a[86:87], v18 offset:55296
  s_waitcnt lgkmcnt(10)
  v_mfma_f32_16x16x32_bf16 v[120:123], a[64:67], v[32:35], 0
  ds_read_b64_tr_b16 a[88:89], v18 offset:57344
  v_cvt_pk_bf16_f32 v44, v44, v45
  v_mfma_f32_16x16x32_bf16 v[124:127], a[64:67], v[36:39], 0
  ds_read_b64_tr_b16 a[90:91], v18 offset:59392
  s_waitcnt lgkmcnt(10)
  v_mfma_f32_16x16x32_bf16 v[120:123], a[68:71], v[48:51], v[120:123]
  ds_read_b64_tr_b16 a[92:93], v18 offset:61440
  v_cvt_pk_bf16_f32 v45, v46, v47
  v_mfma_f32_16x16x32_bf16 v[124:127], a[68:71], v[52:55], v[124:127]
  ds_read_b64_tr_b16 a[94:95], v18 offset:63488
  s_waitcnt lgkmcnt(10)
  v_mfma_f32_16x16x32_bf16 v[120:123], a[72:75], v[64:67], v[120:123]
  ds_read_b64_tr_b16 a[64:65], v19 offset:32768
  v_cvt_pk_bf16_f32 v46, v60, v61
  v_mfma_f32_16x16x32_bf16 v[124:127], a[72:75], v[68:71], v[124:127]
  ds_read_b64_tr_b16 a[66:67], v19 offset:34816
  s_waitcnt lgkmcnt(10)
  v_mfma_f32_16x16x32_bf16 v[120:123], a[76:79], v[80:83], v[120:123]
  ds_read_b64_tr_b16 a[68:69], v19 offset:36864
  v_cvt_pk_bf16_f32 v47, v62, v63
  v_mfma_f32_16x16x32_bf16 v[124:127], a[76:79], v[84:87], v[124:127]
  ds_read_b64_tr_b16 a[70:71], v19 offset:38912
  s_waitcnt lgkmcnt(10)
  v_mfma_f32_16x16x32_bf16 v[120:123], a[80:83], v[96:99], v[120:123]
  ds_read_b64_tr_b16 a[72:73], v19 offset:40960
  buffer_store_dwordx4 v[44:47], v26, s[20:23], s39 offen offset:0 sc1
  v_mfma_f32_16x16x32_bf16 v[124:127], a[80:83], v[100:103], v[124:127]
  ds_read_b64_tr_b16 a[74:75], v19 offset:43008
  s_waitcnt lgkmcnt(10)
  v_mfma_f32_16x16x32_bf16 v[120:123], a[84:87], v[112:115], v[120:123]
  ds_read_b64_tr_b16 a[76:77], v19 offset:45056
  v_cvt_pk_bf16_f32 v72, v72, v73
  v_mfma_f32_16x16x32_bf16 v[124:127], a[84:87], v[116:119], v[124:127]
  ds_read_b64_tr_b16 a[78:79], v19 offset:47104
  s_waitcnt lgkmcnt(10)
  v_mfma_f32_16x16x32_bf16 v[120:123], a[88:91], v[128:131], v[120:123]
  ds_read_b64_tr_b16 a[80:81], v19 offset:49152
  v_cvt_pk_bf16_f32 v73, v74, v75
  v_mfma_f32_16x16x32_bf16 v[124:127], a[88:91], v[132:135], v[124:127]
  ds_read_b64_tr_b16 a[82:83], v19 offset:51200
  s_waitcnt lgkmcnt(10)
  v_mfma_f32_16x16x32_bf16 v[120:123], a[92:95], v[144:147], v[120:123]
  ds_read_b64_tr_b16 a[84:85], v19 offset:53248
  v_cvt_pk_bf16_f32 v74, v88, v89
  v_mfma_f32_16x16x32_bf16 v[124:127], a[92:95], v[148:151], v[124:127]
  ds_read_b64_tr_b16 a[86:87], v19 offset:55296
  s_waitcnt lgkmcnt(10)
  v_mfma_f32_16x16x32_bf16 v[136:139], a[64:67], v[32:35], 0
  ds_read_b64_tr_b16 a[88:89], v19 offset:57344
  v_cvt_pk_bf16_f32 v75, v90, v91
  v_mfma_f32_16x16x32_bf16 v[140:143], a[64:67], v[36:39], 0
  ds_read_b64_tr_b16 a[90:91], v19 offset:59392
  s_waitcnt lgkmcnt(10)
  v_mfma_f32_16x16x32_bf16 v[136:139], a[68:71], v[48:51], v[136:139]
  ds_read_b64_tr_b16 a[92:93], v19 offset:61440
  buffer_store_dwordx4 v[72:75], v25, s[20:23], s39 offen offset:1024 sc1
  v_mfma_f32_16x16x32_bf16 v[140:143], a[68:71], v[52:55], v[140:143]
  ds_read_b64_tr_b16 a[94:95], v19 offset:63488
  s_waitcnt lgkmcnt(10)
  v_mfma_f32_16x16x32_bf16 v[136:139], a[72:75], v[64:67], v[136:139]
  ds_read_b64_tr_b16 a[64:65], v20 offset:32768
  v_cvt_pk_bf16_f32 v76, v76, v77
  v_mfma_f32_16x16x32_bf16 v[140:143], a[72:75], v[68:71], v[140:143]
  ds_read_b64_tr_b16 a[66:67], v20 offset:34816
  s_waitcnt lgkmcnt(10)
  v_mfma_f32_16x16x32_bf16 v[136:139], a[76:79], v[80:83], v[136:139]
  ds_read_b64_tr_b16 a[68:69], v20 offset:36864
  v_cvt_pk_bf16_f32 v77, v78, v79
  v_mfma_f32_16x16x32_bf16 v[140:143], a[76:79], v[84:87], v[140:143]
  ds_read_b64_tr_b16 a[70:71], v20 offset:38912
  s_waitcnt lgkmcnt(10)
  v_mfma_f32_16x16x32_bf16 v[136:139], a[80:83], v[96:99], v[136:139]
  ds_read_b64_tr_b16 a[72:73], v20 offset:40960
  v_cvt_pk_bf16_f32 v78, v92, v93
  v_mfma_f32_16x16x32_bf16 v[140:143], a[80:83], v[100:103], v[140:143]
  ds_read_b64_tr_b16 a[74:75], v20 offset:43008
  s_waitcnt lgkmcnt(10)
  v_mfma_f32_16x16x32_bf16 v[136:139], a[84:87], v[112:115], v[136:139]
  ds_read_b64_tr_b16 a[76:77], v20 offset:45056
  v_cvt_pk_bf16_f32 v79, v94, v95
  v_mfma_f32_16x16x32_bf16 v[140:143], a[84:87], v[116:119], v[140:143]
  ds_read_b64_tr_b16 a[78:79], v20 offset:47104
  s_waitcnt lgkmcnt(10)
  v_mfma_f32_16x16x32_bf16 v[136:139], a[88:91], v[128:131], v[136:139]
  ds_read_b64_tr_b16 a[80:81], v20 offset:49152
  buffer_store_dwordx4 v[76:79], v26, s[20:23], s39 offen offset:1024 sc1
  v_mfma_f32_16x16x32_bf16 v[140:143], a[88:91], v[132:135], v[140:143]
  ds_read_b64_tr_b16 a[82:83], v20 offset:51200
  s_waitcnt lgkmcnt(10)
  v_mfma_f32_16x16x32_bf16 v[136:139], a[92:95], v[144:147], v[136:139]
  ds_read_b64_tr_b16 a[84:85], v20 offset:53248
  v_mfma_f32_16x16x32_bf16 v[140:143], a[92:95], v[148:151], v[140:143]
  ds_read_b64_tr_b16 a[86:87], v20 offset:55296
  s_waitcnt lgkmcnt(10)
  v_mfma_f32_16x16x32_bf16 v[152:155], a[64:67], v[32:35], 0
  ds_read_b64_tr_b16 a[88:89], v20 offset:57344
  v_mfma_f32_16x16x32_bf16 v[156:159], a[64:67], v[36:39], 0
  ds_read_b64_tr_b16 a[90:91], v20 offset:59392
  s_waitcnt lgkmcnt(10)
  v_mfma_f32_16x16x32_bf16 v[152:155], a[68:71], v[48:51], v[152:155]
  ds_read_b64_tr_b16 a[92:93], v20 offset:61440
  v_mfma_f32_16x16x32_bf16 v[156:159], a[68:71], v[52:55], v[156:159]
  ds_read_b64_tr_b16 a[94:95], v20 offset:63488
  s_waitcnt lgkmcnt(10)
  v_mfma_f32_16x16x32_bf16 v[152:155], a[72:75], v[64:67], v[152:155]
  v_mfma_f32_16x16x32_bf16 v[156:159], a[72:75], v[68:71], v[156:159]
  s_waitcnt lgkmcnt(8)
  v_mfma_f32_16x16x32_bf16 v[152:155], a[76:79], v[80:83], v[152:155]
  v_mfma_f32_16x16x32_bf16 v[156:159], a[76:79], v[84:87], v[156:159]
  s_waitcnt lgkmcnt(6)
  v_mfma_f32_16x16x32_bf16 v[152:155], a[80:83], v[96:99], v[152:155]
  v_mfma_f32_16x16x32_bf16 v[156:159], a[80:83], v[100:103], v[156:159]
  s_waitcnt lgkmcnt(4)
  v_mfma_f32_16x16x32_bf16 v[152:155], a[84:87], v[112:115], v[152:155]
  v_mfma_f32_16x16x32_bf16 v[156:159], a[84:87], v[116:119], v[156:159]
  s_waitcnt lgkmcnt(2)
  v_mfma_f32_16x16x32_bf16 v[152:155], a[88:91], v[128:131], v[152:155]
  v_mfma_f32_16x16x32_bf16 v[156:159], a[88:91], v[132:135], v[156:159]
  s_waitcnt lgkmcnt(0)
  v_mfma_f32_16x16x32_bf16 v[152:155], a[92:95], v[144:147], v[152:155]
  v_mfma_f32_16x16x32_bf16 v[156:159], a[92:95], v[148:151], v[156:159]
  s_waitcnt vmcnt(28)
  s_barrier
  ds_read_b64_tr_b16 a[64:65], v13 offset:0
  ds_read_b64_tr_b16 a[66:67], v13 offset:2048
  ds_read_b64_tr_b16 a[68:69], v13 offset:4096
  ds_read_b64_tr_b16 a[70:71], v13 offset:6144
  ds_read_b64_tr_b16 a[72:73], v13 offset:8192
  ds_read_b64_tr_b16 a[74:75], v13 offset:10240
  ds_read_b64_tr_b16 a[76:77], v13 offset:12288
  ds_read_b64_tr_b16 a[78:79], v13 offset:14336
  ds_read_b64_tr_b16 a[80:81], v13 offset:16384
  ds_read_b64_tr_b16 a[82:83], v13 offset:18432
  ds_read_b64_tr_b16 a[84:85], v13 offset:20480
  ds_read_b64_tr_b16 a[86:87], v13 offset:22528
  s_waitcnt lgkmcnt(10)
  v_mfma_f32_16x16x32_bf16 v[40:43], a[64:67], v[32:35], 0
  ds_read_b64_tr_b16 a[88:89], v13 offset:24576
  v_mfma_f32_16x16x32_bf16 v[44:47], a[64:67], v[36:39], 0
  ds_read_b64_tr_b16 a[90:91], v13 offset:26624
  s_waitcnt lgkmcnt(10)
  v_mfma_f32_16x16x32_bf16 v[40:43], a[68:71], v[48:51], v[40:43]
  ds_read_b64_tr_b16 a[92:93], v13 offset:28672
  v_mfma_f32_16x16x32_bf16 v[44:47], a[68:71], v[52:55], v[44:47]
  ds_read_b64_tr_b16 a[94:95], v13 offset:30720
  s_waitcnt lgkmcnt(10)
  v_mfma_f32_16x16x32_bf16 v[40:43], a[72:75], v[64:67], v[40:43]
  ds_read_b64_tr_b16 a[64:65], v14 offset:0
  s_mov_b32 s39, 6144
  v_mfma_f32_16x16x32_bf16 v[44:47], a[72:75], v[68:71], v[44:47]
  ds_read_b64_tr_b16 a[66:67], v14 offset:2048
  s_waitcnt lgkmcnt(10)
  v_mfma_f32_16x16x32_bf16 v[40:43], a[76:79], v[80:83], v[40:43]
  ds_read_b64_tr_b16 a[68:69], v14 offset:4096
  v_cvt_pk_bf16_f32 v104, v104, v105
  v_mfma_f32_16x16x32_bf16 v[44:47], a[76:79], v[84:87], v[44:47]
  ds_read_b64_tr_b16 a[70:71], v14 offset:6144
  s_waitcnt lgkmcnt(10)
  v_mfma_f32_16x16x32_bf16 v[40:43], a[80:83], v[96:99], v[40:43]
  ds_read_b64_tr_b16 a[72:73], v14 offset:8192
  v_cvt_pk_bf16_f32 v105, v106, v107
  v_mfma_f32_16x16x32_bf16 v[44:47], a[80:83], v[100:103], v[44:47]
  ds_read_b64_tr_b16 a[74:75], v14 offset:10240
  s_waitcnt lgkmcnt(10)
  v_mfma_f32_16x16x32_bf16 v[40:43], a[84:87], v[112:115], v[40:43]
  ds_read_b64_tr_b16 a[76:77], v14 offset:12288
  v_cvt_pk_bf16_f32 v106, v120, v121
  v_mfma_f32_16x16x32_bf16 v[44:47], a[84:87], v[116:119], v[44:47]
  ds_read_b64_tr_b16 a[78:79], v14 offset:14336
  s_waitcnt lgkmcnt(10)
  v_mfma_f32_16x16x32_bf16 v[40:43], a[88:91], v[128:131], v[40:43]
  ds_read_b64_tr_b16 a[80:81], v14 offset:16384
  v_cvt_pk_bf16_f32 v107, v122, v123
  v_mfma_f32_16x16x32_bf16 v[44:47], a[88:91], v[132:135], v[44:47]
  ds_read_b64_tr_b16 a[82:83], v14 offset:18432
  s_waitcnt lgkmcnt(10)
  v_mfma_f32_16x16x32_bf16 v[40:43], a[92:95], v[144:147], v[40:43]
  ds_read_b64_tr_b16 a[84:85], v14 offset:20480
  buffer_store_dwordx4 v[104:107], v25, s[20:23], s39 offen offset:0 sc1
  v_mfma_f32_16x16x32_bf16 v[44:47], a[92:95], v[148:151], v[44:47]
  ds_read_b64_tr_b16 a[86:87], v14 offset:22528
  s_waitcnt lgkmcnt(10)
  v_mfma_f32_16x16x32_bf16 v[56:59], a[64:67], v[32:35], 0
  ds_read_b64_tr_b16 a[88:89], v14 offset:24576
  v_cvt_pk_bf16_f32 v108, v108, v109
  v_mfma_f32_16x16x32_bf16 v[60:63], a[64:67], v[36:39], 0
  ds_read_b64_tr_b16 a[90:91], v14 offset:26624
  s_waitcnt lgkmcnt(10)
  v_mfma_f32_16x16x32_bf16 v[56:59], a[68:71], v[48:51], v[56:59]
  ds_read_b64_tr_b16 a[92:93], v14 offset:28672
  v_cvt_pk_bf16_f32 v109, v110, v111
  v_mfma_f32_16x16x32_bf16 v[60:63], a[68:71], v[52:55], v[60:63]
  ds_read_b64_tr_b16 a[94:95], v14 offset:30720
  s_waitcnt lgkmcnt(10)
  v_mfma_f32_16x16x32_bf16 v[56:59], a[72:75], v[64:67], v[56:59]
  ds_read_b64_tr_b16 a[64:65], v15 offset:0
  v_cvt_pk_bf16_f32 v110, v124, v125
  v_mfma_f32_16x16x32_bf16 v[60:63], a[72:75], v[68:71], v[60:63]
  ds_read_b64_tr_b16 a[66:67], v15 offset:2048
  s_waitcnt lgkmcnt(10)
  v_mfma_f32_16x16x32_bf16 v[56:59], a[76:79], v[80:83], v[56:59]
  ds_read_b64_tr_b16 a[68:69], v15 offset:4096
  v_cvt_pk_bf16_f32 v111, v126, v127
  v_mfma_f32_16x16x32_bf16 v[60:63], a[76:79], v[84:87], v[60:63]
  ds_read_b64_tr_b16 a[70:71], v15 offset:6144
  s_waitcnt lgkmcnt(10)
  v_mfma_f32_16x16x32_bf16 v[56:59], a[80:83], v[96:99], v[56:59]
  ds_read_b64_tr_b16 a[72:73], v15 offset:8192
  buffer_store_dwordx4 v[108:111], v26, s[20:23], s39 offen offset:0 sc1
  v_mfma_f32_16x16x32_bf16 v[60:63], a[80:83], v[100:103], v[60:63]
  ds_read_b64_tr_b16 a[74:75], v15 offset:10240
  s_waitcnt lgkmcnt(10)
  v_mfma_f32_16x16x32_bf16 v[56:59], a[84:87], v[112:115], v[56:59]
  ds_read_b64_tr_b16 a[76:77], v15 offset:12288
  v_cvt_pk_bf16_f32 v136, v136, v137
  v_mfma_f32_16x16x32_bf16 v[60:63], a[84:87], v[116:119], v[60:63]
  ds_read_b64_tr_b16 a[78:79], v15 offset:14336
  s_waitcnt lgkmcnt(10)
  v_mfma_f32_16x16x32_bf16 v[56:59], a[88:91], v[128:131], v[56:59]
  ds_read_b64_tr_b16 a[80:81], v15 offset:16384
  v_cvt_pk_bf16_f32 v137, v138, v139
  v_mfma_f32_16x16x32_bf16 v[60:63], a[88:91], v[132:135], v[60:63]
  ds_read_b64_tr_b16 a[82:83], v15 offset:18432
  s_waitcnt lgkmcnt(10)
  v_mfma_f32_16x16x32_bf16 v[56:59], a[92:95], v[144:147], v[56:59]
  ds_read_b64_tr_b16 a[84:85], v15 offset:20480
  v_cvt_pk_bf16_f32 v138, v152, v153
  v_mfma_f32_16x16x32_bf16 v[60:63], a[92:95], v[148:151], v[60:63]
  ds_read_b64_tr_b16 a[86:87], v15 offset:22528
  s_waitcnt lgkmcnt(10)
  v_mfma_f32_16x16x32_bf16 v[72:75], a[64:67], v[32:35], 0
  ds_read_b64_tr_b16 a[88:89], v15 offset:24576
  v_cvt_pk_bf16_f32 v139, v154, v155
  v_mfma_f32_16x16x32_bf16 v[76:79], a[64:67], v[36:39], 0
  ds_read_b64_tr_b16 a[90:91], v15 offset:26624
  s_waitcnt lgkmcnt(10)
  v_mfma_f32_16x16x32_bf16 v[72:75], a[68:71], v[48:51], v[72:75]
  ds_read_b64_tr_b16 a[92:93], v15 offset:28672
  buffer_store_dwordx4 v[136:139], v25, s[20:23], s39 offen offset:1024 sc1
  v_mfma_f32_16x16x32_bf16 v[76:79], a[68:71], v[52:55], v[76:79]
  ds_read_b64_tr_b16 a[94:95], v15 offset:30720
  s_waitcnt lgkmcnt(10)
  v_mfma_f32_16x16x32_bf16 v[72:75], a[72:75], v[64:67], v[72:75]
  ds_read_b64_tr_b16 a[64:65], v16 offset:0
  v_cvt_pk_bf16_f32 v140, v140, v141
  v_mfma_f32_16x16x32_bf16 v[76:79], a[72:75], v[68:71], v[76:79]
  ds_read_b64_tr_b16 a[66:67], v16 offset:2048
  s_waitcnt lgkmcnt(10)
  v_mfma_f32_16x16x32_bf16 v[72:75], a[76:79], v[80:83], v[72:75]
  ds_read_b64_tr_b16 a[68:69], v16 offset:4096
  v_cvt_pk_bf16_f32 v141, v142, v143
  v_mfma_f32_16x16x32_bf16 v[76:79], a[76:79], v[84:87], v[76:79]
  ds_read_b64_tr_b16 a[70:71], v16 offset:6144
  s_waitcnt lgkmcnt(10)
  v_mfma_f32_16x16x32_bf16 v[72:75], a[80:83], v[96:99], v[72:75]
  ds_read_b64_tr_b16 a[72:73], v16 offset:8192
  v_cvt_pk_bf16_f32 v142, v156, v157
  v_mfma_f32_16x16x32_bf16 v[76:79], a[80:83], v[100:103], v[76:79]
  ds_read_b64_tr_b16 a[74:75], v16 offset:10240
  s_waitcnt lgkmcnt(10)
  v_mfma_f32_16x16x32_bf16 v[72:75], a[84:87], v[112:115], v[72:75]
  ds_read_b64_tr_b16 a[76:77], v16 offset:12288
  v_cvt_pk_bf16_f32 v143, v158, v159
  v_mfma_f32_16x16x32_bf16 v[76:79], a[84:87], v[116:119], v[76:79]
  ds_read_b64_tr_b16 a[78:79], v16 offset:14336
  s_waitcnt lgkmcnt(10)
  v_mfma_f32_16x16x32_bf16 v[72:75], a[88:91], v[128:131], v[72:75]
  ds_read_b64_tr_b16 a[80:81], v16 offset:16384
  buffer_store_dwordx4 v[140:143], v26, s[20:23], s39 offen offset:1024 sc1
  v_mfma_f32_16x16x32_bf16 v[76:79], a[88:91], v[132:135], v[76:79]
  ds_read_b64_tr_b16 a[82:83], v16 offset:18432
  s_waitcnt lgkmcnt(10)
  v_mfma_f32_16x16x32_bf16 v[72:75], a[92:95], v[144:147], v[72:75]
  ds_read_b64_tr_b16 a[84:85], v16 offset:20480
  v_mfma_f32_16x16x32_bf16 v[76:79], a[92:95], v[148:151], v[76:79]
  ds_read_b64_tr_b16 a[86:87], v16 offset:22528
  s_waitcnt lgkmcnt(10)
  v_mfma_f32_16x16x32_bf16 v[88:91], a[64:67], v[32:35], 0
  ds_read_b64_tr_b16 a[88:89], v16 offset:24576
  v_mfma_f32_16x16x32_bf16 v[92:95], a[64:67], v[36:39], 0
  ds_read_b64_tr_b16 a[90:91], v16 offset:26624
  s_waitcnt lgkmcnt(10)
  v_mfma_f32_16x16x32_bf16 v[88:91], a[68:71], v[48:51], v[88:91]
  ds_read_b64_tr_b16 a[92:93], v16 offset:28672
  v_mfma_f32_16x16x32_bf16 v[92:95], a[68:71], v[52:55], v[92:95]
  ds_read_b64_tr_b16 a[94:95], v16 offset:30720
  s_waitcnt lgkmcnt(10)
  v_mfma_f32_16x16x32_bf16 v[88:91], a[72:75], v[64:67], v[88:91]
  v_mfma_f32_16x16x32_bf16 v[92:95], a[72:75], v[68:71], v[92:95]
  s_waitcnt lgkmcnt(8)
  v_mfma_f32_16x16x32_bf16 v[88:91], a[76:79], v[80:83], v[88:91]
  v_mfma_f32_16x16x32_bf16 v[92:95], a[76:79], v[84:87], v[92:95]
  s_waitcnt lgkmcnt(6)
  v_mfma_f32_16x16x32_bf16 v[88:91], a[80:83], v[96:99], v[88:91]
  v_mfma_f32_16x16x32_bf16 v[92:95], a[80:83], v[100:103], v[92:95]
  s_waitcnt lgkmcnt(4)
  v_mfma_f32_16x16x32_bf16 v[88:91], a[84:87], v[112:115], v[88:91]
  v_mfma_f32_16x16x32_bf16 v[92:95], a[84:87], v[116:119], v[92:95]
  s_waitcnt lgkmcnt(2)
  v_mfma_f32_16x16x32_bf16 v[88:91], a[88:91], v[128:131], v[88:91]
  v_mfma_f32_16x16x32_bf16 v[92:95], a[88:91], v[132:135], v[92:95]
  s_waitcnt lgkmcnt(0)
  v_mfma_f32_16x16x32_bf16 v[88:91], a[92:95], v[144:147], v[88:91]
  v_mfma_f32_16x16x32_bf16 v[92:95], a[92:95], v[148:151], v[92:95]
  s_waitcnt vmcnt(20)
  s_barrier
  ds_read_b64_tr_b16 a[64:65], v13 offset:32768
  ds_read_b64_tr_b16 a[66:67], v13 offset:34816
  ds_read_b64_tr_b16 a[68:69], v13 offset:36864
  ds_read_b64_tr_b16 a[70:71], v13 offset:38912
  ds_read_b64_tr_b16 a[72:73], v13 offset:40960
  ds_read_b64_tr_b16 a[74:75], v13 offset:43008
  ds_read_b64_tr_b16 a[76:77], v13 offset:45056
  ds_read_b64_tr_b16 a[78:79], v13 offset:47104
  ds_read_b64_tr_b16 a[80:81], v13 offset:49152
  ds_read_b64_tr_b16 a[82:83], v13 offset:51200
  ds_read_b64_tr_b16 a[84:85], v13 offset:53248
  ds_read_b64_tr_b16 a[86:87], v13 offset:55296
  s_waitcnt lgkmcnt(10)
  v_mfma_f32_16x16x32_bf16 v[104:107], a[64:67], v[32:35], 0
  ds_read_b64_tr_b16 a[88:89], v13 offset:57344
  v_mfma_f32_16x16x32_bf16 v[108:111], a[64:67], v[36:39], 0
  ds_read_b64_tr_b16 a[90:91], v13 offset:59392
  s_waitcnt lgkmcnt(10)
  v_mfma_f32_16x16x32_bf16 v[104:107], a[68:71], v[48:51], v[104:107]
  ds_read_b64_tr_b16 a[92:93], v13 offset:61440
  v_mfma_f32_16x16x32_bf16 v[108:111], a[68:71], v[52:55], v[108:111]
  ds_read_b64_tr_b16 a[94:95], v13 offset:63488
  s_waitcnt lgkmcnt(10)
  v_mfma_f32_16x16x32_bf16 v[104:107], a[72:75], v[64:67], v[104:107]
  ds_read_b64_tr_b16 a[64:65], v14 offset:32768
  s_mov_b32 s39, 8192
  v_mfma_f32_16x16x32_bf16 v[108:111], a[72:75], v[68:71], v[108:111]
  ds_read_b64_tr_b16 a[66:67], v14 offset:34816
  s_waitcnt lgkmcnt(10)
  v_mfma_f32_16x16x32_bf16 v[104:107], a[76:79], v[80:83], v[104:107]
  ds_read_b64_tr_b16 a[68:69], v14 offset:36864
  v_cvt_pk_bf16_f32 v40, v40, v41
  v_mfma_f32_16x16x32_bf16 v[108:111], a[76:79], v[84:87], v[108:111]
  ds_read_b64_tr_b16 a[70:71], v14 offset:38912
  s_waitcnt lgkmcnt(10)
  v_mfma_f32_16x16x32_bf16 v[104:107], a[80:83], v[96:99], v[104:107]
  ds_read_b64_tr_b16 a[72:73], v14 offset:40960
  v_cvt_pk_bf16_f32 v41, v42, v43
  v_mfma_f32_16x16x32_bf16 v[108:111], a[80:83], v[100:103], v[108:111]
  ds_read_b64_tr_b16 a[74:75], v14 offset:43008
  s_waitcnt lgkmcnt(10)
  v_mfma_f32_16x16x32_bf16 v[104:107], a[84:87], v[112:115], v[104:107]
  ds_read_b64_tr_b16 a[76:77], v14 offset:45056
  v_cvt_pk_bf16_f32 v42, v56, v57
  v_mfma_f32_16x16x32_bf16 v[108:111], a[84:87], v[116:119], v[108:111]
  ds_read_b64_tr_b16 a[78:79], v14 offset:47104
  s_waitcnt lgkmcnt(10)
  v_mfma_f32_16x16x32_bf16 v[104:107], a[88:91], v[128:131], v[104:107]
  ds_read_b64_tr_b16 a[80:81], v14 offset:49152
  v_cvt_pk_bf16_f32 v43, v58, v59
  v_mfma_f32_16x16x32_bf16 v[108:111], a[88:91], v[132:135], v[108:111]
  ds_read_b64_tr_b16 a[82:83], v14 offset:51200
  s_waitcnt lgkmcnt(10)
  v_mfma_f32_16x16x32_bf16 v[104:107], a[92:95], v[144:147], v[104:107]
  ds_read_b64_tr_b16 a[84:85], v14 offset:53248
  buffer_store_dwordx4 v[40:43], v25, s[20:23], s39 offen offset:0 sc1
  v_mfma_f32_16x16x32_bf16 v[108:111], a[92:95], v[148:151], v[108:111]
  ds_read_b64_tr_b16 a[86:87], v14 offset:55296
  s_waitcnt lgkmcnt(10)
  v_mfma_f32_16x16x32_bf16 v[120:123], a[64:67], v[32:35], 0
  ds_read_b64_tr_b16 a[88:89], v14 offset:57344
  v_cvt_pk_bf16_f32 v44, v44, v45
  v_mfma_f32_16x16x32_bf16 v[124:127], a[64:67], v[36:39], 0
  ds_read_b64_tr_b16 a[90:91], v14 offset:59392
  s_waitcnt lgkmcnt(10)
  v_mfma_f32_16x16x32_bf16 v[120:123], a[68:71], v[48:51], v[120:123]
  ds_read_b64_tr_b16 a[92:93], v14 offset:61440
  v_cvt_pk_bf16_f32 v45, v46, v47
  v_mfma_f32_16x16x32_bf16 v[124:127], a[68:71], v[52:55], v[124:127]
  ds_read_b64_tr_b16 a[94:95], v14 offset:63488
  s_waitcnt lgkmcnt(10)
  v_mfma_f32_16x16x32_bf16 v[120:123], a[72:75], v[64:67], v[120:123]
  ds_read_b64_tr_b16 a[64:65], v15 offset:32768
  v_cvt_pk_bf16_f32 v46, v60, v61
  v_mfma_f32_16x16x32_bf16 v[124:127], a[72:75], v[68:71], v[124:127]
  ds_read_b64_tr_b16 a[66:67], v15 offset:34816
  s_waitcnt lgkmcnt(10)
  v_mfma_f32_16x16x32_bf16 v[120:123], a[76:79], v[80:83], v[120:123]
  ds_read_b64_tr_b16 a[68:69], v15 offset:36864
  v_cvt_pk_bf16_f32 v47, v62, v63
  v_mfma_f32_16x16x32_bf16 v[124:127], a[76:79], v[84:87], v[124:127]
  ds_read_b64_tr_b16 a[70:71], v15 offset:38912
  s_waitcnt lgkmcnt(10)
  v_mfma_f32_16x16x32_bf16 v[120:123], a[80:83], v[96:99], v[120:123]
  ds_read_b64_tr_b16 a[72:73], v15 offset:40960
  buffer_store_dwordx4 v[44:47], v26, s[20:23], s39 offen offset:0 sc1
  v_mfma_f32_16x16x32_bf16 v[124:127], a[80:83], v[100:103], v[124:127]
  ds_read_b64_tr_b16 a[74:75], v15 offset:43008
  s_waitcnt lgkmcnt(10)
  v_mfma_f32_16x16x32_bf16 v[120:123], a[84:87], v[112:115], v[120:123]
  ds_read_b64_tr_b16 a[76:77], v15 offset:45056
  v_cvt_pk_bf16_f32 v72, v72, v73
  v_mfma_f32_16x16x32_bf16 v[124:127], a[84:87], v[116:119], v[124:127]
  ds_read_b64_tr_b16 a[78:79], v15 offset:47104
  s_waitcnt lgkmcnt(10)
  v_mfma_f32_16x16x32_bf16 v[120:123], a[88:91], v[128:131], v[120:123]
  ds_read_b64_tr_b16 a[80:81], v15 offset:49152
  v_cvt_pk_bf16_f32 v73, v74, v75
  v_mfma_f32_16x16x32_bf16 v[124:127], a[88:91], v[132:135], v[124:127]
  ds_read_b64_tr_b16 a[82:83], v15 offset:51200
  s_waitcnt lgkmcnt(10)
  v_mfma_f32_16x16x32_bf16 v[120:123], a[92:95], v[144:147], v[120:123]
  ds_read_b64_tr_b16 a[84:85], v15 offset:53248
  v_cvt_pk_bf16_f32 v74, v88, v89
  v_mfma_f32_16x16x32_bf16 v[124:127], a[92:95], v[148:151], v[124:127]
  ds_read_b64_tr_b16 a[86:87], v15 offset:55296
  s_waitcnt lgkmcnt(10)
  v_mfma_f32_16x16x32_bf16 v[136:139], a[64:67], v[32:35], 0
  ds_read_b64_tr_b16 a[88:89], v15 offset:57344
  v_cvt_pk_bf16_f32 v75, v90, v91
  v_mfma_f32_16x16x32_bf16 v[140:143], a[64:67], v[36:39], 0
  ds_read_b64_tr_b16 a[90:91], v15 offset:59392
  s_waitcnt lgkmcnt(10)
  v_mfma_f32_16x16x32_bf16 v[136:139], a[68:71], v[48:51], v[136:139]
  ds_read_b64_tr_b16 a[92:93], v15 offset:61440
  buffer_store_dwordx4 v[72:75], v25, s[20:23], s39 offen offset:1024 sc1
  v_mfma_f32_16x16x32_bf16 v[140:143], a[68:71], v[52:55], v[140:143]
  ds_read_b64_tr_b16 a[94:95], v15 offset:63488
  s_waitcnt lgkmcnt(10)
  v_mfma_f32_16x16x32_bf16 v[136:139], a[72:75], v[64:67], v[136:139]
  ds_read_b64_tr_b16 a[64:65], v16 offset:32768
  v_cvt_pk_bf16_f32 v76, v76, v77
  v_mfma_f32_16x16x32_bf16 v[140:143], a[72:75], v[68:71], v[140:143]
  ds_read_b64_tr_b16 a[66:67], v16 offset:34816
  s_waitcnt lgkmcnt(10)
  v_mfma_f32_16x16x32_bf16 v[136:139], a[76:79], v[80:83], v[136:139]
  ds_read_b64_tr_b16 a[68:69], v16 offset:36864
  v_cvt_pk_bf16_f32 v77, v78, v79
  v_mfma_f32_16x16x32_bf16 v[140:143], a[76:79], v[84:87], v[140:143]
  ds_read_b64_tr_b16 a[70:71], v16 offset:38912
  s_waitcnt lgkmcnt(10)
  v_mfma_f32_16x16x32_bf16 v[136:139], a[80:83], v[96:99], v[136:139]
  ds_read_b64_tr_b16 a[72:73], v16 offset:40960
  v_cvt_pk_bf16_f32 v78, v92, v93
  v_mfma_f32_16x16x32_bf16 v[140:143], a[80:83], v[100:103], v[140:143]
  ds_read_b64_tr_b16 a[74:75], v16 offset:43008
  s_waitcnt lgkmcnt(10)
  v_mfma_f32_16x16x32_bf16 v[136:139], a[84:87], v[112:115], v[136:139]
  ds_read_b64_tr_b16 a[76:77], v16 offset:45056
  v_cvt_pk_bf16_f32 v79, v94, v95
  v_mfma_f32_16x16x32_bf16 v[140:143], a[84:87], v[116:119], v[140:143]
  ds_read_b64_tr_b16 a[78:79], v16 offset:47104
  s_waitcnt lgkmcnt(10)
  v_mfma_f32_16x16x32_bf16 v[136:139], a[88:91], v[128:131], v[136:139]
  ds_read_b64_tr_b16 a[80:81], v16 offset:49152
  buffer_store_dwordx4 v[76:79], v26, s[20:23], s39 offen offset:1024 sc1
  v_mfma_f32_16x16x32_bf16 v[140:143], a[88:91], v[132:135], v[140:143]
  ds_read_b64_tr_b16 a[82:83], v16 offset:51200
  s_waitcnt lgkmcnt(10)
  v_mfma_f32_16x16x32_bf16 v[136:139], a[92:95], v[144:147], v[136:139]
  ds_read_b64_tr_b16 a[84:85], v16 offset:53248
  v_mfma_f32_16x16x32_bf16 v[140:143], a[92:95], v[148:151], v[140:143]
  ds_read_b64_tr_b16 a[86:87], v16 offset:55296
  s_waitcnt lgkmcnt(10)
  v_mfma_f32_16x16x32_bf16 v[152:155], a[64:67], v[32:35], 0
  ds_read_b64_tr_b16 a[88:89], v16 offset:57344
  v_mfma_f32_16x16x32_bf16 v[156:159], a[64:67], v[36:39], 0
  ds_read_b64_tr_b16 a[90:91], v16 offset:59392
  s_waitcnt lgkmcnt(10)
  v_mfma_f32_16x16x32_bf16 v[152:155], a[68:71], v[48:51], v[152:155]
  ds_read_b64_tr_b16 a[92:93], v16 offset:61440
  v_mfma_f32_16x16x32_bf16 v[156:159], a[68:71], v[52:55], v[156:159]
  ds_read_b64_tr_b16 a[94:95], v16 offset:63488
  s_waitcnt lgkmcnt(10)
  v_mfma_f32_16x16x32_bf16 v[152:155], a[72:75], v[64:67], v[152:155]
  v_mfma_f32_16x16x32_bf16 v[156:159], a[72:75], v[68:71], v[156:159]
  s_waitcnt lgkmcnt(8)
  v_mfma_f32_16x16x32_bf16 v[152:155], a[76:79], v[80:83], v[152:155]
  v_mfma_f32_16x16x32_bf16 v[156:159], a[76:79], v[84:87], v[156:159]
  s_waitcnt lgkmcnt(6)
  v_mfma_f32_16x16x32_bf16 v[152:155], a[80:83], v[96:99], v[152:155]
  v_mfma_f32_16x16x32_bf16 v[156:159], a[80:83], v[100:103], v[156:159]
  s_waitcnt lgkmcnt(4)
  v_mfma_f32_16x16x32_bf16 v[152:155], a[84:87], v[112:115], v[152:155]
  v_mfma_f32_16x16x32_bf16 v[156:159], a[84:87], v[116:119], v[156:159]
  s_waitcnt lgkmcnt(2)
  v_mfma_f32_16x16x32_bf16 v[152:155], a[88:91], v[128:131], v[152:155]
  v_mfma_f32_16x16x32_bf16 v[156:159], a[88:91], v[132:135], v[156:159]
  s_waitcnt lgkmcnt(0)
  v_mfma_f32_16x16x32_bf16 v[152:155], a[92:95], v[144:147], v[152:155]
  v_mfma_f32_16x16x32_bf16 v[156:159], a[92:95], v[148:151], v[156:159]
  s_waitcnt vmcnt(12)
  s_barrier
  ds_read_b64_tr_b16 a[64:65], v17 offset:0
  ds_read_b64_tr_b16 a[66:67], v17 offset:2048
  ds_read_b64_tr_b16 a[68:69], v17 offset:4096
  ds_read_b64_tr_b16 a[70:71], v17 offset:6144
  ds_read_b64_tr_b16 a[72:73], v17 offset:8192
  ds_read_b64_tr_b16 a[74:75], v17 offset:10240
  ds_read_b64_tr_b16 a[76:77], v17 offset:12288
  ds_read_b64_tr_b16 a[78:79], v17 offset:14336
  ds_read_b64_tr_b16 a[80:81], v17 offset:16384
  ds_read_b64_tr_b16 a[82:83], v17 offset:18432
  ds_read_b64_tr_b16 a[84:85], v17 offset:20480
  ds_read_b64_tr_b16 a[86:87], v17 offset:22528
  s_waitcnt lgkmcnt(10)
  v_mfma_f32_16x16x32_bf16 v[40:43], a[64:67], v[32:35], 0
  ds_read_b64_tr_b16 a[88:89], v17 offset:24576
  v_mfma_f32_16x16x32_bf16 v[44:47], a[64:67], v[36:39], 0
  ds_read_b64_tr_b16 a[90:91], v17 offset:26624
  s_waitcnt lgkmcnt(10)
  v_mfma_f32_16x16x32_bf16 v[40:43], a[68:71], v[48:51], v[40:43]
  ds_read_b64_tr_b16 a[92:93], v17 offset:28672
  v_mfma_f32_16x16x32_bf16 v[44:47], a[68:71], v[52:55], v[44:47]
  ds_read_b64_tr_b16 a[94:95], v17 offset:30720
  s_waitcnt lgkmcnt(10)
  v_mfma_f32_16x16x32_bf16 v[40:43], a[72:75], v[64:67], v[40:43]
  ds_read_b64_tr_b16 a[64:65], v18 offset:0
  s_mov_b32 s39, 10240
  v_mfma_f32_16x16x32_bf16 v[44:47], a[72:75], v[68:71], v[44:47]
  ds_read_b64_tr_b16 a[66:67], v18 offset:2048
  s_waitcnt lgkmcnt(10)
  v_mfma_f32_16x16x32_bf16 v[40:43], a[76:79], v[80:83], v[40:43]
  ds_read_b64_tr_b16 a[68:69], v18 offset:4096
  v_cvt_pk_bf16_f32 v104, v104, v105
  v_mfma_f32_16x16x32_bf16 v[44:47], a[76:79], v[84:87], v[44:47]
  ds_read_b64_tr_b16 a[70:71], v18 offset:6144
  s_waitcnt lgkmcnt(10)
  v_mfma_f32_16x16x32_bf16 v[40:43], a[80:83], v[96:99], v[40:43]
  ds_read_b64_tr_b16 a[72:73], v18 offset:8192
  v_cvt_pk_bf16_f32 v105, v106, v107
  v_mfma_f32_16x16x32_bf16 v[44:47], a[80:83], v[100:103], v[44:47]
  ds_read_b64_tr_b16 a[74:75], v18 offset:10240
  s_waitcnt lgkmcnt(10)
  v_mfma_f32_16x16x32_bf16 v[40:43], a[84:87], v[112:115], v[40:43]
  ds_read_b64_tr_b16 a[76:77], v18 offset:12288
  v_cvt_pk_bf16_f32 v106, v120, v121
  v_mfma_f32_16x16x32_bf16 v[44:47], a[84:87], v[116:119], v[44:47]
  ds_read_b64_tr_b16 a[78:79], v18 offset:14336
  s_waitcnt lgkmcnt(10)
  v_mfma_f32_16x16x32_bf16 v[40:43], a[88:91], v[128:131], v[40:43]
  ds_read_b64_tr_b16 a[80:81], v18 offset:16384
  v_cvt_pk_bf16_f32 v107, v122, v123
  v_mfma_f32_16x16x32_bf16 v[44:47], a[88:91], v[132:135], v[44:47]
  ds_read_b64_tr_b16 a[82:83], v18 offset:18432
  s_waitcnt lgkmcnt(10)
  v_mfma_f32_16x16x32_bf16 v[40:43], a[92:95], v[144:147], v[40:43]
  ds_read_b64_tr_b16 a[84:85], v18 offset:20480
  buffer_store_dwordx4 v[104:107], v25, s[20:23], s39 offen offset:0 sc1
  v_mfma_f32_16x16x32_bf16 v[44:47], a[92:95], v[148:151], v[44:47]
  ds_read_b64_tr_b16 a[86:87], v18 offset:22528
  s_waitcnt lgkmcnt(10)
  v_mfma_f32_16x16x32_bf16 v[56:59], a[64:67], v[32:35], 0
  ds_read_b64_tr_b16 a[88:89], v18 offset:24576
  v_cvt_pk_bf16_f32 v108, v108, v109
  v_mfma_f32_16x16x32_bf16 v[60:63], a[64:67], v[36:39], 0
  ds_read_b64_tr_b16 a[90:91], v18 offset:26624
  s_waitcnt lgkmcnt(10)
  v_mfma_f32_16x16x32_bf16 v[56:59], a[68:71], v[48:51], v[56:59]
  ds_read_b64_tr_b16 a[92:93], v18 offset:28672
  v_cvt_pk_bf16_f32 v109, v110, v111
  v_mfma_f32_16x16x32_bf16 v[60:63], a[68:71], v[52:55], v[60:63]
  ds_read_b64_tr_b16 a[94:95], v18 offset:30720
  s_waitcnt lgkmcnt(10)
  v_mfma_f32_16x16x32_bf16 v[56:59], a[72:75], v[64:67], v[56:59]
  ds_read_b64_tr_b16 a[64:65], v19 offset:0
  v_cvt_pk_bf16_f32 v110, v124, v125
  v_mfma_f32_16x16x32_bf16 v[60:63], a[72:75], v[68:71], v[60:63]
  ds_read_b64_tr_b16 a[66:67], v19 offset:2048
  s_waitcnt lgkmcnt(10)
  v_mfma_f32_16x16x32_bf16 v[56:59], a[76:79], v[80:83], v[56:59]
  ds_read_b64_tr_b16 a[68:69], v19 offset:4096
  v_cvt_pk_bf16_f32 v111, v126, v127
  v_mfma_f32_16x16x32_bf16 v[60:63], a[76:79], v[84:87], v[60:63]
  ds_read_b64_tr_b16 a[70:71], v19 offset:6144
  s_waitcnt lgkmcnt(10)
  v_mfma_f32_16x16x32_bf16 v[56:59], a[80:83], v[96:99], v[56:59]
  ds_read_b64_tr_b16 a[72:73], v19 offset:8192
  buffer_store_dwordx4 v[108:111], v26, s[20:23], s39 offen offset:0 sc1
  v_mfma_f32_16x16x32_bf16 v[60:63], a[80:83], v[100:103], v[60:63]
  ds_read_b64_tr_b16 a[74:75], v19 offset:10240
  s_waitcnt lgkmcnt(10)
  v_mfma_f32_16x16x32_bf16 v[56:59], a[84:87], v[112:115], v[56:59]
  ds_read_b64_tr_b16 a[76:77], v19 offset:12288
  v_cvt_pk_bf16_f32 v136, v136, v137
  v_mfma_f32_16x16x32_bf16 v[60:63], a[84:87], v[116:119], v[60:63]
  ds_read_b64_tr_b16 a[78:79], v19 offset:14336
  s_waitcnt lgkmcnt(10)
  v_mfma_f32_16x16x32_bf16 v[56:59], a[88:91], v[128:131], v[56:59]
  ds_read_b64_tr_b16 a[80:81], v19 offset:16384
  v_cvt_pk_bf16_f32 v137, v138, v139
  v_mfma_f32_16x16x32_bf16 v[60:63], a[88:91], v[132:135], v[60:63]
  ds_read_b64_tr_b16 a[82:83], v19 offset:18432
  s_waitcnt lgkmcnt(10)
  v_mfma_f32_16x16x32_bf16 v[56:59], a[92:95], v[144:147], v[56:59]
  ds_read_b64_tr_b16 a[84:85], v19 offset:20480
  v_cvt_pk_bf16_f32 v138, v152, v153
  v_mfma_f32_16x16x32_bf16 v[60:63], a[92:95], v[148:151], v[60:63]
  ds_read_b64_tr_b16 a[86:87], v19 offset:22528
  s_waitcnt lgkmcnt(10)
  v_mfma_f32_16x16x32_bf16 v[72:75], a[64:67], v[32:35], 0
  ds_read_b64_tr_b16 a[88:89], v19 offset:24576
  v_cvt_pk_bf16_f32 v139, v154, v155
  v_mfma_f32_16x16x32_bf16 v[76:79], a[64:67], v[36:39], 0
  ds_read_b64_tr_b16 a[90:91], v19 offset:26624
  s_waitcnt lgkmcnt(10)
  v_mfma_f32_16x16x32_bf16 v[72:75], a[68:71], v[48:51], v[72:75]
  ds_read_b64_tr_b16 a[92:93], v19 offset:28672
  buffer_store_dwordx4 v[136:139], v25, s[20:23], s39 offen offset:1024 sc1
  v_mfma_f32_16x16x32_bf16 v[76:79], a[68:71], v[52:55], v[76:79]
  ds_read_b64_tr_b16 a[94:95], v19 offset:30720
  s_waitcnt lgkmcnt(10)
  v_mfma_f32_16x16x32_bf16 v[72:75], a[72:75], v[64:67], v[72:75]
  ds_read_b64_tr_b16 a[64:65], v20 offset:0
  v_cvt_pk_bf16_f32 v140, v140, v141
  v_mfma_f32_16x16x32_bf16 v[76:79], a[72:75], v[68:71], v[76:79]
  ds_read_b64_tr_b16 a[66:67], v20 offset:2048
  s_waitcnt lgkmcnt(10)
  v_mfma_f32_16x16x32_bf16 v[72:75], a[76:79], v[80:83], v[72:75]
  ds_read_b64_tr_b16 a[68:69], v20 offset:4096
  v_cvt_pk_bf16_f32 v141, v142, v143
  v_mfma_f32_16x16x32_bf16 v[76:79], a[76:79], v[84:87], v[76:79]
  ds_read_b64_tr_b16 a[70:71], v20 offset:6144
  s_waitcnt lgkmcnt(10)
  v_mfma_f32_16x16x32_bf16 v[72:75], a[80:83], v[96:99], v[72:75]
  ds_read_b64_tr_b16 a[72:73], v20 offset:8192
  v_cvt_pk_bf16_f32 v142, v156, v157
  v_mfma_f32_16x16x32_bf16 v[76:79], a[80:83], v[100:103], v[76:79]
  ds_read_b64_tr_b16 a[74:75], v20 offset:10240
  s_waitcnt lgkmcnt(10)
  v_mfma_f32_16x16x32_bf16 v[72:75], a[84:87], v[112:115], v[72:75]
  ds_read_b64_tr_b16 a[76:77], v20 offset:12288
  v_cvt_pk_bf16_f32 v143, v158, v159
  v_mfma_f32_16x16x32_bf16 v[76:79], a[84:87], v[116:119], v[76:79]
  ds_read_b64_tr_b16 a[78:79], v20 offset:14336
  s_waitcnt lgkmcnt(10)
  v_mfma_f32_16x16x32_bf16 v[72:75], a[88:91], v[128:131], v[72:75]
  ds_read_b64_tr_b16 a[80:81], v20 offset:16384
  buffer_store_dwordx4 v[140:143], v26, s[20:23], s39 offen offset:1024 sc1
  v_mfma_f32_16x16x32_bf16 v[76:79], a[88:91], v[132:135], v[76:79]
  ds_read_b64_tr_b16 a[82:83], v20 offset:18432
  s_waitcnt lgkmcnt(10)
  v_mfma_f32_16x16x32_bf16 v[72:75], a[92:95], v[144:147], v[72:75]
  ds_read_b64_tr_b16 a[84:85], v20 offset:20480
  v_mfma_f32_16x16x32_bf16 v[76:79], a[92:95], v[148:151], v[76:79]
  ds_read_b64_tr_b16 a[86:87], v20 offset:22528
  s_waitcnt lgkmcnt(10)
  v_mfma_f32_16x16x32_bf16 v[88:91], a[64:67], v[32:35], 0
  ds_read_b64_tr_b16 a[88:89], v20 offset:24576
  v_mfma_f32_16x16x32_bf16 v[92:95], a[64:67], v[36:39], 0
  ds_read_b64_tr_b16 a[90:91], v20 offset:26624
  s_waitcnt lgkmcnt(10)
  v_mfma_f32_16x16x32_bf16 v[88:91], a[68:71], v[48:51], v[88:91]
  ds_read_b64_tr_b16 a[92:93], v20 offset:28672
  v_mfma_f32_16x16x32_bf16 v[92:95], a[68:71], v[52:55], v[92:95]
  ds_read_b64_tr_b16 a[94:95], v20 offset:30720
  s_waitcnt lgkmcnt(10)
  v_mfma_f32_16x16x32_bf16 v[88:91], a[72:75], v[64:67], v[88:91]
  v_mfma_f32_16x16x32_bf16 v[92:95], a[72:75], v[68:71], v[92:95]
  s_waitcnt lgkmcnt(8)
  v_mfma_f32_16x16x32_bf16 v[88:91], a[76:79], v[80:83], v[88:91]
  v_mfma_f32_16x16x32_bf16 v[92:95], a[76:79], v[84:87], v[92:95]
  s_waitcnt lgkmcnt(6)
  v_mfma_f32_16x16x32_bf16 v[88:91], a[80:83], v[96:99], v[88:91]
  v_mfma_f32_16x16x32_bf16 v[92:95], a[80:83], v[100:103], v[92:95]
  s_waitcnt lgkmcnt(4)
  v_mfma_f32_16x16x32_bf16 v[88:91], a[84:87], v[112:115], v[88:91]
  v_mfma_f32_16x16x32_bf16 v[92:95], a[84:87], v[116:119], v[92:95]
  s_waitcnt lgkmcnt(2)
  v_mfma_f32_16x16x32_bf16 v[88:91], a[88:91], v[128:131], v[88:91]
  v_mfma_f32_16x16x32_bf16 v[92:95], a[88:91], v[132:135], v[92:95]
  s_waitcnt lgkmcnt(0)
  v_mfma_f32_16x16x32_bf16 v[88:91], a[92:95], v[144:147], v[88:91]
  v_mfma_f32_16x16x32_bf16 v[92:95], a[92:95], v[148:151], v[92:95]
  s_nop 7
  s_mov_b32 s39, 12288
  v_cvt_pk_bf16_f32 v40, v40, v41
  v_cvt_pk_bf16_f32 v41, v42, v43
  v_cvt_pk_bf16_f32 v42, v56, v57
  v_cvt_pk_bf16_f32 v43, v58, v59
  buffer_store_dwordx4 v[40:43], v25, s[20:23], s39 offen offset:0 sc1
  v_cvt_pk_bf16_f32 v44, v44, v45
  v_cvt_pk_bf16_f32 v45, v46, v47
  v_cvt_pk_bf16_f32 v46, v60, v61
  v_cvt_pk_bf16_f32 v47, v62, v63
  buffer_store_dwordx4 v[44:47], v26, s[20:23], s39 offen offset:0 sc1
  v_cvt_pk_bf16_f32 v72, v72, v73
  v_cvt_pk_bf16_f32 v73, v74, v75
  v_cvt_pk_bf16_f32 v74, v88, v89
  v_cvt_pk_bf16_f32 v75, v90, v91
  buffer_store_dwordx4 v[72:75], v25, s[20:23], s39 offen offset:1024 sc1
  v_cvt_pk_bf16_f32 v76, v76, v77
  v_cvt_pk_bf16_f32 v77, v78, v79
  v_cvt_pk_bf16_f32 v78, v92, v93
  v_cvt_pk_bf16_f32 v79, v94, v95
  buffer_store_dwordx4 v[76:79], v26, s[20:23], s39 offen offset:1024 sc1
  s_waitcnt vmcnt(0)
  s_barrier
  s_lshl_b32 s60, s30, 7
  s_lshl_b32 s61, s29, 2
  s_add_u32 s60, s60, s61
  s_add_u32 s60, s60, 6144
  s_cmp_eq_u32 s28, 0
  s_cbranch_scc0 k2_pflag
  s_mov_b64 exec, 1
  v_mov_b32 v27, 1
  v_mov_b32 v28, s60
  buffer_store_dword v27, v28, s[56:59], 0 offen sc1
  s_mov_b64 exec, -1
k2_pflag:
  s_branch k2_done
k2_m0_slow:
  s_nop 7
  v_max3_f32 v10, v160, v161, v162
  v_max3_f32 v10, v10, v163, v168
  v_max3_f32 v10, v10, v169, v170
  v_max_f32 v10, v10, v171
  v_mov_b32 v27, v10
  s_nop 1
  v_permlane16_swap_b32 v10, v27
  s_nop 1
  v_max_f32 v10, v10, v27
  v_mov_b32 v27, v10
  s_nop 1
  v_permlane32_swap_b32 v10, v27
  s_nop 1
  v_max_f32 v10, v10, v27
  v_max_f32 v10, 0, v10
  v_sub_f32 v160, v160, v10
  v_sub_f32 v161, v161, v10
  v_sub_f32 v162, v162, v10
  v_sub_f32 v163, v163, v10
  v_sub_f32 v168, v168, v10
  v_sub_f32 v169, v169, v10
  v_sub_f32 v170, v170, v10
  v_sub_f32 v171, v171, v10
  v_sub_f32 v208, v208, v10
  v_sub_f32 v209, v209, v10
  v_sub_f32 v210, v210, v10
  v_sub_f32 v211, v211, v10
  v_exp_f32 v28, -v10
  s_nop 0
  v_mul_f32 v6, v6, v28
  v_mul_f32 v32, v32, v28
  v_mul_f32 v33, v33, v28
  v_mul_f32 v34, v34, v28
  v_mul_f32 v35, v35, v28
  v_mul_f32 v40, v40, v28
  v_mul_f32 v41, v41, v28
  v_mul_f32 v42, v42, v28
  v_mul_f32 v43, v43, v28
  v_mul_f32 v48, v48, v28
  v_mul_f32 v49, v49, v28
  v_mul_f32 v50, v50, v28
  v_mul_f32 v51, v51, v28
  v_mul_f32 v56, v56, v28
  v_mul_f32 v57, v57, v28
  v_mul_f32 v58, v58, v28
  v_mul_f32 v59, v59, v28
  v_mul_f32 v64, v64, v28
  v_mul_f32 v65, v65, v28
  v_mul_f32 v66, v66, v28
  v_mul_f32 v67, v67, v28
  v_mul_f32 v72, v72, v28
  v_mul_f32 v73, v73, v28
  v_mul_f32 v74, v74, v28
  v_mul_f32 v75, v75, v28
  v_mul_f32 v80, v80, v28
  v_mul_f32 v81, v81, v28
  v_mul_f32 v82, v82, v28
  v_mul_f32 v83, v83, v28
  v_mul_f32 v88, v88, v28
  v_mul_f32 v89, v89, v28
  v_mul_f32 v90, v90, v28
  v_mul_f32 v91, v91, v28
  v_mul_f32 v96, v96, v28
  v_mul_f32 v97, v97, v28
  v_mul_f32 v98, v98, v28
  v_mul_f32 v99, v99, v28
  v_mul_f32 v104, v104, v28
  v_mul_f32 v105, v105, v28
  v_mul_f32 v106, v106, v28
  v_mul_f32 v107, v107, v28
  v_mul_f32 v112, v112, v28
  v_mul_f32 v113, v113, v28
  v_mul_f32 v114, v114, v28
  v_mul_f32 v115, v115, v28
  v_mul_f32 v120, v120, v28
  v_mul_f32 v121, v121, v28
  v_mul_f32 v122, v122, v28
  v_mul_f32 v123, v123, v28
  v_mul_f32 v128, v128, v28
  v_mul_f32 v129, v129, v28
  v_mul_f32 v130, v130, v28
  v_mul_f32 v131, v131, v28
  v_mul_f32 v136, v136, v28
  v_mul_f32 v137, v137, v28
  v_mul_f32 v138, v138, v28
  v_mul_f32 v139, v139, v28
  v_mul_f32 v144, v144, v28
  v_mul_f32 v145, v145, v28
  v_mul_f32 v146, v146, v28
  v_mul_f32 v147, v147, v28
  v_mul_f32 v152, v152, v28
  v_mul_f32 v153, v153, v28
  v_mul_f32 v154, v154, v28
  v_mul_f32 v155, v155, v28
  v_max3_f32 v11, v164, v165, v166
  v_max3_f32 v11, v11, v167, v172
  v_max3_f32 v11, v11, v173, v174
  v_max_f32 v11, v11, v175
  v_mov_b32 v27, v11
  s_nop 1
  v_permlane16_swap_b32 v11, v27
  s_nop 1
  v_max_f32 v11, v11, v27
  v_mov_b32 v27, v11
  s_nop 1
  v_permlane32_swap_b32 v11, v27
  s_nop 1
  v_max_f32 v11, v11, v27
  v_max_f32 v11, 0, v11
  v_sub_f32 v164, v164, v11
  v_sub_f32 v165, v165, v11
  v_sub_f32 v166, v166, v11
  v_sub_f32 v167, v167, v11
  v_sub_f32 v172, v172, v11
  v_sub_f32 v173, v173, v11
  v_sub_f32 v174, v174, v11
  v_sub_f32 v175, v175, v11
  v_sub_f32 v212, v212, v11
  v_sub_f32 v213, v213, v11
  v_sub_f32 v214, v214, v11
  v_sub_f32 v215, v215, v11
  v_exp_f32 v28, -v11
  s_nop 0
  v_mul_f32 v7, v7, v28
  v_mul_f32 v36, v36, v28
  v_mul_f32 v37, v37, v28
  v_mul_f32 v38, v38, v28
  v_mul_f32 v39, v39, v28
  v_mul_f32 v44, v44, v28
  v_mul_f32 v45, v45, v28
  v_mul_f32 v46, v46, v28
  v_mul_f32 v47, v47, v28
  v_mul_f32 v52, v52, v28
  v_mul_f32 v53, v53, v28
  v_mul_f32 v54, v54, v28
  v_mul_f32 v55, v55, v28
  v_mul_f32 v60, v60, v28
  v_mul_f32 v61, v61, v28
  v_mul_f32 v62, v62, v28
  v_mul_f32 v63, v63, v28
  v_mul_f32 v68, v68, v28
  v_mul_f32 v69, v69, v28
  v_mul_f32 v70, v70, v28
  v_mul_f32 v71, v71, v28
  v_mul_f32 v76, v76, v28
  v_mul_f32 v77, v77, v28
  v_mul_f32 v78, v78, v28
  v_mul_f32 v79, v79, v28
  v_mul_f32 v84, v84, v28
  v_mul_f32 v85, v85, v28
  v_mul_f32 v86, v86, v28
  v_mul_f32 v87, v87, v28
  v_mul_f32 v92, v92, v28
  v_mul_f32 v93, v93, v28
  v_mul_f32 v94, v94, v28
  v_mul_f32 v95, v95, v28
  v_mul_f32 v100, v100, v28
  v_mul_f32 v101, v101, v28
  v_mul_f32 v102, v102, v28
  v_mul_f32 v103, v103, v28
  v_mul_f32 v108, v108, v28
  v_mul_f32 v109, v109, v28
  v_mul_f32 v110, v110, v28
  v_mul_f32 v111, v111, v28
  v_mul_f32 v116, v116, v28
  v_mul_f32 v117, v117, v28
  v_mul_f32 v118, v118, v28
  v_mul_f32 v119, v119, v28
  v_mul_f32 v124, v124, v28
  v_mul_f32 v125, v125, v28
  v_mul_f32 v126, v126, v28
  v_mul_f32 v127, v127, v28
  v_mul_f32 v132, v132, v28
  v_mul_f32 v133, v133, v28
  v_mul_f32 v134, v134, v28
  v_mul_f32 v135, v135, v28
  v_mul_f32 v140, v140, v28
  v_mul_f32 v141, v141, v28
  v_mul_f32 v142, v142, v28
  v_mul_f32 v143, v143, v28
  v_mul_f32 v148, v148, v28
  v_mul_f32 v149, v149, v28
  v_mul_f32 v150, v150, v28
  v_mul_f32 v151, v151, v28
  v_mul_f32 v156, v156, v28
  v_mul_f32 v157, v157, v28
  v_mul_f32 v158, v158, v28
  v_mul_f32 v159, v159, v28
  s_branch k2_m0_back
k2_m1_slow:
  s_nop 7
  v_max3_f32 v10, v176, v177, v178
  v_max3_f32 v10, v10, v179, v184
  v_max3_f32 v10, v10, v185, v186
  v_max_f32 v10, v10, v187
  v_mov_b32 v27, v10
  s_nop 1
  v_permlane16_swap_b32 v10, v27
  s_nop 1
  v_max_f32 v10, v10, v27
  v_mov_b32 v27, v10
  s_nop 1
  v_permlane32_swap_b32 v10, v27
  s_nop 1
  v_max_f32 v10, v10, v27
  v_max_f32 v10, 0, v10
  v_sub_f32 v176, v176, v10
  v_sub_f32 v177, v177, v10
  v_sub_f32 v178, v178, v10
  v_sub_f32 v179, v179, v10
  v_sub_f32 v184, v184, v10
  v_sub_f32 v185, v185, v10
  v_sub_f32 v186, v186, v10
  v_sub_f32 v187, v187, v10
  v_sub_f32 v208, v208, v10
  v_sub_f32 v209, v209, v10
  v_sub_f32 v210, v210, v10
  v_sub_f32 v211, v211, v10
  v_exp_f32 v28, -v10
  s_nop 0
  v_mul_f32 v6, v6, v28
  v_mul_f32 v32, v32, v28
  v_mul_f32 v33, v33, v28
  v_mul_f32 v34, v34, v28
  v_mul_f32 v35, v35, v28
  v_mul_f32 v40, v40, v28
  v_mul_f32 v41, v41, v28
  v_mul_f32 v42, v42, v28
  v_mul_f32 v43, v43, v28
  v_mul_f32 v48, v48, v28
  v_mul_f32 v49, v49, v28
  v_mul_f32 v50, v50, v28
  v_mul_f32 v51, v51, v28
  v_mul_f32 v56, v56, v28
  v_mul_f32 v57, v57, v28
  v_mul_f32 v58, v58, v28
  v_mul_f32 v59, v59, v28
  v_mul_f32 v64, v64, v28
  v_mul_f32 v65, v65, v28
  v_mul_f32 v66, v66, v28
  v_mul_f32 v67, v67, v28
  v_mul_f32 v72, v72, v28
  v_mul_f32 v73, v73, v28
  v_mul_f32 v74, v74, v28
  v_mul_f32 v75, v75, v28
  v_mul_f32 v80, v80, v28
  v_mul_f32 v81, v81, v28
  v_mul_f32 v82, v82, v28
  v_mul_f32 v83, v83, v28
  v_mul_f32 v88, v88, v28
  v_mul_f32 v89, v89, v28
  v_mul_f32 v90, v90, v28
  v_mul_f32 v91, v91, v28
  v_mul_f32 v96, v96, v28
  v_mul_f32 v97, v97, v28
  v_mul_f32 v98, v98, v28
  v_mul_f32 v99, v99, v28
  v_mul_f32 v104, v104, v28
  v_mul_f32 v105, v105, v28
  v_mul_f32 v106, v106, v28
  v_mul_f32 v107, v107, v28
  v_mul_f32 v112, v112, v28
  v_mul_f32 v113, v113, v28
  v_mul_f32 v114, v114, v28
  v_mul_f32 v115, v115, v28
  v_mul_f32 v120, v120, v28
  v_mul_f32 v121, v121, v28
  v_mul_f32 v122, v122, v28
  v_mul_f32 v123, v123, v28
  v_mul_f32 v128, v128, v28
  v_mul_f32 v129, v129, v28
  v_mul_f32 v130, v130, v28
  v_mul_f32 v131, v131, v28
  v_mul_f32 v136, v136, v28
  v_mul_f32 v137, v137, v28
  v_mul_f32 v138, v138, v28
  v_mul_f32 v139, v139, v28
  v_mul_f32 v144, v144, v28
  v_mul_f32 v145, v145, v28
  v_mul_f32 v146, v146, v28
  v_mul_f32 v147, v147, v28
  v_mul_f32 v152, v152, v28
  v_mul_f32 v153, v153, v28
  v_mul_f32 v154, v154, v28
  v_mul_f32 v155, v155, v28
  v_max3_f32 v11, v180, v181, v182
  v_max3_f32 v11, v11, v183, v188
  v_max3_f32 v11, v11, v189, v190
  v_max_f32 v11, v11, v191
  v_mov_b32 v27, v11
  s_nop 1
  v_permlane16_swap_b32 v11, v27
  s_nop 1
  v_max_f32 v11, v11, v27
  v_mov_b32 v27, v11
  s_nop 1
  v_permlane32_swap_b32 v11, v27
  s_nop 1
  v_max_f32 v11, v11, v27
  v_max_f32 v11, 0, v11
  v_sub_f32 v180, v180, v11
  v_sub_f32 v181, v181, v11
  v_sub_f32 v182, v182, v11
  v_sub_f32 v183, v183, v11
  v_sub_f32 v188, v188, v11
  v_sub_f32 v189, v189, v11
  v_sub_f32 v190, v190, v11
  v_sub_f32 v191, v191, v11
  v_sub_f32 v212, v212, v11
  v_sub_f32 v213, v213, v11
  v_sub_f32 v214, v214, v11
  v_sub_f32 v215, v215, v11
  v_exp_f32 v28, -v11
  s_nop 0
  v_mul_f32 v7, v7, v28
  v_mul_f32 v36, v36, v28
  v_mul_f32 v37, v37, v28
  v_mul_f32 v38, v38, v28
  v_mul_f32 v39, v39, v28
  v_mul_f32 v44, v44, v28
  v_mul_f32 v45, v45, v28
  v_mul_f32 v46, v46, v28
  v_mul_f32 v47, v47, v28
  v_mul_f32 v52, v52, v28
  v_mul_f32 v53, v53, v28
  v_mul_f32 v54, v54, v28
  v_mul_f32 v55, v55, v28
  v_mul_f32 v60, v60, v28
  v_mul_f32 v61, v61, v28
  v_mul_f32 v62, v62, v28
  v_mul_f32 v63, v63, v28
  v_mul_f32 v68, v68, v28
  v_mul_f32 v69, v69, v28
  v_mul_f32 v70, v70, v28
  v_mul_f32 v71, v71, v28
  v_mul_f32 v76, v76, v28
  v_mul_f32 v77, v77, v28
  v_mul_f32 v78, v78, v28
  v_mul_f32 v79, v79, v28
  v_mul_f32 v84, v84, v28
  v_mul_f32 v85, v85, v28
  v_mul_f32 v86, v86, v28
  v_mul_f32 v87, v87, v28
  v_mul_f32 v92, v92, v28
  v_mul_f32 v93, v93, v28
  v_mul_f32 v94, v94, v28
  v_mul_f32 v95, v95, v28
  v_mul_f32 v100, v100, v28
  v_mul_f32 v101, v101, v28
  v_mul_f32 v102, v102, v28
  v_mul_f32 v103, v103, v28
  v_mul_f32 v108, v108, v28
  v_mul_f32 v109, v109, v28
  v_mul_f32 v110, v110, v28
  v_mul_f32 v111, v111, v28
  v_mul_f32 v116, v116, v28
  v_mul_f32 v117, v117, v28
  v_mul_f32 v118, v118, v28
  v_mul_f32 v119, v119, v28
  v_mul_f32 v124, v124, v28
  v_mul_f32 v125, v125, v28
  v_mul_f32 v126, v126, v28
  v_mul_f32 v127, v127, v28
  v_mul_f32 v132, v132, v28
  v_mul_f32 v133, v133, v28
  v_mul_f32 v134, v134, v28
  v_mul_f32 v135, v135, v28
  v_mul_f32 v140, v140, v28
  v_mul_f32 v141, v141, v28
  v_mul_f32 v142, v142, v28
  v_mul_f32 v143, v143, v28
  v_mul_f32 v148, v148, v28
  v_mul_f32 v149, v149, v28
  v_mul_f32 v150, v150, v28
  v_mul_f32 v151, v151, v28
  v_mul_f32 v156, v156, v28
  v_mul_f32 v157, v157, v28
  v_mul_f32 v158, v158, v28
  v_mul_f32 v159, v159, v28
  s_branch k2_m1_back
k2_t0_slow:
  s_nop 7
  v_max3_f32 v10, v160, v161, v162
  v_max3_f32 v10, v10, v163, v168
  v_max3_f32 v10, v10, v169, v170
  v_max_f32 v10, v10, v171
  v_mov_b32 v27, v10
  s_nop 1
  v_permlane16_swap_b32 v10, v27
  s_nop 1
  v_max_f32 v10, v10, v27
  v_mov_b32 v27, v10
  s_nop 1
  v_permlane32_swap_b32 v10, v27
  s_nop 1
  v_max_f32 v10, v10, v27
  v_max_f32 v10, 0, v10
  v_sub_f32 v160, v160, v10
  v_sub_f32 v161, v161, v10
  v_sub_f32 v162, v162, v10
  v_sub_f32 v163, v163, v10
  v_sub_f32 v168, v168, v10
  v_sub_f32 v169, v169, v10
  v_sub_f32 v170, v170, v10
  v_sub_f32 v171, v171, v10
  v_sub_f32 v208, v208, v10
  v_sub_f32 v209, v209, v10
  v_sub_f32 v210, v210, v10
  v_sub_f32 v211, v211, v10
  v_exp_f32 v28, -v10
  s_nop 0
  v_mul_f32 v6, v6, v28
  v_mul_f32 v32, v32, v28
  v_mul_f32 v33, v33, v28
  v_mul_f32 v34, v34, v28
  v_mul_f32 v35, v35, v28
  v_mul_f32 v40, v40, v28
  v_mul_f32 v41, v41, v28
  v_mul_f32 v42, v42, v28
  v_mul_f32 v43, v43, v28
  v_mul_f32 v48, v48, v28
  v_mul_f32 v49, v49, v28
  v_mul_f32 v50, v50, v28
  v_mul_f32 v51, v51, v28
  v_mul_f32 v56, v56, v28
  v_mul_f32 v57, v57, v28
  v_mul_f32 v58, v58, v28
  v_mul_f32 v59, v59, v28
  v_mul_f32 v64, v64, v28
  v_mul_f32 v65, v65, v28
  v_mul_f32 v66, v66, v28
  v_mul_f32 v67, v67, v28
  v_mul_f32 v72, v72, v28
  v_mul_f32 v73, v73, v28
  v_mul_f32 v74, v74, v28
  v_mul_f32 v75, v75, v28
  v_mul_f32 v80, v80, v28
  v_mul_f32 v81, v81, v28
  v_mul_f32 v82, v82, v28
  v_mul_f32 v83, v83, v28
  v_mul_f32 v88, v88, v28
  v_mul_f32 v89, v89, v28
  v_mul_f32 v90, v90, v28
  v_mul_f32 v91, v91, v28
  v_mul_f32 v96, v96, v28
  v_mul_f32 v97, v97, v28
  v_mul_f32 v98, v98, v28
  v_mul_f32 v99, v99, v28
  v_mul_f32 v104, v104, v28
  v_mul_f32 v105, v105, v28
  v_mul_f32 v106, v106, v28
  v_mul_f32 v107, v107, v28
  v_mul_f32 v112, v112, v28
  v_mul_f32 v113, v113, v28
  v_mul_f32 v114, v114, v28
  v_mul_f32 v115, v115, v28
  v_mul_f32 v120, v120, v28
  v_mul_f32 v121, v121, v28
  v_mul_f32 v122, v122, v28
  v_mul_f32 v123, v123, v28
  v_mul_f32 v128, v128, v28
  v_mul_f32 v129, v129, v28
  v_mul_f32 v130, v130, v28
  v_mul_f32 v131, v131, v28
  v_mul_f32 v136, v136, v28
  v_mul_f32 v137, v137, v28
  v_mul_f32 v138, v138, v28
  v_mul_f32 v139, v139, v28
  v_mul_f32 v144, v144, v28
  v_mul_f32 v145, v145, v28
  v_mul_f32 v146, v146, v28
  v_mul_f32 v147, v147, v28
  v_mul_f32 v152, v152, v28
  v_mul_f32 v153, v153, v28
  v_mul_f32 v154, v154, v28
  v_mul_f32 v155, v155, v28
  v_max3_f32 v11, v164, v165, v166
  v_max3_f32 v11, v11, v167, v172
  v_max3_f32 v11, v11, v173, v174
  v_max_f32 v11, v11, v175
  v_mov_b32 v27, v11
  s_nop 1
  v_permlane16_swap_b32 v11, v27
  s_nop 1
  v_max_f32 v11, v11, v27
  v_mov_b32 v27, v11
  s_nop 1
  v_permlane32_swap_b32 v11, v27
  s_nop 1
  v_max_f32 v11, v11, v27
  v_max_f32 v11, 0, v11
  v_sub_f32 v164, v164, v11
  v_sub_f32 v165, v165, v11
  v_sub_f32 v166, v166, v11
  v_sub_f32 v167, v167, v11
  v_sub_f32 v172, v172, v11
  v_sub_f32 v173, v173, v11
  v_sub_f32 v174, v174, v11
  v_sub_f32 v175, v175, v11
  v_sub_f32 v212, v212, v11
  v_sub_f32 v213, v213, v11
  v_sub_f32 v214, v214, v11
  v_sub_f32 v215, v215, v11
  v_exp_f32 v28, -v11
  s_nop 0
  v_mul_f32 v7, v7, v28
  v_mul_f32 v36, v36, v28
  v_mul_f32 v37, v37, v28
  v_mul_f32 v38, v38, v28
  v_mul_f32 v39, v39, v28
  v_mul_f32 v44, v44, v28
  v_mul_f32 v45, v45, v28
  v_mul_f32 v46, v46, v28
  v_mul_f32 v47, v47, v28
  v_mul_f32 v52, v52, v28
  v_mul_f32 v53, v53, v28
  v_mul_f32 v54, v54, v28
  v_mul_f32 v55, v55, v28
  v_mul_f32 v60, v60, v28
  v_mul_f32 v61, v61, v28
  v_mul_f32 v62, v62, v28
  v_mul_f32 v63, v63, v28
  v_mul_f32 v68, v68, v28
  v_mul_f32 v69, v69, v28
  v_mul_f32 v70, v70, v28
  v_mul_f32 v71, v71, v28
  v_mul_f32 v76, v76, v28
  v_mul_f32 v77, v77, v28
  v_mul_f32 v78, v78, v28
  v_mul_f32 v79, v79, v28
  v_mul_f32 v84, v84, v28
  v_mul_f32 v85, v85, v28
  v_mul_f32 v86, v86, v28
  v_mul_f32 v87, v87, v28
  v_mul_f32 v92, v92, v28
  v_mul_f32 v93, v93, v28
  v_mul_f32 v94, v94, v28
  v_mul_f32 v95, v95, v28
  v_mul_f32 v100, v100, v28
  v_mul_f32 v101, v101, v28
  v_mul_f32 v102, v102, v28
  v_mul_f32 v103, v103, v28
  v_mul_f32 v108, v108, v28
  v_mul_f32 v109, v109, v28
  v_mul_f32 v110, v110, v28
  v_mul_f32 v111, v111, v28
  v_mul_f32 v116, v116, v28
  v_mul_f32 v117, v117, v28
  v_mul_f32 v118, v118, v28
  v_mul_f32 v119, v119, v28
  v_mul_f32 v124, v124, v28
  v_mul_f32 v125, v125, v28
  v_mul_f32 v126, v126, v28
  v_mul_f32 v127, v127, v28
  v_mul_f32 v132, v132, v28
  v_mul_f32 v133, v133, v28
  v_mul_f32 v134, v134, v28
  v_mul_f32 v135, v135, v28
  v_mul_f32 v140, v140, v28
  v_mul_f32 v141, v141, v28
  v_mul_f32 v142, v142, v28
  v_mul_f32 v143, v143, v28
  v_mul_f32 v148, v148, v28
  v_mul_f32 v149, v149, v28
  v_mul_f32 v150, v150, v28
  v_mul_f32 v151, v151, v28
  v_mul_f32 v156, v156, v28
  v_mul_f32 v157, v157, v28
  v_mul_f32 v158, v158, v28
  v_mul_f32 v159, v159, v28
  s_branch k2_t0_back
k2_t1_slow:
  s_nop 7
  v_max3_f32 v10, v176, v177, v178
  v_max3_f32 v10, v10, v179, v184
  v_max3_f32 v10, v10, v185, v186
  v_max_f32 v10, v10, v187
  v_mov_b32 v27, v10
  s_nop 1
  v_permlane16_swap_b32 v10, v27
  s_nop 1
  v_max_f32 v10, v10, v27
  v_mov_b32 v27, v10
  s_nop 1
  v_permlane32_swap_b32 v10, v27
  s_nop 1
  v_max_f32 v10, v10, v27
  v_max_f32 v10, 0, v10
  v_sub_f32 v176, v176, v10
  v_sub_f32 v177, v177, v10
  v_sub_f32 v178, v178, v10
  v_sub_f32 v179, v179, v10
  v_sub_f32 v184, v184, v10
  v_sub_f32 v185, v185, v10
  v_sub_f32 v186, v186, v10
  v_sub_f32 v187, v187, v10
  v_sub_f32 v208, v208, v10
  v_sub_f32 v209, v209, v10
  v_sub_f32 v210, v210, v10
  v_sub_f32 v211, v211, v10
  v_exp_f32 v28, -v10
  s_nop 0
  v_mul_f32 v6, v6, v28
  v_mul_f32 v32, v32, v28
  v_mul_f32 v33, v33, v28
  v_mul_f32 v34, v34, v28
  v_mul_f32 v35, v35, v28
  v_mul_f32 v40, v40, v28
  v_mul_f32 v41, v41, v28
  v_mul_f32 v42, v42, v28
  v_mul_f32 v43, v43, v28
  v_mul_f32 v48, v48, v28
  v_mul_f32 v49, v49, v28
  v_mul_f32 v50, v50, v28
  v_mul_f32 v51, v51, v28
  v_mul_f32 v56, v56, v28
  v_mul_f32 v57, v57, v28
  v_mul_f32 v58, v58, v28
  v_mul_f32 v59, v59, v28
  v_mul_f32 v64, v64, v28
  v_mul_f32 v65, v65, v28
  v_mul_f32 v66, v66, v28
  v_mul_f32 v67, v67, v28
  v_mul_f32 v72, v72, v28
  v_mul_f32 v73, v73, v28
  v_mul_f32 v74, v74, v28
  v_mul_f32 v75, v75, v28
  v_mul_f32 v80, v80, v28
  v_mul_f32 v81, v81, v28
  v_mul_f32 v82, v82, v28
  v_mul_f32 v83, v83, v28
  v_mul_f32 v88, v88, v28
  v_mul_f32 v89, v89, v28
  v_mul_f32 v90, v90, v28
  v_mul_f32 v91, v91, v28
  v_mul_f32 v96, v96, v28
  v_mul_f32 v97, v97, v28
  v_mul_f32 v98, v98, v28
  v_mul_f32 v99, v99, v28
  v_mul_f32 v104, v104, v28
  v_mul_f32 v105, v105, v28
  v_mul_f32 v106, v106, v28
  v_mul_f32 v107, v107, v28
  v_mul_f32 v112, v112, v28
  v_mul_f32 v113, v113, v28
  v_mul_f32 v114, v114, v28
  v_mul_f32 v115, v115, v28
  v_mul_f32 v120, v120, v28
  v_mul_f32 v121, v121, v28
  v_mul_f32 v122, v122, v28
  v_mul_f32 v123, v123, v28
  v_mul_f32 v128, v128, v28
  v_mul_f32 v129, v129, v28
  v_mul_f32 v130, v130, v28
  v_mul_f32 v131, v131, v28
  v_mul_f32 v136, v136, v28
  v_mul_f32 v137, v137, v28
  v_mul_f32 v138, v138, v28
  v_mul_f32 v139, v139, v28
  v_mul_f32 v144, v144, v28
  v_mul_f32 v145, v145, v28
  v_mul_f32 v146, v146, v28
  v_mul_f32 v147, v147, v28
  v_mul_f32 v152, v152, v28
  v_mul_f32 v153, v153, v28
  v_mul_f32 v154, v154, v28
  v_mul_f32 v155, v155, v28
  v_max3_f32 v11, v180, v181, v182
  v_max3_f32 v11, v11, v183, v188
  v_max3_f32 v11, v11, v189, v190
  v_max_f32 v11, v11, v191
  v_mov_b32 v27, v11
  s_nop 1
  v_permlane16_swap_b32 v11, v27
  s_nop 1
  v_max_f32 v11, v11, v27
  v_mov_b32 v27, v11
  s_nop 1
  v_permlane32_swap_b32 v11, v27
  s_nop 1
  v_max_f32 v11, v11, v27
  v_max_f32 v11, 0, v11
  v_sub_f32 v180, v180, v11
  v_sub_f32 v181, v181, v11
  v_sub_f32 v182, v182, v11
  v_sub_f32 v183, v183, v11
  v_sub_f32 v188, v188, v11
  v_sub_f32 v189, v189, v11
  v_sub_f32 v190, v190, v11
  v_sub_f32 v191, v191, v11
  v_sub_f32 v212, v212, v11
  v_sub_f32 v213, v213, v11
  v_sub_f32 v214, v214, v11
  v_sub_f32 v215, v215, v11
  v_exp_f32 v28, -v11
  s_nop 0
  v_mul_f32 v7, v7, v28
  v_mul_f32 v36, v36, v28
  v_mul_f32 v37, v37, v28
  v_mul_f32 v38, v38, v28
  v_mul_f32 v39, v39, v28
  v_mul_f32 v44, v44, v28
  v_mul_f32 v45, v45, v28
  v_mul_f32 v46, v46, v28
  v_mul_f32 v47, v47, v28
  v_mul_f32 v52, v52, v28
  v_mul_f32 v53, v53, v28
  v_mul_f32 v54, v54, v28
  v_mul_f32 v55, v55, v28
  v_mul_f32 v60, v60, v28
  v_mul_f32 v61, v61, v28
  v_mul_f32 v62, v62, v28
  v_mul_f32 v63, v63, v28
  v_mul_f32 v68, v68, v28
  v_mul_f32 v69, v69, v28
  v_mul_f32 v70, v70, v28
  v_mul_f32 v71, v71, v28
  v_mul_f32 v76, v76, v28
  v_mul_f32 v77, v77, v28
  v_mul_f32 v78, v78, v28
  v_mul_f32 v79, v79, v28
  v_mul_f32 v84, v84, v28
  v_mul_f32 v85, v85, v28
  v_mul_f32 v86, v86, v28
  v_mul_f32 v87, v87, v28
  v_mul_f32 v92, v92, v28
  v_mul_f32 v93, v93, v28
  v_mul_f32 v94, v94, v28
  v_mul_f32 v95, v95, v28
  v_mul_f32 v100, v100, v28
  v_mul_f32 v101, v101, v28
  v_mul_f32 v102, v102, v28
  v_mul_f32 v103, v103, v28
  v_mul_f32 v108, v108, v28
  v_mul_f32 v109, v109, v28
  v_mul_f32 v110, v110, v28
  v_mul_f32 v111, v111, v28
  v_mul_f32 v116, v116, v28
  v_mul_f32 v117, v117, v28
  v_mul_f32 v118, v118, v28
  v_mul_f32 v119, v119, v28
  v_mul_f32 v124, v124, v28
  v_mul_f32 v125, v125, v28
  v_mul_f32 v126, v126, v28
  v_mul_f32 v127, v127, v28
  v_mul_f32 v132, v132, v28
  v_mul_f32 v133, v133, v28
  v_mul_f32 v134, v134, v28
  v_mul_f32 v135, v135, v28
  v_mul_f32 v140, v140, v28
  v_mul_f32 v141, v141, v28
  v_mul_f32 v142, v142, v28
  v_mul_f32 v143, v143, v28
  v_mul_f32 v148, v148, v28
  v_mul_f32 v149, v149, v28
  v_mul_f32 v150, v150, v28
  v_mul_f32 v151, v151, v28
  v_mul_f32 v156, v156, v28
  v_mul_f32 v157, v157, v28
  v_mul_f32 v158, v158, v28
  v_mul_f32 v159, v159, v28
  s_branch k2_t1_back
k2_t2_slow:
  s_nop 7
  v_max3_f32 v10, v160, v161, v162
  v_max3_f32 v10, v10, v163, v168
  v_max3_f32 v10, v10, v169, v170
  v_max_f32 v10, v10, v171
  v_mov_b32 v27, v10
  s_nop 1
  v_permlane16_swap_b32 v10, v27
  s_nop 1
  v_max_f32 v10, v10, v27
  v_mov_b32 v27, v10
  s_nop 1
  v_permlane32_swap_b32 v10, v27
  s_nop 1
  v_max_f32 v10, v10, v27
  v_max_f32 v10, 0, v10
  v_sub_f32 v160, v160, v10
  v_sub_f32 v161, v161, v10
  v_sub_f32 v162, v162, v10
  v_sub_f32 v163, v163, v10
  v_sub_f32 v168, v168, v10
  v_sub_f32 v169, v169, v10
  v_sub_f32 v170, v170, v10
  v_sub_f32 v171, v171, v10
  v_sub_f32 v208, v208, v10
  v_sub_f32 v209, v209, v10
  v_sub_f32 v210, v210, v10
  v_sub_f32 v211, v211, v10
  v_exp_f32 v28, -v10
  s_nop 0
  v_mul_f32 v6, v6, v28
  v_mul_f32 v32, v32, v28
  v_mul_f32 v33, v33, v28
  v_mul_f32 v34, v34, v28
  v_mul_f32 v35, v35, v28
  v_mul_f32 v40, v40, v28
  v_mul_f32 v41, v41, v28
  v_mul_f32 v42, v42, v28
  v_mul_f32 v43, v43, v28
  v_mul_f32 v48, v48, v28
  v_mul_f32 v49, v49, v28
  v_mul_f32 v50, v50, v28
  v_mul_f32 v51, v51, v28
  v_mul_f32 v56, v56, v28
  v_mul_f32 v57, v57, v28
  v_mul_f32 v58, v58, v28
  v_mul_f32 v59, v59, v28
  v_mul_f32 v64, v64, v28
  v_mul_f32 v65, v65, v28
  v_mul_f32 v66, v66, v28
  v_mul_f32 v67, v67, v28
  v_mul_f32 v72, v72, v28
  v_mul_f32 v73, v73, v28
  v_mul_f32 v74, v74, v28
  v_mul_f32 v75, v75, v28
  v_mul_f32 v80, v80, v28
  v_mul_f32 v81, v81, v28
  v_mul_f32 v82, v82, v28
  v_mul_f32 v83, v83, v28
  v_mul_f32 v88, v88, v28
  v_mul_f32 v89, v89, v28
  v_mul_f32 v90, v90, v28
  v_mul_f32 v91, v91, v28
  v_mul_f32 v96, v96, v28
  v_mul_f32 v97, v97, v28
  v_mul_f32 v98, v98, v28
  v_mul_f32 v99, v99, v28
  v_mul_f32 v104, v104, v28
  v_mul_f32 v105, v105, v28
  v_mul_f32 v106, v106, v28
  v_mul_f32 v107, v107, v28
  v_mul_f32 v112, v112, v28
  v_mul_f32 v113, v113, v28
  v_mul_f32 v114, v114, v28
  v_mul_f32 v115, v115, v28
  v_mul_f32 v120, v120, v28
  v_mul_f32 v121, v121, v28
  v_mul_f32 v122, v122, v28
  v_mul_f32 v123, v123, v28
  v_mul_f32 v128, v128, v28
  v_mul_f32 v129, v129, v28
  v_mul_f32 v130, v130, v28
  v_mul_f32 v131, v131, v28
  v_mul_f32 v136, v136, v28
  v_mul_f32 v137, v137, v28
  v_mul_f32 v138, v138, v28
  v_mul_f32 v139, v139, v28
  v_mul_f32 v144, v144, v28
  v_mul_f32 v145, v145, v28
  v_mul_f32 v146, v146, v28
  v_mul_f32 v147, v147, v28
  v_mul_f32 v152, v152, v28
  v_mul_f32 v153, v153, v28
  v_mul_f32 v154, v154, v28
  v_mul_f32 v155, v155, v28
  v_max3_f32 v11, v164, v165, v166
  v_max3_f32 v11, v11, v167, v172
  v_max3_f32 v11, v11, v173, v174
  v_max_f32 v11, v11, v175
  v_mov_b32 v27, v11
  s_nop 1
  v_permlane16_swap_b32 v11, v27
  s_nop 1
  v_max_f32 v11, v11, v27
  v_mov_b32 v27, v11
  s_nop 1
  v_permlane32_swap_b32 v11, v27
  s_nop 1
  v_max_f32 v11, v11, v27
  v_max_f32 v11, 0, v11
  v_sub_f32 v164, v164, v11
  v_sub_f32 v165, v165, v11
  v_sub_f32 v166, v166, v11
  v_sub_f32 v167, v167, v11
  v_sub_f32 v172, v172, v11
  v_sub_f32 v173, v173, v11
  v_sub_f32 v174, v174, v11
  v_sub_f32 v175, v175, v11
  v_sub_f32 v212, v212, v11
  v_sub_f32 v213, v213, v11
  v_sub_f32 v214, v214, v11
  v_sub_f32 v215, v215, v11
  v_exp_f32 v28, -v11
  s_nop 0
  v_mul_f32 v7, v7, v28
  v_mul_f32 v36, v36, v28
  v_mul_f32 v37, v37, v28
  v_mul_f32 v38, v38, v28
  v_mul_f32 v39, v39, v28
  v_mul_f32 v44, v44, v28
  v_mul_f32 v45, v45, v28
  v_mul_f32 v46, v46, v28
  v_mul_f32 v47, v47, v28
  v_mul_f32 v52, v52, v28
  v_mul_f32 v53, v53, v28
  v_mul_f32 v54, v54, v28
  v_mul_f32 v55, v55, v28
  v_mul_f32 v60, v60, v28
  v_mul_f32 v61, v61, v28
  v_mul_f32 v62, v62, v28
  v_mul_f32 v63, v63, v28
  v_mul_f32 v68, v68, v28
  v_mul_f32 v69, v69, v28
  v_mul_f32 v70, v70, v28
  v_mul_f32 v71, v71, v28
  v_mul_f32 v76, v76, v28
  v_mul_f32 v77, v77, v28
  v_mul_f32 v78, v78, v28
  v_mul_f32 v79, v79, v28
  v_mul_f32 v84, v84, v28
  v_mul_f32 v85, v85, v28
  v_mul_f32 v86, v86, v28
  v_mul_f32 v87, v87, v28
  v_mul_f32 v92, v92, v28
  v_mul_f32 v93, v93, v28
  v_mul_f32 v94, v94, v28
  v_mul_f32 v95, v95, v28
  v_mul_f32 v100, v100, v28
  v_mul_f32 v101, v101, v28
  v_mul_f32 v102, v102, v28
  v_mul_f32 v103, v103, v28
  v_mul_f32 v108, v108, v28
  v_mul_f32 v109, v109, v28
  v_mul_f32 v110, v110, v28
  v_mul_f32 v111, v111, v28
  v_mul_f32 v116, v116, v28
  v_mul_f32 v117, v117, v28
  v_mul_f32 v118, v118, v28
  v_mul_f32 v119, v119, v28
  v_mul_f32 v124, v124, v28
  v_mul_f32 v125, v125, v28
  v_mul_f32 v126, v126, v28
  v_mul_f32 v127, v127, v28
  v_mul_f32 v132, v132, v28
  v_mul_f32 v133, v133, v28
  v_mul_f32 v134, v134, v28
  v_mul_f32 v135, v135, v28
  v_mul_f32 v140, v140, v28
  v_mul_f32 v141, v141, v28
  v_mul_f32 v142, v142, v28
  v_mul_f32 v143, v143, v28
  v_mul_f32 v148, v148, v28
  v_mul_f32 v149, v149, v28
  v_mul_f32 v150, v150, v28
  v_mul_f32 v151, v151, v28
  v_mul_f32 v156, v156, v28
  v_mul_f32 v157, v157, v28
  v_mul_f32 v158, v158, v28
  v_mul_f32 v159, v159, v28
  s_branch k2_t2_back
k2_t3_slow:
  s_nop 7
  v_max3_f32 v10, v176, v177, v178
  v_max3_f32 v10, v10, v179, v184
  v_max3_f32 v10, v10, v185, v186
  v_max_f32 v10, v10, v187
  v_mov_b32 v27, v10
  s_nop 1
  v_permlane16_swap_b32 v10, v27
  s_nop 1
  v_max_f32 v10, v10, v27
  v_mov_b32 v27, v10
  s_nop 1
  v_permlane32_swap_b32 v10, v27
  s_nop 1
  v_max_f32 v10, v10, v27
  v_max_f32 v10, 0, v10
  v_sub_f32 v176, v176, v10
  v_sub_f32 v177, v177, v10
  v_sub_f32 v178, v178, v10
  v_sub_f32 v179, v179, v10
  v_sub_f32 v184, v184, v10
  v_sub_f32 v185, v185, v10
  v_sub_f32 v186, v186, v10
  v_sub_f32 v187, v187, v10
  v_sub_f32 v208, v208, v10
  v_sub_f32 v209, v209, v10
  v_sub_f32 v210, v210, v10
  v_sub_f32 v211, v211, v10
  v_exp_f32 v28, -v10
  s_nop 0
  v_mul_f32 v6, v6, v28
  v_mul_f32 v32, v32, v28
  v_mul_f32 v33, v33, v28
  v_mul_f32 v34, v34, v28
  v_mul_f32 v35, v35, v28
  v_mul_f32 v40, v40, v28
  v_mul_f32 v41, v41, v28
  v_mul_f32 v42, v42, v28
  v_mul_f32 v43, v43, v28
  v_mul_f32 v48, v48, v28
  v_mul_f32 v49, v49, v28
  v_mul_f32 v50, v50, v28
  v_mul_f32 v51, v51, v28
  v_mul_f32 v56, v56, v28
  v_mul_f32 v57, v57, v28
  v_mul_f32 v58, v58, v28
  v_mul_f32 v59, v59, v28
  v_mul_f32 v64, v64, v28
  v_mul_f32 v65, v65, v28
  v_mul_f32 v66, v66, v28
  v_mul_f32 v67, v67, v28
  v_mul_f32 v72, v72, v28
  v_mul_f32 v73, v73, v28
  v_mul_f32 v74, v74, v28
  v_mul_f32 v75, v75, v28
  v_mul_f32 v80, v80, v28
  v_mul_f32 v81, v81, v28
  v_mul_f32 v82, v82, v28
  v_mul_f32 v83, v83, v28
  v_mul_f32 v88, v88, v28
  v_mul_f32 v89, v89, v28
  v_mul_f32 v90, v90, v28
  v_mul_f32 v91, v91, v28
  v_mul_f32 v96, v96, v28
  v_mul_f32 v97, v97, v28
  v_mul_f32 v98, v98, v28
  v_mul_f32 v99, v99, v28
  v_mul_f32 v104, v104, v28
  v_mul_f32 v105, v105, v28
  v_mul_f32 v106, v106, v28
  v_mul_f32 v107, v107, v28
  v_mul_f32 v112, v112, v28
  v_mul_f32 v113, v113, v28
  v_mul_f32 v114, v114, v28
  v_mul_f32 v115, v115, v28
  v_mul_f32 v120, v120, v28
  v_mul_f32 v121, v121, v28
  v_mul_f32 v122, v122, v28
  v_mul_f32 v123, v123, v28
  v_mul_f32 v128, v128, v28
  v_mul_f32 v129, v129, v28
  v_mul_f32 v130, v130, v28
  v_mul_f32 v131, v131, v28
  v_mul_f32 v136, v136, v28
  v_mul_f32 v137, v137, v28
  v_mul_f32 v138, v138, v28
  v_mul_f32 v139, v139, v28
  v_mul_f32 v144, v144, v28
  v_mul_f32 v145, v145, v28
  v_mul_f32 v146, v146, v28
  v_mul_f32 v147, v147, v28
  v_mul_f32 v152, v152, v28
  v_mul_f32 v153, v153, v28
  v_mul_f32 v154, v154, v28
  v_mul_f32 v155, v155, v28
  v_max3_f32 v11, v180, v181, v182
  v_max3_f32 v11, v11, v183, v188
  v_max3_f32 v11, v11, v189, v190
  v_max_f32 v11, v11, v191
  v_mov_b32 v27, v11
  s_nop 1
  v_permlane16_swap_b32 v11, v27
  s_nop 1
  v_max_f32 v11, v11, v27
  v_mov_b32 v27, v11
  s_nop 1
  v_permlane32_swap_b32 v11, v27
  s_nop 1
  v_max_f32 v11, v11, v27
  v_max_f32 v11, 0, v11
  v_sub_f32 v180, v180, v11
  v_sub_f32 v181, v181, v11
  v_sub_f32 v182, v182, v11
  v_sub_f32 v183, v183, v11
  v_sub_f32 v188, v188, v11
  v_sub_f32 v189, v189, v11
  v_sub_f32 v190, v190, v11
  v_sub_f32 v191, v191, v11
  v_sub_f32 v212, v212, v11
  v_sub_f32 v213, v213, v11
  v_sub_f32 v214, v214, v11
  v_sub_f32 v215, v215, v11
  v_exp_f32 v28, -v11
  s_nop 0
  v_mul_f32 v7, v7, v28
  v_mul_f32 v36, v36, v28
  v_mul_f32 v37, v37, v28
  v_mul_f32 v38, v38, v28
  v_mul_f32 v39, v39, v28
  v_mul_f32 v44, v44, v28
  v_mul_f32 v45, v45, v28
  v_mul_f32 v46, v46, v28
  v_mul_f32 v47, v47, v28
  v_mul_f32 v52, v52, v28
  v_mul_f32 v53, v53, v28
  v_mul_f32 v54, v54, v28
  v_mul_f32 v55, v55, v28
  v_mul_f32 v60, v60, v28
  v_mul_f32 v61, v61, v28
  v_mul_f32 v62, v62, v28
  v_mul_f32 v63, v63, v28
  v_mul_f32 v68, v68, v28
  v_mul_f32 v69, v69, v28
  v_mul_f32 v70, v70, v28
  v_mul_f32 v71, v71, v28
  v_mul_f32 v76, v76, v28
  v_mul_f32 v77, v77, v28
  v_mul_f32 v78, v78, v28
  v_mul_f32 v79, v79, v28
  v_mul_f32 v84, v84, v28
  v_mul_f32 v85, v85, v28
  v_mul_f32 v86, v86, v28
  v_mul_f32 v87, v87, v28
  v_mul_f32 v92, v92, v28
  v_mul_f32 v93, v93, v28
  v_mul_f32 v94, v94, v28
  v_mul_f32 v95, v95, v28
  v_mul_f32 v100, v100, v28
  v_mul_f32 v101, v101, v28
  v_mul_f32 v102, v102, v28
  v_mul_f32 v103, v103, v28
  v_mul_f32 v108, v108, v28
  v_mul_f32 v109, v109, v28
  v_mul_f32 v110, v110, v28
  v_mul_f32 v111, v111, v28
  v_mul_f32 v116, v116, v28
  v_mul_f32 v117, v117, v28
  v_mul_f32 v118, v118, v28
  v_mul_f32 v119, v119, v28
  v_mul_f32 v124, v124, v28
  v_mul_f32 v125, v125, v28
  v_mul_f32 v126, v126, v28
  v_mul_f32 v127, v127, v28
  v_mul_f32 v132, v132, v28
  v_mul_f32 v133, v133, v28
  v_mul_f32 v134, v134, v28
  v_mul_f32 v135, v135, v28
  v_mul_f32 v140, v140, v28
  v_mul_f32 v141, v141, v28
  v_mul_f32 v142, v142, v28
  v_mul_f32 v143, v143, v28
  v_mul_f32 v148, v148, v28
  v_mul_f32 v149, v149, v28
  v_mul_f32 v150, v150, v28
  v_mul_f32 v151, v151, v28
  v_mul_f32 v156, v156, v28
  v_mul_f32 v157, v157, v28
  v_mul_f32 v158, v158, v28
  v_mul_f32 v159, v159, v28
  s_branch k2_t3_back
k2_done:
  s_load_dwordx2 s[64:65], s[0:1], 0
  s_load_dwordx4 s[68:71], s[0:1], 56
  s_and_b32 s60, s2, 7
  s_lshr_b32 s61, s2, 3
  s_lshr_b32 s62, s61, 4
  s_lshl_b32 s60, s60, 1
  s_add_u32 s29, s60, s62
  s_and_b32 s30, s61, 15
  s_lshl_b32 s31, s29, 3
  s_lshr_b32 s62, s30, 1
  s_add_u32 s31, s31, s62
  s_and_b32 s32, s30, 1
  s_mov_b32 s51, s61
  s_and_b32 s60, s2, 7
  s_mul_i32 s60, s60, 28
  s_add_u32 s60, s60, s61
  s_lshr_b32 s49, s60, 4
  s_and_b32 s50, s60, 15
  s_mov_b32 s63, 0x7f000000
  s_add_u32 s4, s98, 101711872
  s_addc_u32 s5, s99, 0
  s_mov_b32 s6, 16384
  s_mov_b32 s7, 0x00020000
  s_add_u32 s8, s98, 50331648
  s_addc_u32 s9, s99, 0
  s_mov_b32 s10, 29360128
  s_mov_b32 s11, 0x00020000
  s_add_u32 s16, s98, 104857600
  s_addc_u32 s17, s99, 0
  s_mov_b32 s18, 1835008
  s_mov_b32 s19, 0x00020000
  s_add_u32 s20, s98, 109051904
  s_addc_u32 s21, s99, 0
  s_mov_b32 s22, 1835008
  s_mov_b32 s23, 0x00020000
  v_and_b32 v2, 7, v0
  v_bfe_u32 v3, v0, 3, 2
  v_lshrrev_b32 v4, 5, v0
  s_lshl_b32 s60, s28, 1
  v_add_u32 v4, s60, v4
  s_lshl_b32 s60, s32, 3
  v_add_u32 v5, s60, v2
  v_lshl_add_u32 v6, v3, 4, v5
  v_lshlrev_b32 v7, 10, v4
  v_lshl_add_u32 v7, v6, 4, v7
  s_mul_i32 s60, s31, 14336
  v_add_u32 v7, s60, v7
  s_cmp_lt_u32 s28, 3
  s_cselect_b32 s62, 0x2000, s63
  v_add_u32 v8, s62, v7
  s_waitcnt lgkmcnt(0)
  s_mov_b32 s12, s64
  s_mov_b32 s13, s65
  s_mov_b32 s14, 1835008
  s_mov_b32 s15, 0x00020000
  s_cmp_lt_u32 s28, 2
  s_cselect_b32 s64, s68, s70
  s_cselect_b32 s65, s69, s71
  s_lshl_b32 s66, s49, 8
  s_add_u32 s24, s64, s66
  s_addc_u32 s25, s65, 0
  s_sub_u32 s26, 1605632, s66
  s_mov_b32 s27, 0x00020000
  v_lshrrev_b32 v24, 4, v0
  v_and_b32 v23, 15, v0
  s_and_b32 s64, s28, 1
  s_lshl_b32 s64, s64, 4
  s_movk_i32 s65, 3584
  v_add_u32 v25, 0, v24
  v_and_b32 v26, 7, v25
  v_lshlrev_b32 v26, 1, v26
  v_xor_b32 v26, v23, v26
  v_add_u32 v25, s64, v25
  v_mul_lo_u32 v25, v25, s65
  v_lshl_add_u32 v17, v26, 4, v25
  v_add_u32 v25, 4, v24
  v_and_b32 v26, 7, v25
  v_lshlrev_b32 v26, 1, v26
  v_xor_b32 v26, v23, v26
  v_add_u32 v25, s64, v25
  v_mul_lo_u32 v25, v25, s65
  v_lshl_add_u32 v18, v26, 4, v25
  v_subrev_u32 v18, 1024, v18
  v_add_u32 v25, 8, v24
  v_and_b32 v26, 7, v25
  v_lshlrev_b32 v26, 1, v26
  v_xor_b32 v26, v23, v26
  v_add_u32 v25, s64, v25
  v_mul_lo_u32 v25, v25, s65
  v_lshl_add_u32 v19, v26, 4, v25
  v_subrev_u32 v19, 2048, v19
  v_add_u32 v25, 12, v24
  v_and_b32 v26, 7, v25
  v_lshlrev_b32 v26, 1, v26
  v_xor_b32 v26, v23, v26
  v_add_u32 v25, s64, v25
  v_mul_lo_u32 v25, v25, s65
  v_lshl_add_u32 v20, v26, 4, v25
  v_subrev_u32 v20, 3072, v20
  s_lshl_b32 s58, s28, 12
  s_lshl_b32 s60, s31, 4
  v_add_u32 v9, s60, v5
  s_movk_i32 s60, 896
  v_mul_lo_u32 v9, v9, s60
  v_lshl_add_u32 v9, v4, 6, v9
  v_lshl_add_u32 v9, v3, 3, v9
  s_cmp_lt_u32 s28, 3
  s_cselect_b32 s62, 512, s63
  v_add_u32 v10, s62, v9
  s_mov_b32 s52, 0
  s_lshl_b32 s60, s29, 7
  s_add_u32 s60, s60, 6144
  v_and_b32 v11, 15, v0
  v_lshl_add_u32 v11, v11, 2, s60
  buffer_load_dword v12, v11, s[4:7], 0 offen sc1
  s_waitcnt vmcnt(0)
  v_cmp_ne_u32 vcc, 1, v12
  s_cbranch_vccz p3_go
  s_cmp_lt_u32 s51, 28
  s_cbranch_scc0 p3_nopre
  s_add_u32 m0, s58, 32768
  s_mov_b32 s59, 0
  buffer_load_dwordx4 v17, s[24:27], s59 offen offset:0 lds
  buffer_load_dwordx4 v18, s[24:27], s59 offen offset:1024 lds
  buffer_load_dwordx4 v19, s[24:27], s59 offen offset:2048 lds
  buffer_load_dwordx4 v20, s[24:27], s59 offen offset:3072 lds
  s_add_u32 m0, s58, 49152
  s_mov_b32 s59, 114688
  buffer_load_dwordx4 v17, s[24:27], s59 offen offset:0 lds
  buffer_load_dwordx4 v18, s[24:27], s59 offen offset:1024 lds
  buffer_load_dwordx4 v19, s[24:27], s59 offen offset:2048 lds
  buffer_load_dwordx4 v20, s[24:27], s59 offen offset:3072 lds
  s_add_u32 m0, s58, 65536
  s_mov_b32 s59, 229376
  buffer_load_dwordx4 v17, s[24:27], s59 offen offset:0 lds
  buffer_load_dwordx4 v18, s[24:27], s59 offen offset:1024 lds
  buffer_load_dwordx4 v19, s[24:27], s59 offen offset:2048 lds
  buffer_load_dwordx4 v20, s[24:27], s59 offen offset:3072 lds
  s_add_u32 m0, s58, 81920
  s_mov_b32 s59, 344064
  buffer_load_dwordx4 v17, s[24:27], s59 offen offset:0 lds
  buffer_load_dwordx4 v18, s[24:27], s59 offen offset:1024 lds
  buffer_load_dwordx4 v19, s[24:27], s59 offen offset:2048 lds
  buffer_load_dwordx4 v20, s[24:27], s59 offen offset:3072 lds
  s_add_u32 m0, s58, 98304
  s_mov_b32 s59, 458752
  buffer_load_dwordx4 v17, s[24:27], s59 offen offset:0 lds
  buffer_load_dwordx4 v18, s[24:27], s59 offen offset:1024 lds
  buffer_load_dwordx4 v19, s[24:27], s59 offen offset:2048 lds
  buffer_load_dwordx4 v20, s[24:27], s59 offen offset:3072 lds
  s_add_u32 m0, s58, 114688
  s_mov_b32 s59, 573440
  buffer_load_dwordx4 v17, s[24:27], s59 offen offset:0 lds
  buffer_load_dwordx4 v18, s[24:27], s59 offen offset:1024 lds
  buffer_load_dwordx4 v19, s[24:27], s59 offen offset:2048 lds
  buffer_load_dwordx4 v20, s[24:27], s59 offen offset:3072 lds
  s_add_u32 m0, s58, 131072
  s_mov_b32 s59, 688128
  buffer_load_dwordx4 v17, s[24:27], s59 offen offset:0 lds
  buffer_load_dwordx4 v18, s[24:27], s59 offen offset:1024 lds
  buffer_load_dwordx4 v19, s[24:27], s59 offen offset:2048 lds
  buffer_load_dwordx4 v20, s[24:27], s59 offen offset:3072 lds
  s_add_u32 m0, s58, 147456
  s_mov_b32 s59, 802816
  buffer_load_dwordx4 v17, s[24:27], s59 offen offset:0 lds
  buffer_load_dwordx4 v18, s[24:27], s59 offen offset:1024 lds
  buffer_load_dwordx4 v19, s[24:27], s59 offen offset:2048 lds
  buffer_load_dwordx4 v20, s[24:27], s59 offen offset:3072 lds
  s_add_u32 m0, s58, 0
  s_mov_b32 s59, 917504
  buffer_load_dwordx4 v17, s[24:27], s59 offen offset:0 lds
  buffer_load_dwordx4 v18, s[24:27], s59 offen offset:1024 lds
  buffer_load_dwordx4 v19, s[24:27], s59 offen offset:2048 lds
  buffer_load_dwordx4 v20, s[24:27], s59 offen offset:3072 lds
  s_mov_b32 s52, 1
p3_nopre:
  s_mov_b32 s60, 0
p3_poll:
  buffer_load_dword v12, v11, s[4:7], 0 offen sc1
  s_waitcnt vmcnt(0)
  v_cmp_ne_u32 vcc, 1, v12
  s_add_u32 s60, s60, 1
  s_cbranch_vccz p3_poll_ok
  s_cmp_lt_u32 s60, 262144
  s_cbranch_scc0 p3_poll_ok
  s_sleep 1
  s_branch p3_poll
p3_poll_ok:
p3_go:
  s_mov_b32 s60, 0
  buffer_load_dwordx4 v[32:35], v7, s[8:11], s60 offen sc1
  buffer_load_dwordx4 v[96:99], v8, s[8:11], s60 offen sc1
  s_mov_b32 s60, 1835008
  buffer_load_dwordx4 v[36:39], v7, s[8:11], s60 offen sc1
  buffer_load_dwordx4 v[100:103], v8, s[8:11], s60 offen sc1
  s_mov_b32 s60, 3670016
  buffer_load_dwordx4 v[40:43], v7, s[8:11], s60 offen sc1
  buffer_load_dwordx4 v[104:107], v8, s[8:11], s60 offen sc1
  s_mov_b32 s60, 5505024
  buffer_load_dwordx4 v[44:47], v7, s[8:11], s60 offen sc1
  buffer_load_dwordx4 v[108:111], v8, s[8:11], s60 offen sc1
  s_mov_b32 s60, 7340032
  buffer_load_dwordx4 v[48:51], v7, s[8:11], s60 offen sc1
  buffer_load_dwordx4 v[112:115], v8, s[8:11], s60 offen sc1
  s_mov_b32 s60, 9175040
  buffer_load_dwordx4 v[52:55], v7, s[8:11], s60 offen sc1
  buffer_load_dwordx4 v[116:119], v8, s[8:11], s60 offen sc1
  s_mov_b32 s60, 11010048
  buffer_load_dwordx4 v[56:59], v7, s[8:11], s60 offen sc1
  buffer_load_dwordx4 v[120:123], v8, s[8:11], s60 offen sc1
  s_mov_b32 s60, 12845056
  buffer_load_dwordx4 v[60:63], v7, s[8:11], s60 offen sc1
  buffer_load_dwordx4 v[124:127], v8, s[8:11], s60 offen sc1
  s_mov_b32 s60, 14680064
  buffer_load_dwordx4 v[64:67], v7, s[8:11], s60 offen sc1
  buffer_load_dwordx4 v[128:131], v8, s[8:11], s60 offen sc1
  s_mov_b32 s60, 16515072
  buffer_load_dwordx4 v[68:71], v7, s[8:11], s60 offen sc1
  buffer_load_dwordx4 v[132:135], v8, s[8:11], s60 offen sc1
  s_mov_b32 s60, 18350080
  buffer_load_dwordx4 v[72:75], v7, s[8:11], s60 offen sc1
  buffer_load_dwordx4 v[136:139], v8, s[8:11], s60 offen sc1
  s_mov_b32 s60, 20185088
  buffer_load_dwordx4 v[76:79], v7, s[8:11], s60 offen sc1
  buffer_load_dwordx4 v[140:143], v8, s[8:11], s60 offen sc1
  s_mov_b32 s60, 22020096
  buffer_load_dwordx4 v[80:83], v7, s[8:11], s60 offen sc1
  buffer_load_dwordx4 v[144:147], v8, s[8:11], s60 offen sc1
  s_mov_b32 s60, 23855104
  buffer_load_dwordx4 v[84:87], v7, s[8:11], s60 offen sc1
  buffer_load_dwordx4 v[148:151], v8, s[8:11], s60 offen sc1
  s_mov_b32 s60, 25690112
  buffer_load_dwordx4 v[88:91], v7, s[8:11], s60 offen sc1
  buffer_load_dwordx4 v[152:155], v8, s[8:11], s60 offen sc1
  s_mov_b32 s60, 27525120
  buffer_load_dwordx4 v[92:95], v7, s[8:11], s60 offen sc1
  buffer_load_dwordx4 v[156:159], v8, s[8:11], s60 offen sc1
  buffer_load_dwordx2 v[176:177], v9, s[12:15], 0 offen offset:0
  buffer_load_dwordx2 v[178:179], v9, s[12:15], 0 offen offset:32
  buffer_load_dwordx2 v[180:181], v10, s[12:15], 0 offen offset:0
  buffer_load_dwordx2 v[182:183], v10, s[12:15], 0 offen offset:32
  s_mov_b32 s46, 0x00003f80
  s_mov_b32 s47, 0x3f800000
  s_mov_b32 s48, 0xffff0000
  v_mov_b32 v160, 0
  v_mov_b32 v161, 0
  v_mov_b32 v162, 0
  v_mov_b32 v163, 0
  v_mov_b32 v164, 0
  v_mov_b32 v165, 0
  v_mov_b32 v166, 0
  v_mov_b32 v167, 0
  v_mov_b32 v168, 0
  v_mov_b32 v169, 0
  v_mov_b32 v170, 0
  v_mov_b32 v171, 0
  v_mov_b32 v172, 0
  v_mov_b32 v173, 0
  v_mov_b32 v174, 0
  v_mov_b32 v175, 0
  s_waitcnt vmcnt(34)
  v_dot2c_f32_bf16 v160, s46, v32
  v_dot2c_f32_bf16 v161, s47, v32
  v_dot2c_f32_bf16 v162, s46, v33
  v_dot2c_f32_bf16 v163, s47, v33
  v_dot2c_f32_bf16 v164, s46, v34
  v_dot2c_f32_bf16 v165, s47, v34
  v_dot2c_f32_bf16 v166, s46, v35
  v_dot2c_f32_bf16 v167, s47, v35
  v_dot2c_f32_bf16 v168, s46, v96
  v_dot2c_f32_bf16 v169, s47, v96
  v_dot2c_f32_bf16 v170, s46, v97
  v_dot2c_f32_bf16 v171, s47, v97
  v_dot2c_f32_bf16 v172, s46, v98
  v_dot2c_f32_bf16 v173, s47, v98
  v_dot2c_f32_bf16 v174, s46, v99
  v_dot2c_f32_bf16 v175, s47, v99
  s_waitcnt vmcnt(32)
  v_dot2c_f32_bf16 v160, s46, v36
  v_dot2c_f32_bf16 v161, s47, v36
  v_dot2c_f32_bf16 v162, s46, v37
  v_dot2c_f32_bf16 v163, s47, v37
  v_dot2c_f32_bf16 v164, s46, v38
  v_dot2c_f32_bf16 v165, s47, v38
  v_dot2c_f32_bf16 v166, s46, v39
  v_dot2c_f32_bf16 v167, s47, v39
  v_dot2c_f32_bf16 v168, s46, v100
  v_dot2c_f32_bf16 v169, s47, v100
  v_dot2c_f32_bf16 v170, s46, v101
  v_dot2c_f32_bf16 v171, s47, v101
  v_dot2c_f32_bf16 v172, s46, v102
  v_dot2c_f32_bf16 v173, s47, v102
  v_dot2c_f32_bf16 v174, s46, v103
  v_dot2c_f32_bf16 v175, s47, v103
  s_waitcnt vmcnt(30)
  v_dot2c_f32_bf16 v160, s46, v40
  v_dot2c_f32_bf16 v161, s47, v40
  v_dot2c_f32_bf16 v162, s46, v41
  v_dot2c_f32_bf16 v163, s47, v41
  v_dot2c_f32_bf16 v164, s46, v42
  v_dot2c_f32_bf16 v165, s47, v42
  v_dot2c_f32_bf16 v166, s46, v43
  v_dot2c_f32_bf16 v167, s47, v43
  v_dot2c_f32_bf16 v168, s46, v104
  v_dot2c_f32_bf16 v169, s47, v104
  v_dot2c_f32_bf16 v170, s46, v105
  v_dot2c_f32_bf16 v171, s47, v105
  v_dot2c_f32_bf16 v172, s46, v106
  v_dot2c_f32_bf16 v173, s47, v106
  v_dot2c_f32_bf16 v174, s46, v107
  v_dot2c_f32_bf16 v175, s47, v107
  s_waitcnt vmcnt(28)
  v_dot2c_f32_bf16 v160, s46, v44
  v_dot2c_f32_bf16 v161, s47, v44
  v_dot2c_f32_bf16 v162, s46, v45
  v_dot2c_f32_bf16 v163, s47, v45
  v_dot2c_f32_bf16 v164, s46, v46
  v_dot2c_f32_bf16 v165, s47, v46
  v_dot2c_f32_bf16 v166, s46, v47
  v_dot2c_f32_bf16 v167, s47, v47
  v_dot2c_f32_bf16 v168, s46, v108
  v_dot2c_f32_bf16 v169, s47, v108
  v_dot2c_f32_bf16 v170, s46, v109
  v_dot2c_f32_bf16 v171, s47, v109
  v_dot2c_f32_bf16 v172, s46, v110
  v_dot2c_f32_bf16 v173, s47, v110
  v_dot2c_f32_bf16 v174, s46, v111
  v_dot2c_f32_bf16 v175, s47, v111
  s_waitcnt vmcnt(26)
  v_dot2c_f32_bf16 v160, s46, v48
  v_dot2c_f32_bf16 v161, s47, v48
  v_dot2c_f32_bf16 v162, s46, v49
  v_dot2c_f32_bf16 v163, s47, v49
  v_dot2c_f32_bf16 v164, s46, v50
  v_dot2c_f32_bf16 v165, s47, v50
  v_dot2c_f32_bf16 v166, s46, v51
  v_dot2c_f32_bf16 v167, s47, v51
  v_dot2c_f32_bf16 v168, s46, v112
  v_dot2c_f32_bf16 v169, s47, v112
  v_dot2c_f32_bf16 v170, s46, v113
  v_dot2c_f32_bf16 v171, s47, v113
  v_dot2c_f32_bf16 v172, s46, v114
  v_dot2c_f32_bf16 v173, s47, v114
  v_dot2c_f32_bf16 v174, s46, v115
  v_dot2c_f32_bf16 v175, s47, v115
  s_waitcnt vmcnt(24)
  v_dot2c_f32_bf16 v160, s46, v52
  v_dot2c_f32_bf16 v161, s47, v52
  v_dot2c_f32_bf16 v162, s46, v53
  v_dot2c_f32_bf16 v163, s47, v53
  v_dot2c_f32_bf16 v164, s46, v54
  v_dot2c_f32_bf16 v165, s47, v54
  v_dot2c_f32_bf16 v166, s46, v55
  v_dot2c_f32_bf16 v167, s47, v55
  v_dot2c_f32_bf16 v168, s46, v116
  v_dot2c_f32_bf16 v169, s47, v116
  v_dot2c_f32_bf16 v170, s46, v117
  v_dot2c_f32_bf16 v171, s47, v117
  v_dot2c_f32_bf16 v172, s46, v118
  v_dot2c_f32_bf16 v173, s47, v118
  v_dot2c_f32_bf16 v174, s46, v119
  v_dot2c_f32_bf16 v175, s47, v119
  s_waitcnt vmcnt(22)
  v_dot2c_f32_bf16 v160, s46, v56
  v_dot2c_f32_bf16 v161, s47, v56
  v_dot2c_f32_bf16 v162, s46, v57
  v_dot2c_f32_bf16 v163, s47, v57
  v_dot2c_f32_bf16 v164, s46, v58
  v_dot2c_f32_bf16 v165, s47, v58
  v_dot2c_f32_bf16 v166, s46, v59
  v_dot2c_f32_bf16 v167, s47, v59
  v_dot2c_f32_bf16 v168, s46, v120
  v_dot2c_f32_bf16 v169, s47, v120
  v_dot2c_f32_bf16 v170, s46, v121
  v_dot2c_f32_bf16 v171, s47, v121
  v_dot2c_f32_bf16 v172, s46, v122
  v_dot2c_f32_bf16 v173, s47, v122
  v_dot2c_f32_bf16 v174, s46, v123
  v_dot2c_f32_bf16 v175, s47, v123
  s_waitcnt vmcnt(20)
  v_dot2c_f32_bf16 v160, s46, v60
  v_dot2c_f32_bf16 v161, s47, v60
  v_dot2c_f32_bf16 v162, s46, v61
  v_dot2c_f32_bf16 v163, s47, v61
  v_dot2c_f32_bf16 v164, s46, v62
  v_dot2c_f32_bf16 v165, s47, v62
  v_dot2c_f32_bf16 v166, s46, v63
  v_dot2c_f32_bf16 v167, s47, v63
  v_dot2c_f32_bf16 v168, s46, v124
  v_dot2c_f32_bf16 v169, s47, v124
  v_dot2c_f32_bf16 v170, s46, v125
  v_dot2c_f32_bf16 v171, s47, v125
  v_dot2c_f32_bf16 v172, s46, v126
  v_dot2c_f32_bf16 v173, s47, v126
  v_dot2c_f32_bf16 v174, s46, v127
  v_dot2c_f32_bf16 v175, s47, v127
  s_waitcnt vmcnt(18)
  v_dot2c_f32_bf16 v160, s46, v64
  v_dot2c_f32_bf16 v161, s47, v64
  v_dot2c_f32_bf16 v162, s46, v65
  v_dot2c_f32_bf16 v163, s47, v65
  v_dot2c_f32_bf16 v164, s46, v66
  v_dot2c_f32_bf16 v165, s47, v66
  v_dot2c_f32_bf16 v166, s46, v67
  v_dot2c_f32_bf16 v167, s47, v67
  v_dot2c_f32_bf16 v168, s46, v128
  v_dot2c_f32_bf16 v169, s47, v128
  v_dot2c_f32_bf16 v170, s46, v129
  v_dot2c_f32_bf16 v171, s47, v129
  v_dot2c_f32_bf16 v172, s46, v130
  v_dot2c_f32_bf16 v173, s47, v130
  v_dot2c_f32_bf16 v174, s46, v131
  v_dot2c_f32_bf16 v175, s47, v131
  s_waitcnt vmcnt(16)
  v_dot2c_f32_bf16 v160, s46, v68
  v_dot2c_f32_bf16 v161, s47, v68
  v_dot2c_f32_bf16 v162, s46, v69
  v_dot2c_f32_bf16 v163, s47, v69
  v_dot2c_f32_bf16 v164, s46, v70
  v_dot2c_f32_bf16 v165, s47, v70
  v_dot2c_f32_bf16 v166, s46, v71
  v_dot2c_f32_bf16 v167, s47, v71
  v_dot2c_f32_bf16 v168, s46, v132
  v_dot2c_f32_bf16 v169, s47, v132
  v_dot2c_f32_bf16 v170, s46, v133
  v_dot2c_f32_bf16 v171, s47, v133
  v_dot2c_f32_bf16 v172, s46, v134
  v_dot2c_f32_bf16 v173, s47, v134
  v_dot2c_f32_bf16 v174, s46, v135
  v_dot2c_f32_bf16 v175, s47, v135
  s_waitcnt vmcnt(14)
  v_dot2c_f32_bf16 v160, s46, v72
  v_dot2c_f32_bf16 v161, s47, v72
  v_dot2c_f32_bf16 v162, s46, v73
  v_dot2c_f32_bf16 v163, s47, v73
  v_dot2c_f32_bf16 v164, s46, v74
  v_dot2c_f32_bf16 v165, s47, v74
  v_dot2c_f32_bf16 v166, s46, v75
  v_dot2c_f32_bf16 v167, s47, v75
  v_dot2c_f32_bf16 v168, s46, v136
  v_dot2c_f32_bf16 v169, s47, v136
  v_dot2c_f32_bf16 v170, s46, v137
  v_dot2c_f32_bf16 v171, s47, v137
  v_dot2c_f32_bf16 v172, s46, v138
  v_dot2c_f32_bf16 v173, s47, v138
  v_dot2c_f32_bf16 v174, s46, v139
  v_dot2c_f32_bf16 v175, s47, v139
  s_waitcnt vmcnt(12)
  v_dot2c_f32_bf16 v160, s46, v76
  v_dot2c_f32_bf16 v161, s47, v76
  v_dot2c_f32_bf16 v162, s46, v77
  v_dot2c_f32_bf16 v163, s47, v77
  v_dot2c_f32_bf16 v164, s46, v78
  v_dot2c_f32_bf16 v165, s47, v78
  v_dot2c_f32_bf16 v166, s46, v79
  v_dot2c_f32_bf16 v167, s47, v79
  v_dot2c_f32_bf16 v168, s46, v140
  v_dot2c_f32_bf16 v169, s47, v140
  v_dot2c_f32_bf16 v170, s46, v141
  v_dot2c_f32_bf16 v171, s47, v141
  v_dot2c_f32_bf16 v172, s46, v142
  v_dot2c_f32_bf16 v173, s47, v142
  v_dot2c_f32_bf16 v174, s46, v143
  v_dot2c_f32_bf16 v175, s47, v143
  s_waitcnt vmcnt(10)
  v_dot2c_f32_bf16 v160, s46, v80
  v_dot2c_f32_bf16 v161, s47, v80
  v_dot2c_f32_bf16 v162, s46, v81
  v_dot2c_f32_bf16 v163, s47, v81
  v_dot2c_f32_bf16 v164, s46, v82
  v_dot2c_f32_bf16 v165, s47, v82
  v_dot2c_f32_bf16 v166, s46, v83
  v_dot2c_f32_bf16 v167, s47, v83
  v_dot2c_f32_bf16 v168, s46, v144
  v_dot2c_f32_bf16 v169, s47, v144
  v_dot2c_f32_bf16 v170, s46, v145
  v_dot2c_f32_bf16 v171, s47, v145
  v_dot2c_f32_bf16 v172, s46, v146
  v_dot2c_f32_bf16 v173, s47, v146
  v_dot2c_f32_bf16 v174, s46, v147
  v_dot2c_f32_bf16 v175, s47, v147
  s_waitcnt vmcnt(8)
  v_dot2c_f32_bf16 v160, s46, v84
  v_dot2c_f32_bf16 v161, s47, v84
  v_dot2c_f32_bf16 v162, s46, v85
  v_dot2c_f32_bf16 v163, s47, v85
  v_dot2c_f32_bf16 v164, s46, v86
  v_dot2c_f32_bf16 v165, s47, v86
  v_dot2c_f32_bf16 v166, s46, v87
  v_dot2c_f32_bf16 v167, s47, v87
  v_dot2c_f32_bf16 v168, s46, v148
  v_dot2c_f32_bf16 v169, s47, v148
  v_dot2c_f32_bf16 v170, s46, v149
  v_dot2c_f32_bf16 v171, s47, v149
  v_dot2c_f32_bf16 v172, s46, v150
  v_dot2c_f32_bf16 v173, s47, v150
  v_dot2c_f32_bf16 v174, s46, v151
  v_dot2c_f32_bf16 v175, s47, v151
  s_waitcnt vmcnt(6)
  v_dot2c_f32_bf16 v160, s46, v88
  v_dot2c_f32_bf16 v161, s47, v88
  v_dot2c_f32_bf16 v162, s46, v89
  v_dot2c_f32_bf16 v163, s47, v89
  v_dot2c_f32_bf16 v164, s46, v90
  v_dot2c_f32_bf16 v165, s47, v90
  v_dot2c_f32_bf16 v166, s46, v91
  v_dot2c_f32_bf16 v167, s47, v91
  v_dot2c_f32_bf16 v168, s46, v152
  v_dot2c_f32_bf16 v169, s47, v152
  v_dot2c_f32_bf16 v170, s46, v153
  v_dot2c_f32_bf16 v171, s47, v153
  v_dot2c_f32_bf16 v172, s46, v154
  v_dot2c_f32_bf16 v173, s47, v154
  v_dot2c_f32_bf16 v174, s46, v155
  v_dot2c_f32_bf16 v175, s47, v155
  s_waitcnt vmcnt(4)
  v_dot2c_f32_bf16 v160, s46, v92
  v_dot2c_f32_bf16 v161, s47, v92
  v_dot2c_f32_bf16 v162, s46, v93
  v_dot2c_f32_bf16 v163, s47, v93
  v_dot2c_f32_bf16 v164, s46, v94
  v_dot2c_f32_bf16 v165, s47, v94
  v_dot2c_f32_bf16 v166, s46, v95
  v_dot2c_f32_bf16 v167, s47, v95
  v_dot2c_f32_bf16 v168, s46, v156
  v_dot2c_f32_bf16 v169, s47, v156
  v_dot2c_f32_bf16 v170, s46, v157
  v_dot2c_f32_bf16 v171, s47, v157
  v_dot2c_f32_bf16 v172, s46, v158
  v_dot2c_f32_bf16 v173, s47, v158
  v_dot2c_f32_bf16 v174, s46, v159
  v_dot2c_f32_bf16 v175, s47, v159
p3_summed:
  s_waitcnt vmcnt(0)
  s_nop 2
  v_lshlrev_b32 v12, 16, v176
  v_and_b32 v13, s48, v176
  v_add_f32 v160, v160, v12
  v_add_f32 v161, v161, v13
  v_lshlrev_b32 v12, 16, v177
  v_and_b32 v13, s48, v177
  v_add_f32 v162, v162, v12
  v_add_f32 v163, v163, v13
  v_lshlrev_b32 v12, 16, v178
  v_and_b32 v13, s48, v178
  v_add_f32 v164, v164, v12
  v_add_f32 v165, v165, v13
  v_lshlrev_b32 v12, 16, v179
  v_and_b32 v13, s48, v179
  v_add_f32 v166, v166, v12
  v_add_f32 v167, v167, v13
  v_lshlrev_b32 v12, 16, v180
  v_and_b32 v13, s48, v180
  v_add_f32 v168, v168, v12
  v_add_f32 v169, v169, v13
  v_lshlrev_b32 v12, 16, v181
  v_and_b32 v13, s48, v181
  v_add_f32 v170, v170, v12
  v_add_f32 v171, v171, v13
  v_lshlrev_b32 v12, 16, v182
  v_and_b32 v13, s48, v182
  v_add_f32 v172, v172, v12
  v_add_f32 v173, v173, v13
  v_lshlrev_b32 v12, 16, v183
  v_and_b32 v13, s48, v183
  v_add_f32 v174, v174, v12
  v_add_f32 v175, v175, v13
  v_cvt_pk_bf16_f32 v32, v160, v161
  v_cvt_pk_bf16_f32 v33, v162, v163
  v_cvt_pk_bf16_f32 v34, v164, v165
  v_cvt_pk_bf16_f32 v35, v166, v167
  v_cvt_pk_bf16_f32 v36, v168, v169
  v_cvt_pk_bf16_f32 v37, v170, v171
  v_cvt_pk_bf16_f32 v38, v172, v173
  v_cvt_pk_bf16_f32 v39, v174, v175
  buffer_store_dwordx4 v[32:35], v7, s[16:19], 0 offen sc1
  buffer_store_dwordx4 v[36:39], v8, s[16:19], 0 offen sc1
  v_add_f32 v14, v160, v161
  v_mul_f32 v15, v160, v160
  v_fmac_f32 v15, v161, v161
  v_add_f32 v14, v14, v162
  v_fmac_f32 v15, v162, v162
  v_add_f32 v14, v14, v163
  v_fmac_f32 v15, v163, v163
  v_add_f32 v14, v14, v164
  v_fmac_f32 v15, v164, v164
  v_add_f32 v14, v14, v165
  v_fmac_f32 v15, v165, v165
  v_add_f32 v14, v14, v166
  v_fmac_f32 v15, v166, v166
  v_add_f32 v14, v14, v167
  v_fmac_f32 v15, v167, v167
  v_add_f32 v14, v14, v168
  v_fmac_f32 v15, v168, v168
  v_add_f32 v14, v14, v169
  v_fmac_f32 v15, v169, v169
  v_add_f32 v14, v14, v170
  v_fmac_f32 v15, v170, v170
  v_add_f32 v14, v14, v171
  v_fmac_f32 v15, v171, v171
  v_add_f32 v14, v14, v172
  v_fmac_f32 v15, v172, v172
  v_add_f32 v14, v14, v173
  v_fmac_f32 v15, v173, v173
  v_add_f32 v14, v14, v174
  v_fmac_f32 v15, v174, v174
  v_add_f32 v14, v14, v175
  v_fmac_f32 v15, v175, v175
  s_nop 1
  v_add_f32_dpp v14, v14, v14 row_ror:8 row_mask:0xf bank_mask:0xf
  v_mov_b32 v16, v14
  s_nop 1
  v_permlane16_swap_b32 v14, v16
  s_nop 1
  v_add_f32 v14, v14, v16
  v_mov_b32 v16, v14
  s_nop 1
  v_permlane32_swap_b32 v14, v16
  s_nop 1
  v_add_f32 v14, v14, v16
  s_nop 1
  v_add_f32_dpp v15, v15, v15 row_ror:8 row_mask:0xf bank_mask:0xf
  v_mov_b32 v16, v15
  s_nop 1
  v_permlane16_swap_b32 v15, v16
  s_nop 1
  v_add_f32 v15, v15, v16
  v_mov_b32 v16, v15
  s_nop 1
  v_permlane32_swap_b32 v15, v16
  s_nop 1
  v_add_f32 v15, v15, v16
  s_lshl_b32 s60, s28, 6
  s_add_u32 s60, s60, 16384
  v_lshl_add_u32 v16, v2, 3, s60
  ds_write_b64 v16, v[14:15]
  s_waitcnt lgkmcnt(0)
  s_barrier
  v_lshlrev_b32 v16, 3, v2
  v_add_u32 v16, 16384, v16
  ds_read_b64 v[48:49], v16 offset:0
  ds_read_b64 v[50:51], v16 offset:64
  ds_read_b64 v[52:53], v16 offset:128
  ds_read_b64 v[54:55], v16 offset:192
  s_waitcnt lgkmcnt(0)
  v_add_f32 v48, v48, v50
  v_add_f32 v49, v49, v51
  v_add_f32 v48, v48, v52
  v_add_f32 v49, v49, v53
  v_add_f32 v48, v48, v54
  v_add_f32 v49, v49, v55
  s_mov_b32 s60, 0x3b124925
  s_mov_b32 s62, 0x3727c5ac
  v_mul_f32 v48, s60, v48
  v_mul_f32 v49, s60, v49
  v_fma_f32 v49, -v48, v48, v49
  v_max_f32 v49, 0, v49
  v_add_f32 v49, s62, v49
  v_rsq_f32 v49, v49
  s_nop 0
  v_mul_f32 v48, v48, v49
  v_fma_f32 v160, v160, v49, -v48
  v_fma_f32 v161, v161, v49, -v48
  v_fma_f32 v162, v162, v49, -v48
  v_fma_f32 v163, v163, v49, -v48
  v_fma_f32 v164, v164, v49, -v48
  v_fma_f32 v165, v165, v49, -v48
  v_fma_f32 v166, v166, v49, -v48
  v_fma_f32 v167, v167, v49, -v48
  v_fma_f32 v168, v168, v49, -v48
  v_fma_f32 v169, v169, v49, -v48
  v_fma_f32 v170, v170, v49, -v48
  v_fma_f32 v171, v171, v49, -v48
  v_fma_f32 v172, v172, v49, -v48
  v_fma_f32 v173, v173, v49, -v48
  v_fma_f32 v174, v174, v49, -v48
  v_fma_f32 v175, v175, v49, -v48
  v_cvt_pk_bf16_f32 v40, v160, v161
  v_cvt_pk_bf16_f32 v41, v162, v163
  v_cvt_pk_bf16_f32 v42, v164, v165
  v_cvt_pk_bf16_f32 v43, v166, v167
  v_cvt_pk_bf16_f32 v44, v168, v169
  v_cvt_pk_bf16_f32 v45, v170, v171
  v_cvt_pk_bf16_f32 v46, v172, v173
  v_cvt_pk_bf16_f32 v47, v174, v175
  buffer_store_dwordx4 v[40:43], v7, s[20:23], 0 offen sc1
  buffer_store_dwordx4 v[44:47], v8, s[20:23], 0 offen sc1
  s_waitcnt vmcnt(0)
p3_sig:
  s_barrier
  s_lshl_b32 s61, s29, 7
  s_lshl_b32 s60, s30, 2
  s_add_u32 s61, s61, s60
  s_add_u32 s61, s61, 8192
  s_cmp_eq_u32 s28, 0
  s_cbranch_scc0 p3_flag
  s_mov_b64 exec, 1
  v_mov_b32 v12, 1
  v_mov_b32 v13, s61
  buffer_store_dword v12, v13, s[4:7], 0 offen sc1
  s_mov_b64 exec, -1
p3_flag:
  s_cmp_lt_u32 s51, 28
  s_cbranch_scc0 p3_wdone
  s_cmp_eq_u32 s52, 0
  s_cbranch_scc0 p3_wdone
  s_add_u32 m0, s58, 32768
  s_mov_b32 s59, 0
  buffer_load_dwordx4 v17, s[24:27], s59 offen offset:0 lds
  buffer_load_dwordx4 v18, s[24:27], s59 offen offset:1024 lds
  buffer_load_dwordx4 v19, s[24:27], s59 offen offset:2048 lds
  buffer_load_dwordx4 v20, s[24:27], s59 offen offset:3072 lds
  s_add_u32 m0, s58, 49152
  s_mov_b32 s59, 114688
  buffer_load_dwordx4 v17, s[24:27], s59 offen offset:0 lds
  buffer_load_dwordx4 v18, s[24:27], s59 offen offset:1024 lds
  buffer_load_dwordx4 v19, s[24:27], s59 offen offset:2048 lds
  buffer_load_dwordx4 v20, s[24:27], s59 offen offset:3072 lds
  s_add_u32 m0, s58, 65536
  s_mov_b32 s59, 229376
  buffer_load_dwordx4 v17, s[24:27], s59 offen offset:0 lds
  buffer_load_dwordx4 v18, s[24:27], s59 offen offset:1024 lds
  buffer_load_dwordx4 v19, s[24:27], s59 offen offset:2048 lds
  buffer_load_dwordx4 v20, s[24:27], s59 offen offset:3072 lds
  s_add_u32 m0, s58, 81920
  s_mov_b32 s59, 344064
  buffer_load_dwordx4 v17, s[24:27], s59 offen offset:0 lds
  buffer_load_dwordx4 v18, s[24:27], s59 offen offset:1024 lds
  buffer_load_dwordx4 v19, s[24:27], s59 offen offset:2048 lds
  buffer_load_dwordx4 v20, s[24:27], s59 offen offset:3072 lds
  s_add_u32 m0, s58, 98304
  s_mov_b32 s59, 458752
  buffer_load_dwordx4 v17, s[24:27], s59 offen offset:0 lds
  buffer_load_dwordx4 v18, s[24:27], s59 offen offset:1024 lds
  buffer_load_dwordx4 v19, s[24:27], s59 offen offset:2048 lds
  buffer_load_dwordx4 v20, s[24:27], s59 offen offset:3072 lds
  s_add_u32 m0, s58, 114688
  s_mov_b32 s59, 573440
  buffer_load_dwordx4 v17, s[24:27], s59 offen offset:0 lds
  buffer_load_dwordx4 v18, s[24:27], s59 offen offset:1024 lds
  buffer_load_dwordx4 v19, s[24:27], s59 offen offset:2048 lds
  buffer_load_dwordx4 v20, s[24:27], s59 offen offset:3072 lds
  s_add_u32 m0, s58, 131072
  s_mov_b32 s59, 688128
  buffer_load_dwordx4 v17, s[24:27], s59 offen offset:0 lds
  buffer_load_dwordx4 v18, s[24:27], s59 offen offset:1024 lds
  buffer_load_dwordx4 v19, s[24:27], s59 offen offset:2048 lds
  buffer_load_dwordx4 v20, s[24:27], s59 offen offset:3072 lds
  s_add_u32 m0, s58, 147456
  s_mov_b32 s59, 802816
  buffer_load_dwordx4 v17, s[24:27], s59 offen offset:0 lds
  buffer_load_dwordx4 v18, s[24:27], s59 offen offset:1024 lds
  buffer_load_dwordx4 v19, s[24:27], s59 offen offset:2048 lds
  buffer_load_dwordx4 v20, s[24:27], s59 offen offset:3072 lds
  s_add_u32 m0, s58, 0
  s_mov_b32 s59, 917504
  buffer_load_dwordx4 v17, s[24:27], s59 offen offset:0 lds
  buffer_load_dwordx4 v18, s[24:27], s59 offen offset:1024 lds
  buffer_load_dwordx4 v19, s[24:27], s59 offen offset:2048 lds
  buffer_load_dwordx4 v20, s[24:27], s59 offen offset:3072 lds
p3_wdone:
  s_cmp_lt_u32 s51, 28
  s_cbranch_scc1 tail_p4
  s_cmp_lt_u32 s30, 14
  s_cbranch_scc0 tail_end
  s_load_dwordx4 s[68:71], s[0:1], 72
  s_cmp_ge_u32 s30, 7
  s_cselect_b32 s60, 1, 0
  s_lshl_b32 s34, s29, 1
  s_add_u32 s34, s34, s60
  s_mul_i32 s60, s60, 7
  s_sub_u32 s35, s30, s60
  s_lshl_b32 s64, s35, 7
  s_waitcnt lgkmcnt(0)
  s_add_u32 s40, s68, s64
  s_addc_u32 s41, s69, 0
  s_sub_u32 s42, 1605632, s64
  s_mov_b32 s43, 0x00020000
  s_mov_b32 s44, s70
  s_mov_b32 s45, s71
  s_mov_b32 s46, 1835008
  s_mov_b32 s47, 0x00020000
  s_add_u32 s36, s98, 113246208
  s_addc_u32 s37, s99, 0
  s_mov_b32 s38, 7340032
  s_mov_b32 s39, 0x00020000
  v_lshrrev_b32 v24, 3, v0
  s_mul_i32 s64, s28, 448
  v_add_u32 v24, s64, v24
  s_movk_i32 s64, 896
  v_mul_lo_u32 v24, v24, s64
  v_lshrrev_b32 v25, 4, v0
  v_lshlrev_b32 v25, 1, v25
  v_and_b32 v26, 7, v0
  v_xor_b32 v25, v25, v26
  v_lshl_add_u32 v24, v25, 4, v24
  v_add_u32 v6, 0, v24
  v_add_u32 v7, 6144, v24
  v_add_u32 v8, 12288, v24
  v_add_u32 v9, 18432, v24
  s_mul_i32 s33, s28, 40960
  v_lshlrev_b32 v1, 4, v0
  s_add_u32 m0, s33, 0
  s_mov_b32 s60, 0
  buffer_load_dwordx4 v6, s[40:43], s60 offen offset:0 lds
  buffer_load_dwordx4 v7, s[40:43], s60 offen offset:1024 lds
  buffer_load_dwordx4 v8, s[40:43], s60 offen offset:2048 lds
  buffer_load_dwordx4 v9, s[40:43], s60 offen offset:3072 lds
  s_add_u32 m0, s33, 4096
  s_mov_b32 s60, 28672
  buffer_load_dwordx4 v6, s[40:43], s60 offen offset:0 lds
  buffer_load_dwordx4 v7, s[40:43], s60 offen offset:1024 lds
  buffer_load_dwordx4 v8, s[40:43], s60 offen offset:2048 lds
  buffer_load_dwordx4 v9, s[40:43], s60 offen offset:3072 lds
  s_add_u32 m0, s33, 8192
  s_mov_b32 s60, 57344
  buffer_load_dwordx4 v6, s[40:43], s60 offen offset:0 lds
  buffer_load_dwordx4 v7, s[40:43], s60 offen offset:1024 lds
  buffer_load_dwordx4 v8, s[40:43], s60 offen offset:2048 lds
  buffer_load_dwordx4 v9, s[40:43], s60 offen offset:3072 lds
  s_add_u32 m0, s33, 12288
  s_mov_b32 s60, 86016
  buffer_load_dwordx4 v6, s[40:43], s60 offen offset:0 lds
  buffer_load_dwordx4 v7, s[40:43], s60 offen offset:1024 lds
  buffer_load_dwordx4 v8, s[40:43], s60 offen offset:2048 lds
  buffer_load_dwordx4 v9, s[40:43], s60 offen offset:3072 lds
  s_add_u32 m0, s33, 16384
  s_mov_b32 s60, 114688
  buffer_load_dwordx4 v6, s[40:43], s60 offen offset:0 lds
  buffer_load_dwordx4 v7, s[40:43], s60 offen offset:1024 lds
  buffer_load_dwordx4 v8, s[40:43], s60 offen offset:2048 lds
  buffer_load_dwordx4 v9, s[40:43], s60 offen offset:3072 lds
  s_add_u32 m0, s33, 20480
  s_mov_b32 s60, 143360
  buffer_load_dwordx4 v6, s[40:43], s60 offen offset:0 lds
  buffer_load_dwordx4 v7, s[40:43], s60 offen offset:1024 lds
  buffer_load_dwordx4 v8, s[40:43], s60 offen offset:2048 lds
  buffer_load_dwordx4 v9, s[40:43], s60 offen offset:3072 lds
  s_add_u32 m0, s33, 24576
  s_mov_b32 s60, 172032
  buffer_load_dwordx4 v6, s[40:43], s60 offen offset:0 lds
  buffer_load_dwordx4 v7, s[40:43], s60 offen offset:1024 lds
  buffer_load_dwordx4 v8, s[40:43], s60 offen offset:2048 lds
  buffer_load_dwordx4 v9, s[40:43], s60 offen offset:3072 lds
  s_add_u32 m0, s33, 28672
  s_mov_b32 s60, 200704
  buffer_load_dwordx4 v6, s[40:43], s60 offen offset:0 lds
  buffer_load_dwordx4 v7, s[40:43], s60 offen offset:1024 lds
  buffer_load_dwordx4 v8, s[40:43], s60 offen offset:2048 lds
  buffer_load_dwordx4 v9, s[40:43], s60 offen offset:3072 lds
  s_add_u32 m0, s33, 32768
  s_mov_b32 s60, 229376
  buffer_load_dwordx4 v6, s[40:43], s60 offen offset:0 lds
  buffer_load_dwordx4 v7, s[40:43], s60 offen offset:1024 lds
  buffer_load_dwordx4 v8, s[40:43], s60 offen offset:2048 lds
  buffer_load_dwordx4 v9, s[40:43], s60 offen offset:3072 lds
  s_add_u32 m0, s33, 36864
  s_mov_b32 s60, 258048
  buffer_load_dwordx4 v6, s[40:43], s60 offen offset:0 lds
  buffer_load_dwordx4 v7, s[40:43], s60 offen offset:1024 lds
  buffer_load_dwordx4 v8, s[40:43], s60 offen offset:2048 lds
  buffer_load_dwordx4 v9, s[40:43], s60 offen offset:3072 lds
  s_branch tail_p5
tail_p4:
  s_add_u32 m0, s58, 16384
  s_mov_b32 s59, 1032192
  buffer_load_dwordx4 v17, s[24:27], s59 offen offset:0 lds
  buffer_load_dwordx4 v18, s[24:27], s59 offen offset:1024 lds
  buffer_load_dwordx4 v19, s[24:27], s59 offen offset:2048 lds
  buffer_load_dwordx4 v20, s[24:27], s59 offen offset:3072 lds
  s_add_u32 s36, s98, 113246208
  s_addc_u32 s37, s99, 0
  s_mov_b32 s38, 7340032
  s_mov_b32 s39, 0x00020000
  v_lshlrev_b32 v1, 4, v0
  s_lshl_b32 s64, s50, 3
  s_lshl_b32 s65, s28, 1
  s_add_u32 s64, s64, s65
  s_mul_i32 s65, s64, 14336
  v_add_u32 v27, s65, v1
  v_add_u32 v28, 14336, v27
  v_lshrrev_b32 v24, 4, v0
  v_and_b32 v23, 15, v0
  v_lshrrev_b32 v25, 2, v23
  v_lshl_add_u32 v25, v24, 2, v25
  v_and_b32 v26, 7, v25
  v_lshlrev_b32 v26, 5, v26
  v_lshlrev_b32 v25, 8, v25
  v_and_b32 v29, 3, v23
  v_lshl_add_u32 v25, v29, 3, v25
  v_xor_b32 v29, 0, v26
  v_add_u32 v5, v25, v29
  v_xor_b32 v29, 32, v26
  v_add_u32 v6, v25, v29
  v_xor_b32 v29, 64, v26
  v_add_u32 v7, v25, v29
  v_xor_b32 v29, 96, v26
  v_add_u32 v8, v25, v29
  v_xor_b32 v29, 128, v26
  v_add_u32 v9, v25, v29
  v_xor_b32 v29, 160, v26
  v_add_u32 v10, v25, v29
  v_xor_b32 v29, 192, v26
  v_add_u32 v11, v25, v29
  v_xor_b32 v29, 224, v26
  v_add_u32 v12, v25, v29
  s_mul_i32 s65, s64, 56
  s_lshl_b32 s66, s49, 2
  s_add_u32 s65, s65, s66
  s_lshl_b32 s65, s65, 10
  v_add_u32 v21, s65, v1
  v_add_u32 v22, 57344, v21
  s_lshl_b32 s60, s50, 7
  s_add_u32 s60, s60, 8192
  v_and_b32 v2, 15, v0
  v_lshl_add_u32 v2, v2, 2, s60
  s_waitcnt lgkmcnt(0)
  s_mov_b32 s60, 0
p4_poll:
  buffer_load_dword v3, v2, s[4:7], 0 offen sc1
  s_waitcnt vmcnt(0)
  v_cmp_ne_u32 vcc, 1, v3
  s_add_u32 s60, s60, 1
  s_cbranch_vccz p4_poll_ok
  s_cmp_lt_u32 s60, 262144
  s_cbranch_scc0 p4_poll_ok
  s_sleep 1
  s_branch p4_poll
p4_poll_ok:
  s_mov_b32 s66, 0
  buffer_load_dwordx4 a[112:115], v27, s[20:23], s66 offen offset:0 sc1
  buffer_load_dwordx4 a[168:171], v28, s[20:23], s66 offen offset:0 sc1
  s_mov_b32 s66, 0
  buffer_load_dwordx4 a[116:119], v27, s[20:23], s66 offen offset:1024 sc1
  buffer_load_dwordx4 a[172:175], v28, s[20:23], s66 offen offset:1024 sc1
  s_mov_b32 s66, 0
  buffer_load_dwordx4 a[120:123], v27, s[20:23], s66 offen offset:2048 sc1
  buffer_load_dwordx4 a[176:179], v28, s[20:23], s66 offen offset:2048 sc1
  s_mov_b32 s66, 0
  buffer_load_dwordx4 a[124:127], v27, s[20:23], s66 offen offset:3072 sc1
  buffer_load_dwordx4 a[180:183], v28, s[20:23], s66 offen offset:3072 sc1
  s_mov_b32 s66, 4096
  buffer_load_dwordx4 a[128:131], v27, s[20:23], s66 offen offset:0 sc1
  buffer_load_dwordx4 a[184:187], v28, s[20:23], s66 offen offset:0 sc1
  s_mov_b32 s66, 4096
  buffer_load_dwordx4 a[132:135], v27, s[20:23], s66 offen offset:1024 sc1
  buffer_load_dwordx4 a[188:191], v28, s[20:23], s66 offen offset:1024 sc1
  s_mov_b32 s66, 4096
  buffer_load_dwordx4 a[136:139], v27, s[20:23], s66 offen offset:2048 sc1
  buffer_load_dwordx4 a[192:195], v28, s[20:23], s66 offen offset:2048 sc1
  s_mov_b32 s66, 4096
  buffer_load_dwordx4 a[140:143], v27, s[20:23], s66 offen offset:3072 sc1
  buffer_load_dwordx4 a[196:199], v28, s[20:23], s66 offen offset:3072 sc1
  s_mov_b32 s66, 8192
  buffer_load_dwordx4 a[144:147], v27, s[20:23], s66 offen offset:0 sc1
  buffer_load_dwordx4 a[200:203], v28, s[20:23], s66 offen offset:0 sc1
  s_mov_b32 s66, 8192
  buffer_load_dwordx4 a[148:151], v27, s[20:23], s66 offen offset:1024 sc1
  buffer_load_dwordx4 a[204:207], v28, s[20:23], s66 offen offset:1024 sc1
  s_mov_b32 s66, 8192
  buffer_load_dwordx4 a[152:155], v27, s[20:23], s66 offen offset:2048 sc1
  buffer_load_dwordx4 a[208:211], v28, s[20:23], s66 offen offset:2048 sc1
  s_mov_b32 s66, 8192
  buffer_load_dwordx4 a[156:159], v27, s[20:23], s66 offen offset:3072 sc1
  buffer_load_dwordx4 a[212:215], v28, s[20:23], s66 offen offset:3072 sc1
  s_mov_b32 s66, 12288
  buffer_load_dwordx4 a[160:163], v27, s[20:23], s66 offen offset:0 sc1
  buffer_load_dwordx4 a[216:219], v28, s[20:23], s66 offen offset:0 sc1
  s_mov_b32 s66, 12288
  buffer_load_dwordx4 a[164:167], v27, s[20:23], s66 offen offset:1024 sc1
  buffer_load_dwordx4 a[220:223], v28, s[20:23], s66 offen offset:1024 sc1
  s_barrier
  ds_read_b64_tr_b16 a[32:33], v5 offset:32768
  ds_read_b64_tr_b16 a[34:35], v5 offset:36864
  ds_read_b64_tr_b16 a[36:37], v5 offset:40960
  ds_read_b64_tr_b16 a[38:39], v5 offset:45056
  ds_read_b64_tr_b16 a[40:41], v6 offset:32768
  ds_read_b64_tr_b16 a[42:43], v6 offset:36864
  ds_read_b64_tr_b16 a[44:45], v6 offset:40960
  ds_read_b64_tr_b16 a[46:47], v6 offset:45056
  ds_read_b64_tr_b16 a[48:49], v7 offset:32768
  ds_read_b64_tr_b16 a[50:51], v7 offset:36864
  ds_read_b64_tr_b16 a[52:53], v7 offset:40960
  ds_read_b64_tr_b16 a[54:55], v7 offset:45056
  s_waitcnt vmcnt(26)
  s_waitcnt lgkmcnt(10)
  v_mfma_f32_16x16x32_bf16 v[32:35], a[32:35], a[112:115], 0
  ds_read_b64_tr_b16 a[56:57], v8 offset:32768
  v_mfma_f32_16x16x32_bf16 v[36:39], a[32:35], a[168:171], 0
  ds_read_b64_tr_b16 a[58:59], v8 offset:36864
  s_waitcnt lgkmcnt(10)
  v_mfma_f32_16x16x32_bf16 v[40:43], a[36:39], a[112:115], 0
  ds_read_b64_tr_b16 a[60:61], v8 offset:40960
  v_mfma_f32_16x16x32_bf16 v[44:47], a[36:39], a[168:171], 0
  ds_read_b64_tr_b16 a[62:63], v8 offset:45056
  s_waitcnt lgkmcnt(10)
  v_mfma_f32_16x16x32_bf16 v[48:51], a[40:43], a[112:115], 0
  ds_read_b64_tr_b16 a[32:33], v9 offset:32768
  v_mfma_f32_16x16x32_bf16 v[52:55], a[40:43], a[168:171], 0
  ds_read_b64_tr_b16 a[34:35], v9 offset:36864
  s_waitcnt lgkmcnt(10)
  v_mfma_f32_16x16x32_bf16 v[56:59], a[44:47], a[112:115], 0
  ds_read_b64_tr_b16 a[36:37], v9 offset:40960
  v_mfma_f32_16x16x32_bf16 v[60:63], a[44:47], a[168:171], 0
  ds_read_b64_tr_b16 a[38:39], v9 offset:45056
  s_waitcnt lgkmcnt(10)
  v_mfma_f32_16x16x32_bf16 v[64:67], a[48:51], a[112:115], 0
  ds_read_b64_tr_b16 a[40:41], v10 offset:32768
  v_mfma_f32_16x16x32_bf16 v[68:71], a[48:51], a[168:171], 0
  ds_read_b64_tr_b16 a[42:43], v10 offset:36864
  s_waitcnt lgkmcnt(10)
  v_mfma_f32_16x16x32_bf16 v[72:75], a[52:55], a[112:115], 0
  ds_read_b64_tr_b16 a[44:45], v10 offset:40960
  v_mfma_f32_16x16x32_bf16 v[76:79], a[52:55], a[168:171], 0
  ds_read_b64_tr_b16 a[46:47], v10 offset:45056
  s_waitcnt lgkmcnt(10)
  v_mfma_f32_16x16x32_bf16 v[80:83], a[56:59], a[112:115], 0
  ds_read_b64_tr_b16 a[48:49], v11 offset:32768
  v_mfma_f32_16x16x32_bf16 v[84:87], a[56:59], a[168:171], 0
  ds_read_b64_tr_b16 a[50:51], v11 offset:36864
  s_waitcnt lgkmcnt(10)
  v_mfma_f32_16x16x32_bf16 v[88:91], a[60:63], a[112:115], 0
  ds_read_b64_tr_b16 a[52:53], v11 offset:40960
  v_mfma_f32_16x16x32_bf16 v[92:95], a[60:63], a[168:171], 0
  ds_read_b64_tr_b16 a[54:55], v11 offset:45056
  s_waitcnt lgkmcnt(10)
  v_mfma_f32_16x16x32_bf16 v[96:99], a[32:35], a[112:115], 0
  ds_read_b64_tr_b16 a[56:57], v12 offset:32768
  v_mfma_f32_16x16x32_bf16 v[100:103], a[32:35], a[168:171], 0
  ds_read_b64_tr_b16 a[58:59], v12 offset:36864
  s_waitcnt lgkmcnt(10)
  v_mfma_f32_16x16x32_bf16 v[104:107], a[36:39], a[112:115], 0
  ds_read_b64_tr_b16 a[60:61], v12 offset:40960
  v_mfma_f32_16x16x32_bf16 v[108:111], a[36:39], a[168:171], 0
  ds_read_b64_tr_b16 a[62:63], v12 offset:45056
  s_waitcnt lgkmcnt(10)
  v_mfma_f32_16x16x32_bf16 v[112:115], a[40:43], a[112:115], 0
  ds_read_b64_tr_b16 a[32:33], v5 offset:49152
  v_mfma_f32_16x16x32_bf16 v[116:119], a[40:43], a[168:171], 0
  ds_read_b64_tr_b16 a[34:35], v5 offset:53248
  s_waitcnt lgkmcnt(10)
  v_mfma_f32_16x16x32_bf16 v[120:123], a[44:47], a[112:115], 0
  ds_read_b64_tr_b16 a[36:37], v5 offset:57344
  v_mfma_f32_16x16x32_bf16 v[124:127], a[44:47], a[168:171], 0
  ds_read_b64_tr_b16 a[38:39], v5 offset:61440
  s_waitcnt lgkmcnt(10)
  v_mfma_f32_16x16x32_bf16 v[128:131], a[48:51], a[112:115], 0
  ds_read_b64_tr_b16 a[40:41], v6 offset:49152
  v_mfma_f32_16x16x32_bf16 v[132:135], a[48:51], a[168:171], 0
  ds_read_b64_tr_b16 a[42:43], v6 offset:53248
  s_waitcnt lgkmcnt(10)
  v_mfma_f32_16x16x32_bf16 v[136:139], a[52:55], a[112:115], 0
  ds_read_b64_tr_b16 a[44:45], v6 offset:57344
  v_mfma_f32_16x16x32_bf16 v[140:143], a[52:55], a[168:171], 0
  ds_read_b64_tr_b16 a[46:47], v6 offset:61440
  s_waitcnt lgkmcnt(10)
  v_mfma_f32_16x16x32_bf16 v[144:147], a[56:59], a[112:115], 0
  ds_read_b64_tr_b16 a[48:49], v7 offset:49152
  v_mfma_f32_16x16x32_bf16 v[148:151], a[56:59], a[168:171], 0
  ds_read_b64_tr_b16 a[50:51], v7 offset:53248
  s_waitcnt lgkmcnt(10)
  v_mfma_f32_16x16x32_bf16 v[152:155], a[60:63], a[112:115], 0
  ds_read_b64_tr_b16 a[52:53], v7 offset:57344
  v_mfma_f32_16x16x32_bf16 v[156:159], a[60:63], a[168:171], 0
  ds_read_b64_tr_b16 a[54:55], v7 offset:61440
  s_waitcnt vmcnt(24)
  s_waitcnt lgkmcnt(10)
  v_mfma_f32_16x16x32_bf16 v[32:35], a[32:35], a[116:119], v[32:35]
  ds_read_b64_tr_b16 a[56:57], v8 offset:49152
  v_mfma_f32_16x16x32_bf16 v[36:39], a[32:35], a[172:175], v[36:39]
  ds_read_b64_tr_b16 a[58:59], v8 offset:53248
  s_waitcnt lgkmcnt(10)
  v_mfma_f32_16x16x32_bf16 v[40:43], a[36:39], a[116:119], v[40:43]
  ds_read_b64_tr_b16 a[60:61], v8 offset:57344
  v_mfma_f32_16x16x32_bf16 v[44:47], a[36:39], a[172:175], v[44:47]
  ds_read_b64_tr_b16 a[62:63], v8 offset:61440
  s_waitcnt lgkmcnt(10)
  v_mfma_f32_16x16x32_bf16 v[48:51], a[40:43], a[116:119], v[48:51]
  ds_read_b64_tr_b16 a[32:33], v9 offset:49152
  v_mfma_f32_16x16x32_bf16 v[52:55], a[40:43], a[172:175], v[52:55]
  ds_read_b64_tr_b16 a[34:35], v9 offset:53248
  s_waitcnt lgkmcnt(10)
  v_mfma_f32_16x16x32_bf16 v[56:59], a[44:47], a[116:119], v[56:59]
  ds_read_b64_tr_b16 a[36:37], v9 offset:57344
  v_mfma_f32_16x16x32_bf16 v[60:63], a[44:47], a[172:175], v[60:63]
  ds_read_b64_tr_b16 a[38:39], v9 offset:61440
  s_waitcnt lgkmcnt(10)
  v_mfma_f32_16x16x32_bf16 v[64:67], a[48:51], a[116:119], v[64:67]
  ds_read_b64_tr_b16 a[40:41], v10 offset:49152
  v_mfma_f32_16x16x32_bf16 v[68:71], a[48:51], a[172:175], v[68:71]
  ds_read_b64_tr_b16 a[42:43], v10 offset:53248
  s_waitcnt lgkmcnt(10)
  v_mfma_f32_16x16x32_bf16 v[72:75], a[52:55], a[116:119], v[72:75]
  ds_read_b64_tr_b16 a[44:45], v10 offset:57344
  v_mfma_f32_16x16x32_bf16 v[76:79], a[52:55], a[172:175], v[76:79]
  ds_read_b64_tr_b16 a[46:47], v10 offset:61440
  s_waitcnt lgkmcnt(10)
  v_mfma_f32_16x16x32_bf16 v[80:83], a[56:59], a[116:119], v[80:83]
  ds_read_b64_tr_b16 a[48:49], v11 offset:49152
  v_mfma_f32_16x16x32_bf16 v[84:87], a[56:59], a[172:175], v[84:87]
  ds_read_b64_tr_b16 a[50:51], v11 offset:53248
  s_waitcnt lgkmcnt(10)
  v_mfma_f32_16x16x32_bf16 v[88:91], a[60:63], a[116:119], v[88:91]
  ds_read_b64_tr_b16 a[52:53], v11 offset:57344
  v_mfma_f32_16x16x32_bf16 v[92:95], a[60:63], a[172:175], v[92:95]
  ds_read_b64_tr_b16 a[54:55], v11 offset:61440
  s_waitcnt lgkmcnt(10)
  v_mfma_f32_16x16x32_bf16 v[96:99], a[32:35], a[116:119], v[96:99]
  ds_read_b64_tr_b16 a[56:57], v12 offset:49152
  v_mfma_f32_16x16x32_bf16 v[100:103], a[32:35], a[172:175], v[100:103]
  ds_read_b64_tr_b16 a[58:59], v12 offset:53248
  s_waitcnt lgkmcnt(10)
  v_mfma_f32_16x16x32_bf16 v[104:107], a[36:39], a[116:119], v[104:107]
  ds_read_b64_tr_b16 a[60:61], v12 offset:57344
  v_mfma_f32_16x16x32_bf16 v[108:111], a[36:39], a[172:175], v[108:111]
  ds_read_b64_tr_b16 a[62:63], v12 offset:61440
  s_waitcnt lgkmcnt(10)
  v_mfma_f32_16x16x32_bf16 v[112:115], a[40:43], a[116:119], v[112:115]
  v_add_u32 v5, 0x10000, v5
  ds_read_b64_tr_b16 a[32:33], v5 offset:0
  v_mfma_f32_16x16x32_bf16 v[116:119], a[40:43], a[172:175], v[116:119]
  ds_read_b64_tr_b16 a[34:35], v5 offset:4096
  s_waitcnt lgkmcnt(10)
  v_mfma_f32_16x16x32_bf16 v[120:123], a[44:47], a[116:119], v[120:123]
  ds_read_b64_tr_b16 a[36:37], v5 offset:8192
  v_mfma_f32_16x16x32_bf16 v[124:127], a[44:47], a[172:175], v[124:127]
  ds_read_b64_tr_b16 a[38:39], v5 offset:12288
  s_waitcnt lgkmcnt(10)
  v_mfma_f32_16x16x32_bf16 v[128:131], a[48:51], a[116:119], v[128:131]
  v_add_u32 v6, 0x10000, v6
  ds_read_b64_tr_b16 a[40:41], v6 offset:0
  v_mfma_f32_16x16x32_bf16 v[132:135], a[48:51], a[172:175], v[132:135]
  ds_read_b64_tr_b16 a[42:43], v6 offset:4096
  s_waitcnt lgkmcnt(10)
  v_mfma_f32_16x16x32_bf16 v[136:139], a[52:55], a[116:119], v[136:139]
  ds_read_b64_tr_b16 a[44:45], v6 offset:8192
  v_mfma_f32_16x16x32_bf16 v[140:143], a[52:55], a[172:175], v[140:143]
  ds_read_b64_tr_b16 a[46:47], v6 offset:12288
  s_waitcnt lgkmcnt(10)
  v_mfma_f32_16x16x32_bf16 v[144:147], a[56:59], a[116:119], v[144:147]
  v_add_u32 v7, 0x10000, v7
  ds_read_b64_tr_b16 a[48:49], v7 offset:0
  v_mfma_f32_16x16x32_bf16 v[148:151], a[56:59], a[172:175], v[148:151]
  ds_read_b64_tr_b16 a[50:51], v7 offset:4096
  s_waitcnt lgkmcnt(10)
  v_mfma_f32_16x16x32_bf16 v[152:155], a[60:63], a[116:119], v[152:155]
  ds_read_b64_tr_b16 a[52:53], v7 offset:8192
  v_mfma_f32_16x16x32_bf16 v[156:159], a[60:63], a[172:175], v[156:159]
  ds_read_b64_tr_b16 a[54:55], v7 offset:12288
  s_waitcnt vmcnt(22)
  v_add_u32 v8, 0x10000, v8
  v_add_u32 v9, 0x10000, v9
  v_add_u32 v10, 0x10000, v10
  v_add_u32 v11, 0x10000, v11
  v_add_u32 v12, 0x10000, v12
  s_waitcnt lgkmcnt(10)
  v_mfma_f32_16x16x32_bf16 v[32:35], a[32:35], a[120:123], v[32:35]
  ds_read_b64_tr_b16 a[56:57], v8 offset:0
  v_mfma_f32_16x16x32_bf16 v[36:39], a[32:35], a[176:179], v[36:39]
  ds_read_b64_tr_b16 a[58:59], v8 offset:4096
  s_waitcnt lgkmcnt(10)
  v_mfma_f32_16x16x32_bf16 v[40:43], a[36:39], a[120:123], v[40:43]
  ds_read_b64_tr_b16 a[60:61], v8 offset:8192
  v_mfma_f32_16x16x32_bf16 v[44:47], a[36:39], a[176:179], v[44:47]
  ds_read_b64_tr_b16 a[62:63], v8 offset:12288
  s_waitcnt lgkmcnt(10)
  v_mfma_f32_16x16x32_bf16 v[48:51], a[40:43], a[120:123], v[48:51]
  ds_read_b64_tr_b16 a[32:33], v9 offset:0
  v_mfma_f32_16x16x32_bf16 v[52:55], a[40:43], a[176:179], v[52:55]
  ds_read_b64_tr_b16 a[34:35], v9 offset:4096
  s_waitcnt lgkmcnt(10)
  v_mfma_f32_16x16x32_bf16 v[56:59], a[44:47], a[120:123], v[56:59]
  ds_read_b64_tr_b16 a[36:37], v9 offset:8192
  v_mfma_f32_16x16x32_bf16 v[60:63], a[44:47], a[176:179], v[60:63]
  ds_read_b64_tr_b16 a[38:39], v9 offset:12288
  s_waitcnt lgkmcnt(10)
  v_mfma_f32_16x16x32_bf16 v[64:67], a[48:51], a[120:123], v[64:67]
  ds_read_b64_tr_b16 a[40:41], v10 offset:0
  v_mfma_f32_16x16x32_bf16 v[68:71], a[48:51], a[176:179], v[68:71]
  ds_read_b64_tr_b16 a[42:43], v10 offset:4096
  s_waitcnt lgkmcnt(10)
  v_mfma_f32_16x16x32_bf16 v[72:75], a[52:55], a[120:123], v[72:75]
  ds_read_b64_tr_b16 a[44:45], v10 offset:8192
  v_mfma_f32_16x16x32_bf16 v[76:79], a[52:55], a[176:179], v[76:79]
  ds_read_b64_tr_b16 a[46:47], v10 offset:12288
  s_waitcnt lgkmcnt(10)
  v_mfma_f32_16x16x32_bf16 v[80:83], a[56:59], a[120:123], v[80:83]
  ds_read_b64_tr_b16 a[48:49], v11 offset:0
  v_mfma_f32_16x16x32_bf16 v[84:87], a[56:59], a[176:179], v[84:87]
  ds_read_b64_tr_b16 a[50:51], v11 offset:4096
  s_waitcnt lgkmcnt(10)
  v_mfma_f32_16x16x32_bf16 v[88:91], a[60:63], a[120:123], v[88:91]
  ds_read_b64_tr_b16 a[52:53], v11 offset:8192
  v_mfma_f32_16x16x32_bf16 v[92:95], a[60:63], a[176:179], v[92:95]
  ds_read_b64_tr_b16 a[54:55], v11 offset:12288
  s_waitcnt lgkmcnt(10)
  v_mfma_f32_16x16x32_bf16 v[96:99], a[32:35], a[120:123], v[96:99]
  ds_read_b64_tr_b16 a[56:57], v12 offset:0
  v_mfma_f32_16x16x32_bf16 v[100:103], a[32:35], a[176:179], v[100:103]
  ds_read_b64_tr_b16 a[58:59], v12 offset:4096
  s_waitcnt lgkmcnt(10)
  v_mfma_f32_16x16x32_bf16 v[104:107], a[36:39], a[120:123], v[104:107]
  ds_read_b64_tr_b16 a[60:61], v12 offset:8192
  v_mfma_f32_16x16x32_bf16 v[108:111], a[36:39], a[176:179], v[108:111]
  ds_read_b64_tr_b16 a[62:63], v12 offset:12288
  s_waitcnt lgkmcnt(10)
  v_mfma_f32_16x16x32_bf16 v[112:115], a[40:43], a[120:123], v[112:115]
  ds_read_b64_tr_b16 a[32:33], v5 offset:16384
  v_mfma_f32_16x16x32_bf16 v[116:119], a[40:43], a[176:179], v[116:119]
  ds_read_b64_tr_b16 a[34:35], v5 offset:20480
  s_waitcnt lgkmcnt(10)
  v_mfma_f32_16x16x32_bf16 v[120:123], a[44:47], a[120:123], v[120:123]
  ds_read_b64_tr_b16 a[36:37], v5 offset:24576
  v_mfma_f32_16x16x32_bf16 v[124:127], a[44:47], a[176:179], v[124:127]
  ds_read_b64_tr_b16 a[38:39], v5 offset:28672
  s_waitcnt lgkmcnt(10)
  v_mfma_f32_16x16x32_bf16 v[128:131], a[48:51], a[120:123], v[128:131]
  ds_read_b64_tr_b16 a[40:41], v6 offset:16384
  v_mfma_f32_16x16x32_bf16 v[132:135], a[48:51], a[176:179], v[132:135]
  ds_read_b64_tr_b16 a[42:43], v6 offset:20480
  s_waitcnt lgkmcnt(10)
  v_mfma_f32_16x16x32_bf16 v[136:139], a[52:55], a[120:123], v[136:139]
  ds_read_b64_tr_b16 a[44:45], v6 offset:24576
  v_mfma_f32_16x16x32_bf16 v[140:143], a[52:55], a[176:179], v[140:143]
  ds_read_b64_tr_b16 a[46:47], v6 offset:28672
  s_waitcnt lgkmcnt(10)
  v_mfma_f32_16x16x32_bf16 v[144:147], a[56:59], a[120:123], v[144:147]
  ds_read_b64_tr_b16 a[48:49], v7 offset:16384
  v_mfma_f32_16x16x32_bf16 v[148:151], a[56:59], a[176:179], v[148:151]
  ds_read_b64_tr_b16 a[50:51], v7 offset:20480
  s_waitcnt lgkmcnt(10)
  v_mfma_f32_16x16x32_bf16 v[152:155], a[60:63], a[120:123], v[152:155]
  ds_read_b64_tr_b16 a[52:53], v7 offset:24576
  v_mfma_f32_16x16x32_bf16 v[156:159], a[60:63], a[176:179], v[156:159]
  ds_read_b64_tr_b16 a[54:55], v7 offset:28672
  s_waitcnt vmcnt(20)
  s_waitcnt lgkmcnt(10)
  v_mfma_f32_16x16x32_bf16 v[32:35], a[32:35], a[124:127], v[32:35]
  ds_read_b64_tr_b16 a[56:57], v8 offset:16384
  v_mfma_f32_16x16x32_bf16 v[36:39], a[32:35], a[180:183], v[36:39]
  ds_read_b64_tr_b16 a[58:59], v8 offset:20480
  s_waitcnt lgkmcnt(10)
  v_mfma_f32_16x16x32_bf16 v[40:43], a[36:39], a[124:127], v[40:43]
  ds_read_b64_tr_b16 a[60:61], v8 offset:24576
  v_mfma_f32_16x16x32_bf16 v[44:47], a[36:39], a[180:183], v[44:47]
  ds_read_b64_tr_b16 a[62:63], v8 offset:28672
  s_waitcnt lgkmcnt(10)
  v_mfma_f32_16x16x32_bf16 v[48:51], a[40:43], a[124:127], v[48:51]
  ds_read_b64_tr_b16 a[32:33], v9 offset:16384
  v_mfma_f32_16x16x32_bf16 v[52:55], a[40:43], a[180:183], v[52:55]
  ds_read_b64_tr_b16 a[34:35], v9 offset:20480
  s_waitcnt lgkmcnt(10)
  v_mfma_f32_16x16x32_bf16 v[56:59], a[44:47], a[124:127], v[56:59]
  ds_read_b64_tr_b16 a[36:37], v9 offset:24576
  v_mfma_f32_16x16x32_bf16 v[60:63], a[44:47], a[180:183], v[60:63]
  ds_read_b64_tr_b16 a[38:39], v9 offset:28672
  s_waitcnt lgkmcnt(10)
  v_mfma_f32_16x16x32_bf16 v[64:67], a[48:51], a[124:127], v[64:67]
  ds_read_b64_tr_b16 a[40:41], v10 offset:16384
  v_mfma_f32_16x16x32_bf16 v[68:71], a[48:51], a[180:183], v[68:71]
  ds_read_b64_tr_b16 a[42:43], v10 offset:20480
  s_waitcnt lgkmcnt(10)
  v_mfma_f32_16x16x32_bf16 v[72:75], a[52:55], a[124:127], v[72:75]
  ds_read_b64_tr_b16 a[44:45], v10 offset:24576
  v_mfma_f32_16x16x32_bf16 v[76:79], a[52:55], a[180:183], v[76:79]
  ds_read_b64_tr_b16 a[46:47], v10 offset:28672
  s_waitcnt lgkmcnt(10)
  v_mfma_f32_16x16x32_bf16 v[80:83], a[56:59], a[124:127], v[80:83]
  ds_read_b64_tr_b16 a[48:49], v11 offset:16384
  v_mfma_f32_16x16x32_bf16 v[84:87], a[56:59], a[180:183], v[84:87]
  ds_read_b64_tr_b16 a[50:51], v11 offset:20480
  s_waitcnt lgkmcnt(10)
  v_mfma_f32_16x16x32_bf16 v[88:91], a[60:63], a[124:127], v[88:91]
  ds_read_b64_tr_b16 a[52:53], v11 offset:24576
  v_mfma_f32_16x16x32_bf16 v[92:95], a[60:63], a[180:183], v[92:95]
  ds_read_b64_tr_b16 a[54:55], v11 offset:28672
  s_waitcnt lgkmcnt(10)
  v_mfma_f32_16x16x32_bf16 v[96:99], a[32:35], a[124:127], v[96:99]
  ds_read_b64_tr_b16 a[56:57], v12 offset:16384
  v_mfma_f32_16x16x32_bf16 v[100:103], a[32:35], a[180:183], v[100:103]
  ds_read_b64_tr_b16 a[58:59], v12 offset:20480
  s_waitcnt lgkmcnt(10)
  v_mfma_f32_16x16x32_bf16 v[104:107], a[36:39], a[124:127], v[104:107]
  ds_read_b64_tr_b16 a[60:61], v12 offset:24576
  v_mfma_f32_16x16x32_bf16 v[108:111], a[36:39], a[180:183], v[108:111]
  ds_read_b64_tr_b16 a[62:63], v12 offset:28672
  s_waitcnt lgkmcnt(10)
  v_mfma_f32_16x16x32_bf16 v[112:115], a[40:43], a[124:127], v[112:115]
  ds_read_b64_tr_b16 a[32:33], v5 offset:32768
  v_mfma_f32_16x16x32_bf16 v[116:119], a[40:43], a[180:183], v[116:119]
  ds_read_b64_tr_b16 a[34:35], v5 offset:36864
  s_waitcnt lgkmcnt(10)
  v_mfma_f32_16x16x32_bf16 v[120:123], a[44:47], a[124:127], v[120:123]
  ds_read_b64_tr_b16 a[36:37], v5 offset:40960
  v_mfma_f32_16x16x32_bf16 v[124:127], a[44:47], a[180:183], v[124:127]
  ds_read_b64_tr_b16 a[38:39], v5 offset:45056
  s_waitcnt lgkmcnt(10)
  v_mfma_f32_16x16x32_bf16 v[128:131], a[48:51], a[124:127], v[128:131]
  ds_read_b64_tr_b16 a[40:41], v6 offset:32768
  v_mfma_f32_16x16x32_bf16 v[132:135], a[48:51], a[180:183], v[132:135]
  ds_read_b64_tr_b16 a[42:43], v6 offset:36864
  s_waitcnt lgkmcnt(10)
  v_mfma_f32_16x16x32_bf16 v[136:139], a[52:55], a[124:127], v[136:139]
  ds_read_b64_tr_b16 a[44:45], v6 offset:40960
  v_mfma_f32_16x16x32_bf16 v[140:143], a[52:55], a[180:183], v[140:143]
  ds_read_b64_tr_b16 a[46:47], v6 offset:45056
  s_waitcnt lgkmcnt(10)
  v_mfma_f32_16x16x32_bf16 v[144:147], a[56:59], a[124:127], v[144:147]
  ds_read_b64_tr_b16 a[48:49], v7 offset:32768
  v_mfma_f32_16x16x32_bf16 v[148:151], a[56:59], a[180:183], v[148:151]
  ds_read_b64_tr_b16 a[50:51], v7 offset:36864
  s_waitcnt lgkmcnt(10)
  v_mfma_f32_16x16x32_bf16 v[152:155], a[60:63], a[124:127], v[152:155]
  ds_read_b64_tr_b16 a[52:53], v7 offset:40960
  v_mfma_f32_16x16x32_bf16 v[156:159], a[60:63], a[180:183], v[156:159]
  ds_read_b64_tr_b16 a[54:55], v7 offset:45056
  s_barrier
  s_waitcnt vmcnt(18)
  s_waitcnt lgkmcnt(10)
  v_mfma_f32_16x16x32_bf16 v[32:35], a[32:35], a[128:131], v[32:35]
  ds_read_b64_tr_b16 a[56:57], v8 offset:32768
  v_mfma_f32_16x16x32_bf16 v[36:39], a[32:35], a[184:187], v[36:39]
  ds_read_b64_tr_b16 a[58:59], v8 offset:36864
  s_add_u32 m0, s58, 32768
  s_waitcnt lgkmcnt(10)
  v_mfma_f32_16x16x32_bf16 v[40:43], a[36:39], a[128:131], v[40:43]
  ds_read_b64_tr_b16 a[60:61], v8 offset:40960
  s_mov_b32 s59, 1146880
  v_mfma_f32_16x16x32_bf16 v[44:47], a[36:39], a[184:187], v[44:47]
  ds_read_b64_tr_b16 a[62:63], v8 offset:45056
  buffer_load_dwordx4 v17, s[24:27], s59 offen offset:0 lds
  s_waitcnt lgkmcnt(10)
  v_mfma_f32_16x16x32_bf16 v[48:51], a[40:43], a[128:131], v[48:51]
  ds_read_b64_tr_b16 a[32:33], v9 offset:32768
  buffer_load_dwordx4 v18, s[24:27], s59 offen offset:1024 lds
  v_mfma_f32_16x16x32_bf16 v[52:55], a[40:43], a[184:187], v[52:55]
  ds_read_b64_tr_b16 a[34:35], v9 offset:36864
  buffer_load_dwordx4 v19, s[24:27], s59 offen offset:2048 lds
  s_waitcnt lgkmcnt(10)
  v_mfma_f32_16x16x32_bf16 v[56:59], a[44:47], a[128:131], v[56:59]
  ds_read_b64_tr_b16 a[36:37], v9 offset:40960
  buffer_load_dwordx4 v20, s[24:27], s59 offen offset:3072 lds
  v_mfma_f32_16x16x32_bf16 v[60:63], a[44:47], a[184:187], v[60:63]
  ds_read_b64_tr_b16 a[38:39], v9 offset:45056
  s_add_u32 m0, s58, 49152
  s_waitcnt lgkmcnt(10)
  v_mfma_f32_16x16x32_bf16 v[64:67], a[48:51], a[128:131], v[64:67]
  ds_read_b64_tr_b16 a[40:41], v10 offset:32768
  s_mov_b32 s59, 1261568
  v_mfma_f32_16x16x32_bf16 v[68:71], a[48:51], a[184:187], v[68:71]
  ds_read_b64_tr_b16 a[42:43], v10 offset:36864
  buffer_load_dwordx4 v17, s[24:27], s59 offen offset:0 lds
  s_waitcnt lgkmcnt(10)
  v_mfma_f32_16x16x32_bf16 v[72:75], a[52:55], a[128:131], v[72:75]
  ds_read_b64_tr_b16 a[44:45], v10 offset:40960
  buffer_load_dwordx4 v18, s[24:27], s59 offen offset:1024 lds
  v_mfma_f32_16x16x32_bf16 v[76:79], a[52:55], a[184:187], v[76:79]
  ds_read_b64_tr_b16 a[46:47], v10 offset:45056
  buffer_load_dwordx4 v19, s[24:27], s59 offen offset:2048 lds
  s_waitcnt lgkmcnt(10)
  v_mfma_f32_16x16x32_bf16 v[80:83], a[56:59], a[128:131], v[80:83]
  ds_read_b64_tr_b16 a[48:49], v11 offset:32768
  buffer_load_dwordx4 v20, s[24:27], s59 offen offset:3072 lds
  v_mfma_f32_16x16x32_bf16 v[84:87], a[56:59], a[184:187], v[84:87]
  ds_read_b64_tr_b16 a[50:51], v11 offset:36864
  s_add_u32 m0, s58, 65536
  s_waitcnt lgkmcnt(10)
  v_mfma_f32_16x16x32_bf16 v[88:91], a[60:63], a[128:131], v[88:91]
  ds_read_b64_tr_b16 a[52:53], v11 offset:40960
  s_mov_b32 s59, 1376256
  v_mfma_f32_16x16x32_bf16 v[92:95], a[60:63], a[184:187], v[92:95]
  ds_read_b64_tr_b16 a[54:55], v11 offset:45056
  buffer_load_dwordx4 v17, s[24:27], s59 offen offset:0 lds
  s_waitcnt lgkmcnt(10)
  v_mfma_f32_16x16x32_bf16 v[96:99], a[32:35], a[128:131], v[96:99]
  ds_read_b64_tr_b16 a[56:57], v12 offset:32768
  buffer_load_dwordx4 v18, s[24:27], s59 offen offset:1024 lds
  v_mfma_f32_16x16x32_bf16 v[100:103], a[32:35], a[184:187], v[100:103]
  ds_read_b64_tr_b16 a[58:59], v12 offset:36864
  buffer_load_dwordx4 v19, s[24:27], s59 offen offset:2048 lds
  s_waitcnt lgkmcnt(10)
  v_mfma_f32_16x16x32_bf16 v[104:107], a[36:39], a[128:131], v[104:107]
  ds_read_b64_tr_b16 a[60:61], v12 offset:40960
  buffer_load_dwordx4 v20, s[24:27], s59 offen offset:3072 lds
  v_mfma_f32_16x16x32_bf16 v[108:111], a[36:39], a[184:187], v[108:111]
  ds_read_b64_tr_b16 a[62:63], v12 offset:45056
  s_add_u32 m0, s58, 81920
  s_waitcnt lgkmcnt(10)
  v_mfma_f32_16x16x32_bf16 v[112:115], a[40:43], a[128:131], v[112:115]
  ds_read_b64_tr_b16 a[32:33], v5 offset:49152
  s_mov_b32 s59, 1490944
  v_mfma_f32_16x16x32_bf16 v[116:119], a[40:43], a[184:187], v[116:119]
  ds_read_b64_tr_b16 a[34:35], v5 offset:53248
  buffer_load_dwordx4 v17, s[24:27], s59 offen offset:0 lds
  s_waitcnt lgkmcnt(10)
  v_mfma_f32_16x16x32_bf16 v[120:123], a[44:47], a[128:131], v[120:123]
  ds_read_b64_tr_b16 a[36:37], v5 offset:57344
  buffer_load_dwordx4 v18, s[24:27], s59 offen offset:1024 lds
  v_mfma_f32_16x16x32_bf16 v[124:127], a[44:47], a[184:187], v[124:127]
  ds_read_b64_tr_b16 a[38:39], v5 offset:61440
  buffer_load_dwordx4 v19, s[24:27], s59 offen offset:2048 lds
  s_waitcnt lgkmcnt(10)
  v_mfma_f32_16x16x32_bf16 v[128:131], a[48:51], a[128:131], v[128:131]
  ds_read_b64_tr_b16 a[40:41], v6 offset:49152
  buffer_load_dwordx4 v20, s[24:27], s59 offen offset:3072 lds
  v_mfma_f32_16x16x32_bf16 v[132:135], a[48:51], a[184:187], v[132:135]
  ds_read_b64_tr_b16 a[42:43], v6 offset:53248
  s_waitcnt lgkmcnt(10)
  v_mfma_f32_16x16x32_bf16 v[136:139], a[52:55], a[128:131], v[136:139]
  ds_read_b64_tr_b16 a[44:45], v6 offset:57344
  v_mfma_f32_16x16x32_bf16 v[140:143], a[52:55], a[184:187], v[140:143]
  ds_read_b64_tr_b16 a[46:47], v6 offset:61440
  s_waitcnt lgkmcnt(10)
  v_mfma_f32_16x16x32_bf16 v[144:147], a[56:59], a[128:131], v[144:147]
  ds_read_b64_tr_b16 a[48:49], v7 offset:49152
  v_mfma_f32_16x16x32_bf16 v[148:151], a[56:59], a[184:187], v[148:151]
  ds_read_b64_tr_b16 a[50:51], v7 offset:53248
  s_waitcnt lgkmcnt(10)
  v_mfma_f32_16x16x32_bf16 v[152:155], a[60:63], a[128:131], v[152:155]
  ds_read_b64_tr_b16 a[52:53], v7 offset:57344
  v_mfma_f32_16x16x32_bf16 v[156:159], a[60:63], a[184:187], v[156:159]
  ds_read_b64_tr_b16 a[54:55], v7 offset:61440
  s_waitcnt vmcnt(32)
  s_waitcnt lgkmcnt(10)
  v_mfma_f32_16x16x32_bf16 v[32:35], a[32:35], a[132:135], v[32:35]
  ds_read_b64_tr_b16 a[56:57], v8 offset:49152
  v_mfma_f32_16x16x32_bf16 v[36:39], a[32:35], a[188:191], v[36:39]
  ds_read_b64_tr_b16 a[58:59], v8 offset:53248
  s_waitcnt lgkmcnt(10)
  v_mfma_f32_16x16x32_bf16 v[40:43], a[36:39], a[132:135], v[40:43]
  ds_read_b64_tr_b16 a[60:61], v8 offset:57344
  v_mfma_f32_16x16x32_bf16 v[44:47], a[36:39], a[188:191], v[44:47]
  ds_read_b64_tr_b16 a[62:63], v8 offset:61440
  s_waitcnt lgkmcnt(10)
  v_mfma_f32_16x16x32_bf16 v[48:51], a[40:43], a[132:135], v[48:51]
  ds_read_b64_tr_b16 a[32:33], v9 offset:49152
  v_mfma_f32_16x16x32_bf16 v[52:55], a[40:43], a[188:191], v[52:55]
  ds_read_b64_tr_b16 a[34:35], v9 offset:53248
  s_waitcnt lgkmcnt(10)
  v_mfma_f32_16x16x32_bf16 v[56:59], a[44:47], a[132:135], v[56:59]
  ds_read_b64_tr_b16 a[36:37], v9 offset:57344
  v_mfma_f32_16x16x32_bf16 v[60:63], a[44:47], a[188:191], v[60:63]
  ds_read_b64_tr_b16 a[38:39], v9 offset:61440
  s_waitcnt lgkmcnt(10)
  v_mfma_f32_16x16x32_bf16 v[64:67], a[48:51], a[132:135], v[64:67]
  ds_read_b64_tr_b16 a[40:41], v10 offset:49152
  v_mfma_f32_16x16x32_bf16 v[68:71], a[48:51], a[188:191], v[68:71]
  ds_read_b64_tr_b16 a[42:43], v10 offset:53248
  s_waitcnt lgkmcnt(10)
  v_mfma_f32_16x16x32_bf16 v[72:75], a[52:55], a[132:135], v[72:75]
  ds_read_b64_tr_b16 a[44:45], v10 offset:57344
  v_mfma_f32_16x16x32_bf16 v[76:79], a[52:55], a[188:191], v[76:79]
  ds_read_b64_tr_b16 a[46:47], v10 offset:61440
  s_waitcnt lgkmcnt(10)
  v_mfma_f32_16x16x32_bf16 v[80:83], a[56:59], a[132:135], v[80:83]
  ds_read_b64_tr_b16 a[48:49], v11 offset:49152
  v_mfma_f32_16x16x32_bf16 v[84:87], a[56:59], a[188:191], v[84:87]
  ds_read_b64_tr_b16 a[50:51], v11 offset:53248
  s_waitcnt lgkmcnt(10)
  v_mfma_f32_16x16x32_bf16 v[88:91], a[60:63], a[132:135], v[88:91]
  ds_read_b64_tr_b16 a[52:53], v11 offset:57344
  v_mfma_f32_16x16x32_bf16 v[92:95], a[60:63], a[188:191], v[92:95]
  ds_read_b64_tr_b16 a[54:55], v11 offset:61440
  s_waitcnt lgkmcnt(10)
  v_mfma_f32_16x16x32_bf16 v[96:99], a[32:35], a[132:135], v[96:99]
  ds_read_b64_tr_b16 a[56:57], v12 offset:49152
  v_mfma_f32_16x16x32_bf16 v[100:103], a[32:35], a[188:191], v[100:103]
  ds_read_b64_tr_b16 a[58:59], v12 offset:53248
  s_waitcnt lgkmcnt(10)
  v_mfma_f32_16x16x32_bf16 v[104:107], a[36:39], a[132:135], v[104:107]
  ds_read_b64_tr_b16 a[60:61], v12 offset:57344
  v_mfma_f32_16x16x32_bf16 v[108:111], a[36:39], a[188:191], v[108:111]
  ds_read_b64_tr_b16 a[62:63], v12 offset:61440
  s_waitcnt lgkmcnt(10)
  v_mfma_f32_16x16x32_bf16 v[112:115], a[40:43], a[132:135], v[112:115]
  v_add_u32 v5, 0x10000, v5
  ds_read_b64_tr_b16 a[32:33], v5 offset:0
  v_mfma_f32_16x16x32_bf16 v[116:119], a[40:43], a[188:191], v[116:119]
  ds_read_b64_tr_b16 a[34:35], v5 offset:4096
  s_waitcnt lgkmcnt(10)
  v_mfma_f32_16x16x32_bf16 v[120:123], a[44:47], a[132:135], v[120:123]
  ds_read_b64_tr_b16 a[36:37], v5 offset:8192
  v_mfma_f32_16x16x32_bf16 v[124:127], a[44:47], a[188:191], v[124:127]
  ds_read_b64_tr_b16 a[38:39], v5 offset:12288
  s_waitcnt lgkmcnt(10)
  v_mfma_f32_16x16x32_bf16 v[128:131], a[48:51], a[132:135], v[128:131]
  v_add_u32 v6, 0x10000, v6
  ds_read_b64_tr_b16 a[40:41], v6 offset:0
  v_mfma_f32_16x16x32_bf16 v[132:135], a[48:51], a[188:191], v[132:135]
  ds_read_b64_tr_b16 a[42:43], v6 offset:4096
  s_waitcnt lgkmcnt(10)
  v_mfma_f32_16x16x32_bf16 v[136:139], a[52:55], a[132:135], v[136:139]
  ds_read_b64_tr_b16 a[44:45], v6 offset:8192
  v_mfma_f32_16x16x32_bf16 v[140:143], a[52:55], a[188:191], v[140:143]
  ds_read_b64_tr_b16 a[46:47], v6 offset:12288
  s_waitcnt lgkmcnt(10)
  v_mfma_f32_16x16x32_bf16 v[144:147], a[56:59], a[132:135], v[144:147]
  v_add_u32 v7, 0x10000, v7
  ds_read_b64_tr_b16 a[48:49], v7 offset:0
  v_mfma_f32_16x16x32_bf16 v[148:151], a[56:59], a[188:191], v[148:151]
  ds_read_b64_tr_b16 a[50:51], v7 offset:4096
  s_waitcnt lgkmcnt(10)
  v_mfma_f32_16x16x32_bf16 v[152:155], a[60:63], a[132:135], v[152:155]
  ds_read_b64_tr_b16 a[52:53], v7 offset:8192
  v_mfma_f32_16x16x32_bf16 v[156:159], a[60:63], a[188:191], v[156:159]
  ds_read_b64_tr_b16 a[54:55], v7 offset:12288
  s_waitcnt vmcnt(30)
  v_add_u32 v8, 0x10000, v8
  v_add_u32 v9, 0x10000, v9
  v_add_u32 v10, 0x10000, v10
  v_add_u32 v11, 0x10000, v11
  v_add_u32 v12, 0x10000, v12
  s_waitcnt lgkmcnt(10)
  v_mfma_f32_16x16x32_bf16 v[32:35], a[32:35], a[136:139], v[32:35]
  ds_read_b64_tr_b16 a[56:57], v8 offset:0
  v_mfma_f32_16x16x32_bf16 v[36:39], a[32:35], a[192:195], v[36:39]
  ds_read_b64_tr_b16 a[58:59], v8 offset:4096
  s_waitcnt lgkmcnt(10)
  v_mfma_f32_16x16x32_bf16 v[40:43], a[36:39], a[136:139], v[40:43]
  ds_read_b64_tr_b16 a[60:61], v8 offset:8192
  v_mfma_f32_16x16x32_bf16 v[44:47], a[36:39], a[192:195], v[44:47]
  ds_read_b64_tr_b16 a[62:63], v8 offset:12288
  s_waitcnt lgkmcnt(10)
  v_mfma_f32_16x16x32_bf16 v[48:51], a[40:43], a[136:139], v[48:51]
  ds_read_b64_tr_b16 a[32:33], v9 offset:0
  v_mfma_f32_16x16x32_bf16 v[52:55], a[40:43], a[192:195], v[52:55]
  ds_read_b64_tr_b16 a[34:35], v9 offset:4096
  s_waitcnt lgkmcnt(10)
  v_mfma_f32_16x16x32_bf16 v[56:59], a[44:47], a[136:139], v[56:59]
  ds_read_b64_tr_b16 a[36:37], v9 offset:8192
  v_mfma_f32_16x16x32_bf16 v[60:63], a[44:47], a[192:195], v[60:63]
  ds_read_b64_tr_b16 a[38:39], v9 offset:12288
  s_waitcnt lgkmcnt(10)
  v_mfma_f32_16x16x32_bf16 v[64:67], a[48:51], a[136:139], v[64:67]
  ds_read_b64_tr_b16 a[40:41], v10 offset:0
  v_mfma_f32_16x16x32_bf16 v[68:71], a[48:51], a[192:195], v[68:71]
  ds_read_b64_tr_b16 a[42:43], v10 offset:4096
  s_waitcnt lgkmcnt(10)
  v_mfma_f32_16x16x32_bf16 v[72:75], a[52:55], a[136:139], v[72:75]
  ds_read_b64_tr_b16 a[44:45], v10 offset:8192
  v_mfma_f32_16x16x32_bf16 v[76:79], a[52:55], a[192:195], v[76:79]
  ds_read_b64_tr_b16 a[46:47], v10 offset:12288
  s_waitcnt lgkmcnt(10)
  v_mfma_f32_16x16x32_bf16 v[80:83], a[56:59], a[136:139], v[80:83]
  ds_read_b64_tr_b16 a[48:49], v11 offset:0
  v_mfma_f32_16x16x32_bf16 v[84:87], a[56:59], a[192:195], v[84:87]
  ds_read_b64_tr_b16 a[50:51], v11 offset:4096
  s_waitcnt lgkmcnt(10)
  v_mfma_f32_16x16x32_bf16 v[88:91], a[60:63], a[136:139], v[88:91]
  ds_read_b64_tr_b16 a[52:53], v11 offset:8192
  v_mfma_f32_16x16x32_bf16 v[92:95], a[60:63], a[192:195], v[92:95]
  ds_read_b64_tr_b16 a[54:55], v11 offset:12288
  s_waitcnt lgkmcnt(10)
  v_mfma_f32_16x16x32_bf16 v[96:99], a[32:35], a[136:139], v[96:99]
  ds_read_b64_tr_b16 a[56:57], v12 offset:0
  v_mfma_f32_16x16x32_bf16 v[100:103], a[32:35], a[192:195], v[100:103]
  ds_read_b64_tr_b16 a[58:59], v12 offset:4096
  s_waitcnt lgkmcnt(10)
  v_mfma_f32_16x16x32_bf16 v[104:107], a[36:39], a[136:139], v[104:107]
  ds_read_b64_tr_b16 a[60:61], v12 offset:8192
  v_mfma_f32_16x16x32_bf16 v[108:111], a[36:39], a[192:195], v[108:111]
  ds_read_b64_tr_b16 a[62:63], v12 offset:12288
  s_waitcnt lgkmcnt(10)
  v_mfma_f32_16x16x32_bf16 v[112:115], a[40:43], a[136:139], v[112:115]
  ds_read_b64_tr_b16 a[32:33], v5 offset:16384
  v_mfma_f32_16x16x32_bf16 v[116:119], a[40:43], a[192:195], v[116:119]
  ds_read_b64_tr_b16 a[34:35], v5 offset:20480
  s_waitcnt lgkmcnt(10)
  v_mfma_f32_16x16x32_bf16 v[120:123], a[44:47], a[136:139], v[120:123]
  ds_read_b64_tr_b16 a[36:37], v5 offset:24576
  v_mfma_f32_16x16x32_bf16 v[124:127], a[44:47], a[192:195], v[124:127]
  ds_read_b64_tr_b16 a[38:39], v5 offset:28672
  s_waitcnt lgkmcnt(10)
  v_mfma_f32_16x16x32_bf16 v[128:131], a[48:51], a[136:139], v[128:131]
  ds_read_b64_tr_b16 a[40:41], v6 offset:16384
  v_mfma_f32_16x16x32_bf16 v[132:135], a[48:51], a[192:195], v[132:135]
  ds_read_b64_tr_b16 a[42:43], v6 offset:20480
  s_waitcnt lgkmcnt(10)
  v_mfma_f32_16x16x32_bf16 v[136:139], a[52:55], a[136:139], v[136:139]
  ds_read_b64_tr_b16 a[44:45], v6 offset:24576
  v_mfma_f32_16x16x32_bf16 v[140:143], a[52:55], a[192:195], v[140:143]
  ds_read_b64_tr_b16 a[46:47], v6 offset:28672
  s_waitcnt lgkmcnt(10)
  v_mfma_f32_16x16x32_bf16 v[144:147], a[56:59], a[136:139], v[144:147]
  ds_read_b64_tr_b16 a[48:49], v7 offset:16384
  v_mfma_f32_16x16x32_bf16 v[148:151], a[56:59], a[192:195], v[148:151]
  ds_read_b64_tr_b16 a[50:51], v7 offset:20480
  s_waitcnt lgkmcnt(10)
  v_mfma_f32_16x16x32_bf16 v[152:155], a[60:63], a[136:139], v[152:155]
  ds_read_b64_tr_b16 a[52:53], v7 offset:24576
  v_mfma_f32_16x16x32_bf16 v[156:159], a[60:63], a[192:195], v[156:159]
  ds_read_b64_tr_b16 a[54:55], v7 offset:28672
  s_waitcnt vmcnt(28)
  s_waitcnt lgkmcnt(10)
  v_mfma_f32_16x16x32_bf16 v[32:35], a[32:35], a[140:143], v[32:35]
  ds_read_b64_tr_b16 a[56:57], v8 offset:16384
  v_mfma_f32_16x16x32_bf16 v[36:39], a[32:35], a[196:199], v[36:39]
  ds_read_b64_tr_b16 a[58:59], v8 offset:20480
  s_waitcnt lgkmcnt(10)
  v_mfma_f32_16x16x32_bf16 v[40:43], a[36:39], a[140:143], v[40:43]
  ds_read_b64_tr_b16 a[60:61], v8 offset:24576
  v_mfma_f32_16x16x32_bf16 v[44:47], a[36:39], a[196:199], v[44:47]
  ds_read_b64_tr_b16 a[62:63], v8 offset:28672
  s_waitcnt lgkmcnt(10)
  v_mfma_f32_16x16x32_bf16 v[48:51], a[40:43], a[140:143], v[48:51]
  ds_read_b64_tr_b16 a[32:33], v9 offset:16384
  v_mfma_f32_16x16x32_bf16 v[52:55], a[40:43], a[196:199], v[52:55]
  ds_read_b64_tr_b16 a[34:35], v9 offset:20480
  s_waitcnt lgkmcnt(10)
  v_mfma_f32_16x16x32_bf16 v[56:59], a[44:47], a[140:143], v[56:59]
  ds_read_b64_tr_b16 a[36:37], v9 offset:24576
  v_mfma_f32_16x16x32_bf16 v[60:63], a[44:47], a[196:199], v[60:63]
  ds_read_b64_tr_b16 a[38:39], v9 offset:28672
  s_waitcnt lgkmcnt(10)
  v_mfma_f32_16x16x32_bf16 v[64:67], a[48:51], a[140:143], v[64:67]
  ds_read_b64_tr_b16 a[40:41], v10 offset:16384
  v_mfma_f32_16x16x32_bf16 v[68:71], a[48:51], a[196:199], v[68:71]
  ds_read_b64_tr_b16 a[42:43], v10 offset:20480
  s_waitcnt lgkmcnt(10)
  v_mfma_f32_16x16x32_bf16 v[72:75], a[52:55], a[140:143], v[72:75]
  ds_read_b64_tr_b16 a[44:45], v10 offset:24576
  v_mfma_f32_16x16x32_bf16 v[76:79], a[52:55], a[196:199], v[76:79]
  ds_read_b64_tr_b16 a[46:47], v10 offset:28672
  s_waitcnt lgkmcnt(10)
  v_mfma_f32_16x16x32_bf16 v[80:83], a[56:59], a[140:143], v[80:83]
  ds_read_b64_tr_b16 a[48:49], v11 offset:16384
  v_mfma_f32_16x16x32_bf16 v[84:87], a[56:59], a[196:199], v[84:87]
  ds_read_b64_tr_b16 a[50:51], v11 offset:20480
  s_waitcnt lgkmcnt(10)
  v_mfma_f32_16x16x32_bf16 v[88:91], a[60:63], a[140:143], v[88:91]
  ds_read_b64_tr_b16 a[52:53], v11 offset:24576
  v_mfma_f32_16x16x32_bf16 v[92:95], a[60:63], a[196:199], v[92:95]
  ds_read_b64_tr_b16 a[54:55], v11 offset:28672
  s_waitcnt lgkmcnt(10)
  v_mfma_f32_16x16x32_bf16 v[96:99], a[32:35], a[140:143], v[96:99]
  ds_read_b64_tr_b16 a[56:57], v12 offset:16384
  v_mfma_f32_16x16x32_bf16 v[100:103], a[32:35], a[196:199], v[100:103]
  ds_read_b64_tr_b16 a[58:59], v12 offset:20480
  s_waitcnt lgkmcnt(10)
  v_mfma_f32_16x16x32_bf16 v[104:107], a[36:39], a[140:143], v[104:107]
  ds_read_b64_tr_b16 a[60:61], v12 offset:24576
  v_mfma_f32_16x16x32_bf16 v[108:111], a[36:39], a[196:199], v[108:111]
  ds_read_b64_tr_b16 a[62:63], v12 offset:28672
  s_waitcnt lgkmcnt(10)
  v_mfma_f32_16x16x32_bf16 v[112:115], a[40:43], a[140:143], v[112:115]
  v_add_u32 v5, 0xfffe0000, v5
  ds_read_b64_tr_b16 a[32:33], v5 offset:0
  v_mfma_f32_16x16x32_bf16 v[116:119], a[40:43], a[196:199], v[116:119]
  ds_read_b64_tr_b16 a[34:35], v5 offset:4096
  s_waitcnt lgkmcnt(10)
  v_mfma_f32_16x16x32_bf16 v[120:123], a[44:47], a[140:143], v[120:123]
  ds_read_b64_tr_b16 a[36:37], v5 offset:8192
  v_mfma_f32_16x16x32_bf16 v[124:127], a[44:47], a[196:199], v[124:127]
  ds_read_b64_tr_b16 a[38:39], v5 offset:12288
  s_waitcnt lgkmcnt(10)
  v_mfma_f32_16x16x32_bf16 v[128:131], a[48:51], a[140:143], v[128:131]
  v_add_u32 v6, 0xfffe0000, v6
  ds_read_b64_tr_b16 a[40:41], v6 offset:0
  v_mfma_f32_16x16x32_bf16 v[132:135], a[48:51], a[196:199], v[132:135]
  ds_read_b64_tr_b16 a[42:43], v6 offset:4096
  s_waitcnt lgkmcnt(10)
  v_mfma_f32_16x16x32_bf16 v[136:139], a[52:55], a[140:143], v[136:139]
  ds_read_b64_tr_b16 a[44:45], v6 offset:8192
  v_mfma_f32_16x16x32_bf16 v[140:143], a[52:55], a[196:199], v[140:143]
  ds_read_b64_tr_b16 a[46:47], v6 offset:12288
  s_waitcnt lgkmcnt(10)
  v_mfma_f32_16x16x32_bf16 v[144:147], a[56:59], a[140:143], v[144:147]
  v_add_u32 v7, 0xfffe0000, v7
  ds_read_b64_tr_b16 a[48:49], v7 offset:0
  v_mfma_f32_16x16x32_bf16 v[148:151], a[56:59], a[196:199], v[148:151]
  ds_read_b64_tr_b16 a[50:51], v7 offset:4096
  s_waitcnt lgkmcnt(10)
  v_mfma_f32_16x16x32_bf16 v[152:155], a[60:63], a[140:143], v[152:155]
  ds_read_b64_tr_b16 a[52:53], v7 offset:8192
  v_mfma_f32_16x16x32_bf16 v[156:159], a[60:63], a[196:199], v[156:159]
  ds_read_b64_tr_b16 a[54:55], v7 offset:12288
  s_waitcnt vmcnt(26)
  v_add_u32 v8, 0xfffe0000, v8
  v_add_u32 v9, 0xfffe0000, v9
  v_add_u32 v10, 0xfffe0000, v10
  v_add_u32 v11, 0xfffe0000, v11
  v_add_u32 v12, 0xfffe0000, v12
  s_waitcnt lgkmcnt(10)
  v_mfma_f32_16x16x32_bf16 v[32:35], a[32:35], a[144:147], v[32:35]
  ds_read_b64_tr_b16 a[56:57], v8 offset:0
  v_mfma_f32_16x16x32_bf16 v[36:39], a[32:35], a[200:203], v[36:39]
  ds_read_b64_tr_b16 a[58:59], v8 offset:4096
  s_waitcnt lgkmcnt(10)
  v_mfma_f32_16x16x32_bf16 v[40:43], a[36:39], a[144:147], v[40:43]
  ds_read_b64_tr_b16 a[60:61], v8 offset:8192
  v_mfma_f32_16x16x32_bf16 v[44:47], a[36:39], a[200:203], v[44:47]
  ds_read_b64_tr_b16 a[62:63], v8 offset:12288
  s_waitcnt lgkmcnt(10)
  v_mfma_f32_16x16x32_bf16 v[48:51], a[40:43], a[144:147], v[48:51]
  ds_read_b64_tr_b16 a[32:33], v9 offset:0
  v_mfma_f32_16x16x32_bf16 v[52:55], a[40:43], a[200:203], v[52:55]
  ds_read_b64_tr_b16 a[34:35], v9 offset:4096
  s_waitcnt lgkmcnt(10)
  v_mfma_f32_16x16x32_bf16 v[56:59], a[44:47], a[144:147], v[56:59]
  ds_read_b64_tr_b16 a[36:37], v9 offset:8192
  v_mfma_f32_16x16x32_bf16 v[60:63], a[44:47], a[200:203], v[60:63]
  ds_read_b64_tr_b16 a[38:39], v9 offset:12288
  s_waitcnt lgkmcnt(10)
  v_mfma_f32_16x16x32_bf16 v[64:67], a[48:51], a[144:147], v[64:67]
  ds_read_b64_tr_b16 a[40:41], v10 offset:0
  v_mfma_f32_16x16x32_bf16 v[68:71], a[48:51], a[200:203], v[68:71]
  ds_read_b64_tr_b16 a[42:43], v10 offset:4096
  s_waitcnt lgkmcnt(10)
  v_mfma_f32_16x16x32_bf16 v[72:75], a[52:55], a[144:147], v[72:75]
  ds_read_b64_tr_b16 a[44:45], v10 offset:8192
  v_mfma_f32_16x16x32_bf16 v[76:79], a[52:55], a[200:203], v[76:79]
  ds_read_b64_tr_b16 a[46:47], v10 offset:12288
  s_waitcnt lgkmcnt(10)
  v_mfma_f32_16x16x32_bf16 v[80:83], a[56:59], a[144:147], v[80:83]
  ds_read_b64_tr_b16 a[48:49], v11 offset:0
  v_mfma_f32_16x16x32_bf16 v[84:87], a[56:59], a[200:203], v[84:87]
  ds_read_b64_tr_b16 a[50:51], v11 offset:4096
  s_waitcnt lgkmcnt(10)
  v_mfma_f32_16x16x32_bf16 v[88:91], a[60:63], a[144:147], v[88:91]
  ds_read_b64_tr_b16 a[52:53], v11 offset:8192
  v_mfma_f32_16x16x32_bf16 v[92:95], a[60:63], a[200:203], v[92:95]
  ds_read_b64_tr_b16 a[54:55], v11 offset:12288
  s_waitcnt lgkmcnt(10)
  v_mfma_f32_16x16x32_bf16 v[96:99], a[32:35], a[144:147], v[96:99]
  ds_read_b64_tr_b16 a[56:57], v12 offset:0
  v_mfma_f32_16x16x32_bf16 v[100:103], a[32:35], a[200:203], v[100:103]
  ds_read_b64_tr_b16 a[58:59], v12 offset:4096
  s_waitcnt lgkmcnt(10)
  v_mfma_f32_16x16x32_bf16 v[104:107], a[36:39], a[144:147], v[104:107]
  ds_read_b64_tr_b16 a[60:61], v12 offset:8192
  v_mfma_f32_16x16x32_bf16 v[108:111], a[36:39], a[200:203], v[108:111]
  ds_read_b64_tr_b16 a[62:63], v12 offset:12288
  s_waitcnt lgkmcnt(10)
  v_mfma_f32_16x16x32_bf16 v[112:115], a[40:43], a[144:147], v[112:115]
  ds_read_b64_tr_b16 a[32:33], v5 offset:16384
  v_mfma_f32_16x16x32_bf16 v[116:119], a[40:43], a[200:203], v[116:119]
  ds_read_b64_tr_b16 a[34:35], v5 offset:20480
  s_waitcnt lgkmcnt(10)
  v_mfma_f32_16x16x32_bf16 v[120:123], a[44:47], a[144:147], v[120:123]
  ds_read_b64_tr_b16 a[36:37], v5 offset:24576
  v_mfma_f32_16x16x32_bf16 v[124:127], a[44:47], a[200:203], v[124:127]
  ds_read_b64_tr_b16 a[38:39], v5 offset:28672
  s_waitcnt lgkmcnt(10)
  v_mfma_f32_16x16x32_bf16 v[128:131], a[48:51], a[144:147], v[128:131]
  ds_read_b64_tr_b16 a[40:41], v6 offset:16384
  v_mfma_f32_16x16x32_bf16 v[132:135], a[48:51], a[200:203], v[132:135]
  ds_read_b64_tr_b16 a[42:43], v6 offset:20480
  s_waitcnt lgkmcnt(10)
  v_mfma_f32_16x16x32_bf16 v[136:139], a[52:55], a[144:147], v[136:139]
  ds_read_b64_tr_b16 a[44:45], v6 offset:24576
  v_mfma_f32_16x16x32_bf16 v[140:143], a[52:55], a[200:203], v[140:143]
  ds_read_b64_tr_b16 a[46:47], v6 offset:28672
  s_waitcnt lgkmcnt(10)
  v_mfma_f32_16x16x32_bf16 v[144:147], a[56:59], a[144:147], v[144:147]
  ds_read_b64_tr_b16 a[48:49], v7 offset:16384
  v_mfma_f32_16x16x32_bf16 v[148:151], a[56:59], a[200:203], v[148:151]
  ds_read_b64_tr_b16 a[50:51], v7 offset:20480
  s_waitcnt lgkmcnt(10)
  v_mfma_f32_16x16x32_bf16 v[152:155], a[60:63], a[144:147], v[152:155]
  ds_read_b64_tr_b16 a[52:53], v7 offset:24576
  v_mfma_f32_16x16x32_bf16 v[156:159], a[60:63], a[200:203], v[156:159]
  ds_read_b64_tr_b16 a[54:55], v7 offset:28672
  s_waitcnt vmcnt(0)
  s_barrier
  s_waitcnt lgkmcnt(10)
  v_mfma_f32_16x16x32_bf16 v[32:35], a[32:35], a[148:151], v[32:35]
  ds_read_b64_tr_b16 a[56:57], v8 offset:16384
  v_mfma_f32_16x16x32_bf16 v[36:39], a[32:35], a[204:207], v[36:39]
  ds_read_b64_tr_b16 a[58:59], v8 offset:20480
  s_waitcnt lgkmcnt(10)
  v_mfma_f32_16x16x32_bf16 v[40:43], a[36:39], a[148:151], v[40:43]
  ds_read_b64_tr_b16 a[60:61], v8 offset:24576
  v_mfma_f32_16x16x32_bf16 v[44:47], a[36:39], a[204:207], v[44:47]
  ds_read_b64_tr_b16 a[62:63], v8 offset:28672
  s_waitcnt lgkmcnt(10)
  v_mfma_f32_16x16x32_bf16 v[48:51], a[40:43], a[148:151], v[48:51]
  ds_read_b64_tr_b16 a[32:33], v9 offset:16384
  v_mfma_f32_16x16x32_bf16 v[52:55], a[40:43], a[204:207], v[52:55]
  ds_read_b64_tr_b16 a[34:35], v9 offset:20480
  s_waitcnt lgkmcnt(10)
  v_mfma_f32_16x16x32_bf16 v[56:59], a[44:47], a[148:151], v[56:59]
  ds_read_b64_tr_b16 a[36:37], v9 offset:24576
  v_mfma_f32_16x16x32_bf16 v[60:63], a[44:47], a[204:207], v[60:63]
  ds_read_b64_tr_b16 a[38:39], v9 offset:28672
  s_waitcnt lgkmcnt(10)
  v_mfma_f32_16x16x32_bf16 v[64:67], a[48:51], a[148:151], v[64:67]
  ds_read_b64_tr_b16 a[40:41], v10 offset:16384
  v_mfma_f32_16x16x32_bf16 v[68:71], a[48:51], a[204:207], v[68:71]
  ds_read_b64_tr_b16 a[42:43], v10 offset:20480
  s_waitcnt lgkmcnt(10)
  v_mfma_f32_16x16x32_bf16 v[72:75], a[52:55], a[148:151], v[72:75]
  ds_read_b64_tr_b16 a[44:45], v10 offset:24576
  v_mfma_f32_16x16x32_bf16 v[76:79], a[52:55], a[204:207], v[76:79]
  ds_read_b64_tr_b16 a[46:47], v10 offset:28672
  s_waitcnt lgkmcnt(10)
  v_mfma_f32_16x16x32_bf16 v[80:83], a[56:59], a[148:151], v[80:83]
  ds_read_b64_tr_b16 a[48:49], v11 offset:16384
  v_mfma_f32_16x16x32_bf16 v[84:87], a[56:59], a[204:207], v[84:87]
  ds_read_b64_tr_b16 a[50:51], v11 offset:20480
  s_waitcnt lgkmcnt(10)
  v_mfma_f32_16x16x32_bf16 v[88:91], a[60:63], a[148:151], v[88:91]
  ds_read_b64_tr_b16 a[52:53], v11 offset:24576
  v_mfma_f32_16x16x32_bf16 v[92:95], a[60:63], a[204:207], v[92:95]
  ds_read_b64_tr_b16 a[54:55], v11 offset:28672
  s_waitcnt lgkmcnt(10)
  v_mfma_f32_16x16x32_bf16 v[96:99], a[32:35], a[148:151], v[96:99]
  ds_read_b64_tr_b16 a[56:57], v12 offset:16384
  v_mfma_f32_16x16x32_bf16 v[100:103], a[32:35], a[204:207], v[100:103]
  ds_read_b64_tr_b16 a[58:59], v12 offset:20480
  s_waitcnt lgkmcnt(10)
  v_mfma_f32_16x16x32_bf16 v[104:107], a[36:39], a[148:151], v[104:107]
  ds_read_b64_tr_b16 a[60:61], v12 offset:24576
  v_mfma_f32_16x16x32_bf16 v[108:111], a[36:39], a[204:207], v[108:111]
  ds_read_b64_tr_b16 a[62:63], v12 offset:28672
  s_waitcnt lgkmcnt(10)
  v_mfma_f32_16x16x32_bf16 v[112:115], a[40:43], a[148:151], v[112:115]
  ds_read_b64_tr_b16 a[32:33], v5 offset:32768
  v_mfma_f32_16x16x32_bf16 v[116:119], a[40:43], a[204:207], v[116:119]
  ds_read_b64_tr_b16 a[34:35], v5 offset:36864
  s_waitcnt lgkmcnt(10)
  v_mfma_f32_16x16x32_bf16 v[120:123], a[44:47], a[148:151], v[120:123]
  ds_read_b64_tr_b16 a[36:37], v5 offset:40960
  v_mfma_f32_16x16x32_bf16 v[124:127], a[44:47], a[204:207], v[124:127]
  ds_read_b64_tr_b16 a[38:39], v5 offset:45056
  s_waitcnt lgkmcnt(10)
  v_mfma_f32_16x16x32_bf16 v[128:131], a[48:51], a[148:151], v[128:131]
  ds_read_b64_tr_b16 a[40:41], v6 offset:32768
  v_mfma_f32_16x16x32_bf16 v[132:135], a[48:51], a[204:207], v[132:135]
  ds_read_b64_tr_b16 a[42:43], v6 offset:36864
  s_waitcnt lgkmcnt(10)
  v_mfma_f32_16x16x32_bf16 v[136:139], a[52:55], a[148:151], v[136:139]
  ds_read_b64_tr_b16 a[44:45], v6 offset:40960
  v_mfma_f32_16x16x32_bf16 v[140:143], a[52:55], a[204:207], v[140:143]
  ds_read_b64_tr_b16 a[46:47], v6 offset:45056
  s_waitcnt lgkmcnt(10)
  v_mfma_f32_16x16x32_bf16 v[144:147], a[56:59], a[148:151], v[144:147]
  ds_read_b64_tr_b16 a[48:49], v7 offset:32768
  v_mfma_f32_16x16x32_bf16 v[148:151], a[56:59], a[204:207], v[148:151]
  ds_read_b64_tr_b16 a[50:51], v7 offset:36864
  s_waitcnt lgkmcnt(10)
  v_mfma_f32_16x16x32_bf16 v[152:155], a[60:63], a[148:151], v[152:155]
  ds_read_b64_tr_b16 a[52:53], v7 offset:40960
  v_mfma_f32_16x16x32_bf16 v[156:159], a[60:63], a[204:207], v[156:159]
  ds_read_b64_tr_b16 a[54:55], v7 offset:45056
  s_waitcnt lgkmcnt(10)
  v_mfma_f32_16x16x32_bf16 v[32:35], a[32:35], a[152:155], v[32:35]
  ds_read_b64_tr_b16 a[56:57], v8 offset:32768
  v_mfma_f32_16x16x32_bf16 v[36:39], a[32:35], a[208:211], v[36:39]
  ds_read_b64_tr_b16 a[58:59], v8 offset:36864
  s_waitcnt lgkmcnt(10)
  v_mfma_f32_16x16x32_bf16 v[40:43], a[36:39], a[152:155], v[40:43]
  ds_read_b64_tr_b16 a[60:61], v8 offset:40960
  v_mfma_f32_16x16x32_bf16 v[44:47], a[36:39], a[208:211], v[44:47]
  ds_read_b64_tr_b16 a[62:63], v8 offset:45056
  s_waitcnt lgkmcnt(10)
  v_mfma_f32_16x16x32_bf16 v[48:51], a[40:43], a[152:155], v[48:51]
  ds_read_b64_tr_b16 a[32:33], v9 offset:32768
  v_mfma_f32_16x16x32_bf16 v[52:55], a[40:43], a[208:211], v[52:55]
  ds_read_b64_tr_b16 a[34:35], v9 offset:36864
  s_waitcnt lgkmcnt(10)
  v_mfma_f32_16x16x32_bf16 v[56:59], a[44:47], a[152:155], v[56:59]
  ds_read_b64_tr_b16 a[36:37], v9 offset:40960
  v_mfma_f32_16x16x32_bf16 v[60:63], a[44:47], a[208:211], v[60:63]
  ds_read_b64_tr_b16 a[38:39], v9 offset:45056
  s_waitcnt lgkmcnt(10)
  v_mfma_f32_16x16x32_bf16 v[64:67], a[48:51], a[152:155], v[64:67]
  ds_read_b64_tr_b16 a[40:41], v10 offset:32768
  v_mfma_f32_16x16x32_bf16 v[68:71], a[48:51], a[208:211], v[68:71]
  ds_read_b64_tr_b16 a[42:43], v10 offset:36864
  s_waitcnt lgkmcnt(10)
  v_mfma_f32_16x16x32_bf16 v[72:75], a[52:55], a[152:155], v[72:75]
  ds_read_b64_tr_b16 a[44:45], v10 offset:40960
  v_mfma_f32_16x16x32_bf16 v[76:79], a[52:55], a[208:211], v[76:79]
  ds_read_b64_tr_b16 a[46:47], v10 offset:45056
  s_waitcnt lgkmcnt(10)
  v_mfma_f32_16x16x32_bf16 v[80:83], a[56:59], a[152:155], v[80:83]
  ds_read_b64_tr_b16 a[48:49], v11 offset:32768
  v_mfma_f32_16x16x32_bf16 v[84:87], a[56:59], a[208:211], v[84:87]
  ds_read_b64_tr_b16 a[50:51], v11 offset:36864
  s_waitcnt lgkmcnt(10)
  v_mfma_f32_16x16x32_bf16 v[88:91], a[60:63], a[152:155], v[88:91]
  ds_read_b64_tr_b16 a[52:53], v11 offset:40960
  v_mfma_f32_16x16x32_bf16 v[92:95], a[60:63], a[208:211], v[92:95]
  ds_read_b64_tr_b16 a[54:55], v11 offset:45056
  s_waitcnt lgkmcnt(10)
  v_mfma_f32_16x16x32_bf16 v[96:99], a[32:35], a[152:155], v[96:99]
  ds_read_b64_tr_b16 a[56:57], v12 offset:32768
  v_mfma_f32_16x16x32_bf16 v[100:103], a[32:35], a[208:211], v[100:103]
  ds_read_b64_tr_b16 a[58:59], v12 offset:36864
  s_waitcnt lgkmcnt(10)
  v_mfma_f32_16x16x32_bf16 v[104:107], a[36:39], a[152:155], v[104:107]
  ds_read_b64_tr_b16 a[60:61], v12 offset:40960
  v_mfma_f32_16x16x32_bf16 v[108:111], a[36:39], a[208:211], v[108:111]
  ds_read_b64_tr_b16 a[62:63], v12 offset:45056
  s_waitcnt lgkmcnt(10)
  v_mfma_f32_16x16x32_bf16 v[112:115], a[40:43], a[152:155], v[112:115]
  ds_read_b64_tr_b16 a[32:33], v5 offset:49152
  v_mfma_f32_16x16x32_bf16 v[116:119], a[40:43], a[208:211], v[116:119]
  ds_read_b64_tr_b16 a[34:35], v5 offset:53248
  s_waitcnt lgkmcnt(10)
  v_mfma_f32_16x16x32_bf16 v[120:123], a[44:47], a[152:155], v[120:123]
  ds_read_b64_tr_b16 a[36:37], v5 offset:57344
  v_mfma_f32_16x16x32_bf16 v[124:127], a[44:47], a[208:211], v[124:127]
  ds_read_b64_tr_b16 a[38:39], v5 offset:61440
  s_waitcnt lgkmcnt(10)
  v_mfma_f32_16x16x32_bf16 v[128:131], a[48:51], a[152:155], v[128:131]
  ds_read_b64_tr_b16 a[40:41], v6 offset:49152
  v_mfma_f32_16x16x32_bf16 v[132:135], a[48:51], a[208:211], v[132:135]
  ds_read_b64_tr_b16 a[42:43], v6 offset:53248
  s_waitcnt lgkmcnt(10)
  v_mfma_f32_16x16x32_bf16 v[136:139], a[52:55], a[152:155], v[136:139]
  ds_read_b64_tr_b16 a[44:45], v6 offset:57344
  v_mfma_f32_16x16x32_bf16 v[140:143], a[52:55], a[208:211], v[140:143]
  ds_read_b64_tr_b16 a[46:47], v6 offset:61440
  s_waitcnt lgkmcnt(10)
  v_mfma_f32_16x16x32_bf16 v[144:147], a[56:59], a[152:155], v[144:147]
  ds_read_b64_tr_b16 a[48:49], v7 offset:49152
  v_mfma_f32_16x16x32_bf16 v[148:151], a[56:59], a[208:211], v[148:151]
  ds_read_b64_tr_b16 a[50:51], v7 offset:53248
  s_waitcnt lgkmcnt(10)
  v_mfma_f32_16x16x32_bf16 v[152:155], a[60:63], a[152:155], v[152:155]
  ds_read_b64_tr_b16 a[52:53], v7 offset:57344
  v_mfma_f32_16x16x32_bf16 v[156:159], a[60:63], a[208:211], v[156:159]
  ds_read_b64_tr_b16 a[54:55], v7 offset:61440
  s_waitcnt lgkmcnt(10)
  v_mfma_f32_16x16x32_bf16 v[32:35], a[32:35], a[156:159], v[32:35]
  ds_read_b64_tr_b16 a[56:57], v8 offset:49152
  v_mfma_f32_16x16x32_bf16 v[36:39], a[32:35], a[212:215], v[36:39]
  ds_read_b64_tr_b16 a[58:59], v8 offset:53248
  s_waitcnt lgkmcnt(10)
  v_mfma_f32_16x16x32_bf16 v[40:43], a[36:39], a[156:159], v[40:43]
  ds_read_b64_tr_b16 a[60:61], v8 offset:57344
  v_mfma_f32_16x16x32_bf16 v[44:47], a[36:39], a[212:215], v[44:47]
  ds_read_b64_tr_b16 a[62:63], v8 offset:61440
  s_waitcnt lgkmcnt(10)
  v_mfma_f32_16x16x32_bf16 v[48:51], a[40:43], a[156:159], v[48:51]
  ds_read_b64_tr_b16 a[32:33], v9 offset:49152
  v_mfma_f32_16x16x32_bf16 v[52:55], a[40:43], a[212:215], v[52:55]
  ds_read_b64_tr_b16 a[34:35], v9 offset:53248
  s_waitcnt lgkmcnt(10)
  v_mfma_f32_16x16x32_bf16 v[56:59], a[44:47], a[156:159], v[56:59]
  ds_read_b64_tr_b16 a[36:37], v9 offset:57344
  v_mfma_f32_16x16x32_bf16 v[60:63], a[44:47], a[212:215], v[60:63]
  ds_read_b64_tr_b16 a[38:39], v9 offset:61440
  s_waitcnt lgkmcnt(10)
  v_mfma_f32_16x16x32_bf16 v[64:67], a[48:51], a[156:159], v[64:67]
  ds_read_b64_tr_b16 a[40:41], v10 offset:49152
  v_mfma_f32_16x16x32_bf16 v[68:71], a[48:51], a[212:215], v[68:71]
  ds_read_b64_tr_b16 a[42:43], v10 offset:53248
  s_waitcnt lgkmcnt(10)
  v_mfma_f32_16x16x32_bf16 v[72:75], a[52:55], a[156:159], v[72:75]
  ds_read_b64_tr_b16 a[44:45], v10 offset:57344
  v_mfma_f32_16x16x32_bf16 v[76:79], a[52:55], a[212:215], v[76:79]
  ds_read_b64_tr_b16 a[46:47], v10 offset:61440
  s_waitcnt lgkmcnt(10)
  v_mfma_f32_16x16x32_bf16 v[80:83], a[56:59], a[156:159], v[80:83]
  ds_read_b64_tr_b16 a[48:49], v11 offset:49152
  v_mfma_f32_16x16x32_bf16 v[84:87], a[56:59], a[212:215], v[84:87]
  ds_read_b64_tr_b16 a[50:51], v11 offset:53248
  s_waitcnt lgkmcnt(10)
  v_mfma_f32_16x16x32_bf16 v[88:91], a[60:63], a[156:159], v[88:91]
  ds_read_b64_tr_b16 a[52:53], v11 offset:57344
  v_mfma_f32_16x16x32_bf16 v[92:95], a[60:63], a[212:215], v[92:95]
  ds_read_b64_tr_b16 a[54:55], v11 offset:61440
  s_waitcnt lgkmcnt(10)
  v_mfma_f32_16x16x32_bf16 v[96:99], a[32:35], a[156:159], v[96:99]
  ds_read_b64_tr_b16 a[56:57], v12 offset:49152
  v_mfma_f32_16x16x32_bf16 v[100:103], a[32:35], a[212:215], v[100:103]
  ds_read_b64_tr_b16 a[58:59], v12 offset:53248
  s_waitcnt lgkmcnt(10)
  v_mfma_f32_16x16x32_bf16 v[104:107], a[36:39], a[156:159], v[104:107]
  ds_read_b64_tr_b16 a[60:61], v12 offset:57344
  v_mfma_f32_16x16x32_bf16 v[108:111], a[36:39], a[212:215], v[108:111]
  ds_read_b64_tr_b16 a[62:63], v12 offset:61440
  s_waitcnt lgkmcnt(10)
  v_mfma_f32_16x16x32_bf16 v[112:115], a[40:43], a[156:159], v[112:115]
  v_add_u32 v5, 0x10000, v5
  ds_read_b64_tr_b16 a[32:33], v5 offset:0
  v_mfma_f32_16x16x32_bf16 v[116:119], a[40:43], a[212:215], v[116:119]
  ds_read_b64_tr_b16 a[34:35], v5 offset:4096
  s_waitcnt lgkmcnt(10)
  v_mfma_f32_16x16x32_bf16 v[120:123], a[44:47], a[156:159], v[120:123]
  ds_read_b64_tr_b16 a[36:37], v5 offset:8192
  v_mfma_f32_16x16x32_bf16 v[124:127], a[44:47], a[212:215], v[124:127]
  ds_read_b64_tr_b16 a[38:39], v5 offset:12288
  s_waitcnt lgkmcnt(10)
  v_mfma_f32_16x16x32_bf16 v[128:131], a[48:51], a[156:159], v[128:131]
  v_add_u32 v6, 0x10000, v6
  ds_read_b64_tr_b16 a[40:41], v6 offset:0
  v_mfma_f32_16x16x32_bf16 v[132:135], a[48:51], a[212:215], v[132:135]
  ds_read_b64_tr_b16 a[42:43], v6 offset:4096
  s_waitcnt lgkmcnt(10)
  v_mfma_f32_16x16x32_bf16 v[136:139], a[52:55], a[156:159], v[136:139]
  ds_read_b64_tr_b16 a[44:45], v6 offset:8192
  v_mfma_f32_16x16x32_bf16 v[140:143], a[52:55], a[212:215], v[140:143]
  ds_read_b64_tr_b16 a[46:47], v6 offset:12288
  s_waitcnt lgkmcnt(10)
  v_mfma_f32_16x16x32_bf16 v[144:147], a[56:59], a[156:159], v[144:147]
  v_add_u32 v7, 0x10000, v7
  ds_read_b64_tr_b16 a[48:49], v7 offset:0
  v_mfma_f32_16x16x32_bf16 v[148:151], a[56:59], a[212:215], v[148:151]
  ds_read_b64_tr_b16 a[50:51], v7 offset:4096
  s_waitcnt lgkmcnt(10)
  v_mfma_f32_16x16x32_bf16 v[152:155], a[60:63], a[156:159], v[152:155]
  ds_read_b64_tr_b16 a[52:53], v7 offset:8192
  v_mfma_f32_16x16x32_bf16 v[156:159], a[60:63], a[212:215], v[156:159]
  ds_read_b64_tr_b16 a[54:55], v7 offset:12288
  v_add_u32 v8, 0x10000, v8
  v_add_u32 v9, 0x10000, v9
  v_add_u32 v10, 0x10000, v10
  v_add_u32 v11, 0x10000, v11
  v_add_u32 v12, 0x10000, v12
  s_waitcnt lgkmcnt(10)
  v_mfma_f32_16x16x32_bf16 v[32:35], a[32:35], a[160:163], v[32:35]
  ds_read_b64_tr_b16 a[56:57], v8 offset:0
  v_mfma_f32_16x16x32_bf16 v[36:39], a[32:35], a[216:219], v[36:39]
  ds_read_b64_tr_b16 a[58:59], v8 offset:4096
  s_waitcnt lgkmcnt(10)
  v_mfma_f32_16x16x32_bf16 v[40:43], a[36:39], a[160:163], v[40:43]
  ds_read_b64_tr_b16 a[60:61], v8 offset:8192
  v_mfma_f32_16x16x32_bf16 v[44:47], a[36:39], a[216:219], v[44:47]
  ds_read_b64_tr_b16 a[62:63], v8 offset:12288
  s_waitcnt lgkmcnt(10)
  v_mfma_f32_16x16x32_bf16 v[48:51], a[40:43], a[160:163], v[48:51]
  ds_read_b64_tr_b16 a[32:33], v9 offset:0
  v_mfma_f32_16x16x32_bf16 v[52:55], a[40:43], a[216:219], v[52:55]
  ds_read_b64_tr_b16 a[34:35], v9 offset:4096
  s_waitcnt lgkmcnt(10)
  v_mfma_f32_16x16x32_bf16 v[56:59], a[44:47], a[160:163], v[56:59]
  ds_read_b64_tr_b16 a[36:37], v9 offset:8192
  v_mfma_f32_16x16x32_bf16 v[60:63], a[44:47], a[216:219], v[60:63]
  ds_read_b64_tr_b16 a[38:39], v9 offset:12288
  s_waitcnt lgkmcnt(10)
  v_mfma_f32_16x16x32_bf16 v[64:67], a[48:51], a[160:163], v[64:67]
  ds_read_b64_tr_b16 a[40:41], v10 offset:0
  v_mfma_f32_16x16x32_bf16 v[68:71], a[48:51], a[216:219], v[68:71]
  ds_read_b64_tr_b16 a[42:43], v10 offset:4096
  s_waitcnt lgkmcnt(10)
  v_mfma_f32_16x16x32_bf16 v[72:75], a[52:55], a[160:163], v[72:75]
  ds_read_b64_tr_b16 a[44:45], v10 offset:8192
  v_mfma_f32_16x16x32_bf16 v[76:79], a[52:55], a[216:219], v[76:79]
  ds_read_b64_tr_b16 a[46:47], v10 offset:12288
  s_waitcnt lgkmcnt(10)
  v_mfma_f32_16x16x32_bf16 v[80:83], a[56:59], a[160:163], v[80:83]
  ds_read_b64_tr_b16 a[48:49], v11 offset:0
  v_mfma_f32_16x16x32_bf16 v[84:87], a[56:59], a[216:219], v[84:87]
  ds_read_b64_tr_b16 a[50:51], v11 offset:4096
  s_waitcnt lgkmcnt(10)
  v_mfma_f32_16x16x32_bf16 v[88:91], a[60:63], a[160:163], v[88:91]
  ds_read_b64_tr_b16 a[52:53], v11 offset:8192
  v_mfma_f32_16x16x32_bf16 v[92:95], a[60:63], a[216:219], v[92:95]
  ds_read_b64_tr_b16 a[54:55], v11 offset:12288
  s_waitcnt lgkmcnt(10)
  v_mfma_f32_16x16x32_bf16 v[96:99], a[32:35], a[160:163], v[96:99]
  ds_read_b64_tr_b16 a[56:57], v12 offset:0
  v_mfma_f32_16x16x32_bf16 v[100:103], a[32:35], a[216:219], v[100:103]
  ds_read_b64_tr_b16 a[58:59], v12 offset:4096
  s_waitcnt lgkmcnt(10)
  v_mfma_f32_16x16x32_bf16 v[104:107], a[36:39], a[160:163], v[104:107]
  ds_read_b64_tr_b16 a[60:61], v12 offset:8192
  v_mfma_f32_16x16x32_bf16 v[108:111], a[36:39], a[216:219], v[108:111]
  ds_read_b64_tr_b16 a[62:63], v12 offset:12288
  s_waitcnt lgkmcnt(10)
  v_mfma_f32_16x16x32_bf16 v[112:115], a[40:43], a[160:163], v[112:115]
  ds_read_b64_tr_b16 a[32:33], v5 offset:16384
  v_mfma_f32_16x16x32_bf16 v[116:119], a[40:43], a[216:219], v[116:119]
  ds_read_b64_tr_b16 a[34:35], v5 offset:20480
  s_waitcnt lgkmcnt(10)
  v_mfma_f32_16x16x32_bf16 v[120:123], a[44:47], a[160:163], v[120:123]
  ds_read_b64_tr_b16 a[36:37], v5 offset:24576
  v_mfma_f32_16x16x32_bf16 v[124:127], a[44:47], a[216:219], v[124:127]
  ds_read_b64_tr_b16 a[38:39], v5 offset:28672
  s_waitcnt lgkmcnt(10)
  v_mfma_f32_16x16x32_bf16 v[128:131], a[48:51], a[160:163], v[128:131]
  ds_read_b64_tr_b16 a[40:41], v6 offset:16384
  v_mfma_f32_16x16x32_bf16 v[132:135], a[48:51], a[216:219], v[132:135]
  ds_read_b64_tr_b16 a[42:43], v6 offset:20480
  s_waitcnt lgkmcnt(10)
  v_mfma_f32_16x16x32_bf16 v[136:139], a[52:55], a[160:163], v[136:139]
  ds_read_b64_tr_b16 a[44:45], v6 offset:24576
  v_mfma_f32_16x16x32_bf16 v[140:143], a[52:55], a[216:219], v[140:143]
  ds_read_b64_tr_b16 a[46:47], v6 offset:28672
  s_waitcnt lgkmcnt(10)
  v_mfma_f32_16x16x32_bf16 v[144:147], a[56:59], a[160:163], v[144:147]
  ds_read_b64_tr_b16 a[48:49], v7 offset:16384
  v_mfma_f32_16x16x32_bf16 v[148:151], a[56:59], a[216:219], v[148:151]
  ds_read_b64_tr_b16 a[50:51], v7 offset:20480
  s_waitcnt lgkmcnt(10)
  v_mfma_f32_16x16x32_bf16 v[152:155], a[60:63], a[160:163], v[152:155]
  ds_read_b64_tr_b16 a[52:53], v7 offset:24576
  v_mfma_f32_16x16x32_bf16 v[156:159], a[60:63], a[216:219], v[156:159]
  ds_read_b64_tr_b16 a[54:55], v7 offset:28672
  s_waitcnt lgkmcnt(10)
  v_mfma_f32_16x16x32_bf16 v[32:35], a[32:35], a[164:167], v[32:35]
  ds_read_b64_tr_b16 a[56:57], v8 offset:16384
  v_mfma_f32_16x16x32_bf16 v[36:39], a[32:35], a[220:223], v[36:39]
  ds_read_b64_tr_b16 a[58:59], v8 offset:20480
  s_waitcnt lgkmcnt(10)
  v_mfma_f32_16x16x32_bf16 v[40:43], a[36:39], a[164:167], v[40:43]
  ds_read_b64_tr_b16 a[60:61], v8 offset:24576
  v_mfma_f32_16x16x32_bf16 v[44:47], a[36:39], a[220:223], v[44:47]
  ds_read_b64_tr_b16 a[62:63], v8 offset:28672
  s_waitcnt lgkmcnt(10)
  v_mfma_f32_16x16x32_bf16 v[48:51], a[40:43], a[164:167], v[48:51]
  ds_read_b64_tr_b16 a[32:33], v9 offset:16384
  v_mfma_f32_16x16x32_bf16 v[52:55], a[40:43], a[220:223], v[52:55]
  ds_read_b64_tr_b16 a[34:35], v9 offset:20480
  s_waitcnt lgkmcnt(10)
  v_mfma_f32_16x16x32_bf16 v[56:59], a[44:47], a[164:167], v[56:59]
  ds_read_b64_tr_b16 a[36:37], v9 offset:24576
  v_mfma_f32_16x16x32_bf16 v[60:63], a[44:47], a[220:223], v[60:63]
  ds_read_b64_tr_b16 a[38:39], v9 offset:28672
  s_waitcnt lgkmcnt(10)
  v_mfma_f32_16x16x32_bf16 v[64:67], a[48:51], a[164:167], v[64:67]
  ds_read_b64_tr_b16 a[40:41], v10 offset:16384
  v_mfma_f32_16x16x32_bf16 v[68:71], a[48:51], a[220:223], v[68:71]
  ds_read_b64_tr_b16 a[42:43], v10 offset:20480
  s_waitcnt lgkmcnt(10)
  v_mfma_f32_16x16x32_bf16 v[72:75], a[52:55], a[164:167], v[72:75]
  ds_read_b64_tr_b16 a[44:45], v10 offset:24576
  v_mfma_f32_16x16x32_bf16 v[76:79], a[52:55], a[220:223], v[76:79]
  ds_read_b64_tr_b16 a[46:47], v10 offset:28672
  s_waitcnt lgkmcnt(10)
  v_mfma_f32_16x16x32_bf16 v[80:83], a[56:59], a[164:167], v[80:83]
  ds_read_b64_tr_b16 a[48:49], v11 offset:16384
  v_mfma_f32_16x16x32_bf16 v[84:87], a[56:59], a[220:223], v[84:87]
  ds_read_b64_tr_b16 a[50:51], v11 offset:20480
  s_waitcnt lgkmcnt(10)
  v_mfma_f32_16x16x32_bf16 v[88:91], a[60:63], a[164:167], v[88:91]
  ds_read_b64_tr_b16 a[52:53], v11 offset:24576
  v_mfma_f32_16x16x32_bf16 v[92:95], a[60:63], a[220:223], v[92:95]
  ds_read_b64_tr_b16 a[54:55], v11 offset:28672
  s_waitcnt lgkmcnt(10)
  v_mfma_f32_16x16x32_bf16 v[96:99], a[32:35], a[164:167], v[96:99]
  ds_read_b64_tr_b16 a[56:57], v12 offset:16384
  v_mfma_f32_16x16x32_bf16 v[100:103], a[32:35], a[220:223], v[100:103]
  ds_read_b64_tr_b16 a[58:59], v12 offset:20480
  s_waitcnt lgkmcnt(10)
  v_mfma_f32_16x16x32_bf16 v[104:107], a[36:39], a[164:167], v[104:107]
  ds_read_b64_tr_b16 a[60:61], v12 offset:24576
  v_mfma_f32_16x16x32_bf16 v[108:111], a[36:39], a[220:223], v[108:111]
  ds_read_b64_tr_b16 a[62:63], v12 offset:28672
  s_waitcnt lgkmcnt(10)
  v_mfma_f32_16x16x32_bf16 v[112:115], a[40:43], a[164:167], v[112:115]
  v_mfma_f32_16x16x32_bf16 v[116:119], a[40:43], a[220:223], v[116:119]
  s_waitcnt lgkmcnt(8)
  v_mfma_f32_16x16x32_bf16 v[120:123], a[44:47], a[164:167], v[120:123]
  v_mfma_f32_16x16x32_bf16 v[124:127], a[44:47], a[220:223], v[124:127]
  s_waitcnt lgkmcnt(6)
  v_mfma_f32_16x16x32_bf16 v[128:131], a[48:51], a[164:167], v[128:131]
  v_mfma_f32_16x16x32_bf16 v[132:135], a[48:51], a[220:223], v[132:135]
  s_waitcnt lgkmcnt(4)
  v_mfma_f32_16x16x32_bf16 v[136:139], a[52:55], a[164:167], v[136:139]
  v_mfma_f32_16x16x32_bf16 v[140:143], a[52:55], a[220:223], v[140:143]
  s_waitcnt lgkmcnt(2)
  v_mfma_f32_16x16x32_bf16 v[144:147], a[56:59], a[164:167], v[144:147]
  v_mfma_f32_16x16x32_bf16 v[148:151], a[56:59], a[220:223], v[148:151]
  s_waitcnt lgkmcnt(0)
  v_mfma_f32_16x16x32_bf16 v[152:155], a[60:63], a[164:167], v[152:155]
  v_mfma_f32_16x16x32_bf16 v[156:159], a[60:63], a[220:223], v[156:159]
  s_load_dwordx4 s[68:71], s[0:1], 72
  s_cmp_ge_u32 s30, 7
  s_cselect_b32 s60, 1, 0
  s_lshl_b32 s34, s29, 1
  s_add_u32 s34, s34, s60
  s_mul_i32 s60, s60, 7
  s_sub_u32 s35, s30, s60
  s_lshl_b32 s64, s35, 7
  s_waitcnt lgkmcnt(0)
  s_add_u32 s40, s68, s64
  s_addc_u32 s41, s69, 0
  s_sub_u32 s42, 1605632, s64
  s_mov_b32 s43, 0x00020000
  s_mov_b32 s44, s70
  s_mov_b32 s45, s71
  s_mov_b32 s46, 1835008
  s_mov_b32 s47, 0x00020000
  s_add_u32 s36, s98, 113246208
  s_addc_u32 s37, s99, 0
  s_mov_b32 s38, 7340032
  s_mov_b32 s39, 0x00020000
  v_lshrrev_b32 v24, 3, v0
  s_mul_i32 s64, s28, 448
  v_add_u32 v24, s64, v24
  s_movk_i32 s64, 896
  v_mul_lo_u32 v24, v24, s64
  v_lshrrev_b32 v25, 4, v0
  v_lshlrev_b32 v25, 1, v25
  v_and_b32 v26, 7, v0
  v_xor_b32 v25, v25, v26
  v_lshl_add_u32 v24, v25, 4, v24
  v_add_u32 v6, 0, v24
  v_add_u32 v7, 6144, v24
  v_add_u32 v8, 12288, v24
  v_add_u32 v9, 18432, v24
  s_mul_i32 s33, s28, 40960
  v_lshlrev_b32 v1, 4, v0
  s_barrier
  s_cmp_lt_u32 s30, 14
  s_cbranch_scc0 p4e_now0
  s_add_u32 m0, s33, 0
  s_mov_b32 s60, 0
  buffer_load_dwordx4 v6, s[40:43], s60 offen offset:0 lds
  buffer_load_dwordx4 v7, s[40:43], s60 offen offset:1024 lds
  buffer_load_dwordx4 v8, s[40:43], s60 offen offset:2048 lds
  buffer_load_dwordx4 v9, s[40:43], s60 offen offset:3072 lds
  s_add_u32 m0, s33, 4096
  s_mov_b32 s60, 28672
  buffer_load_dwordx4 v6, s[40:43], s60 offen offset:0 lds
  buffer_load_dwordx4 v7, s[40:43], s60 offen offset:1024 lds
  buffer_load_dwordx4 v8, s[40:43], s60 offen offset:2048 lds
  buffer_load_dwordx4 v9, s[40:43], s60 offen offset:3072 lds
  s_add_u32 m0, s33, 8192
  s_mov_b32 s60, 57344
  buffer_load_dwordx4 v6, s[40:43], s60 offen offset:0 lds
  buffer_load_dwordx4 v7, s[40:43], s60 offen offset:1024 lds
  buffer_load_dwordx4 v8, s[40:43], s60 offen offset:2048 lds
  buffer_load_dwordx4 v9, s[40:43], s60 offen offset:3072 lds
  s_add_u32 m0, s33, 12288
  s_mov_b32 s60, 86016
  buffer_load_dwordx4 v6, s[40:43], s60 offen offset:0 lds
  buffer_load_dwordx4 v7, s[40:43], s60 offen offset:1024 lds
  buffer_load_dwordx4 v8, s[40:43], s60 offen offset:2048 lds
  buffer_load_dwordx4 v9, s[40:43], s60 offen offset:3072 lds
p4e_now0:
  s_mov_b32 s60, 0xc0135761
  s_mov_b32 s61, 0xbdd2d3e8
  v_mov_b32 v28, s60
  v_mov_b32 v29, s60
  v_mov_b32 v26, s61
  v_mov_b32 v27, s61
  v_mov_b32 v30, 1.0
  v_mov_b32 v31, 1.0
  v_pk_mul_f32 v[160:161], v[32:33], v[32:33]
  v_pk_mul_f32 v[162:163], v[34:35], v[34:35]
  v_pk_mul_f32 v[164:165], v[48:49], v[48:49]
  v_pk_mul_f32 v[166:167], v[50:51], v[50:51]
  v_pk_fma_f32 v[160:161], v[160:161], v[26:27], v[28:29]
  v_pk_fma_f32 v[162:163], v[162:163], v[26:27], v[28:29]
  v_pk_fma_f32 v[164:165], v[164:165], v[26:27], v[28:29]
  v_pk_fma_f32 v[166:167], v[166:167], v[26:27], v[28:29]
  v_pk_mul_f32 v[160:161], v[160:161], v[32:33]
  v_pk_mul_f32 v[162:163], v[162:163], v[34:35]
  v_pk_mul_f32 v[164:165], v[164:165], v[48:49]
  v_pk_mul_f32 v[166:167], v[166:167], v[50:51]
  v_exp_f32 v160, v160
  v_exp_f32 v161, v161
  v_exp_f32 v162, v162
  v_exp_f32 v163, v163
  v_exp_f32 v164, v164
  v_exp_f32 v165, v165
  v_exp_f32 v166, v166
  v_exp_f32 v167, v167
  v_pk_mul_f32 v[40:41], v[40:41], v[32:33]
  v_pk_mul_f32 v[42:43], v[42:43], v[34:35]
  v_pk_mul_f32 v[56:57], v[56:57], v[48:49]
  v_pk_mul_f32 v[58:59], v[58:59], v[50:51]
  v_pk_add_f32 v[160:161], v[160:161], v[30:31]
  v_pk_add_f32 v[162:163], v[162:163], v[30:31]
  v_pk_add_f32 v[164:165], v[164:165], v[30:31]
  v_pk_add_f32 v[166:167], v[166:167], v[30:31]
  v_rcp_f32 v160, v160
  v_rcp_f32 v161, v161
  v_rcp_f32 v162, v162
  v_rcp_f32 v163, v163
  v_rcp_f32 v164, v164
  v_rcp_f32 v165, v165
  v_rcp_f32 v166, v166
  v_rcp_f32 v167, v167
  s_nop 0
  v_pk_mul_f32 v[160:161], v[160:161], v[40:41]
  v_pk_mul_f32 v[162:163], v[162:163], v[42:43]
  v_pk_mul_f32 v[164:165], v[164:165], v[56:57]
  v_pk_mul_f32 v[166:167], v[166:167], v[58:59]
  v_cvt_pk_bf16_f32 v168, v160, v161
  v_cvt_pk_bf16_f32 v169, v162, v163
  v_cvt_pk_bf16_f32 v170, v164, v165
  v_cvt_pk_bf16_f32 v171, v166, v167
  buffer_store_dwordx4 v[168:171], v21, s[36:39], 0 offen offset:0 sc1
  v_pk_mul_f32 v[160:161], v[36:37], v[36:37]
  v_pk_mul_f32 v[162:163], v[38:39], v[38:39]
  v_pk_mul_f32 v[164:165], v[52:53], v[52:53]
  v_pk_mul_f32 v[166:167], v[54:55], v[54:55]
  v_pk_fma_f32 v[160:161], v[160:161], v[26:27], v[28:29]
  v_pk_fma_f32 v[162:163], v[162:163], v[26:27], v[28:29]
  v_pk_fma_f32 v[164:165], v[164:165], v[26:27], v[28:29]
  v_pk_fma_f32 v[166:167], v[166:167], v[26:27], v[28:29]
  v_pk_mul_f32 v[160:161], v[160:161], v[36:37]
  v_pk_mul_f32 v[162:163], v[162:163], v[38:39]
  v_pk_mul_f32 v[164:165], v[164:165], v[52:53]
  v_pk_mul_f32 v[166:167], v[166:167], v[54:55]
  v_exp_f32 v160, v160
  v_exp_f32 v161, v161
  v_exp_f32 v162, v162
  v_exp_f32 v163, v163
  v_exp_f32 v164, v164
  v_exp_f32 v165, v165
  v_exp_f32 v166, v166
  v_exp_f32 v167, v167
  v_pk_mul_f32 v[44:45], v[44:45], v[36:37]
  v_pk_mul_f32 v[46:47], v[46:47], v[38:39]
  v_pk_mul_f32 v[60:61], v[60:61], v[52:53]
  v_pk_mul_f32 v[62:63], v[62:63], v[54:55]
  v_pk_add_f32 v[160:161], v[160:161], v[30:31]
  v_pk_add_f32 v[162:163], v[162:163], v[30:31]
  v_pk_add_f32 v[164:165], v[164:165], v[30:31]
  v_pk_add_f32 v[166:167], v[166:167], v[30:31]
  v_rcp_f32 v160, v160
  v_rcp_f32 v161, v161
  v_rcp_f32 v162, v162
  v_rcp_f32 v163, v163
  v_rcp_f32 v164, v164
  v_rcp_f32 v165, v165
  v_rcp_f32 v166, v166
  v_rcp_f32 v167, v167
  s_nop 0
  v_pk_mul_f32 v[160:161], v[160:161], v[44:45]
  v_pk_mul_f32 v[162:163], v[162:163], v[46:47]
  v_pk_mul_f32 v[164:165], v[164:165], v[60:61]
  v_pk_mul_f32 v[166:167], v[166:167], v[62:63]
  v_cvt_pk_bf16_f32 v172, v160, v161
  v_cvt_pk_bf16_f32 v173, v162, v163
  v_cvt_pk_bf16_f32 v174, v164, v165
  v_cvt_pk_bf16_f32 v175, v166, v167
  buffer_store_dwordx4 v[172:175], v22, s[36:39], 0 offen offset:0 sc1
  v_pk_mul_f32 v[160:161], v[64:65], v[64:65]
  v_pk_mul_f32 v[162:163], v[66:67], v[66:67]
  v_pk_mul_f32 v[164:165], v[80:81], v[80:81]
  v_pk_mul_f32 v[166:167], v[82:83], v[82:83]
  v_pk_fma_f32 v[160:161], v[160:161], v[26:27], v[28:29]
  v_pk_fma_f32 v[162:163], v[162:163], v[26:27], v[28:29]
  v_pk_fma_f32 v[164:165], v[164:165], v[26:27], v[28:29]
  v_pk_fma_f32 v[166:167], v[166:167], v[26:27], v[28:29]
  v_pk_mul_f32 v[160:161], v[160:161], v[64:65]
  v_pk_mul_f32 v[162:163], v[162:163], v[66:67]
  v_pk_mul_f32 v[164:165], v[164:165], v[80:81]
  v_pk_mul_f32 v[166:167], v[166:167], v[82:83]
  v_exp_f32 v160, v160
  v_exp_f32 v161, v161
  v_exp_f32 v162, v162
  v_exp_f32 v163, v163
  v_exp_f32 v164, v164
  v_exp_f32 v165, v165
  v_exp_f32 v166, v166
  v_exp_f32 v167, v167
  v_pk_mul_f32 v[72:73], v[72:73], v[64:65]
  v_pk_mul_f32 v[74:75], v[74:75], v[66:67]
  v_pk_mul_f32 v[88:89], v[88:89], v[80:81]
  v_pk_mul_f32 v[90:91], v[90:91], v[82:83]
  v_pk_add_f32 v[160:161], v[160:161], v[30:31]
  v_pk_add_f32 v[162:163], v[162:163], v[30:31]
  v_pk_add_f32 v[164:165], v[164:165], v[30:31]
  v_pk_add_f32 v[166:167], v[166:167], v[30:31]
  v_rcp_f32 v160, v160
  v_rcp_f32 v161, v161
  v_rcp_f32 v162, v162
  v_rcp_f32 v163, v163
  v_rcp_f32 v164, v164
  v_rcp_f32 v165, v165
  v_rcp_f32 v166, v166
  v_rcp_f32 v167, v167
  s_nop 0
  v_pk_mul_f32 v[160:161], v[160:161], v[72:73]
  v_pk_mul_f32 v[162:163], v[162:163], v[74:75]
  v_pk_mul_f32 v[164:165], v[164:165], v[88:89]
  v_pk_mul_f32 v[166:167], v[166:167], v[90:91]
  v_cvt_pk_bf16_f32 v168, v160, v161
  v_cvt_pk_bf16_f32 v169, v162, v163
  v_cvt_pk_bf16_f32 v170, v164, v165
  v_cvt_pk_bf16_f32 v171, v166, v167
  buffer_store_dwordx4 v[168:171], v21, s[36:39], 0 offen offset:1024 sc1
  v_pk_mul_f32 v[160:161], v[68:69], v[68:69]
  v_pk_mul_f32 v[162:163], v[70:71], v[70:71]
  v_pk_mul_f32 v[164:165], v[84:85], v[84:85]
  v_pk_mul_f32 v[166:167], v[86:87], v[86:87]
  v_pk_fma_f32 v[160:161], v[160:161], v[26:27], v[28:29]
  v_pk_fma_f32 v[162:163], v[162:163], v[26:27], v[28:29]
  v_pk_fma_f32 v[164:165], v[164:165], v[26:27], v[28:29]
  v_pk_fma_f32 v[166:167], v[166:167], v[26:27], v[28:29]
  v_pk_mul_f32 v[160:161], v[160:161], v[68:69]
  v_pk_mul_f32 v[162:163], v[162:163], v[70:71]
  v_pk_mul_f32 v[164:165], v[164:165], v[84:85]
  v_pk_mul_f32 v[166:167], v[166:167], v[86:87]
  v_exp_f32 v160, v160
  v_exp_f32 v161, v161
  v_exp_f32 v162, v162
  v_exp_f32 v163, v163
  v_exp_f32 v164, v164
  v_exp_f32 v165, v165
  v_exp_f32 v166, v166
  v_exp_f32 v167, v167
  v_pk_mul_f32 v[76:77], v[76:77], v[68:69]
  v_pk_mul_f32 v[78:79], v[78:79], v[70:71]
  v_pk_mul_f32 v[92:93], v[92:93], v[84:85]
  v_pk_mul_f32 v[94:95], v[94:95], v[86:87]
  v_pk_add_f32 v[160:161], v[160:161], v[30:31]
  v_pk_add_f32 v[162:163], v[162:163], v[30:31]
  v_pk_add_f32 v[164:165], v[164:165], v[30:31]
  v_pk_add_f32 v[166:167], v[166:167], v[30:31]
  v_rcp_f32 v160, v160
  v_rcp_f32 v161, v161
  v_rcp_f32 v162, v162
  v_rcp_f32 v163, v163
  v_rcp_f32 v164, v164
  v_rcp_f32 v165, v165
  v_rcp_f32 v166, v166
  v_rcp_f32 v167, v167
  s_nop 0
  v_pk_mul_f32 v[160:161], v[160:161], v[76:77]
  v_pk_mul_f32 v[162:163], v[162:163], v[78:79]
  v_pk_mul_f32 v[164:165], v[164:165], v[92:93]
  v_pk_mul_f32 v[166:167], v[166:167], v[94:95]
  v_cvt_pk_bf16_f32 v172, v160, v161
  v_cvt_pk_bf16_f32 v173, v162, v163
  v_cvt_pk_bf16_f32 v174, v164, v165
  v_cvt_pk_bf16_f32 v175, v166, v167
  buffer_store_dwordx4 v[172:175], v22, s[36:39], 0 offen offset:1024 sc1
  v_pk_mul_f32 v[160:161], v[96:97], v[96:97]
  v_pk_mul_f32 v[162:163], v[98:99], v[98:99]
  v_pk_mul_f32 v[164:165], v[112:113], v[112:113]
  v_pk_mul_f32 v[166:167], v[114:115], v[114:115]
  v_pk_fma_f32 v[160:161], v[160:161], v[26:27], v[28:29]
  v_pk_fma_f32 v[162:163], v[162:163], v[26:27], v[28:29]
  v_pk_fma_f32 v[164:165], v[164:165], v[26:27], v[28:29]
  v_pk_fma_f32 v[166:167], v[166:167], v[26:27], v[28:29]
  v_pk_mul_f32 v[160:161], v[160:161], v[96:97]
  v_pk_mul_f32 v[162:163], v[162:163], v[98:99]
  v_pk_mul_f32 v[164:165], v[164:165], v[112:113]
  v_pk_mul_f32 v[166:167], v[166:167], v[114:115]
  v_exp_f32 v160, v160
  v_exp_f32 v161, v161
  v_exp_f32 v162, v162
  v_exp_f32 v163, v163
  v_exp_f32 v164, v164
  v_exp_f32 v165, v165
  v_exp_f32 v166, v166
  v_exp_f32 v167, v167
  v_pk_mul_f32 v[104:105], v[104:105], v[96:97]
  v_pk_mul_f32 v[106:107], v[106:107], v[98:99]
  v_pk_mul_f32 v[120:121], v[120:121], v[112:113]
  v_pk_mul_f32 v[122:123], v[122:123], v[114:115]
  v_pk_add_f32 v[160:161], v[160:161], v[30:31]
  v_pk_add_f32 v[162:163], v[162:163], v[30:31]
  v_pk_add_f32 v[164:165], v[164:165], v[30:31]
  v_pk_add_f32 v[166:167], v[166:167], v[30:31]
  v_rcp_f32 v160, v160
  v_rcp_f32 v161, v161
  v_rcp_f32 v162, v162
  v_rcp_f32 v163, v163
  v_rcp_f32 v164, v164
  v_rcp_f32 v165, v165
  v_rcp_f32 v166, v166
  v_rcp_f32 v167, v167
  s_nop 0
  v_pk_mul_f32 v[160:161], v[160:161], v[104:105]
  v_pk_mul_f32 v[162:163], v[162:163], v[106:107]
  v_pk_mul_f32 v[164:165], v[164:165], v[120:121]
  v_pk_mul_f32 v[166:167], v[166:167], v[122:123]
  v_cvt_pk_bf16_f32 v168, v160, v161
  v_cvt_pk_bf16_f32 v169, v162, v163
  v_cvt_pk_bf16_f32 v170, v164, v165
  v_cvt_pk_bf16_f32 v171, v166, v167
  buffer_store_dwordx4 v[168:171], v21, s[36:39], 0 offen offset:2048 sc1
  v_pk_mul_f32 v[160:161], v[100:101], v[100:101]
  v_pk_mul_f32 v[162:163], v[102:103], v[102:103]
  v_pk_mul_f32 v[164:165], v[116:117], v[116:117]
  v_pk_mul_f32 v[166:167], v[118:119], v[118:119]
  v_pk_fma_f32 v[160:161], v[160:161], v[26:27], v[28:29]
  v_pk_fma_f32 v[162:163], v[162:163], v[26:27], v[28:29]
  v_pk_fma_f32 v[164:165], v[164:165], v[26:27], v[28:29]
  v_pk_fma_f32 v[166:167], v[166:167], v[26:27], v[28:29]
  v_pk_mul_f32 v[160:161], v[160:161], v[100:101]
  v_pk_mul_f32 v[162:163], v[162:163], v[102:103]
  v_pk_mul_f32 v[164:165], v[164:165], v[116:117]
  v_pk_mul_f32 v[166:167], v[166:167], v[118:119]
  v_exp_f32 v160, v160
  v_exp_f32 v161, v161
  v_exp_f32 v162, v162
  v_exp_f32 v163, v163
  v_exp_f32 v164, v164
  v_exp_f32 v165, v165
  v_exp_f32 v166, v166
  v_exp_f32 v167, v167
  v_pk_mul_f32 v[108:109], v[108:109], v[100:101]
  v_pk_mul_f32 v[110:111], v[110:111], v[102:103]
  v_pk_mul_f32 v[124:125], v[124:125], v[116:117]
  v_pk_mul_f32 v[126:127], v[126:127], v[118:119]
  v_pk_add_f32 v[160:161], v[160:161], v[30:31]
  v_pk_add_f32 v[162:163], v[162:163], v[30:31]
  v_pk_add_f32 v[164:165], v[164:165], v[30:31]
  v_pk_add_f32 v[166:167], v[166:167], v[30:31]
  v_rcp_f32 v160, v160
  v_rcp_f32 v161, v161
  v_rcp_f32 v162, v162
  v_rcp_f32 v163, v163
  v_rcp_f32 v164, v164
  v_rcp_f32 v165, v165
  v_rcp_f32 v166, v166
  v_rcp_f32 v167, v167
  s_nop 0
  v_pk_mul_f32 v[160:161], v[160:161], v[108:109]
  v_pk_mul_f32 v[162:163], v[162:163], v[110:111]
  v_pk_mul_f32 v[164:165], v[164:165], v[124:125]
  v_pk_mul_f32 v[166:167], v[166:167], v[126:127]
  v_cvt_pk_bf16_f32 v172, v160, v161
  v_cvt_pk_bf16_f32 v173, v162, v163
  v_cvt_pk_bf16_f32 v174, v164, v165
  v_cvt_pk_bf16_f32 v175, v166, v167
  buffer_store_dwordx4 v[172:175], v22, s[36:39], 0 offen offset:2048 sc1
  v_pk_mul_f32 v[160:161], v[128:129], v[128:129]
  v_pk_mul_f32 v[162:163], v[130:131], v[130:131]
  v_pk_mul_f32 v[164:165], v[144:145], v[144:145]
  v_pk_mul_f32 v[166:167], v[146:147], v[146:147]
  v_pk_fma_f32 v[160:161], v[160:161], v[26:27], v[28:29]
  v_pk_fma_f32 v[162:163], v[162:163], v[26:27], v[28:29]
  v_pk_fma_f32 v[164:165], v[164:165], v[26:27], v[28:29]
  v_pk_fma_f32 v[166:167], v[166:167], v[26:27], v[28:29]
  v_pk_mul_f32 v[160:161], v[160:161], v[128:129]
  v_pk_mul_f32 v[162:163], v[162:163], v[130:131]
  v_pk_mul_f32 v[164:165], v[164:165], v[144:145]
  v_pk_mul_f32 v[166:167], v[166:167], v[146:147]
  v_exp_f32 v160, v160
  v_exp_f32 v161, v161
  v_exp_f32 v162, v162
  v_exp_f32 v163, v163
  v_exp_f32 v164, v164
  v_exp_f32 v165, v165
  v_exp_f32 v166, v166
  v_exp_f32 v167, v167
  v_pk_mul_f32 v[136:137], v[136:137], v[128:129]
  v_pk_mul_f32 v[138:139], v[138:139], v[130:131]
  v_pk_mul_f32 v[152:153], v[152:153], v[144:145]
  v_pk_mul_f32 v[154:155], v[154:155], v[146:147]
  v_pk_add_f32 v[160:161], v[160:161], v[30:31]
  v_pk_add_f32 v[162:163], v[162:163], v[30:31]
  v_pk_add_f32 v[164:165], v[164:165], v[30:31]
  v_pk_add_f32 v[166:167], v[166:167], v[30:31]
  v_rcp_f32 v160, v160
  v_rcp_f32 v161, v161
  v_rcp_f32 v162, v162
  v_rcp_f32 v163, v163
  v_rcp_f32 v164, v164
  v_rcp_f32 v165, v165
  v_rcp_f32 v166, v166
  v_rcp_f32 v167, v167
  s_nop 0
  v_pk_mul_f32 v[160:161], v[160:161], v[136:137]
  v_pk_mul_f32 v[162:163], v[162:163], v[138:139]
  v_pk_mul_f32 v[164:165], v[164:165], v[152:153]
  v_pk_mul_f32 v[166:167], v[166:167], v[154:155]
  v_cvt_pk_bf16_f32 v168, v160, v161
  v_cvt_pk_bf16_f32 v169, v162, v163
  v_cvt_pk_bf16_f32 v170, v164, v165
  v_cvt_pk_bf16_f32 v171, v166, v167
  buffer_store_dwordx4 v[168:171], v21, s[36:39], 0 offen offset:3072 sc1
  v_pk_mul_f32 v[160:161], v[132:133], v[132:133]
  v_pk_mul_f32 v[162:163], v[134:135], v[134:135]
  v_pk_mul_f32 v[164:165], v[148:149], v[148:149]
  v_pk_mul_f32 v[166:167], v[150:151], v[150:151]
  v_pk_fma_f32 v[160:161], v[160:161], v[26:27], v[28:29]
  v_pk_fma_f32 v[162:163], v[162:163], v[26:27], v[28:29]
  v_pk_fma_f32 v[164:165], v[164:165], v[26:27], v[28:29]
  v_pk_fma_f32 v[166:167], v[166:167], v[26:27], v[28:29]
  v_pk_mul_f32 v[160:161], v[160:161], v[132:133]
  v_pk_mul_f32 v[162:163], v[162:163], v[134:135]
  v_pk_mul_f32 v[164:165], v[164:165], v[148:149]
  v_pk_mul_f32 v[166:167], v[166:167], v[150:151]
  v_exp_f32 v160, v160
  v_exp_f32 v161, v161
  v_exp_f32 v162, v162
  v_exp_f32 v163, v163
  v_exp_f32 v164, v164
  v_exp_f32 v165, v165
  v_exp_f32 v166, v166
  v_exp_f32 v167, v167
  v_pk_mul_f32 v[140:141], v[140:141], v[132:133]
  v_pk_mul_f32 v[142:143], v[142:143], v[134:135]
  v_pk_mul_f32 v[156:157], v[156:157], v[148:149]
  v_pk_mul_f32 v[158:159], v[158:159], v[150:151]
  v_pk_add_f32 v[160:161], v[160:161], v[30:31]
  v_pk_add_f32 v[162:163], v[162:163], v[30:31]
  v_pk_add_f32 v[164:165], v[164:165], v[30:31]
  v_pk_add_f32 v[166:167], v[166:167], v[30:31]
  v_rcp_f32 v160, v160
  v_rcp_f32 v161, v161
  v_rcp_f32 v162, v162
  v_rcp_f32 v163, v163
  v_rcp_f32 v164, v164
  v_rcp_f32 v165, v165
  v_rcp_f32 v166, v166
  v_rcp_f32 v167, v167
  s_nop 0
  v_pk_mul_f32 v[160:161], v[160:161], v[140:141]
  v_pk_mul_f32 v[162:163], v[162:163], v[142:143]
  v_pk_mul_f32 v[164:165], v[164:165], v[156:157]
  v_pk_mul_f32 v[166:167], v[166:167], v[158:159]
  v_cvt_pk_bf16_f32 v172, v160, v161
  v_cvt_pk_bf16_f32 v173, v162, v163
  v_cvt_pk_bf16_f32 v174, v164, v165
  v_cvt_pk_bf16_f32 v175, v166, v167
  buffer_store_dwordx4 v[172:175], v22, s[36:39], 0 offen offset:3072 sc1
  s_cmp_lt_u32 s30, 14
  s_cbranch_scc1 p4e_more
  s_waitcnt vmcnt(0)
  s_branch p4e_sig
p4e_more:
  s_add_u32 m0, s33, 16384
  s_mov_b32 s60, 114688
  buffer_load_dwordx4 v6, s[40:43], s60 offen offset:0 lds
  buffer_load_dwordx4 v7, s[40:43], s60 offen offset:1024 lds
  buffer_load_dwordx4 v8, s[40:43], s60 offen offset:2048 lds
  buffer_load_dwordx4 v9, s[40:43], s60 offen offset:3072 lds
  s_add_u32 m0, s33, 20480
  s_mov_b32 s60, 143360
  buffer_load_dwordx4 v6, s[40:43], s60 offen offset:0 lds
  buffer_load_dwordx4 v7, s[40:43], s60 offen offset:1024 lds
  buffer_load_dwordx4 v8, s[40:43], s60 offen offset:2048 lds
  buffer_load_dwordx4 v9, s[40:43], s60 offen offset:3072 lds
  s_add_u32 m0, s33, 24576
  s_mov_b32 s60, 172032
  buffer_load_dwordx4 v6, s[40:43], s60 offen offset:0 lds
  buffer_load_dwordx4 v7, s[40:43], s60 offen offset:1024 lds
  buffer_load_dwordx4 v8, s[40:43], s60 offen offset:2048 lds
  buffer_load_dwordx4 v9, s[40:43], s60 offen offset:3072 lds
  s_add_u32 m0, s33, 28672
  s_mov_b32 s60, 200704
  buffer_load_dwordx4 v6, s[40:43], s60 offen offset:0 lds
  buffer_load_dwordx4 v7, s[40:43], s60 offen offset:1024 lds
  buffer_load_dwordx4 v8, s[40:43], s60 offen offset:2048 lds
  buffer_load_dwordx4 v9, s[40:43], s60 offen offset:3072 lds
  s_add_u32 m0, s33, 32768
  s_mov_b32 s60, 229376
  buffer_load_dwordx4 v6, s[40:43], s60 offen offset:0 lds
  buffer_load_dwordx4 v7, s[40:43], s60 offen offset:1024 lds
  buffer_load_dwordx4 v8, s[40:43], s60 offen offset:2048 lds
  buffer_load_dwordx4 v9, s[40:43], s60 offen offset:3072 lds
  s_add_u32 m0, s33, 36864
  s_mov_b32 s60, 258048
  buffer_load_dwordx4 v6, s[40:43], s60 offen offset:0 lds
  buffer_load_dwordx4 v7, s[40:43], s60 offen offset:1024 lds
  buffer_load_dwordx4 v8, s[40:43], s60 offen offset:2048 lds
  buffer_load_dwordx4 v9, s[40:43], s60 offen offset:3072 lds
  s_waitcnt vmcnt(24)
p4e_sig:
  s_barrier
  s_lshl_b32 s61, s50, 7
  s_lshl_b32 s60, s49, 2
  s_add_u32 s61, s61, s60
  s_add_u32 s61, s61, 10240
  s_cmp_eq_u32 s28, 0
  s_cbranch_scc0 p4_flag
  s_mov_b64 exec, 1
  v_mov_b32 v24, 1
  v_mov_b32 v25, s61
  buffer_store_dword v24, v25, s[4:7], 0 offen sc1
  s_mov_b64 exec, -1
p4_flag:
  s_cmp_lt_u32 s30, 14
  s_cbranch_scc0 tail_end
tail_p5:
  s_lshl_b32 s64, s34, 2
  s_mul_i32 s64, s64, 56
  s_mul_i32 s65, s28, 14
  s_add_u32 s64, s64, s65
  s_lshl_b32 s64, s64, 10
  v_add_u32 v10, s64, v1
  v_add_u32 v11, 57344, v10
  v_add_u32 v12, 114688, v10
  v_add_u32 v13, 172032, v10
  v_and_b32 v24, 15, v0
  v_lshrrev_b32 v25, 4, v0
  v_lshlrev_b32 v26, 2, v25
  v_lshrrev_b32 v27, 2, v24
  v_add_u32 v26, v26, v27
  v_lshrrev_b32 v27, 1, v26
  v_and_b32 v27, 3, v27
  v_lshlrev_b32 v27, 5, v27
  v_lshlrev_b32 v26, 7, v26
  v_and_b32 v28, 3, v24
  v_lshl_add_u32 v26, v28, 3, v26
  v_add_u32 v26, s33, v26
  v_xor_b32 v28, 0, v27
  v_add_u32 v2, v26, v28
  v_xor_b32 v28, 32, v27
  v_add_u32 v3, v26, v28
  v_xor_b32 v28, 64, v27
  v_add_u32 v4, v26, v28
  v_xor_b32 v28, 96, v27
  v_add_u32 v5, v26, v28
  s_lshl_b32 s64, s34, 2
  s_add_u32 s64, s64, s28
  s_mul_i32 s64, s64, 14
  s_lshl_b32 s65, s35, 1
  s_add_u32 s64, s64, s65
  s_lshl_b32 s64, s64, 10
  v_add_u32 v29, s64, v1
  s_lshl_b32 s60, s29, 7
  s_add_u32 s60, s60, 10240
  v_and_b32 v24, 15, v0
  v_cmp_gt_u32 vcc, 14, v24
  s_nop 1
  v_cndmask_b32 v24, 0, v24, vcc
  v_lshl_add_u32 v24, v24, 2, s60
  s_mov_b32 s60, 0
p5_poll:
  buffer_load_dword v25, v24, s[4:7], 0 offen sc1
  s_waitcnt vmcnt(0)
  v_cmp_ne_u32 vcc, 1, v25
  s_add_u32 s60, s60, 1
  s_cbranch_vccz p5_poll_ok
  s_cmp_lt_u32 s60, 262144
  s_cbranch_scc0 p5_poll_ok
  s_sleep 1
  s_branch p5_poll
p5_poll_ok:
  s_mov_b32 s60, 0
  buffer_load_dwordx4 v[96:99], v10, s[36:39], s60 offen offset:0 sc1
  buffer_load_dwordx4 v[100:103], v11, s[36:39], s60 offen offset:0 sc1
  buffer_load_dwordx4 v[104:107], v12, s[36:39], s60 offen offset:0 sc1
  buffer_load_dwordx4 v[108:111], v13, s[36:39], s60 offen offset:0 sc1
  s_mov_b32 s60, 0
  buffer_load_dwordx4 v[112:115], v10, s[36:39], s60 offen offset:1024 sc1
  buffer_load_dwordx4 v[116:119], v11, s[36:39], s60 offen offset:1024 sc1
  buffer_load_dwordx4 v[120:123], v12, s[36:39], s60 offen offset:1024 sc1
  buffer_load_dwordx4 v[124:127], v13, s[36:39], s60 offen offset:1024 sc1
  s_mov_b32 s60, 0
  buffer_load_dwordx4 v[128:131], v10, s[36:39], s60 offen offset:2048 sc1
  buffer_load_dwordx4 v[132:135], v11, s[36:39], s60 offen offset:2048 sc1
  buffer_load_dwordx4 v[136:139], v12, s[36:39], s60 offen offset:2048 sc1
  buffer_load_dwordx4 v[140:143], v13, s[36:39], s60 offen offset:2048 sc1
  s_mov_b32 s60, 0
  buffer_load_dwordx4 v[144:147], v10, s[36:39], s60 offen offset:3072 sc1
  buffer_load_dwordx4 v[148:151], v11, s[36:39], s60 offen offset:3072 sc1
  buffer_load_dwordx4 v[152:155], v12, s[36:39], s60 offen offset:3072 sc1
  buffer_load_dwordx4 v[156:159], v13, s[36:39], s60 offen offset:3072 sc1
  s_mov_b32 s60, 4096
  buffer_load_dwordx4 v[160:163], v10, s[36:39], s60 offen offset:0 sc1
  buffer_load_dwordx4 v[164:167], v11, s[36:39], s60 offen offset:0 sc1
  buffer_load_dwordx4 v[168:171], v12, s[36:39], s60 offen offset:0 sc1
  buffer_load_dwordx4 v[172:175], v13, s[36:39], s60 offen offset:0 sc1
  s_mov_b32 s60, 4096
  buffer_load_dwordx4 v[176:179], v10, s[36:39], s60 offen offset:1024 sc1
  buffer_load_dwordx4 v[180:183], v11, s[36:39], s60 offen offset:1024 sc1
  buffer_load_dwordx4 v[184:187], v12, s[36:39], s60 offen offset:1024 sc1
  buffer_load_dwordx4 v[188:191], v13, s[36:39], s60 offen offset:1024 sc1
  s_mov_b32 s60, 4096
  buffer_load_dwordx4 v[192:195], v10, s[36:39], s60 offen offset:2048 sc1
  buffer_load_dwordx4 v[196:199], v11, s[36:39], s60 offen offset:2048 sc1
  buffer_load_dwordx4 v[200:203], v12, s[36:39], s60 offen offset:2048 sc1
  buffer_load_dwordx4 v[204:207], v13, s[36:39], s60 offen offset:2048 sc1
  s_mov_b32 s60, 4096
  buffer_load_dwordx4 v[208:211], v10, s[36:39], s60 offen offset:3072 sc1
  buffer_load_dwordx4 v[212:215], v11, s[36:39], s60 offen offset:3072 sc1
  buffer_load_dwordx4 v[216:219], v12, s[36:39], s60 offen offset:3072 sc1
  buffer_load_dwordx4 v[220:223], v13, s[36:39], s60 offen offset:3072 sc1
  s_mov_b32 s60, 8192
  buffer_load_dwordx4 v[224:227], v10, s[36:39], s60 offen offset:0 sc1
  buffer_load_dwordx4 v[228:231], v11, s[36:39], s60 offen offset:0 sc1
  buffer_load_dwordx4 v[232:235], v12, s[36:39], s60 offen offset:0 sc1
  buffer_load_dwordx4 v[236:239], v13, s[36:39], s60 offen offset:0 sc1
  s_mov_b32 s60, 8192
  buffer_load_dwordx4 v[240:243], v10, s[36:39], s60 offen offset:1024 sc1
  buffer_load_dwordx4 v[244:247], v11, s[36:39], s60 offen offset:1024 sc1
  buffer_load_dwordx4 v[248:251], v12, s[36:39], s60 offen offset:1024 sc1
  buffer_load_dwordx4 v[252:255], v13, s[36:39], s60 offen offset:1024 sc1
  s_mov_b32 s60, 8192
  buffer_load_dwordx4 a[0:3], v10, s[36:39], s60 offen offset:2048 sc1
  buffer_load_dwordx4 a[4:7], v11, s[36:39], s60 offen offset:2048 sc1
  buffer_load_dwordx4 a[8:11], v12, s[36:39], s60 offen offset:2048 sc1
  buffer_load_dwordx4 a[12:15], v13, s[36:39], s60 offen offset:2048 sc1
  s_mov_b32 s60, 8192
  buffer_load_dwordx4 a[16:19], v10, s[36:39], s60 offen offset:3072 sc1
  buffer_load_dwordx4 a[20:23], v11, s[36:39], s60 offen offset:3072 sc1
  buffer_load_dwordx4 a[24:27], v12, s[36:39], s60 offen offset:3072 sc1
  buffer_load_dwordx4 a[28:31], v13, s[36:39], s60 offen offset:3072 sc1
  s_mov_b32 s60, 12288
  buffer_load_dwordx4 a[32:35], v10, s[36:39], s60 offen offset:0 sc1
  buffer_load_dwordx4 a[36:39], v11, s[36:39], s60 offen offset:0 sc1
  buffer_load_dwordx4 a[40:43], v12, s[36:39], s60 offen offset:0 sc1
  buffer_load_dwordx4 a[44:47], v13, s[36:39], s60 offen offset:0 sc1
  s_mov_b32 s60, 12288
  buffer_load_dwordx4 a[48:51], v10, s[36:39], s60 offen offset:1024 sc1
  buffer_load_dwordx4 a[52:55], v11, s[36:39], s60 offen offset:1024 sc1
  buffer_load_dwordx4 a[56:59], v12, s[36:39], s60 offen offset:1024 sc1
  buffer_load_dwordx4 a[60:63], v13, s[36:39], s60 offen offset:1024 sc1
  s_waitcnt vmcnt(48)
  ds_read_b64_tr_b16 a[64:65], v2 offset:0
  ds_read_b64_tr_b16 a[66:67], v2 offset:2048
  ds_read_b64_tr_b16 a[68:69], v3 offset:0
  ds_read_b64_tr_b16 a[70:71], v3 offset:2048
  ds_read_b64_tr_b16 a[72:73], v4 offset:0
  ds_read_b64_tr_b16 a[74:75], v4 offset:2048
  ds_read_b64_tr_b16 a[76:77], v5 offset:0
  ds_read_b64_tr_b16 a[78:79], v5 offset:2048
  s_waitcnt lgkmcnt(6)
  v_mfma_f32_16x16x32_bf16 v[32:35], a[64:67], v[96:99], 0
  ds_read_b64_tr_b16 a[80:81], v2 offset:4096
  v_mfma_f32_16x16x32_bf16 v[36:39], a[64:67], v[100:103], 0
  ds_read_b64_tr_b16 a[82:83], v2 offset:6144
  v_mfma_f32_16x16x32_bf16 v[40:43], a[64:67], v[104:107], 0
  v_mfma_f32_16x16x32_bf16 v[44:47], a[64:67], v[108:111], 0
  s_waitcnt lgkmcnt(6)
  v_mfma_f32_16x16x32_bf16 v[48:51], a[68:71], v[96:99], 0
  ds_read_b64_tr_b16 a[84:85], v3 offset:4096
  v_mfma_f32_16x16x32_bf16 v[52:55], a[68:71], v[100:103], 0
  ds_read_b64_tr_b16 a[86:87], v3 offset:6144
  v_mfma_f32_16x16x32_bf16 v[56:59], a[68:71], v[104:107], 0
  v_mfma_f32_16x16x32_bf16 v[60:63], a[68:71], v[108:111], 0
  s_waitcnt lgkmcnt(6)
  v_mfma_f32_16x16x32_bf16 v[64:67], a[72:75], v[96:99], 0
  ds_read_b64_tr_b16 a[88:89], v4 offset:4096
  v_mfma_f32_16x16x32_bf16 v[68:71], a[72:75], v[100:103], 0
  ds_read_b64_tr_b16 a[90:91], v4 offset:6144
  v_mfma_f32_16x16x32_bf16 v[72:75], a[72:75], v[104:107], 0
  v_mfma_f32_16x16x32_bf16 v[76:79], a[72:75], v[108:111], 0
  s_waitcnt lgkmcnt(6)
  v_mfma_f32_16x16x32_bf16 v[80:83], a[76:79], v[96:99], 0
  ds_read_b64_tr_b16 a[92:93], v5 offset:4096
  v_mfma_f32_16x16x32_bf16 v[84:87], a[76:79], v[100:103], 0
  ds_read_b64_tr_b16 a[94:95], v5 offset:6144
  v_mfma_f32_16x16x32_bf16 v[88:91], a[76:79], v[104:107], 0
  v_mfma_f32_16x16x32_bf16 v[92:95], a[76:79], v[108:111], 0
  s_waitcnt lgkmcnt(6)
  v_mfma_f32_16x16x32_bf16 v[32:35], a[80:83], v[112:115], v[32:35]
  v_mfma_f32_16x16x32_bf16 v[36:39], a[80:83], v[116:119], v[36:39]
  v_mfma_f32_16x16x32_bf16 v[40:43], a[80:83], v[120:123], v[40:43]
  v_mfma_f32_16x16x32_bf16 v[44:47], a[80:83], v[124:127], v[44:47]
  s_waitcnt lgkmcnt(4)
  v_mfma_f32_16x16x32_bf16 v[48:51], a[84:87], v[112:115], v[48:51]
  v_mfma_f32_16x16x32_bf16 v[52:55], a[84:87], v[116:119], v[52:55]
  v_mfma_f32_16x16x32_bf16 v[56:59], a[84:87], v[120:123], v[56:59]
  v_mfma_f32_16x16x32_bf16 v[60:63], a[84:87], v[124:127], v[60:63]
  s_waitcnt lgkmcnt(2)
  v_mfma_f32_16x16x32_bf16 v[64:67], a[88:91], v[112:115], v[64:67]
  v_mfma_f32_16x16x32_bf16 v[68:71], a[88:91], v[116:119], v[68:71]
  v_mfma_f32_16x16x32_bf16 v[72:75], a[88:91], v[120:123], v[72:75]
  v_mfma_f32_16x16x32_bf16 v[76:79], a[88:91], v[124:127], v[76:79]
  s_waitcnt lgkmcnt(0)
  v_mfma_f32_16x16x32_bf16 v[80:83], a[92:95], v[112:115], v[80:83]
  v_mfma_f32_16x16x32_bf16 v[84:87], a[92:95], v[116:119], v[84:87]
  v_mfma_f32_16x16x32_bf16 v[88:91], a[92:95], v[120:123], v[88:91]
  v_mfma_f32_16x16x32_bf16 v[92:95], a[92:95], v[124:127], v[92:95]
  s_add_u32 m0, s33, 0
  s_mov_b32 s60, 286720
  buffer_load_dwordx4 v6, s[40:43], s60 offen offset:0 lds
  buffer_load_dwordx4 v7, s[40:43], s60 offen offset:1024 lds
  buffer_load_dwordx4 v8, s[40:43], s60 offen offset:2048 lds
  buffer_load_dwordx4 v9, s[40:43], s60 offen offset:3072 lds
  s_add_u32 m0, s33, 4096
  s_mov_b32 s60, 315392
  buffer_load_dwordx4 v6, s[40:43], s60 offen offset:0 lds
  buffer_load_dwordx4 v7, s[40:43], s60 offen offset:1024 lds
  buffer_load_dwordx4 v8, s[40:43], s60 offen offset:2048 lds
  buffer_load_dwordx4 v9, s[40:43], s60 offen offset:3072 lds
  s_waitcnt vmcnt(48)
  ds_read_b64_tr_b16 a[64:65], v2 offset:8192
  ds_read_b64_tr_b16 a[66:67], v2 offset:10240
  ds_read_b64_tr_b16 a[68:69], v3 offset:8192
  ds_read_b64_tr_b16 a[70:71], v3 offset:10240
  ds_read_b64_tr_b16 a[72:73], v4 offset:8192
  ds_read_b64_tr_b16 a[74:75], v4 offset:10240
  ds_read_b64_tr_b16 a[76:77], v5 offset:8192
  ds_read_b64_tr_b16 a[78:79], v5 offset:10240
  s_waitcnt lgkmcnt(6)
  v_mfma_f32_16x16x32_bf16 v[32:35], a[64:67], v[128:131], v[32:35]
  ds_read_b64_tr_b16 a[80:81], v2 offset:12288
  v_mfma_f32_16x16x32_bf16 v[36:39], a[64:67], v[132:135], v[36:39]
  ds_read_b64_tr_b16 a[82:83], v2 offset:14336
  v_mfma_f32_16x16x32_bf16 v[40:43], a[64:67], v[136:139], v[40:43]
  v_mfma_f32_16x16x32_bf16 v[44:47], a[64:67], v[140:143], v[44:47]
  s_waitcnt lgkmcnt(6)
  v_mfma_f32_16x16x32_bf16 v[48:51], a[68:71], v[128:131], v[48:51]
  ds_read_b64_tr_b16 a[84:85], v3 offset:12288
  v_mfma_f32_16x16x32_bf16 v[52:55], a[68:71], v[132:135], v[52:55]
  ds_read_b64_tr_b16 a[86:87], v3 offset:14336
  v_mfma_f32_16x16x32_bf16 v[56:59], a[68:71], v[136:139], v[56:59]
  v_mfma_f32_16x16x32_bf16 v[60:63], a[68:71], v[140:143], v[60:63]
  s_waitcnt lgkmcnt(6)
  v_mfma_f32_16x16x32_bf16 v[64:67], a[72:75], v[128:131], v[64:67]
  ds_read_b64_tr_b16 a[88:89], v4 offset:12288
  v_mfma_f32_16x16x32_bf16 v[68:71], a[72:75], v[132:135], v[68:71]
  ds_read_b64_tr_b16 a[90:91], v4 offset:14336
  v_mfma_f32_16x16x32_bf16 v[72:75], a[72:75], v[136:139], v[72:75]
  v_mfma_f32_16x16x32_bf16 v[76:79], a[72:75], v[140:143], v[76:79]
  s_waitcnt lgkmcnt(6)
  v_mfma_f32_16x16x32_bf16 v[80:83], a[76:79], v[128:131], v[80:83]
  ds_read_b64_tr_b16 a[92:93], v5 offset:12288
  v_mfma_f32_16x16x32_bf16 v[84:87], a[76:79], v[132:135], v[84:87]
  ds_read_b64_tr_b16 a[94:95], v5 offset:14336
  v_mfma_f32_16x16x32_bf16 v[88:91], a[76:79], v[136:139], v[88:91]
  v_mfma_f32_16x16x32_bf16 v[92:95], a[76:79], v[140:143], v[92:95]
  s_waitcnt lgkmcnt(6)
  v_mfma_f32_16x16x32_bf16 v[32:35], a[80:83], v[144:147], v[32:35]
  v_mfma_f32_16x16x32_bf16 v[36:39], a[80:83], v[148:151], v[36:39]
  v_mfma_f32_16x16x32_bf16 v[40:43], a[80:83], v[152:155], v[40:43]
  v_mfma_f32_16x16x32_bf16 v[44:47], a[80:83], v[156:159], v[44:47]
  s_waitcnt lgkmcnt(4)
  v_mfma_f32_16x16x32_bf16 v[48:51], a[84:87], v[144:147], v[48:51]
  v_mfma_f32_16x16x32_bf16 v[52:55], a[84:87], v[148:151], v[52:55]
  v_mfma_f32_16x16x32_bf16 v[56:59], a[84:87], v[152:155], v[56:59]
  v_mfma_f32_16x16x32_bf16 v[60:63], a[84:87], v[156:159], v[60:63]
  s_waitcnt lgkmcnt(2)
  v_mfma_f32_16x16x32_bf16 v[64:67], a[88:91], v[144:147], v[64:67]
  v_mfma_f32_16x16x32_bf16 v[68:71], a[88:91], v[148:151], v[68:71]
  v_mfma_f32_16x16x32_bf16 v[72:75], a[88:91], v[152:155], v[72:75]
  v_mfma_f32_16x16x32_bf16 v[76:79], a[88:91], v[156:159], v[76:79]
  s_waitcnt lgkmcnt(0)
  v_mfma_f32_16x16x32_bf16 v[80:83], a[92:95], v[144:147], v[80:83]
  v_mfma_f32_16x16x32_bf16 v[84:87], a[92:95], v[148:151], v[84:87]
  v_mfma_f32_16x16x32_bf16 v[88:91], a[92:95], v[152:155], v[88:91]
  v_mfma_f32_16x16x32_bf16 v[92:95], a[92:95], v[156:159], v[92:95]
  s_add_u32 m0, s33, 8192
  s_mov_b32 s60, 344064
  buffer_load_dwordx4 v6, s[40:43], s60 offen offset:0 lds
  buffer_load_dwordx4 v7, s[40:43], s60 offen offset:1024 lds
  buffer_load_dwordx4 v8, s[40:43], s60 offen offset:2048 lds
  buffer_load_dwordx4 v9, s[40:43], s60 offen offset:3072 lds
  s_add_u32 m0, s33, 12288
  s_mov_b32 s60, 372736
  buffer_load_dwordx4 v6, s[40:43], s60 offen offset:0 lds
  buffer_load_dwordx4 v7, s[40:43], s60 offen offset:1024 lds
  buffer_load_dwordx4 v8, s[40:43], s60 offen offset:2048 lds
  buffer_load_dwordx4 v9, s[40:43], s60 offen offset:3072 lds
  s_waitcnt vmcnt(48)
  ds_read_b64_tr_b16 a[64:65], v2 offset:16384
  ds_read_b64_tr_b16 a[66:67], v2 offset:18432
  ds_read_b64_tr_b16 a[68:69], v3 offset:16384
  ds_read_b64_tr_b16 a[70:71], v3 offset:18432
  ds_read_b64_tr_b16 a[72:73], v4 offset:16384
  ds_read_b64_tr_b16 a[74:75], v4 offset:18432
  ds_read_b64_tr_b16 a[76:77], v5 offset:16384
  ds_read_b64_tr_b16 a[78:79], v5 offset:18432
  s_waitcnt lgkmcnt(6)
  v_mfma_f32_16x16x32_bf16 v[32:35], a[64:67], v[160:163], v[32:35]
  ds_read_b64_tr_b16 a[80:81], v2 offset:20480
  v_mfma_f32_16x16x32_bf16 v[36:39], a[64:67], v[164:167], v[36:39]
  ds_read_b64_tr_b16 a[82:83], v2 offset:22528
  v_mfma_f32_16x16x32_bf16 v[40:43], a[64:67], v[168:171], v[40:43]
  v_mfma_f32_16x16x32_bf16 v[44:47], a[64:67], v[172:175], v[44:47]
  s_waitcnt lgkmcnt(6)
  v_mfma_f32_16x16x32_bf16 v[48:51], a[68:71], v[160:163], v[48:51]
  ds_read_b64_tr_b16 a[84:85], v3 offset:20480
  v_mfma_f32_16x16x32_bf16 v[52:55], a[68:71], v[164:167], v[52:55]
  ds_read_b64_tr_b16 a[86:87], v3 offset:22528
  v_mfma_f32_16x16x32_bf16 v[56:59], a[68:71], v[168:171], v[56:59]
  v_mfma_f32_16x16x32_bf16 v[60:63], a[68:71], v[172:175], v[60:63]
  s_waitcnt lgkmcnt(6)
  v_mfma_f32_16x16x32_bf16 v[64:67], a[72:75], v[160:163], v[64:67]
  ds_read_b64_tr_b16 a[88:89], v4 offset:20480
  v_mfma_f32_16x16x32_bf16 v[68:71], a[72:75], v[164:167], v[68:71]
  ds_read_b64_tr_b16 a[90:91], v4 offset:22528
  v_mfma_f32_16x16x32_bf16 v[72:75], a[72:75], v[168:171], v[72:75]
  v_mfma_f32_16x16x32_bf16 v[76:79], a[72:75], v[172:175], v[76:79]
  s_waitcnt lgkmcnt(6)
  v_mfma_f32_16x16x32_bf16 v[80:83], a[76:79], v[160:163], v[80:83]
  ds_read_b64_tr_b16 a[92:93], v5 offset:20480
  v_mfma_f32_16x16x32_bf16 v[84:87], a[76:79], v[164:167], v[84:87]
  ds_read_b64_tr_b16 a[94:95], v5 offset:22528
  v_mfma_f32_16x16x32_bf16 v[88:91], a[76:79], v[168:171], v[88:91]
  v_mfma_f32_16x16x32_bf16 v[92:95], a[76:79], v[172:175], v[92:95]
  s_waitcnt lgkmcnt(6)
  v_mfma_f32_16x16x32_bf16 v[32:35], a[80:83], v[176:179], v[32:35]
  v_mfma_f32_16x16x32_bf16 v[36:39], a[80:83], v[180:183], v[36:39]
  v_mfma_f32_16x16x32_bf16 v[40:43], a[80:83], v[184:187], v[40:43]
  v_mfma_f32_16x16x32_bf16 v[44:47], a[80:83], v[188:191], v[44:47]
  s_waitcnt lgkmcnt(4)
  v_mfma_f32_16x16x32_bf16 v[48:51], a[84:87], v[176:179], v[48:51]
  v_mfma_f32_16x16x32_bf16 v[52:55], a[84:87], v[180:183], v[52:55]
  v_mfma_f32_16x16x32_bf16 v[56:59], a[84:87], v[184:187], v[56:59]
  v_mfma_f32_16x16x32_bf16 v[60:63], a[84:87], v[188:191], v[60:63]
  s_waitcnt lgkmcnt(2)
  v_mfma_f32_16x16x32_bf16 v[64:67], a[88:91], v[176:179], v[64:67]
  v_mfma_f32_16x16x32_bf16 v[68:71], a[88:91], v[180:183], v[68:71]
  v_mfma_f32_16x16x32_bf16 v[72:75], a[88:91], v[184:187], v[72:75]
  v_mfma_f32_16x16x32_bf16 v[76:79], a[88:91], v[188:191], v[76:79]
  s_waitcnt lgkmcnt(0)
  v_mfma_f32_16x16x32_bf16 v[80:83], a[92:95], v[176:179], v[80:83]
  v_mfma_f32_16x16x32_bf16 v[84:87], a[92:95], v[180:183], v[84:87]
  v_mfma_f32_16x16x32_bf16 v[88:91], a[92:95], v[184:187], v[88:91]
  v_mfma_f32_16x16x32_bf16 v[92:95], a[92:95], v[188:191], v[92:95]
  s_waitcnt vmcnt(40)
  ds_read_b64_tr_b16 a[64:65], v2 offset:24576
  ds_read_b64_tr_b16 a[66:67], v2 offset:26624
  ds_read_b64_tr_b16 a[68:69], v3 offset:24576
  ds_read_b64_tr_b16 a[70:71], v3 offset:26624
  ds_read_b64_tr_b16 a[72:73], v4 offset:24576
  ds_read_b64_tr_b16 a[74:75], v4 offset:26624
  ds_read_b64_tr_b16 a[76:77], v5 offset:24576
  ds_read_b64_tr_b16 a[78:79], v5 offset:26624
  s_waitcnt lgkmcnt(6)
  v_mfma_f32_16x16x32_bf16 v[32:35], a[64:67], v[192:195], v[32:35]
  ds_read_b64_tr_b16 a[80:81], v2 offset:28672
  v_mfma_f32_16x16x32_bf16 v[36:39], a[64:67], v[196:199], v[36:39]
  ds_read_b64_tr_b16 a[82:83], v2 offset:30720
  v_mfma_f32_16x16x32_bf16 v[40:43], a[64:67], v[200:203], v[40:43]
  v_mfma_f32_16x16x32_bf16 v[44:47], a[64:67], v[204:207], v[44:47]
  s_waitcnt lgkmcnt(6)
  v_mfma_f32_16x16x32_bf16 v[48:51], a[68:71], v[192:195], v[48:51]
  ds_read_b64_tr_b16 a[84:85], v3 offset:28672
  v_mfma_f32_16x16x32_bf16 v[52:55], a[68:71], v[196:199], v[52:55]
  ds_read_b64_tr_b16 a[86:87], v3 offset:30720
  v_mfma_f32_16x16x32_bf16 v[56:59], a[68:71], v[200:203], v[56:59]
  v_mfma_f32_16x16x32_bf16 v[60:63], a[68:71], v[204:207], v[60:63]
  s_waitcnt lgkmcnt(6)
  v_mfma_f32_16x16x32_bf16 v[64:67], a[72:75], v[192:195], v[64:67]
  ds_read_b64_tr_b16 a[88:89], v4 offset:28672
  v_mfma_f32_16x16x32_bf16 v[68:71], a[72:75], v[196:199], v[68:71]
  ds_read_b64_tr_b16 a[90:91], v4 offset:30720
  v_mfma_f32_16x16x32_bf16 v[72:75], a[72:75], v[200:203], v[72:75]
  v_mfma_f32_16x16x32_bf16 v[76:79], a[72:75], v[204:207], v[76:79]
  s_waitcnt lgkmcnt(6)
  v_mfma_f32_16x16x32_bf16 v[80:83], a[76:79], v[192:195], v[80:83]
  ds_read_b64_tr_b16 a[92:93], v5 offset:28672
  v_mfma_f32_16x16x32_bf16 v[84:87], a[76:79], v[196:199], v[84:87]
  ds_read_b64_tr_b16 a[94:95], v5 offset:30720
  v_mfma_f32_16x16x32_bf16 v[88:91], a[76:79], v[200:203], v[88:91]
  v_mfma_f32_16x16x32_bf16 v[92:95], a[76:79], v[204:207], v[92:95]
  s_waitcnt lgkmcnt(6)
  v_mfma_f32_16x16x32_bf16 v[32:35], a[80:83], v[208:211], v[32:35]
  v_mfma_f32_16x16x32_bf16 v[36:39], a[80:83], v[212:215], v[36:39]
  v_mfma_f32_16x16x32_bf16 v[40:43], a[80:83], v[216:219], v[40:43]
  v_mfma_f32_16x16x32_bf16 v[44:47], a[80:83], v[220:223], v[44:47]
  s_waitcnt lgkmcnt(4)
  v_mfma_f32_16x16x32_bf16 v[48:51], a[84:87], v[208:211], v[48:51]
  v_mfma_f32_16x16x32_bf16 v[52:55], a[84:87], v[212:215], v[52:55]
  v_mfma_f32_16x16x32_bf16 v[56:59], a[84:87], v[216:219], v[56:59]
  v_mfma_f32_16x16x32_bf16 v[60:63], a[84:87], v[220:223], v[60:63]
  s_waitcnt lgkmcnt(2)
  v_mfma_f32_16x16x32_bf16 v[64:67], a[88:91], v[208:211], v[64:67]
  v_mfma_f32_16x16x32_bf16 v[68:71], a[88:91], v[212:215], v[68:71]
  v_mfma_f32_16x16x32_bf16 v[72:75], a[88:91], v[216:219], v[72:75]
  v_mfma_f32_16x16x32_bf16 v[76:79], a[88:91], v[220:223], v[76:79]
  s_waitcnt lgkmcnt(0)
  v_mfma_f32_16x16x32_bf16 v[80:83], a[92:95], v[208:211], v[80:83]
  v_mfma_f32_16x16x32_bf16 v[84:87], a[92:95], v[212:215], v[84:87]
  v_mfma_f32_16x16x32_bf16 v[88:91], a[92:95], v[216:219], v[88:91]
  v_mfma_f32_16x16x32_bf16 v[92:95], a[92:95], v[220:223], v[92:95]
  s_waitcnt vmcnt(32)
  ds_read_b64_tr_b16 a[64:65], v2 offset:32768
  ds_read_b64_tr_b16 a[66:67], v2 offset:34816
  ds_read_b64_tr_b16 a[68:69], v3 offset:32768
  ds_read_b64_tr_b16 a[70:71], v3 offset:34816
  ds_read_b64_tr_b16 a[72:73], v4 offset:32768
  ds_read_b64_tr_b16 a[74:75], v4 offset:34816
  ds_read_b64_tr_b16 a[76:77], v5 offset:32768
  ds_read_b64_tr_b16 a[78:79], v5 offset:34816
  s_waitcnt lgkmcnt(6)
  v_mfma_f32_16x16x32_bf16 v[32:35], a[64:67], v[224:227], v[32:35]
  ds_read_b64_tr_b16 a[80:81], v2 offset:36864
  v_mfma_f32_16x16x32_bf16 v[36:39], a[64:67], v[228:231], v[36:39]
  ds_read_b64_tr_b16 a[82:83], v2 offset:38912
  v_mfma_f32_16x16x32_bf16 v[40:43], a[64:67], v[232:235], v[40:43]
  v_mfma_f32_16x16x32_bf16 v[44:47], a[64:67], v[236:239], v[44:47]
  s_waitcnt lgkmcnt(6)
  v_mfma_f32_16x16x32_bf16 v[48:51], a[68:71], v[224:227], v[48:51]
  ds_read_b64_tr_b16 a[84:85], v3 offset:36864
  v_mfma_f32_16x16x32_bf16 v[52:55], a[68:71], v[228:231], v[52:55]
  ds_read_b64_tr_b16 a[86:87], v3 offset:38912
  v_mfma_f32_16x16x32_bf16 v[56:59], a[68:71], v[232:235], v[56:59]
  v_mfma_f32_16x16x32_bf16 v[60:63], a[68:71], v[236:239], v[60:63]
  s_waitcnt lgkmcnt(6)
  v_mfma_f32_16x16x32_bf16 v[64:67], a[72:75], v[224:227], v[64:67]
  ds_read_b64_tr_b16 a[88:89], v4 offset:36864
  v_mfma_f32_16x16x32_bf16 v[68:71], a[72:75], v[228:231], v[68:71]
  ds_read_b64_tr_b16 a[90:91], v4 offset:38912
  v_mfma_f32_16x16x32_bf16 v[72:75], a[72:75], v[232:235], v[72:75]
  v_mfma_f32_16x16x32_bf16 v[76:79], a[72:75], v[236:239], v[76:79]
  s_waitcnt lgkmcnt(6)
  v_mfma_f32_16x16x32_bf16 v[80:83], a[76:79], v[224:227], v[80:83]
  ds_read_b64_tr_b16 a[92:93], v5 offset:36864
  v_mfma_f32_16x16x32_bf16 v[84:87], a[76:79], v[228:231], v[84:87]
  ds_read_b64_tr_b16 a[94:95], v5 offset:38912
  v_mfma_f32_16x16x32_bf16 v[88:91], a[76:79], v[232:235], v[88:91]
  v_mfma_f32_16x16x32_bf16 v[92:95], a[76:79], v[236:239], v[92:95]
  s_waitcnt lgkmcnt(6)
  v_mfma_f32_16x16x32_bf16 v[32:35], a[80:83], v[240:243], v[32:35]
  v_mfma_f32_16x16x32_bf16 v[36:39], a[80:83], v[244:247], v[36:39]
  v_mfma_f32_16x16x32_bf16 v[40:43], a[80:83], v[248:251], v[40:43]
  v_mfma_f32_16x16x32_bf16 v[44:47], a[80:83], v[252:255], v[44:47]
  s_waitcnt lgkmcnt(4)
  v_mfma_f32_16x16x32_bf16 v[48:51], a[84:87], v[240:243], v[48:51]
  v_mfma_f32_16x16x32_bf16 v[52:55], a[84:87], v[244:247], v[52:55]
  v_mfma_f32_16x16x32_bf16 v[56:59], a[84:87], v[248:251], v[56:59]
  v_mfma_f32_16x16x32_bf16 v[60:63], a[84:87], v[252:255], v[60:63]
  s_waitcnt lgkmcnt(2)
  v_mfma_f32_16x16x32_bf16 v[64:67], a[88:91], v[240:243], v[64:67]
  v_mfma_f32_16x16x32_bf16 v[68:71], a[88:91], v[244:247], v[68:71]
  v_mfma_f32_16x16x32_bf16 v[72:75], a[88:91], v[248:251], v[72:75]
  v_mfma_f32_16x16x32_bf16 v[76:79], a[88:91], v[252:255], v[76:79]
  s_waitcnt lgkmcnt(0)
  v_mfma_f32_16x16x32_bf16 v[80:83], a[92:95], v[240:243], v[80:83]
  v_mfma_f32_16x16x32_bf16 v[84:87], a[92:95], v[244:247], v[84:87]
  v_mfma_f32_16x16x32_bf16 v[88:91], a[92:95], v[248:251], v[88:91]
  v_mfma_f32_16x16x32_bf16 v[92:95], a[92:95], v[252:255], v[92:95]
  buffer_load_dwordx4 v[16:19], v29, s[16:19], 0 offen offset:0 sc1
  buffer_load_dwordx4 v[20:23], v29, s[16:19], 0 offen offset:1024 sc1
  s_waitcnt vmcnt(10)
  ds_read_b64_tr_b16 a[64:65], v2 offset:0
  ds_read_b64_tr_b16 a[66:67], v2 offset:2048
  ds_read_b64_tr_b16 a[68:69], v3 offset:0
  ds_read_b64_tr_b16 a[70:71], v3 offset:2048
  ds_read_b64_tr_b16 a[72:73], v4 offset:0
  ds_read_b64_tr_b16 a[74:75], v4 offset:2048
  ds_read_b64_tr_b16 a[76:77], v5 offset:0
  ds_read_b64_tr_b16 a[78:79], v5 offset:2048
  s_waitcnt lgkmcnt(6)
  v_mfma_f32_16x16x32_bf16 v[32:35], a[64:67], a[0:3], v[32:35]
  ds_read_b64_tr_b16 a[80:81], v2 offset:4096
  v_mfma_f32_16x16x32_bf16 v[36:39], a[64:67], a[4:7], v[36:39]
  ds_read_b64_tr_b16 a[82:83], v2 offset:6144
  v_mfma_f32_16x16x32_bf16 v[40:43], a[64:67], a[8:11], v[40:43]
  v_mfma_f32_16x16x32_bf16 v[44:47], a[64:67], a[12:15], v[44:47]
  s_waitcnt lgkmcnt(6)
  v_mfma_f32_16x16x32_bf16 v[48:51], a[68:71], a[0:3], v[48:51]
  ds_read_b64_tr_b16 a[84:85], v3 offset:4096
  v_mfma_f32_16x16x32_bf16 v[52:55], a[68:71], a[4:7], v[52:55]
  ds_read_b64_tr_b16 a[86:87], v3 offset:6144
  v_mfma_f32_16x16x32_bf16 v[56:59], a[68:71], a[8:11], v[56:59]
  v_mfma_f32_16x16x32_bf16 v[60:63], a[68:71], a[12:15], v[60:63]
  s_waitcnt lgkmcnt(6)
  v_mfma_f32_16x16x32_bf16 v[64:67], a[72:75], a[0:3], v[64:67]
  ds_read_b64_tr_b16 a[88:89], v4 offset:4096
  v_mfma_f32_16x16x32_bf16 v[68:71], a[72:75], a[4:7], v[68:71]
  ds_read_b64_tr_b16 a[90:91], v4 offset:6144
  v_mfma_f32_16x16x32_bf16 v[72:75], a[72:75], a[8:11], v[72:75]
  v_mfma_f32_16x16x32_bf16 v[76:79], a[72:75], a[12:15], v[76:79]
  s_waitcnt lgkmcnt(6)
  v_mfma_f32_16x16x32_bf16 v[80:83], a[76:79], a[0:3], v[80:83]
  ds_read_b64_tr_b16 a[92:93], v5 offset:4096
  v_mfma_f32_16x16x32_bf16 v[84:87], a[76:79], a[4:7], v[84:87]
  ds_read_b64_tr_b16 a[94:95], v5 offset:6144
  v_mfma_f32_16x16x32_bf16 v[88:91], a[76:79], a[8:11], v[88:91]
  v_mfma_f32_16x16x32_bf16 v[92:95], a[76:79], a[12:15], v[92:95]
  s_waitcnt lgkmcnt(6)
  v_mfma_f32_16x16x32_bf16 v[32:35], a[80:83], a[16:19], v[32:35]
  v_mfma_f32_16x16x32_bf16 v[36:39], a[80:83], a[20:23], v[36:39]
  v_mfma_f32_16x16x32_bf16 v[40:43], a[80:83], a[24:27], v[40:43]
  v_mfma_f32_16x16x32_bf16 v[44:47], a[80:83], a[28:31], v[44:47]
  s_waitcnt lgkmcnt(4)
  v_mfma_f32_16x16x32_bf16 v[48:51], a[84:87], a[16:19], v[48:51]
  v_mfma_f32_16x16x32_bf16 v[52:55], a[84:87], a[20:23], v[52:55]
  v_mfma_f32_16x16x32_bf16 v[56:59], a[84:87], a[24:27], v[56:59]
  v_mfma_f32_16x16x32_bf16 v[60:63], a[84:87], a[28:31], v[60:63]
  s_waitcnt lgkmcnt(2)
  v_mfma_f32_16x16x32_bf16 v[64:67], a[88:91], a[16:19], v[64:67]
  v_mfma_f32_16x16x32_bf16 v[68:71], a[88:91], a[20:23], v[68:71]
  v_mfma_f32_16x16x32_bf16 v[72:75], a[88:91], a[24:27], v[72:75]
  v_mfma_f32_16x16x32_bf16 v[76:79], a[88:91], a[28:31], v[76:79]
  s_waitcnt lgkmcnt(0)
  v_mfma_f32_16x16x32_bf16 v[80:83], a[92:95], a[16:19], v[80:83]
  v_mfma_f32_16x16x32_bf16 v[84:87], a[92:95], a[20:23], v[84:87]
  v_mfma_f32_16x16x32_bf16 v[88:91], a[92:95], a[24:27], v[88:91]
  v_mfma_f32_16x16x32_bf16 v[92:95], a[92:95], a[28:31], v[92:95]
  s_waitcnt vmcnt(2)
  ds_read_b64_tr_b16 a[64:65], v2 offset:8192
  ds_read_b64_tr_b16 a[66:67], v2 offset:10240
  ds_read_b64_tr_b16 a[68:69], v3 offset:8192
  ds_read_b64_tr_b16 a[70:71], v3 offset:10240
  ds_read_b64_tr_b16 a[72:73], v4 offset:8192
  ds_read_b64_tr_b16 a[74:75], v4 offset:10240
  ds_read_b64_tr_b16 a[76:77], v5 offset:8192
  ds_read_b64_tr_b16 a[78:79], v5 offset:10240
  s_waitcnt lgkmcnt(6)
  v_mfma_f32_16x16x32_bf16 v[32:35], a[64:67], a[32:35], v[32:35]
  ds_read_b64_tr_b16 a[80:81], v2 offset:12288
  v_mfma_f32_16x16x32_bf16 v[36:39], a[64:67], a[36:39], v[36:39]
  ds_read_b64_tr_b16 a[82:83], v2 offset:14336
  v_mfma_f32_16x16x32_bf16 v[40:43], a[64:67], a[40:43], v[40:43]
  v_mfma_f32_16x16x32_bf16 v[44:47], a[64:67], a[44:47], v[44:47]
  s_waitcnt lgkmcnt(6)
  v_mfma_f32_16x16x32_bf16 v[48:51], a[68:71], a[32:35], v[48:51]
  ds_read_b64_tr_b16 a[84:85], v3 offset:12288
  v_mfma_f32_16x16x32_bf16 v[52:55], a[68:71], a[36:39], v[52:55]
  ds_read_b64_tr_b16 a[86:87], v3 offset:14336
  v_mfma_f32_16x16x32_bf16 v[56:59], a[68:71], a[40:43], v[56:59]
  v_mfma_f32_16x16x32_bf16 v[60:63], a[68:71], a[44:47], v[60:63]
  s_waitcnt lgkmcnt(6)
  v_mfma_f32_16x16x32_bf16 v[64:67], a[72:75], a[32:35], v[64:67]
  ds_read_b64_tr_b16 a[88:89], v4 offset:12288
  v_mfma_f32_16x16x32_bf16 v[68:71], a[72:75], a[36:39], v[68:71]
  ds_read_b64_tr_b16 a[90:91], v4 offset:14336
  v_mfma_f32_16x16x32_bf16 v[72:75], a[72:75], a[40:43], v[72:75]
  v_mfma_f32_16x16x32_bf16 v[76:79], a[72:75], a[44:47], v[76:79]
  s_waitcnt lgkmcnt(6)
  v_mfma_f32_16x16x32_bf16 v[80:83], a[76:79], a[32:35], v[80:83]
  ds_read_b64_tr_b16 a[92:93], v5 offset:12288
  v_mfma_f32_16x16x32_bf16 v[84:87], a[76:79], a[36:39], v[84:87]
  ds_read_b64_tr_b16 a[94:95], v5 offset:14336
  v_mfma_f32_16x16x32_bf16 v[88:91], a[76:79], a[40:43], v[88:91]
  v_mfma_f32_16x16x32_bf16 v[92:95], a[76:79], a[44:47], v[92:95]
  s_waitcnt lgkmcnt(6)
  v_mfma_f32_16x16x32_bf16 v[32:35], a[80:83], a[48:51], v[32:35]
  v_mfma_f32_16x16x32_bf16 v[36:39], a[80:83], a[52:55], v[36:39]
  v_mfma_f32_16x16x32_bf16 v[40:43], a[80:83], a[56:59], v[40:43]
  v_mfma_f32_16x16x32_bf16 v[44:47], a[80:83], a[60:63], v[44:47]
  s_waitcnt lgkmcnt(4)
  v_mfma_f32_16x16x32_bf16 v[48:51], a[84:87], a[48:51], v[48:51]
  v_mfma_f32_16x16x32_bf16 v[52:55], a[84:87], a[52:55], v[52:55]
  v_mfma_f32_16x16x32_bf16 v[56:59], a[84:87], a[56:59], v[56:59]
  v_mfma_f32_16x16x32_bf16 v[60:63], a[84:87], a[60:63], v[60:63]
  s_waitcnt lgkmcnt(2)
  v_mfma_f32_16x16x32_bf16 v[64:67], a[88:91], a[48:51], v[64:67]
  v_mfma_f32_16x16x32_bf16 v[68:71], a[88:91], a[52:55], v[68:71]
  v_mfma_f32_16x16x32_bf16 v[72:75], a[88:91], a[56:59], v[72:75]
  v_mfma_f32_16x16x32_bf16 v[76:79], a[88:91], a[60:63], v[76:79]
  s_waitcnt lgkmcnt(0)
  v_mfma_f32_16x16x32_bf16 v[80:83], a[92:95], a[48:51], v[80:83]
  v_mfma_f32_16x16x32_bf16 v[84:87], a[92:95], a[52:55], v[84:87]
  v_mfma_f32_16x16x32_bf16 v[88:91], a[92:95], a[56:59], v[88:91]
  v_mfma_f32_16x16x32_bf16 v[92:95], a[92:95], a[60:63], v[92:95]
  v_add_u32 v25, s33, v1
  s_nop 6
  ds_write_b128 v25, v[32:35] offset:0
  ds_write_b128 v25, v[36:39] offset:4096
  ds_write_b128 v25, v[40:43] offset:8192
  ds_write_b128 v25, v[44:47] offset:12288
  ds_write_b128 v25, v[48:51] offset:1024
  ds_write_b128 v25, v[52:55] offset:5120
  ds_write_b128 v25, v[56:59] offset:9216
  ds_write_b128 v25, v[60:63] offset:13312
  ds_write_b128 v25, v[64:67] offset:2048
  ds_write_b128 v25, v[68:71] offset:6144
  ds_write_b128 v25, v[72:75] offset:10240
  ds_write_b128 v25, v[76:79] offset:14336
  ds_write_b128 v25, v[80:83] offset:3072
  ds_write_b128 v25, v[84:87] offset:7168
  ds_write_b128 v25, v[88:91] offset:11264
  ds_write_b128 v25, v[92:95] offset:15360
  s_lshl_b32 s64, s28, 12
  v_add_u32 v25, s64, v1
  v_add_u32 v26, 81920, v25
  s_waitcnt lgkmcnt(0)
  s_barrier
  ds_read_b128 v[112:115], v25 offset:0
  ds_read_b128 v[116:119], v25 offset:1024
  ds_read_b128 v[120:123], v25 offset:2048
  ds_read_b128 v[124:127], v25 offset:3072
  ds_read_b128 v[128:131], v25 offset:40960
  ds_read_b128 v[132:135], v25 offset:41984
  ds_read_b128 v[136:139], v25 offset:43008
  ds_read_b128 v[140:143], v25 offset:44032
  ds_read_b128 v[144:147], v26 offset:0
  ds_read_b128 v[148:151], v26 offset:1024
  ds_read_b128 v[152:155], v26 offset:2048
  ds_read_b128 v[156:159], v26 offset:3072
  ds_read_b128 v[160:163], v26 offset:40960
  ds_read_b128 v[164:167], v26 offset:41984
  ds_read_b128 v[168:171], v26 offset:43008
  ds_read_b128 v[172:175], v26 offset:44032
  s_waitcnt vmcnt(0) lgkmcnt(0)
  s_mov_b32 s64, 0xffff0000
  v_lshlrev_b32 v96, 16, v16
  v_and_b32 v97, s64, v16
  v_lshlrev_b32 v98, 16, v17
  v_and_b32 v99, s64, v17
  v_lshlrev_b32 v100, 16, v18
  v_and_b32 v101, s64, v18
  v_lshlrev_b32 v102, 16, v19
  v_and_b32 v103, s64, v19
  v_lshlrev_b32 v104, 16, v20
  v_and_b32 v105, s64, v20
  v_lshlrev_b32 v106, 16, v21
  v_and_b32 v107, s64, v21
  v_lshlrev_b32 v108, 16, v22
  v_and_b32 v109, s64, v22
  v_lshlrev_b32 v110, 16, v23
  v_and_b32 v111, s64, v23
  v_add_f32 v96, v96, v112
  v_add_f32 v96, v96, v128
  v_add_f32 v96, v96, v144
  v_add_f32 v96, v96, v160
  v_add_f32 v97, v97, v113
  v_add_f32 v97, v97, v129
  v_add_f32 v97, v97, v145
  v_add_f32 v97, v97, v161
  v_add_f32 v98, v98, v114
  v_add_f32 v98, v98, v130
  v_add_f32 v98, v98, v146
  v_add_f32 v98, v98, v162
  v_add_f32 v99, v99, v115
  v_add_f32 v99, v99, v131
  v_add_f32 v99, v99, v147
  v_add_f32 v99, v99, v163
  v_add_f32 v100, v100, v116
  v_add_f32 v100, v100, v132
  v_add_f32 v100, v100, v148
  v_add_f32 v100, v100, v164
  v_add_f32 v101, v101, v117
  v_add_f32 v101, v101, v133
  v_add_f32 v101, v101, v149
  v_add_f32 v101, v101, v165
  v_add_f32 v102, v102, v118
  v_add_f32 v102, v102, v134
  v_add_f32 v102, v102, v150
  v_add_f32 v102, v102, v166
  v_add_f32 v103, v103, v119
  v_add_f32 v103, v103, v135
  v_add_f32 v103, v103, v151
  v_add_f32 v103, v103, v167
  v_add_f32 v104, v104, v120
  v_add_f32 v104, v104, v136
  v_add_f32 v104, v104, v152
  v_add_f32 v104, v104, v168
  v_add_f32 v105, v105, v121
  v_add_f32 v105, v105, v137
  v_add_f32 v105, v105, v153
  v_add_f32 v105, v105, v169
  v_add_f32 v106, v106, v122
  v_add_f32 v106, v106, v138
  v_add_f32 v106, v106, v154
  v_add_f32 v106, v106, v170
  v_add_f32 v107, v107, v123
  v_add_f32 v107, v107, v139
  v_add_f32 v107, v107, v155
  v_add_f32 v107, v107, v171
  v_add_f32 v108, v108, v124
  v_add_f32 v108, v108, v140
  v_add_f32 v108, v108, v156
  v_add_f32 v108, v108, v172
  v_add_f32 v109, v109, v125
  v_add_f32 v109, v109, v141
  v_add_f32 v109, v109, v157
  v_add_f32 v109, v109, v173
  v_add_f32 v110, v110, v126
  v_add_f32 v110, v110, v142
  v_add_f32 v110, v110, v158
  v_add_f32 v110, v110, v174
  v_add_f32 v111, v111, v127
  v_add_f32 v111, v111, v143
  v_add_f32 v111, v111, v159
  v_add_f32 v111, v111, v175
  v_and_b32 v24, 15, v0
  v_lshrrev_b32 v25, 4, v0
  s_lshl_b32 s64, s34, 6
  s_lshl_b32 s65, s28, 4
  s_add_u32 s64, s64, s65
  v_add_u32 v24, s64, v24
  s_movk_i32 s64, 896
  v_mul_lo_u32 v24, v24, s64
  v_lshl_add_u32 v24, v25, 3, v24
  s_lshl_b32 s64, s35, 7
  v_add_u32 v24, s64, v24
  v_cvt_pk_bf16_f32 v32, v96, v97
  v_cvt_pk_bf16_f32 v33, v98, v99
  v_cvt_pk_bf16_f32 v34, v100, v101
  v_cvt_pk_bf16_f32 v35, v102, v103
  v_cvt_pk_bf16_f32 v36, v104, v105
  v_cvt_pk_bf16_f32 v37, v106, v107
  v_cvt_pk_bf16_f32 v38, v108, v109
  v_cvt_pk_bf16_f32 v39, v110, v111
  buffer_store_dwordx2 v[32:33], v24, s[44:47], 0 offen offset:0
  buffer_store_dwordx2 v[34:35], v24, s[44:47], 0 offen offset:32
  buffer_store_dwordx2 v[36:37], v24, s[44:47], 0 offen offset:64
  buffer_store_dwordx2 v[38:39], v24, s[44:47], 0 offen offset:96
tail_end:
mega_end:
  s_endpgm
.section .rodata,"a"
.p2align 6
.amdhsa_kernel sequential_preLN__compressed_kv_cla__geglu_ffn__prompt_kernel
.amdhsa_next_free_vgpr 512
.amdhsa_next_free_sgpr 102
.amdhsa_accum_offset 256
.amdhsa_group_segment_fixed_size 0
.amdhsa_kernarg_size 104
.amdhsa_user_sgpr_count 2
.amdhsa_user_sgpr_kernarg_segment_ptr 1
.amdhsa_system_sgpr_workgroup_id_x 1
.end_amdhsa_kernel
```
